```python
import torch

def _softmax(x, axis=-1):
    return torch.softmax(x, dim=axis)
def _gelu(x):
    return torch.nn.functional.gelu(x, approximate="tanh")
def _silu(x):
    return torch.nn.functional.silu(x)
def _sigmoid(x):
    return torch.sigmoid(x)
def _layernorm(x, axis=-1, eps=1e-5):
    m = x.mean(dim=axis, keepdim=True)
    v = x.var(dim=axis, keepdim=True, unbiased=False)
    return (x - m) / torch.sqrt(v + eps)
def _scatter_add(tgt, idx, src, axis=0):
    return tgt.clone().index_add_(axis, idx, src)
def _segment_sum(src, seg, n):
    out = torch.zeros((n,) + src.shape[1:], dtype=src.dtype)
    return out.index_add_(0, seg, src)
def _pad(x, pw):
    flat = tuple(v for pair in reversed(pw) for v in pair)
    return torch.nn.functional.pad(x, flat)

kernel_name = 'concat_heads__mha_block_cached__mha_block_cached__near_ridge'

def setup_inputs():

    _w = (lambda a: (lambda t: t.to(torch.bfloat16) if t.is_floating_point() else t)(torch.as_tensor(a)))
    def _A_setup():
        B, Sq, D = 16, 240, 448
        H, Sk, Dh = 16, 512, 256
        return {
            "x": _w((lambda *s: torch.randn(*s, dtype=torch.bfloat16) * 0.8)(B, Sq, D)),
            "k_cache": _w((lambda *s: torch.randn(*s, dtype=torch.bfloat16) * 0.8)(B, H, Sk, Dh)),
            "v_cache": _w((lambda *s: torch.randn(*s, dtype=torch.bfloat16) * 0.05)(B, H, Sk, Dh)),
            "wq": _w((lambda *s: torch.randn(*s, dtype=torch.bfloat16) * 0.8)(D, H * Dh) * (D ** -0.5)),
            "wo": _w((lambda *s: torch.randn(*s, dtype=torch.bfloat16) * 0.05)(H * Dh, D) * ((H * Dh) ** -0.5)),
        }
    _A_in = _A_setup()

    def _B_setup():
        B, Sq, D = 16, 240, 448
        H, Sk, Dh = 16, 512, 256
        return {
            "x": _w((lambda *s: torch.randn(*s, dtype=torch.bfloat16) * 0.8)(B, Sq, D)),
            "k_cache": _w((lambda *s: torch.randn(*s, dtype=torch.bfloat16) * 0.8)(B, H, Sk, Dh)),
            "v_cache": _w((lambda *s: torch.randn(*s, dtype=torch.bfloat16) * 0.05)(B, H, Sk, Dh)),
            "wq": _w((lambda *s: torch.randn(*s, dtype=torch.bfloat16) * 0.8)(D, H * Dh) * (D ** -0.5)),
            "wo": _w((lambda *s: torch.randn(*s, dtype=torch.bfloat16) * 0.05)(H * Dh, D) * ((H * Dh) ** -0.5)),
        }
    _B_in = _B_setup()

    return {
        "A_x": _A_in["x"],
        "A_k_cache": _A_in["k_cache"],
        "A_v_cache": _A_in["v_cache"],
        "A_wq": _A_in["wq"],
        "A_wo": _A_in["wo"],
        "B_x": _B_in["x"],
        "B_k_cache": _B_in["k_cache"],
        "B_v_cache": _B_in["v_cache"],
        "B_wq": _B_in["wq"],
        "B_wo": _B_in["wo"],
    }

def reference(A_x, A_k_cache, A_v_cache, A_wq, A_wo, B_x, B_k_cache, B_v_cache, B_wq, B_wo):
    def _A_ref(x, k_cache, v_cache, wq, wo):
        B, Sq, D = x.shape
        H, Dh = 16, 256
        q = (lambda x, *d: x.permute(*d))((x @ wq).reshape(B, Sq, H, Dh), 0, 2, 1, 3)
        scores = torch.einsum("bhqd,bhkd->bhqk", q, k_cache) * (Dh ** -0.5)
        p = _softmax(scores, axis=-1)
        o = torch.einsum("bhqk,bhkd->bhqd", p, v_cache)
        return (lambda x, *d: x.permute(*d))(o, 0, 2, 1, 3).reshape(B, Sq, H * Dh) @ wo

    def _B_ref(x, k_cache, v_cache, wq, wo):
        B, Sq, D = x.shape
        H, Dh = 16, 256
        q = (lambda x, *d: x.permute(*d))((x @ wq).reshape(B, Sq, H, Dh), 0, 2, 1, 3)
        scores = torch.einsum("bhqd,bhkd->bhqk", q, k_cache) * (Dh ** -0.5)
        p = _softmax(scores, axis=-1)
        o = torch.einsum("bhqk,bhkd->bhqd", p, v_cache)
        return (lambda x, *d: x.permute(*d))(o, 0, 2, 1, 3).reshape(B, Sq, H * Dh) @ wo

    a = _A_ref(A_x, A_k_cache, A_v_cache, A_wq, A_wo)
    b = _B_ref(B_x, B_k_cache, B_v_cache, B_wq, B_wo)
    return torch.concatenate([a, b], axis=-1)
```

```asm
; @launch grid=(256,1,1) block=(256,1,1) lds=152320
.amdgcn_target "amdgcn-amd-amdhsa--gfx950"
.text
.macro mvvaz d, a, b
v_mfma_f32_16x16x32_bf16 v[\d:\d+3], v[\a:\a+3], a[\b:\b+3], 0
.endm
.macro mvva d, a, b
v_mfma_f32_16x16x32_bf16 v[\d:\d+3], v[\a:\a+3], a[\b:\b+3], v[\d:\d+3]
.endm
.macro mvvvz d, a, b
v_mfma_f32_16x16x32_bf16 v[\d:\d+3], v[\a:\a+3], v[\b:\b+3], 0
.endm
.macro mvvv d, a, b
v_mfma_f32_16x16x32_bf16 v[\d:\d+3], v[\a:\a+3], v[\b:\b+3], v[\d:\d+3]
.endm
.macro mavvz d, a, b
v_mfma_f32_16x16x32_bf16 a[\d:\d+3], v[\a:\a+3], v[\b:\b+3], 0
.endm
.macro mavv d, a, b
v_mfma_f32_16x16x32_bf16 a[\d:\d+3], v[\a:\a+3], v[\b:\b+3], a[\d:\d+3]
.endm
.macro mvaaz d, a, b
v_mfma_f32_16x16x32_bf16 v[\d:\d+3], a[\a:\a+3], a[\b:\b+3], 0
.endm
.macro mvaa d, a, b
v_mfma_f32_16x16x32_bf16 v[\d:\d+3], a[\a:\a+3], a[\b:\b+3], v[\d:\d+3]
.endm
.macro tr d, a, o
ds_read_b64_tr_b16 v[\d:\d+1], v\a offset:\o
.endm
.macro pk d, a, b
v_cvt_pk_bf16_f32 v\d, v\a, v\b
.endm
.globl concat_heads__mha_block_cached__mha_block_cached__near_ridge_kernel
.p2align 8
.type concat_heads__mha_block_cached__mha_block_cached__near_ridge_kernel,@function
concat_heads__mha_block_cached__mha_block_cached__near_ridge_kernel:
s_cmp_ge_u32 s2, 256
s_cbranch_scc1 L_end
s_getpc_b64 s[84:85]
L_code_pf:
s_mov_b32 s86, L_code_end-L_code_pf
s_mov_b32 s87, 0x20000
v_and_b32 v2, 63, v0
v_lshlrev_b32 v7, 6, v2
s_lshr_b32 s6, s2, 3
s_lshl_b32 s6, s6, 12
v_and_b32 v1, 64, v0
v_lshl_add_u32 v7, v1, 11, v7
s_mov_b32 m0, 152064
s_mov_b64 s[78:79], s[84:85]
buffer_load_dword v7, s[84:87], s6 offen lds
s_bfe_u32 s3, s2, 0x10002
s_mul_i32 s6, s3, 40
s_add_u32 s6, s0, s6
s_addc_u32 s7, s1, 0
s_load_dwordx8 s[84:91], s[6:7], 0
s_load_dwordx2 s[30:31], s[6:7], 32
s_load_dwordx4 s[32:35], s[0:1], 80
s_load_dwordx2 s[28:29], s[0:1], 96
v_lshrrev_b32 v1, 6, v0
v_and_b32 v2, 63, v0
v_readfirstlane_b32 s4, v1
v_lshrrev_b32 v3, 4, v2
v_and_b32 v4, 15, v2
s_and_b32 s92, s2, 3
s_lshl_b32 s92, s92, 2
s_lshr_b32 s93, s2, 6
s_add_u32 s92, s92, s93
s_bfe_u32 s65, s2, 0x30003
s_lshr_b32 s95, s4, 1
s_mul_i32 s96, s95, 40
s_and_b32 s94, s4, 1
s_lshl_b32 s94, s94, 3
s_add_u32 s96, s96, s94
s_add_u32 s96, s96, 24
s_load_dwordx2 s[36:37], s[0:1], s96
s_movk_i32 s42, 16896
s_mov_b32 s43, 0x25200
s_movk_i32 s53, 1032
s_movk_i32 s54, 1080
s_mov_b32 s55, 0x10000
s_mov_b32 s56, 0xffff2000
s_mov_b32 s57, 0x6e000
s_movk_i32 s59, 7168
s_mov_b32 s60, 0xffff3c80
s_movk_i32 s61, 1088
s_movk_i32 s62, 1024
s_movk_i32 s41, 0
s_mul_i32 s49, s4, 4224
s_and_b32 s7, s4, 1
s_lshl_b32 s50, s4, 12
s_lshl_b32 s94, s95, 8
s_add_u32 s50, s50, s94
s_lshl_b32 s94, s7, 7
s_add_u32 s50, s50, s94
s_lshl_b32 s75, s95, 18
s_lshl_b32 s94, s7, 14
s_add_u32 s75, s75, s94
s_mul_i32 s76, s4, 57344
s_mov_b32 s58, s75
s_add_u32 s82, s75, 3670016
s_add_u32 s83, s76, 896
s_lshr_b32 s94, s92, 2
s_lshl_b32 s96, s94, 20
s_add_u32 s46, s75, s96
s_lshl_b32 s96, s94, 8
s_add_u32 s47, s76, s96
v_and_b32 v9, 1, v3
v_lshrrev_b32 v10, 1, v3
v_lshlrev_b32 v7, 17, v10
v_lshl_add_u32 v7, v9, 15, v7
v_lshl_add_u32 v241, v4, 4, v7
v_lshrrev_b32 v7, 3, v2
v_mul_u32_u24 v7, 896, v7
v_and_b32 v8, 7, v2
v_xor_b32 v8, v8, v3
v_lshl_add_u32 v242, v8, 4, v7
s_mul_i32 s94, s92, 215040
s_lshl_b32 s96, s65, 10
s_mov_b32 s22, 215040
s_sub_u32 s18, 0x380000, s96
s_mov_b32 s23, 0x20000
s_mov_b32 s19, 0x20000
s_waitcnt lgkmcnt(0)
s_add_u32 s20, s84, s94
s_addc_u32 s21, s85, 0
s_add_u32 s16, s90, s96
s_addc_u32 s17, s91, 0
s_add_u32 m0, s41, s49
s_add_u32 s41, s41, s42
s_cmp_eq_u32 s41, s43
s_cselect_b32 s41, 0, s41
buffer_load_dwordx4 v242, s[20:23], s47 offen lds
s_add_u32 s47, s47, s59
s_add_u32 m0, m0, s61
s_nop 0
buffer_load_dwordx4 v242, s[20:23], s47 offen lds
s_add_u32 s47, s47, s59
s_add_u32 m0, m0, s62
s_nop 0
buffer_load_dwordx4 v242, s[20:23], s47 offen lds
s_add_u32 s47, s47, s59
s_add_u32 m0, m0, s61
s_nop 0
buffer_load_dwordx4 v242, s[20:23], s47 offen lds
s_add_u32 s47, s47, s59
s_add_u32 m0, s41, s49
s_add_u32 s41, s41, s42
s_cmp_eq_u32 s41, s43
s_cselect_b32 s41, 0, s41
buffer_load_dwordx4 v242, s[20:23], s47 offen lds
s_add_u32 s47, s47, s59
s_add_u32 m0, m0, s61
s_nop 0
buffer_load_dwordx4 v242, s[20:23], s47 offen lds
s_add_u32 s47, s47, s59
s_add_u32 m0, m0, s62
s_nop 0
buffer_load_dwordx4 v242, s[20:23], s47 offen lds
s_add_u32 s47, s47, s59
s_add_u32 m0, m0, s61
s_nop 0
buffer_load_dwordx4 v242, s[20:23], s47 offen lds
s_add_u32 s47, s47, s60
s_cmp_eq_u32 s47, s83
s_cselect_b32 s47, s76, s47
s_add_u32 m0, s41, s50
s_add_u32 s41, s41, s42
s_cmp_eq_u32 s41, s43
s_cselect_b32 s41, 0, s41
buffer_load_dwordx4 v241, s[16:19], s46 offen lds
s_add_u32 s46, s46, s55
s_add_u32 m0, m0, s53
s_nop 0
buffer_load_dwordx4 v241, s[16:19], s46 offen lds
s_add_u32 s46, s46, s56
s_add_u32 m0, m0, s54
s_nop 0
buffer_load_dwordx4 v241, s[16:19], s46 offen lds
s_add_u32 s46, s46, s55
s_add_u32 m0, m0, s53
s_nop 0
buffer_load_dwordx4 v241, s[16:19], s46 offen lds
s_add_u32 s46, s46, s57
s_cmp_eq_u32 s46, s82
s_cselect_b32 s46, s58, s46
s_lshl_b32 s94, s92, 3
s_add_u32 s94, s94, s65
s_lshl_b32 s94, s94, 19
s_add_u32 s8, s86, s94
s_addc_u32 s9, s87, 0
s_mov_b32 s10, 0x80000
s_mov_b32 s11, 0x20000
s_add_u32 s12, s88, s94
s_addc_u32 s13, s89, 0
s_mov_b32 s14, 0x80000
s_mov_b32 s15, 0x20000
s_mov_b32 s73, 152064
s_lshr_b32 s88, s2, 3
s_lshl_b32 s88, s88, 12
s_lshl_b32 s94, s7, 17
s_add_u32 s88, s88, s94
s_mov_b64 s[84:85], s[78:79]
s_mov_b32 s86, L_code_end-L_code_pf
s_mov_b32 s87, 0x20000
s_lshl_b32 s51, s3, 4
s_add_u32 s51, s51, s92
s_lshl_b32 s94, s51, 8
s_lshl_b32 s96, s65, 2
s_add_u32 s94, s94, s96
s_add_u32 s94, s94, 0x6000000
s_add_u32 s24, s28, s94
s_addc_u32 s25, s29, 0
s_sub_u32 s96, s24, s96
s_subb_u32 s97, s25, 0
s_movk_i32 s26, 132
s_mov_b32 s27, 0x20000
v_lshlrev_b32 v240, 4, v2
v_lshlrev_b32 v7, 7, v2
v_mov_b32 v8, 0
buffer_store_dword v8, v7, s[24:27], 0 offen sc1
s_lshl_b32 s94, s51, 3
s_add_u32 s94, s94, s65
s_lshl_b32 s94, s94, 17
s_add_u32 s94, s94, 0x4000000
s_add_u32 s24, s28, s94
s_addc_u32 s25, s29, 0
s_mov_b32 s26, 0
s_lshl_b32 s70, s4, 15
s_mov_b32 s48, s70
s_mul_i32 s94, s2, 14336
s_add_u32 s36, s36, s94
s_addc_u32 s37, s37, 0
s_mul_i32 s94, s65, 0x70000
s_add_u32 s30, s30, s94
s_addc_u32 s31, s31, 0
s_lshl_b32 s94, s95, 6
s_lshl_b32 s93, s7, 2
s_add_u32 s94, s94, s93
s_add_u32 s94, s94, 256
s_mul_i32 s71, s94, 896
s_lshl_b32 s94, s51, 2
s_add_u32 s34, s34, s94
s_addc_u32 s35, s35, 0
s_mul_i32 s94, s92, 430080
s_mul_i32 s93, s3, 896
s_add_u32 s94, s94, s93
s_add_u32 s32, s32, s94
s_addc_u32 s33, s33, 0
s_mul_i32 s94, s51, 2097152
s_add_u32 s28, s28, s94
s_addc_u32 s29, s29, 0
s_lshl_b32 s65, s65, 2
s_add_u32 s94, s65, s4
s_lshl_b32 s68, s94, 16
s_lshl_b32 s66, s94, 15
s_addk_i32 s66, 0x6000
s_cmp_eq_u32 s4, 3
s_cselect_b32 s67, 0x70000000, s66
s_cselect_b32 s69, 0x70000000, s68
s_lshr_b32 s93, s94, 1
s_mul_i32 s3, s93, 28672
s_and_b32 s93, s93, 3
s_lshl_b32 s93, s93, 10
s_lshl_b32 s6, s7, 12
s_add_u32 s93, s93, s6
s_lshl_b32 s6, s7, 6
s_add_u32 s3, s3, s6
s_cmp_ge_u32 s94, 30
s_cselect_b32 s93, 0x70000000, s93
s_lshr_b32 s94, s94, 3
s_lshl_b32 s7, s94, 16
s_add_u32 s7, s7, s93
s_lshl_b32 s6, s94, 15
s_add_u32 s6, s6, s93
s_addk_i32 s6, 0x6000
s_lshr_b32 s94, s92, 2
s_lshl_b32 s74, s94, 8
s_and_b32 s74, s74, 0x3ff
s_getreg_b32 s94, hwreg(HW_REG_XCC_ID, 0, 4)
s_and_b32 s94, s94, 7
s_mul_i32 s93, s94, s94
s_lshl_b32 s93, s93, 10
s_lshl_b32 s94, s94, 4
s_add_u32 s94, s94, s93
s_add_u32 s51, s94, 1
s_mov_b32 s38, 0x3db8aa3b
s_mov_b32 s39, 0x41000000
s_mov_b32 s52, 16384
s_mov_b32 s72, 4096
s_mov_b32 s81, 0xffff0000
s_mov_b32 s98, 0
s_mov_b32 s40, 0
s_mov_b32 s5, 0
s_mov_b32 s63, 0
s_mov_b32 s77, 0xff61b1e6
s_cmp_eq_u32 s4, 3
s_cselect_b32 s77, 0x461c4000, s77
s_cselect_b32 s93, 2.0, 0
s_lshl_b32 s44, s4, 12
s_mov_b32 s45, s44
v_bfe_u32 v5, v2, 2, 2
v_and_b32 v6, 3, v2
v_and_b32 v7, 1, v5
v_lshl_add_u32 v7, v7, 2, v6
v_mul_u32_u24 v7, 1056, v7
v_lshrrev_b32 v8, 1, v5
v_lshl_add_u32 v7, v8, 9, v7
v_lshl_add_u32 v232, v3, 4, v7
v_lshl_add_u32 v7, v9, 2, v5
v_mul_u32_u24 v7, 1056, v7
v_lshl_add_u32 v7, v10, 9, v7
v_lshl_add_u32 v233, v6, 3, v7
v_mul_u32_u24 v7, 2112, v5
v_mul_u32_u24 v8, 1032, v9
v_add_u32 v7, v7, v8
v_lshl_add_u32 v7, v10, 9, v7
v_lshl_add_u32 v234, v6, 4, v7
v_lshrrev_b32 v7, 3, v4
v_mul_u32_u24 v7, 1088, v7
v_and_b32 v8, 7, v4
v_lshl_add_u32 v7, v8, 7, v7
v_lshrrev_b32 v8, 1, v8
v_xor_b32 v8, v8, v3
v_lshl_add_u32 v7, v8, 4, v7
v_add_u32 v235, s49, v7
v_mov_b32 v236, 0
v_mov_b32 v237, 0
v_mov_b32 v238, 0
v_mov_b32 v239, 0
v_mov_b32 v244, 0
v_mov_b32 v249, 0
s_mov_b64 vcc, -1
s_cmp_eq_u32 s4, 0
s_cbranch_scc1 L_padA0
s_cmp_eq_u32 s4, 1
s_cbranch_scc1 L_padA1
s_cmp_eq_u32 s4, 2
s_cbranch_scc1 L_padA2
s_branch L_hopxA
L_hopxA:
s_cmp_eq_u32 s4, 0
s_cbranch_scc1 L_padB0
s_cmp_eq_u32 s4, 1
s_cbranch_scc1 L_padB1
s_cmp_eq_u32 s4, 2
s_cbranch_scc1 L_padB2
s_branch L_padB3
L_hop_done:
s_mov_b64 vcc, 0
s_add_u32 m0, s41, s49
s_add_u32 s41, s41, s42
s_cmp_eq_u32 s41, s43
s_cselect_b32 s41, 0, s41
buffer_load_dwordx4 v242, s[20:23], s47 offen lds
s_add_u32 s47, s47, s59
s_add_u32 m0, m0, s61
s_nop 0
buffer_load_dwordx4 v242, s[20:23], s47 offen lds
s_add_u32 s47, s47, s59
s_add_u32 m0, m0, s62
s_nop 0
buffer_load_dwordx4 v242, s[20:23], s47 offen lds
s_add_u32 s47, s47, s59
s_add_u32 m0, m0, s61
s_nop 0
buffer_load_dwordx4 v242, s[20:23], s47 offen lds
s_add_u32 s47, s47, s59
s_add_u32 m0, s41, s49
s_add_u32 s41, s41, s42
s_cmp_eq_u32 s41, s43
s_cselect_b32 s41, 0, s41
buffer_load_dwordx4 v242, s[20:23], s47 offen lds
s_add_u32 s47, s47, s59
s_add_u32 m0, m0, s61
s_nop 0
buffer_load_dwordx4 v242, s[20:23], s47 offen lds
s_add_u32 s47, s47, s59
s_add_u32 m0, m0, s62
s_nop 0
buffer_load_dwordx4 v242, s[20:23], s47 offen lds
s_add_u32 s47, s47, s59
s_add_u32 m0, m0, s61
s_nop 0
buffer_load_dwordx4 v242, s[20:23], s47 offen lds
s_add_u32 s47, s47, s60
s_cmp_eq_u32 s47, s83
s_cselect_b32 s47, s76, s47
s_waitcnt vmcnt(13)
v_add_u32 v239, s40, v235
s_add_u32 s40, s40, s42
s_cmp_eq_u32 s40, s43
s_cselect_b32 s40, 0, s40
ds_read_b128 a[0:3], v239 offset:0
ds_read_b128 a[16:19], v239 offset:64
ds_read_b128 a[4:7], v239 offset:2112
ds_read_b128 a[20:23], v239 offset:2176
v_add_u32 v239, s40, v235
s_add_u32 s40, s40, s42
s_cmp_eq_u32 s40, s43
s_cselect_b32 s40, 0, s40
ds_read_b128 a[8:11], v239 offset:0
ds_read_b128 a[24:27], v239 offset:64
ds_read_b128 a[12:15], v239 offset:2112
ds_read_b128 a[28:31], v239 offset:2176
v_add_u32 v238, s40, v234
s_add_u32 s40, s40, s42
s_cmp_eq_u32 s40, s43
s_cselect_b32 s40, 0, s40
s_add_u32 m0, s41, s50
s_add_u32 s41, s41, s42
s_cmp_eq_u32 s41, s43
s_cselect_b32 s41, 0, s41
buffer_load_dwordx4 v241, s[16:19], s46 offen lds
s_add_u32 s46, s46, s55
s_add_u32 m0, m0, s53
s_nop 0
buffer_load_dwordx4 v241, s[16:19], s46 offen lds
s_add_u32 s46, s46, s56
s_add_u32 m0, m0, s54
s_nop 0
buffer_load_dwordx4 v241, s[16:19], s46 offen lds
s_add_u32 s46, s46, s55
s_add_u32 m0, m0, s53
s_nop 0
buffer_load_dwordx4 v241, s[16:19], s46 offen lds
s_add_u32 s46, s46, s57
s_cmp_eq_u32 s46, s82
s_cselect_b32 s46, s58, s46
s_add_u32 m0, s41, s49
s_add_u32 s41, s41, s42
s_cmp_eq_u32 s41, s43
s_cselect_b32 s41, 0, s41
buffer_load_dwordx4 v242, s[20:23], s47 offen lds
s_add_u32 s47, s47, s59
s_add_u32 m0, m0, s61
s_nop 0
buffer_load_dwordx4 v242, s[20:23], s47 offen lds
s_add_u32 s47, s47, s59
s_add_u32 m0, m0, s62
s_nop 0
buffer_load_dwordx4 v242, s[20:23], s47 offen lds
s_add_u32 s47, s47, s59
s_add_u32 m0, m0, s61
s_nop 0
buffer_load_dwordx4 v242, s[20:23], s47 offen lds
s_add_u32 s47, s47, s59
s_add_u32 m0, s41, s49
s_add_u32 s41, s41, s42
s_cmp_eq_u32 s41, s43
s_cselect_b32 s41, 0, s41
buffer_load_dwordx4 v242, s[20:23], s47 offen lds
s_add_u32 s47, s47, s59
s_add_u32 m0, m0, s61
s_nop 0
buffer_load_dwordx4 v242, s[20:23], s47 offen lds
s_add_u32 s47, s47, s59
s_add_u32 m0, m0, s62
s_nop 0
buffer_load_dwordx4 v242, s[20:23], s47 offen lds
s_add_u32 s47, s47, s59
s_add_u32 m0, m0, s61
s_nop 0
buffer_load_dwordx4 v242, s[20:23], s47 offen lds
s_add_u32 s47, s47, s60
s_cmp_eq_u32 s47, s83
s_cselect_b32 s47, s76, s47
s_waitcnt vmcnt(21)
s_barrier
tr 192,238,0
tr 194,238,256
tr 196,238,8448
tr 198,238,8704
tr 200,238,8
tr 202,238,264
tr 204,238,8456
tr 206,238,8712
s_waitcnt lgkmcnt(6)
s_cmp_eq_u32 s4, 3
s_cbranch_scc1 L_mainw
s_branch L_main
.p2align 12
.fill 697, 4, 0xbf800000
L_main:
mvvaz 64,192,0
L_padA0:
s_cbranch_vccnz L_hopxA
s_waitcnt lgkmcnt(4)
tr 208,238,64
mvva 64,196,16
s_add_u32 m0, s41, s50
s_add_u32 s41, s41, s42
tr 210,238,320
mvvaz 72,196,20
s_cmp_eq_u32 s41, s43
s_cselect_b32 s41, 0, s41
tr 212,238,8512
mvva 72,192,4
buffer_load_dwordx4 v241, s[16:19], s46 offen lds
mvvaz 80,192,8
s_add_u32 s46, s46, s55
s_add_u32 m0, m0, s53
tr 214,238,8768
mvva 80,196,24
tr 216,238,72
mvvaz 88,196,28
s_waitcnt lgkmcnt(7)
tr 218,238,328
v_add_u32 v239, s40, v235
mvva 88,192,12
buffer_load_dwordx4 v241, s[16:19], s46 offen lds
mvvaz 68,200,0
s_waitcnt lgkmcnt(4)
s_add_u32 s46, s46, s56
tr 220,238,8520
mvva 68,204,16
s_waitcnt vmcnt(18)
s_add_u32 m0, m0, s54
tr 222,238,8776
mvvaz 76,204,20
s_add_u32 s40, s40, s42
ds_read_b128 a[32:35], v239 offset:0
mvva 76,200,4
buffer_load_dwordx4 v241, s[16:19], s46 offen lds
mvvaz 84,200,8
s_add_u32 s46, s46, s55
s_add_u32 m0, m0, s53
ds_read_b128 a[48:51], v239 offset:64
mvva 84,204,24
s_cmp_eq_u32 s40, s43
s_cselect_b32 s40, 0, s40
ds_read_b128 a[36:39], v239 offset:2112
mvvaz 92,204,28
ds_read_b128 a[52:55], v239 offset:2176
mvva 92,200,12
buffer_load_dwordx4 v241, s[16:19], s46 offen lds
mvvaz 96,208,0
s_waitcnt lgkmcnt(4)
s_add_u32 s46, s46, s57
tr 192,238,128
mvva 96,212,16
s_cmp_eq_u32 s46, s82
s_cselect_b32 s46, s58, s46
tr 194,238,384
mvvaz 104,212,20
tr 196,238,8576
mvva 104,208,4
mvvaz 112,208,8
tr 198,238,8832
mvva 112,212,24
tr 200,238,136
mvvaz 120,212,28
tr 202,238,392
v_add_u32 v239, s40, v235
mvva 120,208,12
s_add_u32 s40, s40, s42
s_cmp_eq_u32 s40, s43
s_cselect_b32 s40, 0, s40
mvvaz 100,216,0
tr 204,238,8584
mvva 100,220,16
s_waitcnt vmcnt(16)
tr 206,238,8840
mvvaz 108,220,20
ds_read_b128 a[40:43], v239 offset:0
mvva 108,216,4
mvvaz 116,216,8
ds_read_b128 a[56:59], v239 offset:64
mvva 116,220,24
ds_read_b128 a[44:47], v239 offset:2112
mvvaz 124,220,28
ds_read_b128 a[60:63], v239 offset:2176
mvva 124,216,12
s_waitcnt lgkmcnt(5)
mvvaz 128,192,0
tr 208,238,192
mvva 128,196,16
tr 210,238,448
mvvaz 136,196,20
tr 212,238,8640
mvva 136,192,4
mvvaz 144,192,8
tr 214,238,8896
mvva 144,196,24
tr 216,238,200
mvvaz 152,196,28
tr 218,238,456
mvva 152,192,12
mvvaz 132,200,0
s_waitcnt lgkmcnt(4)
tr 220,238,8648
mvva 132,204,16
tr 222,238,8904
mvvaz 140,204,20
mvva 140,200,4
v_add_u32 v238, s40, v234
mvvaz 148,200,8
s_add_u32 s40, s40, s42
s_cmp_eq_u32 s40, s43
s_cselect_b32 s40, 0, s40
mvva 148,204,24
mvvaz 156,204,28
mvva 156,200,12
s_waitcnt vmcnt(4) lgkmcnt(0)
s_barrier
mvvaz 160,208,0
s_add_u32 m0, s41, s49
s_add_u32 s41, s41, s42
tr 192,238,0
mvva 160,212,16
s_cmp_eq_u32 s41, s43
s_cselect_b32 s41, 0, s41
tr 194,238,256
mvvaz 168,212,20
tr 196,238,8448
mvva 168,208,4
buffer_load_dwordx4 v242, s[20:23], s47 offen lds
mvvaz 176,208,8
s_add_u32 s47, s47, s59
s_add_u32 m0, m0, s61
tr 198,238,8704
mvva 176,212,24
tr 200,238,8
mvvaz 184,212,28
tr 202,238,264
mvva 184,208,12
buffer_load_dwordx4 v242, s[20:23], s47 offen lds
mvvaz 164,216,0
s_add_u32 s47, s47, s59
s_add_u32 m0, m0, s62
tr 204,238,8456
mvva 164,220,16
tr 206,238,8712
mvvaz 172,220,20
mvva 172,216,4
buffer_load_dwordx4 v242, s[20:23], s47 offen lds
mvvaz 180,216,8
s_add_u32 s47, s47, s59
s_add_u32 m0, m0, s61
mvva 180,220,24
mvvaz 188,220,28
s_waitcnt lgkmcnt(1)
mvva 188,216,12
buffer_load_dwordx4 v242, s[20:23], s47 offen lds
mvva 64,192,32
s_add_u32 s47, s47, s59
s_add_u32 m0, s41, s49
tr 208,238,64
mvva 64,196,48
s_add_u32 s41, s41, s42
tr 210,238,320
mvva 72,196,52
s_cmp_eq_u32 s41, s43
s_cselect_b32 s41, 0, s41
tr 212,238,8512
mvva 72,192,36
buffer_load_dwordx4 v242, s[20:23], s47 offen lds
mvva 80,192,40
s_add_u32 s47, s47, s59
s_add_u32 m0, m0, s61
tr 214,238,8768
mvva 80,196,56
tr 216,238,72
mvva 88,196,60
tr 218,238,328
v_add_u32 v239, s40, v235
mvva 88,192,44
buffer_load_dwordx4 v242, s[20:23], s47 offen lds
mvva 68,200,32
s_waitcnt lgkmcnt(4)
s_add_u32 s47, s47, s59
tr 220,238,8520
mvva 68,204,48
s_add_u32 m0, m0, s62
s_add_u32 s40, s40, s42
tr 222,238,8776
mvva 76,204,52
s_cmp_eq_u32 s40, s43
s_cselect_b32 s40, 0, s40
ds_read_b128 a[64:67], v239 offset:0
mvva 76,200,36
L_padA1:
s_cbranch_vccnz L_hopxA
buffer_load_dwordx4 v242, s[20:23], s47 offen lds
mvva 84,200,40
s_add_u32 s47, s47, s59
s_add_u32 m0, m0, s61
ds_read_b128 a[80:83], v239 offset:64
mvva 84,204,56
ds_read_b128 a[68:71], v239 offset:2112
mvva 92,204,60
ds_read_b128 a[84:87], v239 offset:2176
mvva 92,200,44
buffer_load_dwordx4 v242, s[20:23], s47 offen lds
mvva 96,208,32
s_waitcnt lgkmcnt(4)
s_add_u32 s47, s47, s60
tr 192,238,128
mvva 96,212,48
s_cmp_eq_u32 s47, s83
s_cselect_b32 s47, s76, s47
tr 194,238,384
mvva 104,212,52
s_add_u32 m0, s41, s50
s_add_u32 s41, s41, s42
tr 196,238,8576
mvva 104,208,36
buffer_load_dwordx4 v241, s[16:19], s46 offen lds
mvva 112,208,40
s_add_u32 s46, s46, s55
s_add_u32 m0, m0, s53
tr 198,238,8832
mvva 112,212,56
s_cmp_eq_u32 s41, s43
s_cselect_b32 s41, 0, s41
tr 200,238,136
mvva 120,212,60
tr 202,238,392
v_add_u32 v239, s40, v235
mvva 120,208,44
buffer_load_dwordx4 v241, s[16:19], s46 offen lds
mvva 100,216,32
s_add_u32 s46, s46, s56
s_add_u32 m0, m0, s54
tr 204,238,8584
mvva 100,220,48
s_add_u32 s40, s40, s42
tr 206,238,8840
mvva 108,220,52
s_cmp_eq_u32 s40, s43
s_cselect_b32 s40, 0, s40
ds_read_b128 a[72:75], v239 offset:0
mvva 108,216,36
buffer_load_dwordx4 v241, s[16:19], s46 offen lds
mvva 116,216,40
s_add_u32 s46, s46, s55
s_add_u32 m0, m0, s53
ds_read_b128 a[88:91], v239 offset:64
mvva 116,220,56
ds_read_b128 a[76:79], v239 offset:2112
mvva 124,220,60
s_waitcnt lgkmcnt(4)
ds_read_b128 a[92:95], v239 offset:2176
mvva 124,216,44
buffer_load_dwordx4 v241, s[16:19], s46 offen lds
mvva 128,192,32
s_add_u32 s46, s46, s57
s_add_u32 m0, s41, s49
tr 208,238,192
mvva 128,196,48
s_cmp_eq_u32 s46, s82
s_cselect_b32 s46, s58, s46
tr 210,238,448
mvva 136,196,52
s_add_u32 s41, s41, s42
tr 212,238,8640
mvva 136,192,36
buffer_load_dwordx4 v242, s[20:23], s47 offen lds
mvva 144,192,40
s_add_u32 s47, s47, s59
s_add_u32 m0, m0, s61
tr 214,238,8896
mvva 144,196,56
s_cmp_eq_u32 s41, s43
s_cselect_b32 s41, 0, s41
tr 216,238,200
mvva 152,196,60
tr 218,238,456
mvva 152,192,44
buffer_load_dwordx4 v242, s[20:23], s47 offen lds
mvva 132,200,32
s_waitcnt lgkmcnt(4)
s_add_u32 s47, s47, s59
tr 220,238,8648
mvva 132,204,48
s_add_u32 m0, m0, s62
tr 222,238,8904
mvva 140,204,52
buffer_load_dwordx4 v242, s[20:23], s47 offen lds
mvva 140,200,36
s_add_u32 s47, s47, s59
s_add_u32 m0, m0, s61
v_add_u32 v238, s40, v234
mvva 148,200,40
s_add_u32 s40, s40, s42
s_cmp_eq_u32 s40, s43
s_cselect_b32 s40, 0, s40
mvva 148,204,56
buffer_load_dwordx4 v242, s[20:23], s47 offen lds
mvva 156,204,60
s_add_u32 s47, s47, s59
mvva 156,200,44
s_waitcnt vmcnt(8) lgkmcnt(0)
s_barrier
mvva 160,208,32
s_add_u32 m0, s41, s49
s_add_u32 s41, s41, s42
tr 192,238,0
mvva 160,212,48
s_cmp_eq_u32 s41, s43
s_cselect_b32 s41, 0, s41
tr 194,238,256
mvva 168,212,52
tr 196,238,8448
mvva 168,208,36
buffer_load_dwordx4 v242, s[20:23], s47 offen lds
mvva 176,208,40
s_add_u32 s47, s47, s59
s_add_u32 m0, m0, s61
tr 198,238,8704
mvva 176,212,56
tr 200,238,8
mvva 184,212,60
tr 202,238,264
mvva 184,208,44
buffer_load_dwordx4 v242, s[20:23], s47 offen lds
mvva 164,216,32
s_add_u32 s47, s47, s59
s_add_u32 m0, m0, s62
tr 204,238,8456
mvva 164,220,48
tr 206,238,8712
mvva 172,220,52
mvva 172,216,36
buffer_load_dwordx4 v242, s[20:23], s47 offen lds
mvva 180,216,40
s_add_u32 s47, s47, s59
s_add_u32 m0, m0, s61
mvva 180,220,56
mvva 188,220,60
s_waitcnt lgkmcnt(1)
mvva 188,216,44
buffer_load_dwordx4 v242, s[20:23], s47 offen lds
mvva 64,192,64
s_add_u32 s47, s47, s60
s_add_u32 m0, s41, s50
tr 208,238,64
mvva 64,196,80
s_cmp_eq_u32 s47, s83
s_cselect_b32 s47, s76, s47
tr 210,238,320
mvva 72,196,84
s_add_u32 s41, s41, s42
tr 212,238,8512
mvva 72,192,68
buffer_load_dwordx4 v241, s[16:19], s46 offen lds
mvva 80,192,72
s_add_u32 s46, s46, s55
s_add_u32 m0, m0, s53
tr 214,238,8768
mvva 80,196,88
s_cmp_eq_u32 s41, s43
s_cselect_b32 s41, 0, s41
tr 216,238,72
mvva 88,196,92
tr 218,238,328
v_add_u32 v239, s40, v235
mvva 88,192,76
buffer_load_dwordx4 v241, s[16:19], s46 offen lds
mvva 68,200,64
s_waitcnt lgkmcnt(4)
s_add_u32 s46, s46, s56
tr 220,238,8520
mvva 68,204,80
s_add_u32 m0, m0, s54
s_add_u32 s40, s40, s42
tr 222,238,8776
mvva 76,204,84
s_cmp_eq_u32 s40, s43
s_cselect_b32 s40, 0, s40
ds_read_b128 a[96:99], v239 offset:0
mvva 76,200,68
buffer_load_dwordx4 v241, s[16:19], s46 offen lds
mvva 84,200,72
s_add_u32 s46, s46, s55
s_add_u32 m0, m0, s53
ds_read_b128 a[112:115], v239 offset:64
mvva 84,204,88
ds_read_b128 a[100:103], v239 offset:2112
mvva 92,204,92
ds_read_b128 a[116:119], v239 offset:2176
mvva 92,200,76
buffer_load_dwordx4 v241, s[16:19], s46 offen lds
mvva 96,208,64
s_waitcnt lgkmcnt(4)
s_add_u32 s46, s46, s57
tr 192,238,128
mvva 96,212,80
s_cmp_eq_u32 s46, s82
s_cselect_b32 s46, s58, s46
tr 194,238,384
mvva 104,212,84
s_add_u32 m0, s41, s49
s_add_u32 s41, s41, s42
tr 196,238,8576
mvva 104,208,68
buffer_load_dwordx4 v242, s[20:23], s47 offen lds
mvva 112,208,72
s_add_u32 s47, s47, s59
s_add_u32 m0, m0, s61
tr 198,238,8832
mvva 112,212,88
s_cmp_eq_u32 s41, s43
s_cselect_b32 s41, 0, s41
tr 200,238,136
mvva 120,212,92
tr 202,238,392
v_add_u32 v239, s40, v235
mvva 120,208,76
buffer_load_dwordx4 v242, s[20:23], s47 offen lds
mvva 100,216,64
s_add_u32 s47, s47, s59
s_add_u32 m0, m0, s62
tr 204,238,8584
mvva 100,220,80
s_add_u32 s40, s40, s42
tr 206,238,8840
mvva 108,220,84
s_cmp_eq_u32 s40, s43
s_cselect_b32 s40, 0, s40
ds_read_b128 a[104:107], v239 offset:0
mvva 108,216,68
buffer_load_dwordx4 v242, s[20:23], s47 offen lds
mvva 116,216,72
s_add_u32 s47, s47, s59
s_add_u32 m0, m0, s61
ds_read_b128 a[120:123], v239 offset:64
mvva 116,220,88
ds_read_b128 a[108:111], v239 offset:2112
mvva 124,220,92
s_waitcnt lgkmcnt(4)
ds_read_b128 a[124:127], v239 offset:2176
mvva 124,216,76
buffer_load_dwordx4 v242, s[20:23], s47 offen lds
mvva 128,192,64
s_add_u32 s47, s47, s59
s_add_u32 m0, s41, s49
tr 208,238,192
mvva 128,196,80
s_add_u32 s41, s41, s42
tr 210,238,448
mvva 136,196,84
s_cmp_eq_u32 s41, s43
s_cselect_b32 s41, 0, s41
tr 212,238,8640
mvva 136,192,68
buffer_load_dwordx4 v242, s[20:23], s47 offen lds
mvva 144,192,72
s_add_u32 s47, s47, s59
s_add_u32 m0, m0, s61
tr 214,238,8896
mvva 144,196,88
tr 216,238,200
mvva 152,196,92
tr 218,238,456
mvva 152,192,76
buffer_load_dwordx4 v242, s[20:23], s47 offen lds
mvva 132,200,64
s_waitcnt lgkmcnt(4)
s_add_u32 s47, s47, s59
tr 220,238,8648
mvva 132,204,80
s_add_u32 m0, m0, s62
tr 222,238,8904
mvva 140,204,84
buffer_load_dwordx4 v242, s[20:23], s47 offen lds
mvva 140,200,68
s_add_u32 s47, s47, s59
s_add_u32 m0, m0, s61
v_add_u32 v238, s40, v234
mvva 148,200,72
s_add_u32 s40, s40, s42
s_cmp_eq_u32 s40, s43
s_cselect_b32 s40, 0, s40
mvva 148,204,88
buffer_load_dwordx4 v242, s[20:23], s47 offen lds
mvva 156,204,92
s_add_u32 s47, s47, s60
s_cmp_eq_u32 s47, s83
s_cselect_b32 s47, s76, s47
mvva 156,200,76
s_waitcnt vmcnt(12) lgkmcnt(0)
s_barrier
mvva 160,208,64
s_add_u32 m0, s41, s50
s_add_u32 s41, s41, s42
tr 192,238,0
mvva 160,212,80
s_cmp_eq_u32 s41, s43
s_cselect_b32 s41, 0, s41
tr 194,238,256
mvva 168,212,84
tr 196,238,8448
mvva 168,208,68
buffer_load_dwordx4 v241, s[16:19], s46 offen lds
mvva 176,208,72
s_add_u32 s46, s46, s55
s_add_u32 m0, m0, s53
tr 198,238,8704
mvva 176,212,88
tr 200,238,8
mvva 184,212,92
tr 202,238,264
mvva 184,208,76
buffer_load_dwordx4 v241, s[16:19], s46 offen lds
mvva 164,216,64
s_add_u32 s46, s46, s56
s_add_u32 m0, m0, s54
tr 204,238,8456
mvva 164,220,80
tr 206,238,8712
mvva 172,220,84
mvva 172,216,68
buffer_load_dwordx4 v241, s[16:19], s46 offen lds
mvva 180,216,72
s_add_u32 s46, s46, s55
s_add_u32 m0, m0, s53
mvva 180,220,88
mvva 188,220,92
s_waitcnt lgkmcnt(1)
mvva 188,216,76
buffer_load_dwordx4 v241, s[16:19], s46 offen lds
mvva 64,192,96
s_add_u32 s46, s46, s57
s_add_u32 m0, s41, s49
tr 208,238,64
mvva 64,196,112
s_cmp_eq_u32 s46, s82
s_cselect_b32 s46, s58, s46
tr 210,238,320
mvva 72,196,116
s_add_u32 s41, s41, s42
tr 212,238,8512
mvva 72,192,100
buffer_load_dwordx4 v242, s[20:23], s47 offen lds
mvva 80,192,104
s_add_u32 s47, s47, s59
s_add_u32 m0, m0, s61
tr 214,238,8768
mvva 80,196,120
s_cmp_eq_u32 s41, s43
s_cselect_b32 s41, 0, s41
tr 216,238,72
mvva 88,196,124
tr 218,238,328
v_add_u32 v239, s40, v235
mvva 88,192,108
buffer_load_dwordx4 v242, s[20:23], s47 offen lds
mvva 68,200,96
s_waitcnt lgkmcnt(4)
s_add_u32 s47, s47, s59
tr 220,238,8520
mvva 68,204,112
s_add_u32 m0, m0, s62
s_add_u32 s40, s40, s42
tr 222,238,8776
mvva 76,204,116
s_cmp_eq_u32 s40, s43
s_cselect_b32 s40, 0, s40
ds_read_b128 a[128:131], v239 offset:0
mvva 76,200,100
buffer_load_dwordx4 v242, s[20:23], s47 offen lds
mvva 84,200,104
s_add_u32 s47, s47, s59
s_add_u32 m0, m0, s61
ds_read_b128 a[144:147], v239 offset:64
mvva 84,204,120
ds_read_b128 a[132:135], v239 offset:2112
mvva 92,204,124
ds_read_b128 a[148:151], v239 offset:2176
mvva 92,200,108
buffer_load_dwordx4 v242, s[20:23], s47 offen lds
mvva 96,208,96
s_waitcnt lgkmcnt(4)
s_add_u32 s47, s47, s59
tr 192,238,128
mvva 96,212,112
s_add_u32 m0, s41, s49
s_add_u32 s41, s41, s42
tr 194,238,384
mvva 104,212,116
s_cmp_eq_u32 s41, s43
s_cselect_b32 s41, 0, s41
tr 196,238,8576
mvva 104,208,100
buffer_load_dwordx4 v242, s[20:23], s47 offen lds
mvva 112,208,104
s_add_u32 s47, s47, s59
s_add_u32 m0, m0, s61
tr 198,238,8832
mvva 112,212,120
tr 200,238,136
mvva 120,212,124
tr 202,238,392
v_add_u32 v239, s40, v235
mvva 120,208,108
buffer_load_dwordx4 v242, s[20:23], s47 offen lds
mvva 100,216,96
s_add_u32 s47, s47, s59
s_add_u32 m0, m0, s62
tr 204,238,8584
mvva 100,220,112
s_add_u32 s40, s40, s42
tr 206,238,8840
mvva 108,220,116
s_cmp_eq_u32 s40, s43
s_cselect_b32 s40, 0, s40
ds_read_b128 a[136:139], v239 offset:0
mvva 108,216,100
buffer_load_dwordx4 v242, s[20:23], s47 offen lds
mvva 116,216,104
s_add_u32 s47, s47, s59
s_add_u32 m0, m0, s61
ds_read_b128 a[152:155], v239 offset:64
mvva 116,220,120
ds_read_b128 a[140:143], v239 offset:2112
mvva 124,220,124
s_waitcnt lgkmcnt(4)
ds_read_b128 a[156:159], v239 offset:2176
mvva 124,216,108
buffer_load_dwordx4 v242, s[20:23], s47 offen lds
mvva 128,192,96
s_add_u32 s47, s47, s60
tr 208,238,192
mvva 128,196,112
s_cmp_eq_u32 s47, s83
s_cselect_b32 s47, s76, s47
tr 210,238,448
mvva 136,196,116
tr 212,238,8640
mvva 136,192,100
mvva 144,192,104
tr 214,238,8896
mvva 144,196,120
tr 216,238,200
mvva 152,196,124
tr 218,238,456
mvva 152,192,108
mvva 132,200,96
s_waitcnt lgkmcnt(4)
tr 220,238,8648
mvva 132,204,112
tr 222,238,8904
mvva 140,204,116
mvva 140,200,100
v_add_u32 v238, s40, v234
mvva 148,200,104
s_add_u32 s40, s40, s42
s_cmp_eq_u32 s40, s43
s_cselect_b32 s40, 0, s40
mvva 148,204,120
mvva 156,204,124
mvva 156,200,108
s_waitcnt vmcnt(12) lgkmcnt(0)
s_barrier
mvva 160,208,96
s_add_u32 m0, s41, s50
s_add_u32 s41, s41, s42
tr 192,238,0
mvva 160,212,112
s_cmp_eq_u32 s41, s43
s_cselect_b32 s41, 0, s41
tr 194,238,256
mvva 168,212,116
tr 196,238,8448
mvva 168,208,100
buffer_load_dwordx4 v241, s[16:19], s46 offen lds
mvva 176,208,104
s_add_u32 s46, s46, s55
s_add_u32 m0, m0, s53
tr 198,238,8704
mvva 176,212,120
tr 200,238,8
mvva 184,212,124
tr 202,238,264
mvva 184,208,108
mvva 164,216,96
tr 204,238,8456
mvva 164,220,112
tr 206,238,8712
mvva 172,220,116
mvva 172,216,100
buffer_load_dwordx4 v241, s[16:19], s46 offen lds
mvva 180,216,104
s_add_u32 s46, s46, s56
s_add_u32 m0, m0, s54
mvva 180,220,120
mvva 188,220,124
mvva 188,216,108
s_waitcnt lgkmcnt(1)
mvva 64,192,128
tr 208,238,64
mvva 64,196,144
tr 210,238,320
mvva 72,196,148
tr 212,238,8512
mvva 72,192,132
buffer_load_dwordx4 v241, s[16:19], s46 offen lds
mvva 80,192,136
s_add_u32 s46, s46, s55
s_add_u32 m0, m0, s53
tr 214,238,8768
mvva 80,196,152
tr 216,238,72
mvva 88,196,156
tr 218,238,328
v_add_u32 v239, s40, v235
mvva 88,192,140
s_add_u32 s40, s40, s42
s_cmp_eq_u32 s40, s43
s_cselect_b32 s40, 0, s40
mvva 68,200,128
s_waitcnt lgkmcnt(4)
tr 220,238,8520
mvva 68,204,144
tr 222,238,8776
mvva 76,204,148
ds_read_b128 a[160:163], v239 offset:0
mvva 76,200,132
buffer_load_dwordx4 v241, s[16:19], s46 offen lds
mvva 84,200,136
s_add_u32 s46, s46, s57
ds_read_b128 a[176:179], v239 offset:64
mvva 84,204,152
s_cmp_eq_u32 s46, s82
s_cselect_b32 s46, s58, s46
ds_read_b128 a[164:167], v239 offset:2112
mvva 92,204,156
s_addk_i32 s46, 256
s_addk_i32 s82, 256
s_addk_i32 s58, 256
ds_read_b128 a[180:183], v239 offset:2176
mvva 92,200,140
s_add_u32 m0, s41, s50
s_add_u32 s41, s41, s42
mvva 96,208,128
s_waitcnt lgkmcnt(4)
tr 192,238,128
mvva 96,212,144
s_cmp_eq_u32 s41, s43
s_cselect_b32 s41, 0, s41
tr 194,238,384
mvva 104,212,148
tr 196,238,8576
mvva 104,208,132
buffer_load_dwordx4 v241, s[16:19], s46 offen lds
mvva 112,208,136
s_add_u32 s46, s46, s55
s_add_u32 m0, m0, s53
tr 198,238,8832
mvva 112,212,152
tr 200,238,136
mvva 120,212,156
tr 202,238,392
v_add_u32 v239, s40, v235
mvva 120,208,140
s_add_u32 s40, s40, s42
s_cmp_eq_u32 s40, s43
s_cselect_b32 s40, 0, s40
mvva 100,216,128
tr 204,238,8584
mvva 100,220,144
tr 206,238,8840
mvva 108,220,148
ds_read_b128 a[168:171], v239 offset:0
mvva 108,216,132
buffer_load_dwordx4 v241, s[16:19], s46 offen lds
mvva 116,216,136
s_add_u32 s46, s46, s56
s_add_u32 m0, m0, s54
ds_read_b128 a[184:187], v239 offset:64
mvva 116,220,152
ds_read_b128 a[172:175], v239 offset:2112
mvva 124,220,156
ds_read_b128 a[188:191], v239 offset:2176
mvva 124,216,140
s_waitcnt lgkmcnt(5)
mvva 128,192,128
tr 208,238,192
mvva 128,196,144
tr 210,238,448
mvva 136,196,148
tr 212,238,8640
mvva 136,192,132
buffer_load_dwordx4 v241, s[16:19], s46 offen lds
mvva 144,192,136
s_add_u32 s46, s46, s55
s_add_u32 m0, m0, s53
tr 214,238,8896
mvva 144,196,152
tr 216,238,200
mvva 152,196,156
tr 218,238,456
mvva 152,192,140
mvva 132,200,128
L_padA2:
s_cbranch_vccnz L_hopxA
s_waitcnt lgkmcnt(4)
tr 220,238,8648
mvva 132,204,144
tr 222,238,8904
mvva 140,204,148
mvva 140,200,132
buffer_load_dwordx4 v241, s[16:19], s46 offen lds
mvva 148,200,136
s_add_u32 s46, s46, s57
s_cmp_eq_u32 s46, s82
s_cselect_b32 s46, s58, s46
mvva 148,204,152
v_add_u32 v238, s40, v234
mvva 156,204,156
s_add_u32 s40, s40, s42
s_cmp_eq_u32 s40, s43
s_cselect_b32 s40, 0, s40
mvva 156,200,140
s_waitcnt vmcnt(8) lgkmcnt(0)
s_barrier
mvva 160,208,128
s_add_u32 m0, s41, s50
s_add_u32 s41, s41, s42
tr 192,238,0
mvva 160,212,144
s_cmp_eq_u32 s41, s43
s_cselect_b32 s41, 0, s41
tr 194,238,256
mvva 168,212,148
tr 196,238,8448
mvva 168,208,132
buffer_load_dwordx4 v241, s[16:19], s46 offen lds
mvva 176,208,136
s_add_u32 s46, s46, s55
s_add_u32 m0, m0, s53
tr 198,238,8704
mvva 176,212,152
tr 200,238,8
mvva 184,212,156
tr 202,238,264
mvva 184,208,140
mvva 164,216,128
tr 204,238,8456
mvva 164,220,144
tr 206,238,8712
mvva 172,220,148
mvva 172,216,132
buffer_load_dwordx4 v241, s[16:19], s46 offen lds
mvva 180,216,136
s_add_u32 s46, s46, s56
s_add_u32 m0, m0, s54
mvva 180,220,152
mvva 188,220,156
mvva 188,216,140
s_waitcnt lgkmcnt(6)
L_body:
mvva 64,192,160
s_waitcnt lgkmcnt(4)
tr 208,238,64
v_mul_f32 v231, v231, v252
v_mul_f32 v243, v243, v252
mvva 64,196,176
tr 210,238,320
v_mul_f32 v236, v236, v252
pk 56,248,249
mvva 72,196,180
tr 212,238,8512
pk 57,228,229
mvva 72,192,164
buffer_load_dwordx4 v241, s[16:19], s46 offen lds
pk 58,230,231
mvva 80,192,168
s_add_u32 s46, s46, s55
s_add_u32 m0, m0, s53
tr 214,238,8768
pk 59,243,236
mvva 80,196,184
tr 216,238,72
v_accvgpr_read_b32 v237, a204
mvva 88,196,188
tr 218,238,328
v_add_u32 v239, s40, v235
v_accvgpr_read_b32 v248, a205
mvva 88,192,172
s_waitcnt lgkmcnt(8)
s_add_u32 s40, s40, s42
v_accvgpr_read_b32 v249, a206
v_accvgpr_read_b32 v228, a207
mvva 68,200,160
s_waitcnt lgkmcnt(4)
tr 220,238,8520
v_accvgpr_read_b32 v229, a220
mvva 68,204,176
s_cmp_eq_u32 s40, s43
s_cselect_b32 s40, 0, s40
tr 222,238,8776
v_accvgpr_read_b32 v230, a221
mvva 76,204,180
ds_read_b128 a[192:195], v239 offset:0
v_accvgpr_read_b32 v231, a222
v_accvgpr_read_b32 v243, a223
mvva 76,200,164
buffer_load_dwordx4 v241, s[16:19], s46 offen lds
v_mul_f32 v237, v237, v253
mvva 84,200,168
s_add_u32 s46, s46, s57
ds_read_b128 a[208:211], v239 offset:64
v_mul_f32 v248, v248, v253
mvva 84,204,184
s_cmp_eq_u32 s46, s82
s_cselect_b32 s46, s58, s46
ds_read_b128 a[196:199], v239 offset:2112
v_mul_f32 v249, v249, v253
mvva 92,204,188
s_add_u32 m0, s41, s50
s_add_u32 s41, s41, s42
ds_read_b128 a[212:215], v239 offset:2176
v_mul_f32 v228, v228, v253
mvva 92,200,172
buffer_store_dwordx4 v[28:31], v240, s[24:27], s98 offen offset:3072 nt
mvva 96,208,160
s_waitcnt lgkmcnt(4)
s_add_u32 s48, s48, s72
tr 192,238,128
v_mul_f32 v229, v229, v253
mvva 96,212,176
s_cmp_eq_u32 s41, s43
s_cselect_b32 s41, 0, s41
tr 194,238,384
v_mul_f32 v230, v230, v253
mvva 104,212,180
tr 196,238,8576
v_mul_f32 v231, v231, v253
mvva 104,208,164
buffer_load_dwordx4 v241, s[16:19], s46 offen lds
v_mul_f32 v243, v243, v253
mvva 112,208,168
s_add_u32 s46, s46, s55
s_add_u32 m0, m0, s53
tr 198,238,8832
pk 60,237,248
mvva 112,212,184
tr 200,238,136
pk 61,249,228
pk 62,229,230
mvva 120,212,188
tr 202,238,392
v_add_u32 v239, s40, v235
mvva 120,208,172
s_add_u32 s40, s40, s42
s_cmp_eq_u32 s40, s43
s_cselect_b32 s40, 0, s40
pk 63,231,243
mvva 100,216,160
tr 204,238,8584
mvva 100,220,176
tr 206,238,8840
mvva 108,220,180
ds_read_b128 a[200:203], v239 offset:0
mvva 108,216,164
buffer_load_dwordx4 v241, s[16:19], s46 offen lds
mvva 116,216,168
s_add_u32 s46, s46, s56
s_add_u32 m0, m0, s54
ds_read_b128 a[216:219], v239 offset:64
mvva 116,220,184
ds_read_b128 a[204:207], v239 offset:2112
mvva 124,220,188
s_waitcnt lgkmcnt(4)
ds_read_b128 a[220:223], v239 offset:2176
mvva 124,216,172
buffer_store_dwordx4 v[32:35], v240, s[24:27], s48 offen nt
mvva 128,192,160
tr 208,238,192
mvva 128,196,176
tr 210,238,448
mvva 136,196,180
tr 212,238,8640
mvva 136,192,164
buffer_load_dwordx4 v241, s[16:19], s46 offen lds
mvva 144,192,168
s_add_u32 s46, s46, s55
s_add_u32 m0, m0, s53
tr 214,238,8896
mvva 144,196,184
tr 216,238,200
mvva 152,196,188
tr 218,238,456
mvva 152,192,172
mvva 132,200,160
s_waitcnt lgkmcnt(4)
tr 220,238,8648
mvva 132,204,176
tr 222,238,8904
mvva 140,204,180
mvva 140,200,164
buffer_load_dwordx4 v241, s[16:19], s46 offen lds
mvva 148,200,168
s_add_u32 s46, s46, s57
s_cmp_eq_u32 s46, s82
s_cselect_b32 s46, s58, s46
mvva 148,204,184
v_add_u32 v238, s40, v234
mvva 156,204,188
s_add_u32 s40, s40, s42
s_cmp_eq_u32 s40, s43
s_cselect_b32 s40, 0, s40
mvva 156,200,172
s_waitcnt vmcnt(14) lgkmcnt(0)
s_barrier
mvva 160,208,160
s_add_u32 m0, s41, s50
s_add_u32 s41, s41, s42
tr 192,238,0
mvva 160,212,176
s_cmp_eq_u32 s41, s43
s_cselect_b32 s41, 0, s41
tr 194,238,256
mvva 168,212,180
tr 196,238,8448
mvva 168,208,164
buffer_load_dwordx4 v241, s[16:19], s46 offen lds
mvva 176,208,168
s_add_u32 s46, s46, s55
s_add_u32 m0, m0, s53
tr 198,238,8704
mvva 176,212,184
tr 200,238,8
mvva 184,212,188
tr 202,238,264
mvva 184,208,172
buffer_store_dwordx4 v[36:39], v240, s[24:27], s48 offen offset:1024 nt
mvva 164,216,160
tr 204,238,8456
mvva 164,220,176
tr 206,238,8712
mvva 172,220,180
mvva 172,216,164
buffer_load_dwordx4 v241, s[16:19], s46 offen lds
mvva 180,216,168
s_add_u32 s46, s46, s56
s_add_u32 m0, m0, s54
mvva 180,220,184
mvva 188,220,188
mvva 188,216,172
s_waitcnt lgkmcnt(1)
mvva 64,192,192
tr 208,238,64
mvva 64,196,208
tr 210,238,320
mvva 72,196,212
tr 212,238,8512
mvva 72,192,196
buffer_load_dwordx4 v241, s[16:19], s46 offen lds
mvva 80,192,200
s_add_u32 s46, s46, s55
s_add_u32 m0, m0, s53
tr 214,238,8768
mvva 80,196,216
tr 216,238,72
mvva 88,196,220
tr 218,238,328
mvva 88,192,204
mvva 68,200,192
s_waitcnt lgkmcnt(4)
tr 220,238,8520
mvva 68,204,208
tr 222,238,8776
mvva 76,204,212
mvva 76,200,196
buffer_load_dwordx4 v241, s[16:19], s46 offen lds
mvva 84,200,200
s_add_u32 s46, s46, s57
s_cmp_eq_u32 s46, s82
s_cselect_b32 s46, s58, s46
mvva 84,204,216
s_add_u32 m0, s41, s50
s_add_u32 s41, s41, s42
pk 0,64,65
mvva 92,204,220
s_cmp_eq_u32 s41, s43
s_cselect_b32 s41, 0, s41
pk 1,66,67
mvva 92,200,204
buffer_store_dwordx4 v[40:43], v240, s[24:27], s48 offen offset:2048 sc1
mvva 96,208,192
s_waitcnt lgkmcnt(0)
s_or_b32 s98, s48, s93
tr 192,238,128
mvva 96,212,208
tr 194,238,384
pk 2,68,69
mvva 104,212,212
tr 196,238,8576
pk 3,70,71
mvva 104,208,196
buffer_load_dwordx4 v241, s[16:19], s46 offen lds
mvva 112,208,200
s_add_u32 s46, s46, s55
s_add_u32 m0, m0, s53
tr 198,238,8832
mvva 112,212,216
tr 200,238,136
pk 4,72,73
mvva 120,212,220
tr 202,238,392
pk 5,74,75
mvva 120,208,204
pk 6,76,77
pk 7,78,79
mvva 100,216,192
tr 204,238,8584
pk 8,80,81
mvva 100,220,208
tr 206,238,8840
pk 9,82,83
mvva 108,220,212
pk 10,84,85
pk 11,86,87
mvva 108,216,196
buffer_load_dwordx4 v241, s[16:19], s46 offen lds
mvva 116,216,200
s_add_u32 s46, s46, s56
s_add_u32 m0, m0, s54
pk 12,88,89
mvva 116,220,216
pk 13,90,91
pk 14,92,93
mvva 124,220,220
s_waitcnt lgkmcnt(1)
pk 15,94,95
pk 16,96,97
mvva 124,216,204
buffer_store_dwordx4 v[44:47], v240, s[24:27], s98 offen offset:3072 sc1
mvva 128,192,192
s_add_u32 s48, s48, s72
tr 208,238,192
pk 17,98,99
mvva 128,196,208
tr 210,238,448
pk 18,100,101
mvva 136,196,212
tr 212,238,8640
pk 19,102,103
mvva 136,192,196
buffer_load_dwordx4 v241, s[16:19], s46 offen lds
mvva 144,192,200
s_add_u32 s46, s46, s55
s_add_u32 m0, m0, s53
tr 214,238,8896
mvva 144,196,216
tr 216,238,200
pk 20,104,105
mvva 152,196,220
tr 218,238,456
pk 21,106,107
mvva 152,192,204
pk 22,108,109
pk 23,110,111
mvva 132,200,192
s_waitcnt lgkmcnt(4)
tr 220,238,8648
pk 24,112,113
mvva 132,204,208
tr 222,238,8904
pk 25,114,115
mvva 140,204,212
pk 26,116,117
pk 27,118,119
mvva 140,200,196
buffer_load_dwordx4 v241, s[16:19], s46 offen lds
mvva 148,200,200
s_add_u32 s46, s46, s57
s_cmp_eq_u32 s46, s82
s_cselect_b32 s46, s58, s46
mvva 148,204,216
v_add_u32 v238, s40, v234
pk 28,120,121
mvva 156,204,220
s_add_u32 s40, s40, s42
s_cmp_eq_u32 s40, s43
s_cselect_b32 s40, 0, s40
mvva 156,200,204
s_waitcnt vmcnt(21) lgkmcnt(0)
s_barrier
pk 29,122,123
mvva 160,208,192
s_add_u32 m0, s41, s50
s_add_u32 s41, s41, s42
tr 192,238,0
mvva 160,212,208
s_cmp_eq_u32 s41, s43
s_cselect_b32 s41, 0, s41
tr 194,238,256
mvva 168,212,212
tr 196,238,8448
pk 30,124,125
mvva 168,208,196
buffer_load_dwordx4 v241, s[16:19], s46 offen lds
mvva 176,208,200
s_add_u32 s46, s46, s55
s_add_u32 m0, m0, s53
tr 198,238,8704
mvva 176,212,216
tr 200,238,8
pk 31,126,127
mvva 184,212,220
tr 202,238,264
pk 32,128,129
mvva 184,208,204
buffer_store_dwordx4 v[48:51], v240, s[24:27], s48 offen sc1
mvva 164,216,192
tr 204,238,8456
pk 33,130,131
mvva 164,220,208
tr 206,238,8712
pk 34,132,133
mvva 172,220,212
pk 35,134,135
pk 36,136,137
mvva 172,216,196
buffer_load_dwordx4 v241, s[16:19], s46 offen lds
mvva 180,216,200
s_add_u32 s46, s46, s56
s_add_u32 m0, m0, s54
pk 37,138,139
mvva 180,220,216
pk 38,140,141
pk 39,142,143
mvva 188,220,220
pk 40,144,145
pk 41,146,147
mvva 188,216,204
s_waitcnt lgkmcnt(1)
pk 42,148,149
pk 43,150,151
mvvaz 64,192,0
tr 208,238,64
pk 44,152,153
mvva 64,196,16
tr 210,238,320
pk 45,154,155
mvvaz 72,196,20
tr 212,238,8512
pk 46,156,157
mvva 72,192,4
buffer_load_dwordx4 v241, s[16:19], s46 offen lds
mvvaz 80,192,8
s_add_u32 s46, s46, s55
s_add_u32 m0, m0, s53
tr 214,238,8768
mvva 80,196,24
tr 216,238,72
pk 47,158,159
mvvaz 88,196,28
tr 218,238,328
mvva 88,192,12
buffer_store_dwordx4 v[52:55], v240, s[24:27], s48 offen offset:1024 sc1
mvvaz 68,200,0
s_waitcnt lgkmcnt(4)
tr 220,238,8520
mvva 68,204,16
tr 222,238,8776
mvvaz 76,204,20
mvva 76,200,4
buffer_load_dwordx4 v241, s[16:19], s46 offen lds
mvvaz 84,200,8
s_add_u32 s46, s46, s57
s_cmp_eq_u32 s46, s82
s_cselect_b32 s46, s58, s46
mvva 84,204,24
s_add_u32 m0, s41, s50
s_add_u32 s41, s41, s42
mvvaz 92,204,28
s_cmp_eq_u32 s41, s43
s_cselect_b32 s41, 0, s41
mvva 92,200,12
buffer_store_dwordx4 v[56:59], v240, s[24:27], s48 offen offset:2048 sc1
mvvaz 96,208,0
s_waitcnt lgkmcnt(0)
s_or_b32 s98, s48, s93
tr 192,238,128
mvva 96,212,16
tr 194,238,384
mvvaz 104,212,20
tr 196,238,8576
mvva 104,208,4
buffer_load_dwordx4 v241, s[16:19], s46 offen lds
mvvaz 112,208,8
s_add_u32 s46, s46, s55
s_add_u32 m0, m0, s53
tr 198,238,8832
mvva 112,212,24
tr 200,238,136
mvvaz 120,212,28
tr 202,238,392
mvva 120,208,12
mvvaz 100,216,0
tr 204,238,8584
mvva 100,220,16
tr 206,238,8840
mvvaz 108,220,20
mvva 108,216,4
buffer_load_dwordx4 v241, s[16:19], s46 offen lds
buffer_store_dwordx4 v[60:63], v240, s[24:27], s98 offen offset:3072 sc1
mvvaz 116,216,8
s_add_u32 s46, s46, s56
s_add_u32 m0, m0, s54
s_add_u32 s48, s48, s72
mvva 116,220,24
pk 48,160,161
pk 49,162,163
mvvaz 124,220,28
pk 50,164,165
pk 51,166,167
mvva 124,216,12
s_waitcnt lgkmcnt(1)
pk 52,168,169
pk 53,170,171
mvvaz 128,192,0
tr 208,238,192
pk 54,172,173
mvva 128,196,16
tr 210,238,448
pk 55,174,175
mvvaz 136,196,20
tr 212,238,8640
pk 56,176,177
mvva 136,192,4
buffer_load_dwordx4 v241, s[16:19], s46 offen lds
mvvaz 144,192,8
s_add_u32 s46, s46, s55
s_add_u32 m0, m0, s53
tr 214,238,8896
mvva 144,196,24
tr 216,238,200
pk 57,178,179
mvvaz 152,196,28
tr 218,238,456
pk 58,180,181
mvva 152,192,12
pk 59,182,183
pk 60,184,185
mvvaz 132,200,0
s_waitcnt lgkmcnt(4)
tr 220,238,8648
pk 61,186,187
mvva 132,204,16
tr 222,238,8904
pk 62,188,189
mvvaz 140,204,20
pk 63,190,191
mvva 140,200,4
buffer_load_dwordx4 v241, s[16:19], s46 offen lds
mvvaz 148,200,8
s_add_u32 s46, s46, s57
s_cmp_eq_u32 s46, s82
s_cselect_b32 s46, s58, s46
mvva 148,204,24
v_add_u32 v238, s40, v234
mvvaz 156,204,28
s_add_u32 s40, s40, s42
s_cmp_eq_u32 s40, s43
s_cselect_b32 s40, 0, s40
mvva 156,200,12
s_waitcnt vmcnt(29) lgkmcnt(0)
s_barrier
mvvaz 160,208,0
s_add_u32 m0, s41, s49
s_add_u32 s41, s41, s42
tr 192,238,0
mvva 160,212,16
s_cmp_eq_u32 s41, s43
s_cselect_b32 s41, 0, s41
tr 194,238,256
mvvaz 168,212,20
tr 196,238,8448
mvva 168,208,4
buffer_load_dwordx4 v240, s[8:11], s44 offen nt lds
mvvaz 176,208,8
s_add_u32 m0, m0, 32
tr 198,238,8704
mvva 176,212,24
tr 200,238,8
mvvaz 184,212,28
tr 202,238,264
mvva 184,208,12
mvvaz 164,216,0
tr 204,238,8456
mvva 164,220,16
L_padB0:
s_cbranch_vccnz L_hop_body
tr 206,238,8712
mvvaz 172,220,20
mvva 172,216,4
buffer_load_dwordx4 v240, s[8:11], s44 offen offset:1024 nt lds
mvvaz 180,216,8
s_add_u32 m0, m0, 32
mvva 180,220,24
mvvaz 188,220,28
mvva 188,216,12
s_waitcnt lgkmcnt(1)
mvva 64,192,32
tr 208,238,64
mvva 64,196,48
tr 210,238,320
mvva 72,196,52
tr 212,238,8512
mvva 72,192,36
buffer_load_dwordx4 v240, s[8:11], s44 offen offset:2048 nt lds
mvva 80,192,40
s_add_u32 m0, m0, 32
tr 214,238,8768
v_accvgpr_read_b32 v236, a224
mvva 80,196,56
tr 216,238,72
v_accvgpr_read_b32 v237, a225
mvva 88,196,60
tr 218,238,328
v_accvgpr_read_b32 v248, a226
mvva 88,192,44
v_accvgpr_read_b32 v249, a227
v_accvgpr_read_b32 v228, a240
mvva 68,200,32
s_waitcnt lgkmcnt(4)
tr 220,238,8520
v_accvgpr_read_b32 v229, a241
mvva 68,204,48
tr 222,238,8776
v_accvgpr_read_b32 v230, a242
mvva 76,204,52
v_accvgpr_read_b32 v231, a243
v_mul_f32 v236, v236, v250
mvva 76,200,36
buffer_load_dwordx4 v240, s[8:11], s44 offen offset:3072 nt lds
mvva 84,200,40
s_add_u32 s44, s44, s52
v_mul_f32 v237, v237, v250
v_mul_f32 v248, v248, v250
mvva 84,204,56
v_mul_f32 v249, v249, v250
v_mul_f32 v228, v228, v250
mvva 92,204,60
v_mul_f32 v229, v229, v250
v_mul_f32 v230, v230, v250
mvva 92,200,44
v_mul_f32 v231, v231, v250
pk 224,236,237
mvva 96,208,32
s_waitcnt lgkmcnt(0)
tr 192,238,128
pk 225,248,249
mvva 96,212,48
tr 194,238,384
pk 226,228,229
mvva 104,212,52
tr 196,238,8576
pk 227,230,231
mvva 104,208,36
mvva 112,208,40
tr 198,238,8832
mvva 112,212,56
tr 200,238,136
mvva 120,212,60
tr 202,238,392
mvva 120,208,44
buffer_store_dwordx4 v[224:227], v240, s[24:27], s48 offen sc1
mvva 100,216,32
tr 204,238,8584
mvva 100,220,48
tr 206,238,8840
v_accvgpr_read_b32 v243, a228
mvva 108,220,52
v_accvgpr_read_b32 v236, a229
v_accvgpr_read_b32 v237, a230
mvva 108,216,36
v_accvgpr_read_b32 v248, a231
v_accvgpr_read_b32 v249, a244
mvva 116,216,40
v_accvgpr_read_b32 v228, a245
v_accvgpr_read_b32 v229, a246
mvva 116,220,56
v_accvgpr_read_b32 v230, a247
v_mul_f32 v243, v243, v251
mvva 124,220,60
v_mul_f32 v236, v236, v251
v_mul_f32 v237, v237, v251
mvva 124,216,44
s_waitcnt lgkmcnt(1)
v_mul_f32 v248, v248, v251
v_mul_f32 v249, v249, v251
mvva 128,192,32
tr 208,238,192
v_mul_f32 v228, v228, v251
mvva 128,196,48
tr 210,238,448
v_mul_f32 v229, v229, v251
mvva 136,196,52
tr 212,238,8640
v_mul_f32 v230, v230, v251
mvva 136,192,36
pk 244,243,236
pk 245,237,248
mvva 144,192,40
tr 214,238,8896
pk 246,249,228
mvva 144,196,56
tr 216,238,200
pk 247,229,230
mvva 152,196,60
tr 218,238,456
mvva 152,192,44
mvva 132,200,32
s_waitcnt lgkmcnt(4)
tr 220,238,8648
mvva 132,204,48
tr 222,238,8904
mvva 140,204,52
mvva 140,200,36
v_add_u32 v238, s40, v234
mvva 148,200,40
s_add_u32 s40, s40, s42
s_cmp_eq_u32 s40, s43
s_cselect_b32 s40, 0, s40
mvva 148,204,56
buffer_store_dwordx4 v[244:247], v240, s[24:27], s48 offen offset:1024 sc1
mvva 156,204,60
mvva 156,200,44
s_waitcnt vmcnt(29) lgkmcnt(0)
s_barrier
mvva 160,208,32
s_add_u32 m0, s41, s49
s_add_u32 s41, s41, s42
tr 192,238,0
mvva 160,212,48
s_cmp_eq_u32 s41, s43
s_cselect_b32 s41, 0, s41
tr 194,238,256
mvva 168,212,52
tr 196,238,8448
mvva 168,208,36
buffer_load_dwordx4 v240, s[8:11], s44 offen nt lds
mvva 176,208,40
s_add_u32 m0, m0, 32
tr 198,238,8704
mvva 176,212,56
tr 200,238,8
mvva 184,212,60
tr 202,238,264
mvva 184,208,44
mvva 164,216,32
tr 204,238,8456
mvva 164,220,48
tr 206,238,8712
mvva 172,220,52
mvva 172,216,36
buffer_load_dwordx4 v240, s[8:11], s44 offen offset:1024 nt lds
mvva 180,216,40
s_add_u32 m0, m0, 32
mvva 180,220,56
mvva 188,220,60
mvva 188,216,44
s_waitcnt lgkmcnt(1)
mvva 64,192,64
tr 208,238,64
mvva 64,196,80
tr 210,238,320
mvva 72,196,84
tr 212,238,8512
mvva 72,192,68
buffer_load_dwordx4 v240, s[8:11], s44 offen offset:2048 nt lds
mvva 80,192,72
s_add_u32 m0, m0, 32
tr 214,238,8768
v_accvgpr_read_b32 v231, a232
mvva 80,196,88
tr 216,238,72
v_accvgpr_read_b32 v243, a233
mvva 88,196,92
tr 218,238,328
v_accvgpr_read_b32 v236, a234
mvva 88,192,76
v_accvgpr_read_b32 v237, a235
v_accvgpr_read_b32 v248, a248
mvva 68,200,64
s_waitcnt lgkmcnt(4)
tr 220,238,8520
v_accvgpr_read_b32 v249, a249
mvva 68,204,80
tr 222,238,8776
v_accvgpr_read_b32 v228, a250
mvva 76,204,84
v_accvgpr_read_b32 v229, a251
v_mul_f32 v231, v231, v252
mvva 76,200,68
buffer_load_dwordx4 v240, s[8:11], s44 offen offset:3072 nt lds
mvva 84,200,72
s_add_u32 s44, s44, s52
v_mul_f32 v243, v243, v252
v_mul_f32 v236, v236, v252
mvva 84,204,88
v_mul_f32 v237, v237, v252
v_mul_f32 v248, v248, v252
mvva 92,204,92
v_mul_f32 v249, v249, v252
v_mul_f32 v228, v228, v252
mvva 92,200,76
v_mul_f32 v229, v229, v252
pk 224,231,243
mvva 96,208,64
s_waitcnt lgkmcnt(0)
tr 192,238,128
pk 225,236,237
mvva 96,212,80
tr 194,238,384
pk 226,248,249
mvva 104,212,84
tr 196,238,8576
pk 227,228,229
mvva 104,208,68
mvva 112,208,72
tr 198,238,8832
mvva 112,212,88
tr 200,238,136
mvva 120,212,92
tr 202,238,392
mvva 120,208,76
buffer_store_dwordx4 v[224:227], v240, s[24:27], s48 offen offset:2048 sc1
mvva 100,216,64
s_or_b32 s98, s48, s93
tr 204,238,8584
mvva 100,220,80
tr 206,238,8840
v_accvgpr_read_b32 v230, a236
mvva 108,220,84
v_accvgpr_read_b32 v231, a237
v_accvgpr_read_b32 v243, a238
mvva 108,216,68
v_accvgpr_read_b32 v236, a239
v_accvgpr_read_b32 v237, a252
mvva 116,216,72
v_accvgpr_read_b32 v248, a253
v_accvgpr_read_b32 v249, a254
mvva 116,220,88
v_accvgpr_read_b32 v228, a255
v_mul_f32 v230, v230, v253
mvva 124,220,92
v_mul_f32 v231, v231, v253
v_mul_f32 v243, v243, v253
mvva 124,216,76
s_waitcnt lgkmcnt(1)
v_mul_f32 v236, v236, v253
v_mul_f32 v237, v237, v253
mvva 128,192,64
tr 208,238,192
v_mul_f32 v248, v248, v253
mvva 128,196,80
tr 210,238,448
v_mul_f32 v249, v249, v253
mvva 136,196,84
tr 212,238,8640
v_mul_f32 v228, v228, v253
mvva 136,192,68
pk 244,230,231
pk 245,243,236
mvva 144,192,72
tr 214,238,8896
pk 246,237,248
mvva 144,196,88
tr 216,238,200
pk 247,249,228
mvva 152,196,92
tr 218,238,456
mvva 152,192,76
mvva 132,200,64
s_waitcnt lgkmcnt(4)
tr 220,238,8648
mvva 132,204,80
tr 222,238,8904
mvva 140,204,84
mvva 140,200,68
v_add_u32 v238, s40, v234
mvva 148,200,72
s_add_u32 s40, s40, s42
s_cmp_eq_u32 s40, s43
s_cselect_b32 s40, 0, s40
mvva 148,204,88
buffer_store_dwordx4 v[244:247], v240, s[24:27], s98 offen offset:3072 sc1
mvva 156,204,92
s_add_u32 s48, s48, s72
mvva 156,200,76
s_waitcnt vmcnt(30) lgkmcnt(0)
s_barrier
mvva 160,208,64
s_add_u32 m0, s41, s49
s_add_u32 s41, s41, s42
tr 192,238,0
mvva 160,212,80
s_cmp_eq_u32 s41, s43
s_cselect_b32 s41, 0, s41
tr 194,238,256
mvva 168,212,84
tr 196,238,8448
mvva 168,208,68
buffer_load_dwordx4 v240, s[12:15], s45 offen nt lds
mvva 176,208,72
s_add_u32 m0, m0, 32
tr 198,238,8704
mvva 176,212,88
tr 200,238,8
mvva 184,212,92
tr 202,238,264
mvva 184,208,76
mvva 164,216,64
tr 204,238,8456
mvva 164,220,80
tr 206,238,8712
mvva 172,220,84
mvva 172,216,68
buffer_load_dwordx4 v240, s[12:15], s45 offen offset:1024 nt lds
mvva 180,216,72
s_add_u32 m0, m0, 32
mvva 180,220,88
mvva 188,220,92
mvva 188,216,76
s_waitcnt lgkmcnt(1)
mvva 64,192,96
tr 208,238,64
mvva 64,196,112
tr 210,238,320
mvva 72,196,116
tr 212,238,8512
mvva 72,192,100
buffer_load_dwordx4 v240, s[12:15], s45 offen offset:2048 nt lds
mvva 80,192,104
s_add_u32 m0, m0, 32
tr 214,238,8768
mvva 80,196,120
tr 216,238,72
mvva 88,196,124
tr 218,238,328
mvva 88,192,108
mvva 68,200,96
s_waitcnt lgkmcnt(4)
tr 220,238,8520
mvva 68,204,112
tr 222,238,8776
mvva 76,204,116
mvva 76,200,100
buffer_load_dwordx4 v240, s[12:15], s45 offen offset:3072 nt lds
mvva 84,200,104
s_add_u32 s45, s45, s52
mvva 84,204,120
mvva 92,204,124
mvva 92,200,108
mvva 96,208,96
s_waitcnt lgkmcnt(0)
tr 192,238,128
mvva 96,212,112
tr 194,238,384
mvva 104,212,116
tr 196,238,8576
mvva 104,208,100
mvva 112,208,104
tr 198,238,8832
mvva 112,212,120
tr 200,238,136
mvva 120,212,124
tr 202,238,392
mvva 120,208,108
mvva 100,216,96
tr 204,238,8584
mvva 100,220,112
tr 206,238,8840
mvva 108,220,116
mvva 108,216,100
mvva 116,216,104
mvva 116,220,120
mvva 124,220,124
mvva 124,216,108
s_waitcnt lgkmcnt(1)
mvva 128,192,96
tr 208,238,192
mvva 128,196,112
tr 210,238,448
mvva 136,196,116
tr 212,238,8640
mvva 136,192,100
mvva 144,192,104
tr 214,238,8896
mvva 144,196,120
tr 216,238,200
mvva 152,196,124
tr 218,238,456
mvva 152,192,108
mvva 132,200,96
s_waitcnt lgkmcnt(4)
tr 220,238,8648
mvva 132,204,112
tr 222,238,8904
mvva 140,204,116
mvva 140,200,100
v_add_u32 v238, s40, v234
mvva 148,200,104
s_add_u32 s40, s40, s42
s_cmp_eq_u32 s40, s43
s_cselect_b32 s40, 0, s40
mvva 148,204,120
mvva 156,204,124
mvva 156,200,108
s_waitcnt vmcnt(28) lgkmcnt(0)
s_barrier
mvva 160,208,96
s_add_u32 m0, s41, s49
s_add_u32 s41, s41, s42
tr 192,238,0
mvva 160,212,112
s_cmp_eq_u32 s41, s43
s_cselect_b32 s41, 0, s41
tr 194,238,256
mvva 168,212,116
tr 196,238,8448
mvva 168,208,100
buffer_load_dwordx4 v240, s[8:11], s44 offen nt lds
mvva 176,208,104
s_add_u32 m0, m0, 32
tr 198,238,8704
mvva 176,212,120
tr 200,238,8
mvva 184,212,124
tr 202,238,264
mvva 184,208,108
mvva 164,216,96
tr 204,238,8456
mvva 164,220,112
tr 206,238,8712
mvva 172,220,116
mvva 172,216,100
buffer_load_dwordx4 v240, s[8:11], s44 offen offset:1024 nt lds
mvva 180,216,104
s_add_u32 m0, m0, 32
mvva 180,220,120
mvva 188,220,124
mvva 188,216,108
s_waitcnt lgkmcnt(1)
mvva 64,192,128
tr 208,238,64
mvva 64,196,144
tr 210,238,320
mvva 72,196,148
tr 212,238,8512
mvva 72,192,132
buffer_load_dwordx4 v240, s[8:11], s44 offen offset:2048 nt lds
mvva 80,192,136
s_add_u32 m0, m0, 32
tr 214,238,8768
mvva 80,196,152
tr 216,238,72
mvva 88,196,156
tr 218,238,328
mvva 88,192,140
mvva 68,200,128
s_waitcnt lgkmcnt(4)
tr 220,238,8520
mvva 68,204,144
tr 222,238,8776
mvva 76,204,148
mvva 76,200,132
buffer_load_dwordx4 v240, s[8:11], s44 offen offset:3072 nt lds
mvva 84,200,136
s_add_u32 s44, s44, s52
mvva 84,204,152
mvva 92,204,156
mvva 92,200,140
mvva 96,208,128
s_waitcnt lgkmcnt(0)
tr 192,238,128
mvva 96,212,144
tr 194,238,384
mvva 104,212,148
tr 196,238,8576
mvva 104,208,132
mvva 112,208,136
tr 198,238,8832
mvva 112,212,152
tr 200,238,136
mvva 120,212,156
tr 202,238,392
mvva 120,208,140
mvva 100,216,128
tr 204,238,8584
mvva 100,220,144
tr 206,238,8840
mvva 108,220,148
mvva 108,216,132
mvva 116,216,136
mvva 116,220,152
mvva 124,220,156
mvva 124,216,140
s_waitcnt lgkmcnt(1)
mvva 128,192,128
tr 208,238,192
mvva 128,196,144
tr 210,238,448
mvva 136,196,148
tr 212,238,8640
mvva 136,192,132
mvva 144,192,136
tr 214,238,8896
mvva 144,196,152
tr 216,238,200
mvva 152,196,156
tr 218,238,456
mvva 152,192,140
mvva 132,200,128
s_waitcnt lgkmcnt(4)
tr 220,238,8648
mvva 132,204,144
tr 222,238,8904
mvva 140,204,148
mvva 140,200,132
v_add_u32 v238, s40, v234
mvva 148,200,136
s_add_u32 s40, s40, s42
s_cmp_eq_u32 s40, s43
s_cselect_b32 s40, 0, s40
mvva 148,204,152
mvva 156,204,156
mvva 156,200,140
s_waitcnt vmcnt(26) lgkmcnt(0)
s_barrier
mvva 160,208,128
s_add_u32 m0, s41, s49
s_add_u32 s41, s41, s42
tr 192,238,0
mvva 160,212,144
s_cmp_eq_u32 s41, s43
s_cselect_b32 s41, 0, s41
tr 194,238,256
mvva 168,212,148
tr 196,238,8448
mvva 168,208,132
buffer_load_dwordx4 v240, s[12:15], s45 offen nt lds
mvva 176,208,136
s_add_u32 m0, m0, 32
tr 198,238,8704
mvva 176,212,152
tr 200,238,8
mvva 184,212,156
tr 202,238,264
mvva 184,208,140
mvva 164,216,128
tr 204,238,8456
mvva 164,220,144
tr 206,238,8712
mvva 172,220,148
mvva 172,216,132
L_padB1:
s_cbranch_vccnz L_hop_body
buffer_load_dwordx4 v240, s[12:15], s45 offen offset:1024 nt lds
mvva 180,216,136
s_add_u32 m0, m0, 32
mvva 180,220,152
mvva 188,220,156
mvva 188,216,140
s_waitcnt lgkmcnt(1)
mvva 64,192,160
tr 208,238,64
mvva 64,196,176
tr 210,238,320
mvva 72,196,180
tr 212,238,8512
mvva 72,192,164
buffer_load_dwordx4 v240, s[12:15], s45 offen offset:2048 nt lds
mvva 80,192,168
s_add_u32 m0, m0, 32
tr 214,238,8768
mvva 80,196,184
tr 216,238,72
mvva 88,196,188
tr 218,238,328
mvva 88,192,172
mvva 68,200,160
s_waitcnt lgkmcnt(4)
tr 220,238,8520
mvva 68,204,176
tr 222,238,8776
mvva 76,204,180
mvva 76,200,164
buffer_load_dwordx4 v240, s[12:15], s45 offen offset:3072 nt lds
mvva 84,200,168
s_add_u32 s45, s45, s52
mvva 84,204,184
mvva 92,204,188
mvva 92,200,172
mvva 96,208,160
s_waitcnt lgkmcnt(0)
tr 192,238,128
mvva 96,212,176
tr 194,238,384
mvva 104,212,180
tr 196,238,8576
mvva 104,208,164
mvva 112,208,168
tr 198,238,8832
mvva 112,212,184
tr 200,238,136
mvva 120,212,188
tr 202,238,392
mvva 120,208,172
mvva 100,216,160
tr 204,238,8584
mvva 100,220,176
tr 206,238,8840
mvva 108,220,180
mvva 108,216,164
mvva 116,216,168
mvva 116,220,184
mvva 124,220,188
mvva 124,216,172
s_waitcnt lgkmcnt(1)
mvva 128,192,160
s_mov_b32 m0, s73
tr 208,238,192
v_lshlrev_b32 v244, 2, v240
mvva 128,196,176
tr 210,238,448
mvva 136,196,180
tr 212,238,8640
mvva 136,192,164
buffer_load_dword v244, s[84:87], s88 offen lds
mvva 144,192,168
tr 214,238,8896
mvva 144,196,184
tr 216,238,200
mvva 152,196,188
tr 218,238,456
mvva 152,192,172
mvva 132,200,160
s_waitcnt lgkmcnt(4)
tr 220,238,8648
mvva 132,204,176
tr 222,238,8904
mvva 140,204,180
mvva 140,200,164
v_add_u32 v238, s40, v234
mvva 148,200,168
s_add_u32 s40, s40, s42
s_cmp_eq_u32 s40, s43
s_cselect_b32 s40, 0, s40
mvva 148,204,184
mvva 156,204,188
mvva 156,200,172
s_waitcnt vmcnt(25) lgkmcnt(0)
s_barrier
mvva 160,208,160
s_add_u32 m0, s41, s49
s_add_u32 s41, s41, s42
tr 192,238,0
mvva 160,212,176
s_cmp_eq_u32 s41, s43
s_cselect_b32 s41, 0, s41
tr 194,238,256
mvva 168,212,180
tr 196,238,8448
mvva 168,208,164
buffer_load_dwordx4 v240, s[8:11], s44 offen nt lds
mvva 176,208,168
s_add_u32 m0, m0, 32
tr 198,238,8704
mvva 176,212,184
tr 200,238,8
mvva 184,212,188
tr 202,238,264
mvva 184,208,172
mvva 164,216,160
tr 204,238,8456
mvva 164,220,176
tr 206,238,8712
mvva 172,220,180
mvva 172,216,164
buffer_load_dwordx4 v240, s[8:11], s44 offen offset:1024 nt lds
mvva 180,216,168
s_add_u32 m0, m0, 32
mvva 180,220,184
mvva 188,220,188
mvva 188,216,172
s_waitcnt lgkmcnt(1)
mvva 64,192,192
tr 208,238,64
mvva 64,196,208
tr 210,238,320
mvva 72,196,212
tr 212,238,8512
mvva 72,192,196
buffer_load_dwordx4 v240, s[8:11], s44 offen offset:2048 nt lds
mvva 80,192,200
s_add_u32 m0, m0, 32
tr 214,238,8768
mvva 80,196,216
tr 216,238,72
mvva 88,196,220
tr 218,238,328
mvva 88,192,204
mvva 68,200,192
s_waitcnt lgkmcnt(4)
tr 220,238,8520
mvva 68,204,208
tr 222,238,8776
mvva 76,204,212
mvva 76,200,196
buffer_load_dwordx4 v240, s[8:11], s44 offen offset:3072 nt lds
mvva 84,200,200
s_add_u32 s44, s44, s52
mvva 84,204,216
mvva 92,204,220
pk 64,64,65
pk 65,66,67
mvva 92,200,204
pk 66,68,69
pk 67,70,71
mvva 96,208,192
s_waitcnt lgkmcnt(0)
tr 192,238,128
pk 68,72,73
mvva 96,212,208
tr 194,238,384
pk 69,74,75
mvva 104,212,212
tr 196,238,8576
pk 70,76,77
mvva 104,208,196
pk 71,78,79
pk 72,80,81
mvva 112,208,200
tr 198,238,8832
pk 73,82,83
mvva 112,212,216
tr 200,238,136
pk 74,84,85
mvva 120,212,220
tr 202,238,392
pk 75,86,87
mvva 120,208,204
pk 76,88,89
pk 77,90,91
mvva 100,216,192
tr 204,238,8584
pk 78,92,93
mvva 100,220,208
tr 206,238,8840
pk 79,94,95
mvva 108,220,212
mvva 108,216,196
mvva 116,216,200
mvva 116,220,216
mvva 124,220,220
mvva 124,216,204
s_waitcnt lgkmcnt(1)
pk 80,96,97
pk 81,98,99
mvva 128,192,192
tr 208,238,192
pk 82,100,101
mvva 128,196,208
tr 210,238,448
pk 83,102,103
mvva 136,196,212
tr 212,238,8640
pk 84,104,105
mvva 136,192,196
pk 85,106,107
pk 86,108,109
mvva 144,192,200
tr 214,238,8896
pk 87,110,111
mvva 144,196,216
tr 216,238,200
pk 88,112,113
mvva 152,196,220
tr 218,238,456
pk 89,114,115
mvva 152,192,204
pk 90,116,117
pk 91,118,119
mvva 132,200,192
s_waitcnt lgkmcnt(4)
tr 220,238,8648
pk 92,120,121
mvva 132,204,208
tr 222,238,8904
pk 93,122,123
mvva 140,204,212
pk 94,124,125
pk 95,126,127
mvva 140,200,196
v_add_u32 v236, s40, v232
mvva 148,200,200
s_add_u32 s40, s40, s42
s_cmp_eq_u32 s40, s43
s_cselect_b32 s40, 0, s40
mvva 148,204,216
pk 96,128,129
pk 97,130,131
mvva 156,204,220
pk 98,132,133
pk 99,134,135
mvva 156,200,204
s_waitcnt vmcnt(25) lgkmcnt(0)
s_barrier
pk 100,136,137
mvva 160,208,192
s_add_u32 m0, s41, s49
s_add_u32 s41, s41, s42
ds_read_b128 v[192:195], v236 offset:0
mvva 160,212,208
s_cmp_eq_u32 s41, s43
s_cselect_b32 s41, 0, s41
pk 101,138,139
mvva 168,212,212
ds_read_b128 v[196:199], v236 offset:64
pk 102,140,141
mvva 168,208,196
buffer_load_dwordx4 v240, s[12:15], s45 offen nt lds
mvva 176,208,200
s_add_u32 m0, m0, 32
ds_read_b128 v[200:203], v236 offset:128
pk 103,142,143
mvva 176,212,216
pk 104,144,145
pk 105,146,147
mvva 184,212,220
ds_read_b128 v[204:207], v236 offset:192
pk 106,148,149
mvva 184,208,204
buffer_load_dwordx4 v240, s[12:15], s45 offen offset:1024 nt lds
mvva 164,216,192
s_add_u32 m0, m0, 32
pk 107,150,151
pk 108,152,153
mvva 164,220,208
pk 109,154,155
pk 110,156,157
mvva 172,220,212
pk 111,158,159
mvva 172,216,196
buffer_load_dwordx4 v240, s[12:15], s45 offen offset:2048 nt lds
mvva 180,216,200
s_add_u32 m0, m0, 32
pk 112,160,161
pk 113,162,163
mvva 180,220,216
pk 114,164,165
pk 115,166,167
mvva 188,220,220
s_waitcnt lgkmcnt(0)
pk 116,168,169
pk 117,170,171
mvva 188,216,204
buffer_load_dwordx4 v240, s[12:15], s45 offen offset:3072 nt lds
mvvvz 128,192,0
s_add_u32 s45, s45, s52
ds_read_b128 v[208:211], v236 offset:256
pk 118,172,173
mvvv 128,196,16
pk 119,174,175
pk 120,176,177
mvvv 128,200,32
s_add_u32 s16, s16, 0x200
s_addc_u32 s17, s17, 0
ds_read_b128 v[212:215], v236 offset:320
mvvv 128,204,48
s_sub_u32 s18, s18, 0x200
pk 121,178,179
pk 122,180,181
mvvvz 136,204,52
s_addk_i32 s46, -256
ds_read_b128 v[216:219], v236 offset:384
pk 123,182,183
mvvv 136,200,36
s_addk_i32 s82, -256
pk 124,184,185
pk 125,186,187
mvvv 136,196,20
s_addk_i32 s58, -256
ds_read_b128 v[220:223], v236 offset:448
pk 126,188,189
mvvv 136,192,4
pk 127,190,191
mvvvz 144,192,8
mvvv 144,196,24
v_mov_b32 v228, 0
v_mov_b32 v229, 0
mvvv 144,200,40
v_mov_b32 v230, 0
v_mov_b32 v231, 0
mvvv 144,204,56
mvvvz 152,204,60
mvvv 152,200,44
mvvv 152,196,28
mvvv 152,192,12
s_waitcnt lgkmcnt(0)
mvvv 128,208,64
ds_read_b128 v[192:195], v236 offset:8448
mvvv 128,212,80
mvvv 128,216,96
ds_read_b128 v[196:199], v236 offset:8512
mvvv 128,220,112
mvvv 136,220,116
ds_read_b128 v[200:203], v236 offset:8576
mvvv 136,216,100
mvvv 136,212,84
ds_read_b128 v[204:207], v236 offset:8640
mvvv 136,208,68
mvvv 144,208,72
mvvv 144,212,88
v_max3_f32 v160, v128, v129, v130
v_max_f32 v160, v160, v131
mvvv 144,216,104
v_mov_b32 v164, v160
mvvv 144,220,120
mvvv 152,220,124
v_permlane32_swap_b32 v160, v164
v_max3_f32 v161, v136, v137, v138
mvvv 152,216,108
v_max_f32 v160, v160, v164
v_mov_b32 v164, v160
mvvv 152,212,92
v_max_f32 v161, v161, v139
v_mov_b32 v165, v161
mvvv 152,208,76
s_waitcnt lgkmcnt(0)
v_permlane16_swap_b32 v160, v164
v_max3_f32 v162, v144, v145, v146
mvvvz 132,192,0
ds_read_b128 v[208:211], v236 offset:8704
v_max_f32 v160, v160, v164
mvvv 132,196,16
v_mul_f32 v224, s38, -v160
v_fma_f32 v128, v128, s38, v224
mvvv 132,200,32
ds_read_b128 v[212:215], v236 offset:8768
v_fma_f32 v129, v129, s38, v224
mvvv 132,204,48
v_fma_f32 v130, v130, s38, v224
v_fma_f32 v131, v131, s38, v224
mvvvz 140,204,52
ds_read_b128 v[216:219], v236 offset:8832
v_permlane32_swap_b32 v161, v165
mvvv 140,200,36
v_max_f32 v161, v161, v165
v_mov_b32 v165, v161
mvvv 140,196,20
ds_read_b128 v[220:223], v236 offset:8896
v_max_f32 v162, v162, v147
mvvv 140,192,4
v_permlane16_swap_b32 v161, v165
v_mov_b32 v166, v162
mvvvz 148,192,8
v_max_f32 v161, v161, v165
v_mul_f32 v225, s38, -v161
mvvv 148,196,24
v_fma_f32 v136, v136, s38, v225
v_fma_f32 v137, v137, s38, v225
mvvv 148,200,40
v_fma_f32 v138, v138, s38, v225
v_fma_f32 v139, v139, s38, v225
mvvv 148,204,56
v_add_u32 v236, s40, v232
v_permlane32_swap_b32 v162, v166
mvvvz 156,204,60
s_add_u32 s40, s40, s42
s_cmp_eq_u32 s40, s43
s_cselect_b32 s40, 0, s40
mvvv 156,200,44
v_max_f32 v162, v162, v166
v_mov_b32 v166, v162
mvvv 156,196,28
v_max3_f32 v163, v152, v153, v154
v_max_f32 v163, v163, v155
mvvv 156,192,12
s_waitcnt vmcnt(17) lgkmcnt(0)
s_barrier
v_permlane16_swap_b32 v162, v166
mvvv 132,208,64
ds_read_b128 v[192:195], v236 offset:0
v_max_f32 v162, v162, v166
mvvv 132,212,80
v_mul_f32 v226, s38, -v162
v_fma_f32 v144, v144, s38, v226
mvvv 132,216,96
ds_read_b128 v[196:199], v236 offset:64
v_fma_f32 v145, v145, s38, v226
mvvv 132,220,112
v_fma_f32 v146, v146, s38, v226
v_fma_f32 v147, v147, s38, v226
mvvv 140,220,116
ds_read_b128 v[200:203], v236 offset:128
v_mov_b32 v167, v163
mvvv 140,216,100
mvvv 140,212,84
ds_read_b128 v[204:207], v236 offset:192
v_permlane32_swap_b32 v163, v167
mvvv 140,208,68
v_max_f32 v163, v163, v167
v_mov_b32 v167, v163
mvvv 148,208,72
mvvv 148,212,88
v_permlane16_swap_b32 v163, v167
mvvv 148,216,104
v_max_f32 v163, v163, v167
v_max_f32 v163, s77, v163
mvvv 148,220,120
v_mul_f32 v227, s38, -v163
v_fma_f32 v152, v152, s38, v227
mvvv 156,220,124
v_fma_f32 v153, v153, s38, v227
v_fma_f32 v154, v154, s38, v227
mvvv 156,216,108
s_add_u32 m0, s41, s49
s_add_u32 s41, s41, s42
v_fma_f32 v155, v155, s38, v227
mvvv 156,212,92
s_cmp_eq_u32 s41, s43
s_cselect_b32 s41, 0, s41
v_fma_f32 v132, v132, s38, v224
mvvv 156,208,76
s_waitcnt lgkmcnt(0)
v_fma_f32 v133, v133, s38, v224
v_max_f32 v243, v132, v133
mvvvz 160,192,0
ds_read_b128 v[208:211], v236 offset:256
v_fma_f32 v134, v134, s38, v224
mvvv 160,196,16
v_fma_f32 v135, v135, s38, v224
v_max3_f32 v243, v243, v134, v135
mvvv 160,200,32
ds_read_b128 v[212:215], v236 offset:320
v_fma_f32 v140, v140, s38, v225
mvvv 160,204,48
buffer_load_dwordx4 v240, s[8:11], s44 offen nt lds
mvvvz 168,204,52
s_add_u32 m0, m0, 32
ds_read_b128 v[216:219], v236 offset:384
v_fma_f32 v141, v141, s38, v225
mvvv 168,200,36
v_max3_f32 v243, v243, v140, v141
v_fma_f32 v142, v142, s38, v225
mvvv 168,196,20
s_mov_b32 s63, 0
ds_read_b128 v[220:223], v236 offset:448
v_fma_f32 v143, v143, s38, v225
mvvv 168,192,4
v_max3_f32 v243, v243, v142, v143
v_fma_f32 v148, v148, s38, v226
mvvvz 176,192,8
v_fma_f32 v149, v149, s38, v226
v_max3_f32 v243, v243, v148, v149
mvvv 176,196,24
v_fma_f32 v150, v150, s38, v226
v_fma_f32 v151, v151, s38, v226
mvvv 176,200,40
v_max3_f32 v243, v243, v150, v151
v_fma_f32 v156, v156, s38, v227
mvvv 176,204,56
buffer_load_dwordx4 v240, s[8:11], s44 offen offset:1024 nt lds
mvvvz 184,204,60
s_add_u32 m0, m0, 32
v_fma_f32 v157, v157, s38, v227
v_max3_f32 v243, v243, v156, v157
mvvv 184,200,44
v_fma_f32 v158, v158, s38, v227
v_fma_f32 v159, v159, s38, v227
mvvv 184,196,28
v_max3_f32 v243, v243, v158, v159
v_cmp_lt_f32 vcc, s39, v243
mvvv 184,192,12
s_waitcnt lgkmcnt(0)
mvvv 160,208,64
s_cbranch_vccnz L_rare0
L_ret0:
ds_read_b128 v[192:195], v236 offset:8448
v_exp_f32 v128, v128
mvvv 160,212,80
v_exp_f32 v129, v129
v_add_f32 v228, v228, v128
mvvv 160,216,96
ds_read_b128 v[196:199], v236 offset:8512
v_exp_f32 v130, v130
v_add_f32 v228, v228, v129
mvvv 160,220,112
buffer_load_dwordx4 v240, s[8:11], s44 offen offset:2048 nt lds
pk 128,128,129
mvvv 168,220,116
s_add_u32 m0, m0, 32
ds_read_b128 v[200:203], v236 offset:8576
v_exp_f32 v131, v131
v_add_f32 v228, v228, v130
mvvv 168,216,100
v_exp_f32 v132, v132
v_add_f32 v228, v228, v131
pk 129,130,131
mvvv 168,212,84
ds_read_b128 v[204:207], v236 offset:8640
v_exp_f32 v133, v133
v_add_f32 v228, v228, v132
mvvv 168,208,68
v_fma_f32 v160, v160, s38, v224
v_fma_f32 v161, v161, s38, v224
v_exp_f32 v134, v134
mvvv 176,208,72
v_max_f32 v243, v160, v161
v_fma_f32 v162, v162, s38, v224
v_add_f32 v228, v228, v133
pk 130,132,133
mvvv 176,212,88
v_fma_f32 v163, v163, s38, v224
v_max3_f32 v243, v243, v162, v163
v_exp_f32 v135, v135
mvvv 176,216,104
v_fma_f32 v168, v168, s38, v225
v_fma_f32 v169, v169, s38, v225
v_add_f32 v228, v228, v134
mvvv 176,220,120
buffer_load_dwordx4 v240, s[8:11], s44 offen offset:3072 nt lds
v_exp_f32 v136, v136
mvvv 184,220,124
s_add_u32 s44, s44, s52
v_max3_f32 v243, v243, v168, v169
v_fma_f32 v170, v170, s38, v225
v_add_f32 v228, v228, v135
pk 131,134,135
mvvv 184,216,108
L_padB2:
s_cbranch_vccnz L_hop_body
v_fma_f32 v171, v171, s38, v225
v_max3_f32 v243, v243, v170, v171
v_exp_f32 v137, v137
mvvv 184,212,92
v_fma_f32 v176, v176, s38, v226
v_fma_f32 v177, v177, s38, v226
v_add_f32 v229, v229, v136
mvvv 184,208,76
s_waitcnt lgkmcnt(0)
v_max3_f32 v243, v243, v176, v177
v_fma_f32 v178, v178, s38, v226
v_exp_f32 v138, v138
mvvvz 164,192,0
ds_read_b128 v[208:211], v236 offset:8704
v_fma_f32 v179, v179, s38, v226
v_add_f32 v229, v229, v137
pk 136,136,137
mvvv 164,196,16
v_max3_f32 v243, v243, v178, v179
v_exp_f32 v139, v139
v_add_f32 v229, v229, v138
mvvv 164,200,32
ds_read_b128 v[212:215], v236 offset:8768
v_fma_f32 v184, v184, s38, v227
v_exp_f32 v140, v140
mvvv 164,204,48
v_fma_f32 v185, v185, s38, v227
v_max3_f32 v243, v243, v184, v185
v_add_f32 v229, v229, v139
pk 137,138,139
mvvvz 172,204,52
ds_read_b128 v[216:219], v236 offset:8832
v_fma_f32 v186, v186, s38, v227
mvvv 172,200,36
v_fma_f32 v187, v187, s38, v227
v_max3_f32 v243, v243, v186, v187
v_exp_f32 v141, v141
mvvv 172,196,20
ds_read_b128 v[220:223], v236 offset:8896
v_add_f32 v229, v229, v140
v_exp_f32 v142, v142
mvvv 172,192,4
v_add_f32 v229, v229, v141
pk 138,140,141
v_exp_f32 v143, v143
mvvvz 180,192,8
v_add_f32 v229, v229, v142
v_exp_f32 v144, v144
v_add_f32 v229, v229, v143
mvvv 180,196,24
pk 139,142,143
v_exp_f32 v145, v145
v_add_f32 v230, v230, v144
mvvv 180,200,40
v_exp_f32 v146, v146
v_add_f32 v230, v230, v145
pk 144,144,145
mvvv 180,204,56
v_add_u32 v237, s40, v233
v_exp_f32 v147, v147
v_add_f32 v230, v230, v146
mvvvz 188,204,60
s_add_u32 s40, s40, s42
s_cmp_eq_u32 s40, s43
s_cselect_b32 s40, 0, s40
v_exp_f32 v148, v148
mvvv 188,200,44
v_add_f32 v230, v230, v147
pk 145,146,147
v_exp_f32 v149, v149
mvvv 188,196,28
v_add_f32 v230, v230, v148
v_exp_f32 v150, v150
mvvv 188,192,12
s_waitcnt lgkmcnt(0)
v_add_f32 v230, v230, v149
pk 146,148,149
v_exp_f32 v151, v151
mvvv 164,208,64
tr 192,237,0
v_add_f32 v230, v230, v150
v_exp_f32 v152, v152
mvvv 164,212,80
tr 194,237,8448
v_add_f32 v230, v230, v151
pk 147,150,151
mvvv 164,216,96
tr 196,237,32
v_exp_f32 v153, v153
v_add_f32 v231, v231, v152
mvvv 164,220,112
v_exp_f32 v154, v154
v_add_f32 v231, v231, v153
pk 152,152,153
mvvv 172,220,116
tr 198,237,8480
v_exp_f32 v155, v155
v_add_f32 v231, v231, v154
mvvv 172,216,100
tr 200,237,64
v_exp_f32 v156, v156
v_add_f32 v231, v231, v155
mvvv 172,212,84
tr 202,237,8512
pk 153,154,155
v_exp_f32 v157, v157
mvvv 172,208,68
v_add_f32 v231, v231, v156
v_exp_f32 v158, v158
v_add_f32 v231, v231, v157
mvvv 180,208,72
tr 204,237,96
v_fma_f32 v164, v164, s38, v224
pk 154,156,157
mvvv 180,212,88
tr 206,237,8544
v_fma_f32 v165, v165, s38, v224
v_exp_f32 v159, v159
mvvv 180,216,104
v_max3_f32 v243, v243, v164, v165
v_fma_f32 v166, v166, s38, v224
v_add_f32 v231, v231, v158
s_nop 0
mvvv 180,220,120
v_fma_f32 v167, v167, s38, v224
v_max3_f32 v243, v243, v166, v167
v_add_f32 v231, v231, v159
pk 155,158,159
mvvv 188,220,124
v_fma_f32 v172, v172, s38, v225
v_fma_f32 v173, v173, s38, v225
mvvv 188,216,108
v_max3_f32 v243, v243, v172, v173
v_fma_f32 v174, v174, s38, v225
mvvv 188,212,92
v_fma_f32 v175, v175, s38, v225
v_max3_f32 v243, v243, v174, v175
mvvv 188,208,76
s_waitcnt lgkmcnt(1)
v_fma_f32 v180, v180, s38, v226
v_fma_f32 v181, v181, s38, v226
mavvz 0,192,128
s_mov_b32 s63, 1
tr 208,237,128
v_max3_f32 v243, v243, v180, v181
mavvz 4,192,136
tr 210,237,8576
v_fma_f32 v182, v182, s38, v226
mavvz 8,192,144
v_fma_f32 v183, v183, s38, v226
v_max3_f32 v243, v243, v182, v183
mavvz 12,192,152
tr 212,237,160
v_fma_f32 v188, v188, s38, v227
mavvz 28,196,152
tr 214,237,8608
v_fma_f32 v189, v189, s38, v227
mavvz 24,196,144
v_max3_f32 v243, v243, v188, v189
v_fma_f32 v190, v190, s38, v227
mavvz 20,196,136
tr 216,237,192
v_fma_f32 v191, v191, s38, v227
mavvz 16,196,128
tr 218,237,8640
v_max3_f32 v243, v243, v190, v191
mavvz 32,200,128
v_cmp_lt_f32 vcc, s39, v243
mavvz 36,200,136
tr 220,237,224
mavvz 40,200,144
s_cbranch_vccnz L_rare1
L_ret1:
tr 222,237,8672
mavvz 44,200,152
s_waitcnt lgkmcnt(4)
v_exp_f32 v160, v160
mavvz 60,204,152
tr 192,237,256
v_add_f32 v228, v228, v160
mavvz 56,204,144
tr 194,237,8704
mavvz 52,204,136
v_exp_f32 v161, v161
mavvz 48,204,128
tr 196,237,288
v_add_f32 v228, v228, v161
mavvz 64,208,128
tr 198,237,8736
pk 160,160,161
mavvz 68,208,136
v_exp_f32 v162, v162
mavvz 72,208,144
tr 200,237,320
v_add_f32 v228, v228, v162
mavvz 76,208,152
tr 202,237,8768
mavvz 92,212,152
v_exp_f32 v163, v163
mavvz 88,212,144
tr 204,237,352
v_add_f32 v228, v228, v163
mavvz 84,212,136
tr 206,237,8800
pk 161,162,163
mavvz 80,212,128
s_waitcnt lgkmcnt(4)
v_exp_f32 v164, v164
mavvz 96,216,128
tr 208,237,384
v_add_f32 v228, v228, v164
mavvz 100,216,136
tr 210,237,8832
mavvz 104,216,144
v_exp_f32 v165, v165
mavvz 108,216,152
tr 212,237,416
v_add_f32 v228, v228, v165
mavvz 124,220,152
tr 214,237,8864
pk 162,164,165
mavvz 120,220,144
v_exp_f32 v166, v166
mavvz 116,220,136
tr 216,237,448
v_add_f32 v228, v228, v166
mavvz 112,220,128
tr 218,237,8896
mavvz 128,192,128
v_exp_f32 v167, v167
mavvz 132,192,136
tr 220,237,480
v_add_f32 v228, v228, v167
mavvz 136,192,144
tr 222,237,8928
pk 163,166,167
mavvz 140,192,152
v_exp_f32 v168, v168
mavvz 156,196,152
v_exp_f32 v169, v169
mavvz 152,196,144
v_exp_f32 v170, v170
mavvz 148,196,136
v_exp_f32 v171, v171
mavvz 144,196,128
s_waitcnt lgkmcnt(2)
v_exp_f32 v172, v172
mavvz 160,200,128
v_exp_f32 v173, v173
mavvz 164,200,136
v_exp_f32 v174, v174
mavvz 168,200,144
v_exp_f32 v175, v175
mavvz 172,200,152
v_add_u32 v236, s40, v232
v_add_f32 v229, v229, v168
mavvz 188,204,152
s_add_u32 s40, s40, s42
s_cmp_eq_u32 s40, s43
s_cselect_b32 s40, 0, s40
mavvz 184,204,144
v_exp_f32 v176, v176
mavvz 180,204,136
v_exp_f32 v177, v177
mavvz 176,204,128
s_waitcnt vmcnt(13) lgkmcnt(0)
s_barrier
v_add_f32 v229, v229, v169
mavvz 192,208,128
s_add_u32 m0, s41, s49
s_add_u32 s41, s41, s42
ds_read_b128 v[192:195], v236 offset:0
mavvz 196,208,136
s_cmp_eq_u32 s41, s43
s_cselect_b32 s41, 0, s41
pk 168,168,169
mavvz 200,208,144
ds_read_b128 v[196:199], v236 offset:64
v_add_f32 v229, v229, v170
mavvz 204,208,152
buffer_load_dwordx4 v240, s[12:15], s45 offen nt lds
mavvz 220,212,152
s_add_u32 m0, m0, 32
ds_read_b128 v[200:203], v236 offset:128
v_add_f32 v229, v229, v171
mavvz 216,212,144
v_exp_f32 v178, v178
mavvz 212,212,136
ds_read_b128 v[204:207], v236 offset:192
pk 169,170,171
mavvz 208,212,128
buffer_load_dwordx4 v240, s[12:15], s45 offen offset:1024 nt lds
mavvz 224,216,128
s_add_u32 m0, m0, 32
v_exp_f32 v179, v179
mavvz 228,216,136
v_exp_f32 v180, v180
mavvz 232,216,144
v_exp_f32 v181, v181
mavvz 236,216,152
buffer_load_dwordx4 v240, s[12:15], s45 offen offset:2048 nt lds
mavvz 252,220,152
s_add_u32 m0, m0, 32
v_exp_f32 v182, v182
mavvz 248,220,144
v_exp_f32 v183, v183
mavvz 244,220,136
s_waitcnt lgkmcnt(0)
v_exp_f32 v184, v184
mavvz 240,220,128
buffer_load_dwordx4 v240, s[12:15], s45 offen offset:3072 nt lds
s_mov_b32 s64, 5
L_loop:
mvvvz 128,192,0
s_add_u32 s45, s45, s52
s_add_u32 m0, s41, s49
ds_read_b128 v[208:211], v236 offset:256
mvvv 128,196,16
s_add_u32 s41, s41, s42
s_cmp_eq_u32 s41, s43
s_cselect_b32 s41, 0, s41
mvvv 128,200,32
ds_read_b128 v[212:215], v236 offset:320
v_add_f32 v229, v229, v172
mvvv 128,204,48
buffer_load_dwordx4 v240, s[8:11], s44 offen nt lds
mvvvz 136,204,52
s_add_u32 m0, m0, 32
ds_read_b128 v[216:219], v236 offset:384
v_add_f32 v229, v229, v173
mvvv 136,200,36
v_exp_f32 v185, v185
mvvv 136,196,20
ds_read_b128 v[220:223], v236 offset:448
pk 170,172,173
mvvv 136,192,4
v_exp_f32 v186, v186
mvvvz 144,192,8
v_exp_f32 v187, v187
mvvv 144,196,24
v_exp_f32 v188, v188
mvvv 144,200,40
v_exp_f32 v189, v189
mvvv 144,204,56
buffer_load_dwordx4 v240, s[8:11], s44 offen offset:1024 nt lds
mvvvz 152,204,60
s_add_u32 m0, m0, 32
v_exp_f32 v190, v190
mvvv 152,200,44
v_exp_f32 v191, v191
mvvv 152,196,28
v_add_f32 v229, v229, v174
v_add_f32 v229, v229, v175
mvvv 152,192,12
s_waitcnt lgkmcnt(0)
pk 171,174,175
v_add_f32 v230, v230, v176
mvvv 128,208,64
ds_read_b128 v[192:195], v236 offset:8448
v_add_f32 v230, v230, v177
mvvv 128,212,80
pk 176,176,177
v_add_f32 v230, v230, v178
mvvv 128,216,96
ds_read_b128 v[196:199], v236 offset:8512
v_add_f32 v230, v230, v179
mvvv 128,220,112
buffer_load_dwordx4 v240, s[8:11], s44 offen offset:2048 nt lds
mvvv 136,220,116
s_add_u32 m0, m0, 32
ds_read_b128 v[200:203], v236 offset:8576
pk 177,178,179
mvvv 136,216,100
v_add_f32 v230, v230, v180
v_add_f32 v230, v230, v181
mvvv 136,212,84
ds_read_b128 v[204:207], v236 offset:8640
pk 178,180,181
mvvv 136,208,68
v_fma_f32 v128, v128, s38, v224
v_fma_f32 v129, v129, s38, v224
mvvv 144,208,72
v_max_f32 v243, v128, v129
v_fma_f32 v130, v130, s38, v224
mvvv 144,212,88
v_fma_f32 v131, v131, s38, v224
v_max3_f32 v243, v243, v130, v131
mvvv 144,216,104
v_fma_f32 v136, v136, s38, v225
v_fma_f32 v137, v137, s38, v225
mvvv 144,220,120
buffer_load_dwordx4 v240, s[8:11], s44 offen offset:3072 nt lds
mvvv 152,220,124
s_add_u32 s44, s44, s52
v_max3_f32 v243, v243, v136, v137
v_fma_f32 v138, v138, s38, v225
mvvv 152,216,108
v_fma_f32 v139, v139, s38, v225
v_max3_f32 v243, v243, v138, v139
mvvv 152,212,92
v_fma_f32 v144, v144, s38, v226
v_fma_f32 v145, v145, s38, v226
mvvv 152,208,76
s_waitcnt lgkmcnt(0)
v_max3_f32 v243, v243, v144, v145
v_fma_f32 v146, v146, s38, v226
mvvvz 132,192,0
ds_read_b128 v[208:211], v236 offset:8704
v_fma_f32 v147, v147, s38, v226
mvvv 132,196,16
v_max3_f32 v243, v243, v146, v147
v_add_f32 v230, v230, v182
mvvv 132,200,32
ds_read_b128 v[212:215], v236 offset:8768
v_fma_f32 v152, v152, s38, v227
mvvv 132,204,48
v_fma_f32 v153, v153, s38, v227
v_max3_f32 v243, v243, v152, v153
mvvvz 140,204,52
ds_read_b128 v[216:219], v236 offset:8832
v_fma_f32 v154, v154, s38, v227
mvvv 140,200,36
v_fma_f32 v155, v155, s38, v227
v_max3_f32 v243, v243, v154, v155
mvvv 140,196,20
ds_read_b128 v[220:223], v236 offset:8896
v_add_f32 v230, v230, v183
mvvv 140,192,4
pk 179,182,183
v_add_f32 v231, v231, v184
mvvvz 148,192,8
v_add_f32 v231, v231, v185
pk 184,184,185
mvvv 148,196,24
v_add_f32 v231, v231, v186
v_add_f32 v231, v231, v187
mvvv 148,200,40
pk 185,186,187
v_add_f32 v231, v231, v188
mvvv 148,204,56
v_add_u32 v237, s40, v233
v_add_f32 v231, v231, v189
mvvvz 156,204,60
s_add_u32 s40, s40, s42
s_cmp_eq_u32 s40, s43
s_cselect_b32 s40, 0, s40
mvvv 156,200,44
pk 186,188,189
v_add_f32 v231, v231, v190
mvvv 156,196,28
v_add_f32 v231, v231, v191
pk 187,190,191
mvvv 156,192,12
s_waitcnt lgkmcnt(0)
mvvv 132,208,64
tr 192,237,0
mvvv 132,212,80
tr 194,237,8448
mvvv 132,216,96
tr 196,237,32
mvvv 132,220,112
mvvv 140,220,116
tr 198,237,8480
mvvv 140,216,100
tr 200,237,64
mvvv 140,212,84
tr 202,237,8512
mvvv 140,208,68
mvvv 148,208,72
tr 204,237,96
v_fma_f32 v132, v132, s38, v224
mvvv 148,212,88
tr 206,237,8544
v_fma_f32 v133, v133, s38, v224
mvvv 148,216,104
v_max3_f32 v243, v243, v132, v133
v_fma_f32 v134, v134, s38, v224
mvvv 148,220,120
v_fma_f32 v135, v135, s38, v224
v_max3_f32 v243, v243, v134, v135
mvvv 156,220,124
v_fma_f32 v140, v140, s38, v225
v_fma_f32 v141, v141, s38, v225
mvvv 156,216,108
v_max3_f32 v243, v243, v140, v141
v_fma_f32 v142, v142, s38, v225
mvvv 156,212,92
v_fma_f32 v143, v143, s38, v225
v_max3_f32 v243, v243, v142, v143
mvvv 156,208,76
s_waitcnt lgkmcnt(1)
v_fma_f32 v148, v148, s38, v226
v_fma_f32 v149, v149, s38, v226
mavv 0,192,160
s_mov_b32 s63, 2
tr 208,237,128
v_max3_f32 v243, v243, v148, v149
mavv 4,192,168
tr 210,237,8576
v_fma_f32 v150, v150, s38, v226
mavv 8,192,176
v_fma_f32 v151, v151, s38, v226
v_max3_f32 v243, v243, v150, v151
mavv 12,192,184
tr 212,237,160
v_fma_f32 v156, v156, s38, v227
mavv 28,196,184
tr 214,237,8608
v_fma_f32 v157, v157, s38, v227
mavv 24,196,176
v_max3_f32 v243, v243, v156, v157
v_fma_f32 v158, v158, s38, v227
mavv 20,196,168
tr 216,237,192
v_fma_f32 v159, v159, s38, v227
mavv 16,196,160
tr 218,237,8640
v_max3_f32 v243, v243, v158, v159
mavv 32,200,160
v_cmp_lt_f32 vcc, s39, v243
mavv 36,200,168
tr 220,237,224
mavv 40,200,176
s_cbranch_vccnz L_rare0
L_ret2:
tr 222,237,8672
mavv 44,200,184
s_waitcnt lgkmcnt(4)
v_exp_f32 v128, v128
mavv 60,204,184
tr 192,237,256
v_add_f32 v228, v228, v128
mavv 56,204,176
tr 194,237,8704
mavv 52,204,168
v_exp_f32 v129, v129
mavv 48,204,160
tr 196,237,288
v_add_f32 v228, v228, v129
mavv 64,208,160
tr 198,237,8736
pk 128,128,129
mavv 68,208,168
v_exp_f32 v130, v130
mavv 72,208,176
tr 200,237,320
v_add_f32 v228, v228, v130
mavv 76,208,184
tr 202,237,8768
mavv 92,212,184
v_exp_f32 v131, v131
mavv 88,212,176
tr 204,237,352
v_add_f32 v228, v228, v131
mavv 84,212,168
tr 206,237,8800
pk 129,130,131
mavv 80,212,160
s_waitcnt lgkmcnt(4)
v_exp_f32 v132, v132
mavv 96,216,160
tr 208,237,384
v_add_f32 v228, v228, v132
mavv 100,216,168
tr 210,237,8832
mavv 104,216,176
v_exp_f32 v133, v133
mavv 108,216,184
tr 212,237,416
v_add_f32 v228, v228, v133
mavv 124,220,184
tr 214,237,8864
pk 130,132,133
mavv 120,220,176
v_exp_f32 v134, v134
mavv 116,220,168
tr 216,237,448
v_add_f32 v228, v228, v134
mavv 112,220,160
tr 218,237,8896
mavv 128,192,160
v_exp_f32 v135, v135
mavv 132,192,168
tr 220,237,480
v_add_f32 v228, v228, v135
mavv 136,192,176
tr 222,237,8928
pk 131,134,135
mavv 140,192,184
v_exp_f32 v136, v136
mavv 156,196,184
v_exp_f32 v137, v137
mavv 152,196,176
v_exp_f32 v138, v138
mavv 148,196,168
v_exp_f32 v139, v139
mavv 144,196,160
s_waitcnt lgkmcnt(2)
v_exp_f32 v140, v140
mavv 160,200,160
v_exp_f32 v141, v141
mavv 164,200,168
v_exp_f32 v142, v142
mavv 168,200,176
v_exp_f32 v143, v143
mavv 172,200,184
v_add_u32 v236, s40, v232
v_add_f32 v229, v229, v136
mavv 188,204,184
L_padB3:
s_cbranch_vccnz L_hop_body
s_add_u32 s40, s40, s42
s_cmp_eq_u32 s40, s43
s_cselect_b32 s40, 0, s40
mavv 184,204,176
v_exp_f32 v144, v144
mavv 180,204,168
v_exp_f32 v145, v145
mavv 176,204,160
s_waitcnt vmcnt(12) lgkmcnt(0)
s_barrier
v_add_f32 v229, v229, v137
mavv 192,208,160
s_add_u32 m0, s41, s49
s_add_u32 s41, s41, s42
ds_read_b128 v[192:195], v236 offset:0
mavv 196,208,168
s_cmp_eq_u32 s41, s43
s_cselect_b32 s41, 0, s41
pk 136,136,137
mavv 200,208,176
ds_read_b128 v[196:199], v236 offset:64
v_add_f32 v229, v229, v138
mavv 204,208,184
buffer_load_dwordx4 v240, s[12:15], s45 offen nt lds
mavv 220,212,184
s_add_u32 m0, m0, 32
ds_read_b128 v[200:203], v236 offset:128
v_add_f32 v229, v229, v139
mavv 216,212,176
v_exp_f32 v146, v146
mavv 212,212,168
ds_read_b128 v[204:207], v236 offset:192
pk 137,138,139
mavv 208,212,160
buffer_load_dwordx4 v240, s[12:15], s45 offen offset:1024 nt lds
mavv 224,216,160
s_add_u32 m0, m0, 32
v_exp_f32 v147, v147
mavv 228,216,168
v_exp_f32 v148, v148
mavv 232,216,176
v_exp_f32 v149, v149
mavv 236,216,184
buffer_load_dwordx4 v240, s[12:15], s45 offen offset:2048 nt lds
mavv 252,220,184
s_add_u32 m0, m0, 32
v_exp_f32 v150, v150
mavv 248,220,176
v_exp_f32 v151, v151
mavv 244,220,168
s_waitcnt lgkmcnt(0)
v_exp_f32 v152, v152
mavv 240,220,160
buffer_load_dwordx4 v240, s[12:15], s45 offen offset:3072 nt lds
mvvvz 160,192,0
s_add_u32 s45, s45, s52
s_add_u32 m0, s41, s49
ds_read_b128 v[208:211], v236 offset:256
mvvv 160,196,16
s_add_u32 s41, s41, s42
s_cmp_eq_u32 s41, s43
s_cselect_b32 s41, 0, s41
mvvv 160,200,32
ds_read_b128 v[212:215], v236 offset:320
v_add_f32 v229, v229, v140
mvvv 160,204,48
buffer_load_dwordx4 v240, s[8:11], s44 offen nt lds
mvvvz 168,204,52
s_add_u32 m0, m0, 32
ds_read_b128 v[216:219], v236 offset:384
v_add_f32 v229, v229, v141
mvvv 168,200,36
v_exp_f32 v153, v153
mvvv 168,196,20
ds_read_b128 v[220:223], v236 offset:448
pk 138,140,141
mvvv 168,192,4
v_exp_f32 v154, v154
mvvvz 176,192,8
v_exp_f32 v155, v155
mvvv 176,196,24
v_exp_f32 v156, v156
mvvv 176,200,40
v_exp_f32 v157, v157
mvvv 176,204,56
buffer_load_dwordx4 v240, s[8:11], s44 offen offset:1024 nt lds
mvvvz 184,204,60
s_add_u32 m0, m0, 32
v_exp_f32 v158, v158
mvvv 184,200,44
v_exp_f32 v159, v159
mvvv 184,196,28
v_add_f32 v229, v229, v142
v_add_f32 v229, v229, v143
mvvv 184,192,12
s_waitcnt lgkmcnt(0)
pk 139,142,143
v_add_f32 v230, v230, v144
mvvv 160,208,64
ds_read_b128 v[192:195], v236 offset:8448
v_add_f32 v230, v230, v145
mvvv 160,212,80
pk 144,144,145
v_add_f32 v230, v230, v146
mvvv 160,216,96
ds_read_b128 v[196:199], v236 offset:8512
v_add_f32 v230, v230, v147
mvvv 160,220,112
buffer_load_dwordx4 v240, s[8:11], s44 offen offset:2048 nt lds
mvvv 168,220,116
s_add_u32 m0, m0, 32
ds_read_b128 v[200:203], v236 offset:8576
pk 145,146,147
mvvv 168,216,100
v_add_f32 v230, v230, v148
v_add_f32 v230, v230, v149
mvvv 168,212,84
ds_read_b128 v[204:207], v236 offset:8640
pk 146,148,149
mvvv 168,208,68
v_fma_f32 v160, v160, s38, v224
v_fma_f32 v161, v161, s38, v224
mvvv 176,208,72
v_max_f32 v243, v160, v161
v_fma_f32 v162, v162, s38, v224
mvvv 176,212,88
v_fma_f32 v163, v163, s38, v224
v_max3_f32 v243, v243, v162, v163
mvvv 176,216,104
v_fma_f32 v168, v168, s38, v225
v_fma_f32 v169, v169, s38, v225
mvvv 176,220,120
buffer_load_dwordx4 v240, s[8:11], s44 offen offset:3072 nt lds
mvvv 184,220,124
s_add_u32 s44, s44, s52
v_max3_f32 v243, v243, v168, v169
v_fma_f32 v170, v170, s38, v225
mvvv 184,216,108
v_fma_f32 v171, v171, s38, v225
v_max3_f32 v243, v243, v170, v171
mvvv 184,212,92
v_fma_f32 v176, v176, s38, v226
v_fma_f32 v177, v177, s38, v226
mvvv 184,208,76
s_waitcnt lgkmcnt(0)
v_max3_f32 v243, v243, v176, v177
v_fma_f32 v178, v178, s38, v226
mvvvz 164,192,0
ds_read_b128 v[208:211], v236 offset:8704
v_fma_f32 v179, v179, s38, v226
mvvv 164,196,16
v_max3_f32 v243, v243, v178, v179
v_add_f32 v230, v230, v150
mvvv 164,200,32
ds_read_b128 v[212:215], v236 offset:8768
v_fma_f32 v184, v184, s38, v227
mvvv 164,204,48
v_fma_f32 v185, v185, s38, v227
v_max3_f32 v243, v243, v184, v185
mvvvz 172,204,52
ds_read_b128 v[216:219], v236 offset:8832
v_fma_f32 v186, v186, s38, v227
mvvv 172,200,36
v_fma_f32 v187, v187, s38, v227
v_max3_f32 v243, v243, v186, v187
mvvv 172,196,20
ds_read_b128 v[220:223], v236 offset:8896
v_add_f32 v230, v230, v151
mvvv 172,192,4
pk 147,150,151
v_add_f32 v231, v231, v152
mvvvz 180,192,8
v_add_f32 v231, v231, v153
pk 152,152,153
mvvv 180,196,24
v_add_f32 v231, v231, v154
v_add_f32 v231, v231, v155
mvvv 180,200,40
pk 153,154,155
v_add_f32 v231, v231, v156
mvvv 180,204,56
v_add_u32 v237, s40, v233
v_add_f32 v231, v231, v157
mvvvz 188,204,60
s_add_u32 s40, s40, s42
s_cmp_eq_u32 s40, s43
s_cselect_b32 s40, 0, s40
mvvv 188,200,44
pk 154,156,157
v_add_f32 v231, v231, v158
mvvv 188,196,28
v_add_f32 v231, v231, v159
pk 155,158,159
mvvv 188,192,12
s_waitcnt lgkmcnt(0)
mvvv 164,208,64
tr 192,237,0
mvvv 164,212,80
tr 194,237,8448
mvvv 164,216,96
tr 196,237,32
mvvv 164,220,112
mvvv 172,220,116
tr 198,237,8480
mvvv 172,216,100
tr 200,237,64
mvvv 172,212,84
tr 202,237,8512
mvvv 172,208,68
mvvv 180,208,72
tr 204,237,96
v_fma_f32 v164, v164, s38, v224
mvvv 180,212,88
tr 206,237,8544
v_fma_f32 v165, v165, s38, v224
mvvv 180,216,104
v_max3_f32 v243, v243, v164, v165
v_fma_f32 v166, v166, s38, v224
mvvv 180,220,120
v_fma_f32 v167, v167, s38, v224
v_max3_f32 v243, v243, v166, v167
mvvv 188,220,124
v_fma_f32 v172, v172, s38, v225
v_fma_f32 v173, v173, s38, v225
mvvv 188,216,108
v_max3_f32 v243, v243, v172, v173
v_fma_f32 v174, v174, s38, v225
mvvv 188,212,92
v_fma_f32 v175, v175, s38, v225
v_max3_f32 v243, v243, v174, v175
mvvv 188,208,76
s_waitcnt lgkmcnt(1)
v_fma_f32 v180, v180, s38, v226
v_fma_f32 v181, v181, s38, v226
mavv 0,192,128
s_mov_b32 s63, 3
tr 208,237,128
v_max3_f32 v243, v243, v180, v181
mavv 4,192,136
tr 210,237,8576
v_fma_f32 v182, v182, s38, v226
mavv 8,192,144
v_fma_f32 v183, v183, s38, v226
v_max3_f32 v243, v243, v182, v183
mavv 12,192,152
tr 212,237,160
v_fma_f32 v188, v188, s38, v227
mavv 28,196,152
tr 214,237,8608
v_fma_f32 v189, v189, s38, v227
mavv 24,196,144
v_max3_f32 v243, v243, v188, v189
v_fma_f32 v190, v190, s38, v227
mavv 20,196,136
tr 216,237,192
v_fma_f32 v191, v191, s38, v227
mavv 16,196,128
tr 218,237,8640
v_max3_f32 v243, v243, v190, v191
mavv 32,200,128
v_cmp_lt_f32 vcc, s39, v243
mavv 36,200,136
tr 220,237,224
mavv 40,200,144
s_cbranch_vccnz L_rare1
L_ret3:
tr 222,237,8672
mavv 44,200,152
s_waitcnt lgkmcnt(4)
v_exp_f32 v160, v160
mavv 60,204,152
tr 192,237,256
v_add_f32 v228, v228, v160
mavv 56,204,144
tr 194,237,8704
mavv 52,204,136
v_exp_f32 v161, v161
mavv 48,204,128
tr 196,237,288
v_add_f32 v228, v228, v161
mavv 64,208,128
tr 198,237,8736
pk 160,160,161
mavv 68,208,136
v_exp_f32 v162, v162
mavv 72,208,144
tr 200,237,320
v_add_f32 v228, v228, v162
mavv 76,208,152
tr 202,237,8768
mavv 92,212,152
v_exp_f32 v163, v163
mavv 88,212,144
tr 204,237,352
v_add_f32 v228, v228, v163
mavv 84,212,136
tr 206,237,8800
pk 161,162,163
mavv 80,212,128
s_waitcnt lgkmcnt(4)
v_exp_f32 v164, v164
mavv 96,216,128
tr 208,237,384
v_add_f32 v228, v228, v164
mavv 100,216,136
tr 210,237,8832
mavv 104,216,144
v_exp_f32 v165, v165
mavv 108,216,152
tr 212,237,416
v_add_f32 v228, v228, v165
mavv 124,220,152
tr 214,237,8864
pk 162,164,165
mavv 120,220,144
v_exp_f32 v166, v166
mavv 116,220,136
tr 216,237,448
v_add_f32 v228, v228, v166
mavv 112,220,128
tr 218,237,8896
mavv 128,192,128
v_exp_f32 v167, v167
mavv 132,192,136
tr 220,237,480
v_add_f32 v228, v228, v167
mavv 136,192,144
tr 222,237,8928
pk 163,166,167
mavv 140,192,152
v_exp_f32 v168, v168
mavv 156,196,152
v_exp_f32 v169, v169
mavv 152,196,144
v_exp_f32 v170, v170
mavv 148,196,136
v_exp_f32 v171, v171
mavv 144,196,128
s_waitcnt lgkmcnt(2)
v_exp_f32 v172, v172
mavv 160,200,128
v_exp_f32 v173, v173
mavv 164,200,136
v_exp_f32 v174, v174
mavv 168,200,144
v_exp_f32 v175, v175
mavv 172,200,152
v_add_u32 v236, s40, v232
v_add_f32 v229, v229, v168
mavv 188,204,152
s_add_u32 s40, s40, s42
s_cmp_eq_u32 s40, s43
s_cselect_b32 s40, 0, s40
mavv 184,204,144
v_exp_f32 v176, v176
mavv 180,204,136
v_exp_f32 v177, v177
mavv 176,204,128
s_waitcnt vmcnt(12) lgkmcnt(0)
s_barrier
v_add_f32 v229, v229, v169
mavv 192,208,128
s_add_u32 m0, s41, s49
s_add_u32 s41, s41, s42
ds_read_b128 v[192:195], v236 offset:0
mavv 196,208,136
s_cmp_eq_u32 s41, s43
s_cselect_b32 s41, 0, s41
pk 168,168,169
mavv 200,208,144
ds_read_b128 v[196:199], v236 offset:64
v_add_f32 v229, v229, v170
mavv 204,208,152
buffer_load_dwordx4 v240, s[12:15], s45 offen nt lds
mavv 220,212,152
s_add_u32 m0, m0, 32
ds_read_b128 v[200:203], v236 offset:128
v_add_f32 v229, v229, v171
mavv 216,212,144
v_exp_f32 v178, v178
mavv 212,212,136
ds_read_b128 v[204:207], v236 offset:192
pk 169,170,171
mavv 208,212,128
buffer_load_dwordx4 v240, s[12:15], s45 offen offset:1024 nt lds
mavv 224,216,128
s_add_u32 m0, m0, 32
v_exp_f32 v179, v179
mavv 228,216,136
v_exp_f32 v180, v180
mavv 232,216,144
v_exp_f32 v181, v181
mavv 236,216,152
buffer_load_dwordx4 v240, s[12:15], s45 offen offset:2048 nt lds
mavv 252,220,152
s_add_u32 m0, m0, 32
v_exp_f32 v182, v182
mavv 248,220,144
v_exp_f32 v183, v183
mavv 244,220,136
s_waitcnt lgkmcnt(0)
v_exp_f32 v184, v184
mavv 240,220,128
buffer_load_dwordx4 v240, s[12:15], s45 offen offset:3072 nt lds
s_sub_u32 s64, s64, 1
s_cmp_lg_u32 s64, 0
s_cbranch_scc1 L_loop
s_cmp_lg_u32 s5, 0
s_cbranch_scc1 L_pre_b
s_mov_b64 vcc, -1
s_cmp_eq_u32 s4, 0
s_cbranch_scc1 L_padC0
s_cmp_eq_u32 s4, 1
s_cbranch_scc1 L_padC1
s_cmp_eq_u32 s4, 2
s_cbranch_scc1 L_padC2
s_branch L_padC3
L_hop_a:
s_cmp_eq_u32 s4, 3
s_cbranch_scc1 L_ret_aw
L_ret_a:
s_mov_b64 vcc, 0
L_tail_a:
mvvvz 128,192,0
s_add_u32 s45, s45, s52
s_add_u32 m0, s41, s49
ds_read_b128 v[208:211], v236 offset:256
mvvv 128,196,16
s_add_u32 s41, s41, s42
s_cmp_eq_u32 s41, s43
s_cselect_b32 s41, 0, s41
mvvv 128,200,32
s_mov_b32 s26, 0x20000
s_mov_b32 s48, s70
ds_read_b128 v[212:215], v236 offset:320
mvvv 128,204,48
buffer_load_dwordx4 v240, s[8:11], s44 offen nt lds
mvvvz 136,204,52
s_add_u32 m0, m0, 32
s_mov_b32 s84, s36
ds_read_b128 v[216:219], v236 offset:384
mvvv 136,200,36
s_mov_b32 s85, s37
s_bitcmp1_b32 s4, 0
s_cselect_b32 s86, 0x3800, 0x3800
s_bitcmp1_b32 s4, 0
s_cselect_b32 s94, 0, 0x200
mvvv 136,196,20
s_movk_i32 s95, 0x400
s_bitcmp1_b32 s4, 0
s_cselect_b32 s95, 0x200, s95
ds_read_b128 v[220:223], v236 offset:448
mvvv 136,192,4
s_movk_i32 s64, 0x4000
s_bitcmp1_b32 s4, 0
s_cselect_b32 s64, 0x2000, s64
v_add_f32 v229, v229, v172
mvvvz 144,192,8
v_exp_f32 v185, v185
mvvv 144,196,24
v_exp_f32 v186, v186
mvvv 144,200,40
v_exp_f32 v187, v187
mvvv 144,204,56
buffer_load_dwordx4 v240, s[8:11], s44 offen offset:1024 nt lds
mvvvz 152,204,60
s_add_u32 m0, m0, 32
v_exp_f32 v188, v188
mvvv 152,200,44
v_exp_f32 v189, v189
mvvv 152,196,28
v_exp_f32 v190, v190
mvvv 152,192,12
s_waitcnt lgkmcnt(0)
v_exp_f32 v191, v191
mvvv 128,208,64
ds_read_b128 v[192:195], v236 offset:8448
v_add_f32 v229, v229, v173
mvvv 128,212,80
pk 170,172,173
v_add_f32 v229, v229, v174
mvvv 128,216,96
ds_read_b128 v[196:199], v236 offset:8512
v_add_f32 v229, v229, v175
mvvv 128,220,112
buffer_load_dwordx4 v240, s[8:11], s44 offen offset:2048 nt lds
mvvv 136,220,116
s_add_u32 m0, m0, 32
ds_read_b128 v[200:203], v236 offset:8576
pk 171,174,175
mvvv 136,216,100
v_add_f32 v230, v230, v176
v_add_f32 v230, v230, v177
mvvv 136,212,84
ds_read_b128 v[204:207], v236 offset:8640
pk 176,176,177
mvvv 136,208,68
v_fma_f32 v128, v128, s38, v224
v_fma_f32 v129, v129, s38, v224
mvvv 144,208,72
v_max_f32 v243, v128, v129
v_fma_f32 v130, v130, s38, v224
mvvv 144,212,88
v_fma_f32 v131, v131, s38, v224
v_max3_f32 v243, v243, v130, v131
mvvv 144,216,104
v_fma_f32 v136, v136, s38, v225
v_fma_f32 v137, v137, s38, v225
mvvv 144,220,120
buffer_load_dwordx4 v240, s[8:11], s44 offen offset:3072 nt lds
mvvv 152,220,124
s_add_u32 s44, s44, s52
v_max3_f32 v243, v243, v136, v137
v_fma_f32 v138, v138, s38, v225
mvvv 152,216,108
v_fma_f32 v139, v139, s38, v225
v_max3_f32 v243, v243, v138, v139
mvvv 152,212,92
v_fma_f32 v144, v144, s38, v226
v_fma_f32 v145, v145, s38, v226
mvvv 152,208,76
s_waitcnt lgkmcnt(0)
v_max3_f32 v243, v243, v144, v145
v_fma_f32 v146, v146, s38, v226
mvvvz 132,192,0
ds_read_b128 v[208:211], v236 offset:8704
v_fma_f32 v147, v147, s38, v226
mvvv 132,196,16
v_max3_f32 v243, v243, v146, v147
v_add_f32 v230, v230, v178
mvvv 132,200,32
ds_read_b128 v[212:215], v236 offset:8768
v_fma_f32 v152, v152, s38, v227
mvvv 132,204,48
v_fma_f32 v153, v153, s38, v227
v_max3_f32 v243, v243, v152, v153
mvvvz 140,204,52
ds_read_b128 v[216:219], v236 offset:8832
v_fma_f32 v154, v154, s38, v227
mvvv 140,200,36
v_fma_f32 v155, v155, s38, v227
v_max3_f32 v243, v243, v154, v155
mvvv 140,196,20
ds_read_b128 v[220:223], v236 offset:8896
v_add_f32 v230, v230, v179
mvvv 140,192,4
pk 177,178,179
v_add_f32 v230, v230, v180
mvvvz 148,192,8
v_add_f32 v230, v230, v181
pk 178,180,181
mvvv 148,196,24
v_add_f32 v230, v230, v182
v_add_f32 v230, v230, v183
mvvv 148,200,40
pk 179,182,183
v_add_f32 v231, v231, v184
mvvv 148,204,56
v_add_u32 v237, s40, v233
v_add_f32 v231, v231, v185
mvvvz 156,204,60
s_add_u32 s40, s40, s42
s_cmp_eq_u32 s40, s43
s_cselect_b32 s40, 0, s40
mvvv 156,200,44
pk 184,184,185
v_add_f32 v231, v231, v186
mvvv 156,196,28
v_add_f32 v231, v231, v187
pk 185,186,187
mvvv 156,192,12
s_waitcnt lgkmcnt(0)
v_add_f32 v231, v231, v188
v_add_f32 v231, v231, v189
mvvv 132,208,64
tr 192,237,0
pk 186,188,189
mvvv 132,212,80
tr 194,237,8448
v_add_f32 v231, v231, v190
mvvv 132,216,96
tr 196,237,32
v_add_f32 v231, v231, v191
mvvv 132,220,112
pk 187,190,191
mvvv 140,220,116
tr 198,237,8480
mvvv 140,216,100
tr 200,237,64
mvvv 140,212,84
tr 202,237,8512
mvvv 140,208,68
mvvv 148,208,72
tr 204,237,96
v_fma_f32 v132, v132, s38, v224
mvvv 148,212,88
tr 206,237,8544
v_fma_f32 v133, v133, s38, v224
mvvv 148,216,104
v_max3_f32 v243, v243, v132, v133
v_fma_f32 v134, v134, s38, v224
mvvv 148,220,120
v_fma_f32 v135, v135, s38, v224
v_max3_f32 v243, v243, v134, v135
mvvv 156,220,124
v_fma_f32 v140, v140, s38, v225
v_fma_f32 v141, v141, s38, v225
mvvv 156,216,108
v_max3_f32 v243, v243, v140, v141
v_fma_f32 v142, v142, s38, v225
mvvv 156,212,92
v_fma_f32 v143, v143, s38, v225
v_max3_f32 v243, v243, v142, v143
mvvv 156,208,76
L_padC0:
s_cbranch_vccnz L_padC4
s_waitcnt lgkmcnt(1)
v_fma_f32 v148, v148, s38, v226
v_fma_f32 v149, v149, s38, v226
mavv 0,192,160
s_mov_b32 s63, 12
tr 208,237,128
v_max3_f32 v243, v243, v148, v149
mavv 4,192,168
tr 210,237,8576
v_fma_f32 v150, v150, s38, v226
mavv 8,192,176
v_fma_f32 v151, v151, s38, v226
v_max3_f32 v243, v243, v150, v151
mavv 12,192,184
tr 212,237,160
v_fma_f32 v156, v156, s38, v227
mavv 28,196,184
tr 214,237,8608
v_fma_f32 v157, v157, s38, v227
mavv 24,196,176
v_max3_f32 v243, v243, v156, v157
v_fma_f32 v158, v158, s38, v227
mavv 20,196,168
tr 216,237,192
v_fma_f32 v159, v159, s38, v227
mavv 16,196,160
tr 218,237,8640
v_max3_f32 v243, v243, v158, v159
mavv 32,200,160
v_cmp_lt_f32 vcc, s39, v243
mavv 36,200,168
tr 220,237,224
mavv 40,200,176
s_cbranch_vccnz L_rare0
L_ret12:
tr 222,237,8672
mavv 44,200,184
s_waitcnt lgkmcnt(4)
v_exp_f32 v128, v128
mavv 60,204,184
tr 192,237,256
v_add_f32 v228, v228, v128
mavv 56,204,176
tr 194,237,8704
mavv 52,204,168
v_exp_f32 v129, v129
mavv 48,204,160
tr 196,237,288
v_add_f32 v228, v228, v129
mavv 64,208,160
tr 198,237,8736
pk 128,128,129
mavv 68,208,168
v_exp_f32 v130, v130
mavv 72,208,176
tr 200,237,320
v_add_f32 v228, v228, v130
mavv 76,208,184
tr 202,237,8768
mavv 92,212,184
v_exp_f32 v131, v131
mavv 88,212,176
tr 204,237,352
v_add_f32 v228, v228, v131
mavv 84,212,168
tr 206,237,8800
pk 129,130,131
mavv 80,212,160
s_waitcnt lgkmcnt(4)
v_exp_f32 v132, v132
mavv 96,216,160
tr 208,237,384
v_add_f32 v228, v228, v132
mavv 100,216,168
tr 210,237,8832
mavv 104,216,176
v_exp_f32 v133, v133
mavv 108,216,184
tr 212,237,416
v_add_f32 v228, v228, v133
mavv 124,220,184
tr 214,237,8864
pk 130,132,133
mavv 120,220,176
v_exp_f32 v134, v134
mavv 116,220,168
tr 216,237,448
v_add_f32 v228, v228, v134
mavv 112,220,160
tr 218,237,8896
mavv 128,192,160
v_exp_f32 v135, v135
mavv 132,192,168
tr 220,237,480
v_add_f32 v228, v228, v135
mavv 136,192,176
tr 222,237,8928
pk 131,134,135
mavv 140,192,184
v_exp_f32 v136, v136
mavv 156,196,184
v_exp_f32 v137, v137
mavv 152,196,176
v_exp_f32 v138, v138
mavv 148,196,168
v_exp_f32 v139, v139
mavv 144,196,160
s_waitcnt lgkmcnt(2)
v_exp_f32 v140, v140
mavv 160,200,160
v_exp_f32 v141, v141
mavv 164,200,168
v_exp_f32 v142, v142
mavv 168,200,176
v_exp_f32 v143, v143
mavv 172,200,184
v_add_u32 v236, s40, v232
v_add_f32 v229, v229, v136
mavv 188,204,184
s_add_u32 s40, s40, s42
s_cmp_eq_u32 s40, s43
s_cselect_b32 s40, 0, s40
mavv 184,204,176
v_exp_f32 v144, v144
mavv 180,204,168
v_exp_f32 v145, v145
mavv 176,204,160
s_waitcnt vmcnt(12) lgkmcnt(0)
s_barrier
v_add_f32 v229, v229, v137
mavv 192,208,160
s_add_u32 m0, s41, s49
s_add_u32 s41, s41, s42
ds_read_b128 v[192:195], v236 offset:0
mavv 196,208,168
s_cmp_eq_u32 s41, s43
s_cselect_b32 s41, 0, s41
pk 136,136,137
mavv 200,208,176
ds_read_b128 v[196:199], v236 offset:64
v_add_f32 v229, v229, v138
mavv 204,208,184
buffer_load_dwordx4 v240, s[12:15], s45 offen nt lds
mavv 220,212,184
s_add_u32 m0, m0, 32
ds_read_b128 v[200:203], v236 offset:128
v_add_f32 v229, v229, v139
mavv 216,212,176
v_exp_f32 v146, v146
mavv 212,212,168
ds_read_b128 v[204:207], v236 offset:192
pk 137,138,139
mavv 208,212,160
buffer_load_dwordx4 v240, s[12:15], s45 offen offset:1024 nt lds
mavv 224,216,160
s_add_u32 m0, m0, 32
v_exp_f32 v147, v147
mavv 228,216,168
v_exp_f32 v148, v148
mavv 232,216,176
v_exp_f32 v149, v149
mavv 236,216,184
buffer_load_dwordx4 v240, s[12:15], s45 offen offset:2048 nt lds
mavv 252,220,184
s_add_u32 m0, m0, 32
v_exp_f32 v150, v150
mavv 248,220,176
v_exp_f32 v151, v151
mavv 244,220,168
s_waitcnt lgkmcnt(0)
v_exp_f32 v152, v152
mavv 240,220,160
buffer_load_dwordx4 v240, s[12:15], s45 offen offset:3072 nt lds
mvvvz 160,192,0
s_add_u32 s45, s45, s52
s_add_u32 m0, s41, s49
ds_read_b128 v[208:211], v236 offset:256
mvvv 160,196,16
s_add_u32 s41, s41, s42
s_cmp_eq_u32 s41, s43
s_cselect_b32 s41, 0, s41
mvvv 160,200,32
ds_read_b128 v[212:215], v236 offset:320
v_add_f32 v229, v229, v140
mvvv 160,204,48
buffer_load_dwordx4 v240, s[12:15], s45 offen nt lds
mvvvz 168,204,52
s_add_u32 m0, m0, 32
ds_read_b128 v[216:219], v236 offset:384
v_add_f32 v229, v229, v141
mvvv 168,200,36
v_exp_f32 v153, v153
mvvv 168,196,20
ds_read_b128 v[220:223], v236 offset:448
pk 138,140,141
mvvv 168,192,4
v_exp_f32 v154, v154
mvvvz 176,192,8
v_exp_f32 v155, v155
mvvv 176,196,24
v_exp_f32 v156, v156
mvvv 176,200,40
v_exp_f32 v157, v157
mvvv 176,204,56
buffer_load_dwordx4 v240, s[12:15], s45 offen offset:1024 nt lds
mvvvz 184,204,60
s_add_u32 m0, m0, 32
v_exp_f32 v158, v158
mvvv 184,200,44
v_exp_f32 v159, v159
mvvv 184,196,28
v_add_f32 v229, v229, v142
v_add_f32 v229, v229, v143
mvvv 184,192,12
s_waitcnt lgkmcnt(0)
pk 139,142,143
v_add_f32 v230, v230, v144
mvvv 160,208,64
ds_read_b128 v[192:195], v236 offset:8448
v_add_f32 v230, v230, v145
mvvv 160,212,80
pk 144,144,145
v_add_f32 v230, v230, v146
mvvv 160,216,96
ds_read_b128 v[196:199], v236 offset:8512
v_add_f32 v230, v230, v147
mvvv 160,220,112
buffer_load_dwordx4 v240, s[12:15], s45 offen offset:2048 nt lds
mvvv 168,220,116
s_add_u32 m0, m0, 32
ds_read_b128 v[200:203], v236 offset:8576
pk 145,146,147
mvvv 168,216,100
v_add_f32 v230, v230, v148
v_add_f32 v230, v230, v149
mvvv 168,212,84
ds_read_b128 v[204:207], v236 offset:8640
pk 146,148,149
mvvv 168,208,68
v_fma_f32 v160, v160, s38, v224
v_fma_f32 v161, v161, s38, v224
mvvv 176,208,72
v_max_f32 v243, v160, v161
v_fma_f32 v162, v162, s38, v224
mvvv 176,212,88
v_fma_f32 v163, v163, s38, v224
v_max3_f32 v243, v243, v162, v163
mvvv 176,216,104
v_fma_f32 v168, v168, s38, v225
v_fma_f32 v169, v169, s38, v225
mvvv 176,220,120
buffer_load_dwordx4 v240, s[12:15], s45 offen offset:3072 nt lds
mvvv 184,220,124
s_add_u32 s45, s45, s52
s_add_u32 m0, s41, s49
s_add_u32 s41, s41, s42
mvvv 184,216,108
s_cmp_eq_u32 s41, s43
s_cselect_b32 s41, 0, s41
v_max3_f32 v243, v243, v168, v169
mvvv 184,212,92
s_waitcnt lgkmcnt(0)
v_fma_f32 v170, v170, s38, v225
v_fma_f32 v171, v171, s38, v225
mvvv 184,208,76
buffer_load_dwordx4 v242, s[20:23], s47 offen lds
mvvvz 164,192,0
s_add_u32 s47, s47, s59
s_add_u32 m0, m0, s61
ds_read_b128 v[208:211], v236 offset:8704
mvvv 164,196,16
v_max3_f32 v243, v243, v170, v171
v_fma_f32 v176, v176, s38, v226
mvvv 164,200,32
ds_read_b128 v[212:215], v236 offset:8768
v_fma_f32 v177, v177, s38, v226
mvvv 164,204,48
buffer_load_dwordx4 v242, s[20:23], s47 offen lds
mvvvz 172,204,52
s_add_u32 s47, s47, s59
s_add_u32 m0, m0, s62
ds_read_b128 v[216:219], v236 offset:8832
mvvv 172,200,36
v_max3_f32 v243, v243, v176, v177
v_fma_f32 v178, v178, s38, v226
mvvv 172,196,20
ds_read_b128 v[220:223], v236 offset:8896
v_fma_f32 v179, v179, s38, v226
mvvv 172,192,4
buffer_load_dwordx4 v242, s[20:23], s47 offen lds
mvvvz 180,192,8
s_add_u32 s47, s47, s59
s_add_u32 m0, m0, s61
v_max3_f32 v243, v243, v178, v179
mvvv 180,196,24
v_fma_f32 v184, v184, s38, v227
v_fma_f32 v185, v185, s38, v227
mvvv 180,200,40
v_max3_f32 v243, v243, v184, v185
v_fma_f32 v186, v186, s38, v227
mvvv 180,204,56
v_add_u32 v237, s40, v233
v_fma_f32 v187, v187, s38, v227
mvvvz 188,204,60
s_add_u32 s40, s40, s42
s_cmp_eq_u32 s40, s43
s_cselect_b32 s40, 0, s40
mvvv 188,200,44
buffer_load_dwordx4 v242, s[20:23], s47 offen lds
mvvv 188,196,28
s_add_u32 s47, s47, s59
v_max3_f32 v243, v243, v186, v187
v_add_f32 v230, v230, v150
mvvv 188,192,12
s_waitcnt lgkmcnt(0)
v_add_f32 v230, v230, v151
pk 147,150,151
mvvv 164,208,64
tr 192,237,0
v_add_f32 v231, v231, v152
mvvv 164,212,80
tr 194,237,8448
v_add_f32 v231, v231, v153
mvvv 164,216,96
tr 196,237,32
pk 152,152,153
mvvv 164,220,112
v_add_f32 v231, v231, v154
v_add_f32 v231, v231, v155
mvvv 172,220,116
tr 198,237,8480
pk 153,154,155
mvvv 172,216,100
tr 200,237,64
v_add_f32 v231, v231, v156
mvvv 172,212,84
tr 202,237,8512
v_add_f32 v231, v231, v157
mvvv 172,208,68
pk 154,156,157
v_add_f32 v231, v231, v158
v_add_f32 v231, v231, v159
mvvv 180,208,72
tr 204,237,96
v_fma_f32 v164, v164, s38, v224
pk 155,158,159
mvvv 180,212,88
tr 206,237,8544
v_fma_f32 v165, v165, s38, v224
mvvv 180,216,104
v_max3_f32 v243, v243, v164, v165
v_fma_f32 v166, v166, s38, v224
mvvv 180,220,120
v_fma_f32 v167, v167, s38, v224
v_max3_f32 v243, v243, v166, v167
mvvv 188,220,124
v_fma_f32 v172, v172, s38, v225
v_fma_f32 v173, v173, s38, v225
mvvv 188,216,108
v_max3_f32 v243, v243, v172, v173
v_fma_f32 v174, v174, s38, v225
mvvv 188,212,92
v_fma_f32 v175, v175, s38, v225
v_max3_f32 v243, v243, v174, v175
mvvv 188,208,76
s_waitcnt lgkmcnt(1)
v_fma_f32 v180, v180, s38, v226
v_fma_f32 v181, v181, s38, v226
mavv 0,192,128
s_mov_b32 s63, 13
tr 208,237,128
v_max3_f32 v243, v243, v180, v181
mavv 4,192,136
tr 210,237,8576
v_fma_f32 v182, v182, s38, v226
mavv 8,192,144
v_fma_f32 v183, v183, s38, v226
v_max3_f32 v243, v243, v182, v183
mavv 12,192,152
tr 212,237,160
v_fma_f32 v188, v188, s38, v227
mavv 28,196,152
tr 214,237,8608
v_fma_f32 v189, v189, s38, v227
mavv 24,196,144
v_max3_f32 v243, v243, v188, v189
v_fma_f32 v190, v190, s38, v227
mavv 20,196,136
tr 216,237,192
v_fma_f32 v191, v191, s38, v227
mavv 16,196,128
tr 218,237,8640
v_max3_f32 v243, v243, v190, v191
mavv 32,200,128
v_cmp_lt_f32 vcc, s39, v243
mavv 36,200,136
tr 220,237,224
mavv 40,200,144
s_cbranch_vccnz L_rare1
L_ret13:
tr 222,237,8672
mavv 44,200,152
s_waitcnt lgkmcnt(4)
v_exp_f32 v160, v160
mavv 60,204,152
tr 192,237,256
v_add_f32 v228, v228, v160
mavv 56,204,144
tr 194,237,8704
mavv 52,204,136
v_exp_f32 v161, v161
mavv 48,204,128
tr 196,237,288
v_add_f32 v228, v228, v161
mavv 64,208,128
tr 198,237,8736
pk 160,160,161
mavv 68,208,136
v_exp_f32 v162, v162
mavv 72,208,144
tr 200,237,320
v_add_f32 v228, v228, v162
mavv 76,208,152
tr 202,237,8768
mavv 92,212,152
v_exp_f32 v163, v163
mavv 88,212,144
tr 204,237,352
v_add_f32 v228, v228, v163
mavv 84,212,136
tr 206,237,8800
pk 161,162,163
mavv 80,212,128
s_waitcnt lgkmcnt(4)
v_exp_f32 v164, v164
mavv 96,216,128
tr 208,237,384
v_add_f32 v228, v228, v164
mavv 100,216,136
tr 210,237,8832
mavv 104,216,144
v_exp_f32 v165, v165
mavv 108,216,152
tr 212,237,416
v_add_f32 v228, v228, v165
mavv 124,220,152
tr 214,237,8864
pk 162,164,165
mavv 120,220,144
v_exp_f32 v166, v166
mavv 116,220,136
tr 216,237,448
v_add_f32 v228, v228, v166
mavv 112,220,128
tr 218,237,8896
mavv 128,192,128
v_exp_f32 v167, v167
mavv 132,192,136
tr 220,237,480
v_add_f32 v228, v228, v167
mavv 136,192,144
tr 222,237,8928
pk 163,166,167
mavv 140,192,152
v_exp_f32 v168, v168
mavv 156,196,152
v_exp_f32 v169, v169
mavv 152,196,144
v_exp_f32 v170, v170
mavv 148,196,136
v_exp_f32 v171, v171
mavv 144,196,128
s_waitcnt lgkmcnt(2)
v_exp_f32 v172, v172
mavv 160,200,128
v_exp_f32 v173, v173
mavv 164,200,136
v_exp_f32 v174, v174
mavv 168,200,144
v_exp_f32 v175, v175
mavv 172,200,152
v_add_u32 v236, s40, v232
v_add_f32 v229, v229, v168
mavv 188,204,152
s_add_u32 s40, s40, s42
s_cmp_eq_u32 s40, s43
s_cselect_b32 s40, 0, s40
mavv 184,204,144
v_exp_f32 v176, v176
mavv 180,204,136
v_exp_f32 v177, v177
mavv 176,204,128
s_waitcnt vmcnt(16) lgkmcnt(0)
s_barrier
v_add_f32 v229, v229, v169
mavv 192,208,128
s_add_u32 m0, s41, s49
s_add_u32 s41, s41, s42
ds_read_b128 v[192:195], v236 offset:0
mavv 196,208,136
s_cmp_eq_u32 s41, s43
s_cselect_b32 s41, 0, s41
pk 168,168,169
mavv 200,208,144
ds_read_b128 v[196:199], v236 offset:64
v_add_f32 v229, v229, v170
mavv 204,208,152
buffer_load_dwordx4 v242, s[20:23], s47 offen lds
mavv 220,212,152
s_add_u32 s47, s47, s59
s_add_u32 m0, m0, s61
ds_read_b128 v[200:203], v236 offset:128
mavv 216,212,144
v_exp_f32 v178, v178
mavv 212,212,136
ds_read_b128 v[204:207], v236 offset:192
v_add_f32 v229, v229, v171
mavv 208,212,128
buffer_load_dwordx4 v242, s[20:23], s47 offen lds
mavv 224,216,128
s_add_u32 s47, s47, s59
s_add_u32 m0, m0, s62
pk 169,170,171
mavv 228,216,136
v_exp_f32 v179, v179
mavv 232,216,144
v_exp_f32 v180, v180
mavv 236,216,152
buffer_load_dwordx4 v242, s[20:23], s47 offen lds
mavv 252,220,152
s_add_u32 s47, s47, s59
s_add_u32 m0, m0, s61
v_add_f32 v229, v229, v172
mavv 248,220,144
v_exp_f32 v181, v181
mavv 244,220,136
s_waitcnt lgkmcnt(0)
v_exp_f32 v182, v182
mavv 240,220,128
buffer_load_dwordx4 v242, s[20:23], s47 offen lds
mvvvz 128,192,0
s_add_u32 s47, s47, s60
s_add_u32 m0, s41, s50
ds_read_b128 v[208:211], v236 offset:256
mvvv 128,196,16
s_cmp_eq_u32 s47, s83
s_cselect_b32 s47, s76, s47
s_add_u32 s41, s41, s42
mvvv 128,200,32
s_cmp_eq_u32 s41, s43
s_cselect_b32 s41, 0, s41
ds_read_b128 v[212:215], v236 offset:320
mvvv 128,204,48
buffer_load_dwordx4 v241, s[16:19], s46 offen lds
mvvvz 136,204,52
s_add_u32 s46, s46, s55
s_add_u32 m0, m0, s53
ds_read_b128 v[216:219], v236 offset:384
mvvv 136,200,36
v_exp_f32 v183, v183
mvvv 136,196,20
ds_read_b128 v[220:223], v236 offset:448
v_add_f32 v229, v229, v173
mvvv 136,192,4
v_exp_f32 v184, v184
mvvvz 144,192,8
v_exp_f32 v185, v185
mvvv 144,196,24
v_exp_f32 v186, v186
mvvv 144,200,40
v_exp_f32 v187, v187
mvvv 144,204,56
buffer_load_dwordx4 v241, s[16:19], s46 offen lds
mvvvz 152,204,60
s_add_u32 s46, s46, s56
s_add_u32 m0, m0, s54
pk 170,172,173
mvvv 152,200,44
v_exp_f32 v188, v188
mvvv 152,196,28
v_exp_f32 v189, v189
mvvv 152,192,12
s_waitcnt lgkmcnt(0)
v_exp_f32 v190, v190
mvvv 128,208,64
ds_read_b128 v[192:195], v236 offset:8448
v_add_f32 v229, v229, v174
mvvv 128,212,80
v_exp_f32 v191, v191
mvvv 128,216,96
ds_read_b128 v[196:199], v236 offset:8512
v_add_f32 v229, v229, v175
mvvv 128,220,112
buffer_load_dwordx4 v241, s[16:19], s46 offen lds
mvvv 136,220,116
s_add_u32 s46, s46, s55
s_add_u32 m0, m0, s53
ds_read_b128 v[200:203], v236 offset:8576
mvvv 136,216,100
pk 171,174,175
v_add_f32 v230, v230, v176
mvvv 136,212,84
ds_read_b128 v[204:207], v236 offset:8640
v_fma_f32 v128, v128, s38, v224
mvvv 136,208,68
v_fma_f32 v129, v129, s38, v224
v_max_f32 v243, v128, v129
mvvv 144,208,72
v_fma_f32 v130, v130, s38, v224
v_fma_f32 v131, v131, s38, v224
mvvv 144,212,88
v_max3_f32 v243, v243, v130, v131
v_add_f32 v230, v230, v177
mvvv 144,216,104
L_padC1:
s_cbranch_vccnz L_hop_a
v_fma_f32 v136, v136, s38, v225
v_fma_f32 v137, v137, s38, v225
mvvv 144,220,120
buffer_load_dwordx4 v241, s[16:19], s46 offen lds
mvvv 152,220,124
s_add_u32 s46, s46, s57
s_cmp_eq_u32 s46, s82
s_cselect_b32 s46, s58, s46
mvvv 152,216,108
s_add_u32 m0, s41, s49
s_add_u32 s41, s41, s42
v_max3_f32 v243, v243, v136, v137
mvvv 152,212,92
s_waitcnt lgkmcnt(0)
s_cmp_eq_u32 s41, s43
s_cselect_b32 s41, 0, s41
mvvv 152,208,76
buffer_load_dwordx4 v242, s[20:23], s47 offen lds
mvvvz 132,192,0
s_add_u32 s47, s47, s59
s_add_u32 m0, m0, s61
ds_read_b128 v[208:211], v236 offset:8704
mvvv 132,196,16
v_fma_f32 v138, v138, s38, v225
v_fma_f32 v139, v139, s38, v225
mvvv 132,200,32
ds_read_b128 v[212:215], v236 offset:8768
v_max3_f32 v243, v243, v138, v139
mvvv 132,204,48
buffer_load_dwordx4 v242, s[20:23], s47 offen lds
mvvvz 140,204,52
s_add_u32 s47, s47, s59
s_add_u32 m0, m0, s62
ds_read_b128 v[216:219], v236 offset:8832
mvvv 140,200,36
v_fma_f32 v144, v144, s38, v226
v_fma_f32 v145, v145, s38, v226
mvvv 140,196,20
ds_read_b128 v[220:223], v236 offset:8896
v_max3_f32 v243, v243, v144, v145
mvvv 140,192,4
buffer_load_dwordx4 v242, s[20:23], s47 offen lds
mvvvz 148,192,8
s_add_u32 s47, s47, s59
s_add_u32 m0, m0, s61
v_fma_f32 v146, v146, s38, v226
mvvv 148,196,24
v_fma_f32 v147, v147, s38, v226
v_max3_f32 v243, v243, v146, v147
mvvv 148,200,40
v_fma_f32 v152, v152, s38, v227
v_fma_f32 v153, v153, s38, v227
mvvv 148,204,56
v_add_u32 v237, s40, v233
v_max3_f32 v243, v243, v152, v153
mvvvz 156,204,60
s_add_u32 s40, s40, s42
s_cmp_eq_u32 s40, s43
s_cselect_b32 s40, 0, s40
mvvv 156,200,44
buffer_load_dwordx4 v242, s[20:23], s47 offen lds
mvvv 156,196,28
s_add_u32 s47, s47, s59
v_fma_f32 v154, v154, s38, v227
v_fma_f32 v155, v155, s38, v227
mvvv 156,192,12
s_waitcnt lgkmcnt(0)
v_max3_f32 v243, v243, v154, v155
pk 176,176,177
mvvv 132,208,64
tr 192,237,0
v_add_f32 v230, v230, v178
mvvv 132,212,80
tr 194,237,8448
v_add_f32 v230, v230, v179
mvvv 132,216,96
tr 196,237,32
pk 177,178,179
mvvv 132,220,112
v_add_f32 v230, v230, v180
v_add_f32 v230, v230, v181
mvvv 140,220,116
tr 198,237,8480
pk 178,180,181
mvvv 140,216,100
tr 200,237,64
v_add_f32 v230, v230, v182
mvvv 140,212,84
tr 202,237,8512
v_add_f32 v230, v230, v183
mvvv 140,208,68
pk 179,182,183
v_add_f32 v231, v231, v184
v_add_f32 v231, v231, v185
mvvv 148,208,72
tr 204,237,96
v_fma_f32 v132, v132, s38, v224
pk 184,184,185
mvvv 148,212,88
tr 206,237,8544
v_fma_f32 v133, v133, s38, v224
v_add_f32 v231, v231, v186
mvvv 148,216,104
v_max3_f32 v243, v243, v132, v133
v_fma_f32 v134, v134, s38, v224
v_add_f32 v231, v231, v187
mvvv 148,220,120
v_fma_f32 v135, v135, s38, v224
v_max3_f32 v243, v243, v134, v135
pk 185,186,187
mvvv 156,220,124
v_fma_f32 v140, v140, s38, v225
v_fma_f32 v141, v141, s38, v225
v_add_f32 v231, v231, v188
mvvv 156,216,108
v_max3_f32 v243, v243, v140, v141
v_fma_f32 v142, v142, s38, v225
v_add_f32 v231, v231, v189
mvvv 156,212,92
v_fma_f32 v143, v143, s38, v225
v_max3_f32 v243, v243, v142, v143
pk 186,188,189
v_add_f32 v231, v231, v190
v_add_f32 v231, v231, v191
pk 187,190,191
mvvv 156,208,76
s_waitcnt lgkmcnt(1)
v_fma_f32 v148, v148, s38, v226
v_fma_f32 v149, v149, s38, v226
mavv 0,192,160
s_mov_b32 s63, 14
tr 208,237,128
v_max3_f32 v243, v243, v148, v149
mavv 4,192,168
tr 210,237,8576
v_fma_f32 v150, v150, s38, v226
mavv 8,192,176
v_fma_f32 v151, v151, s38, v226
v_max3_f32 v243, v243, v150, v151
mavv 12,192,184
tr 212,237,160
v_fma_f32 v156, v156, s38, v227
mavv 28,196,184
tr 214,237,8608
v_fma_f32 v157, v157, s38, v227
mavv 24,196,176
v_max3_f32 v243, v243, v156, v157
v_fma_f32 v158, v158, s38, v227
mavv 20,196,168
tr 216,237,192
v_fma_f32 v159, v159, s38, v227
mavv 16,196,160
tr 218,237,8640
v_max3_f32 v243, v243, v158, v159
mavv 32,200,160
v_cmp_lt_f32 vcc, s39, v243
mavv 36,200,168
tr 220,237,224
mavv 40,200,176
s_cbranch_vccnz L_rare0
L_ret14:
tr 222,237,8672
mavv 44,200,184
s_waitcnt lgkmcnt(4)
v_exp_f32 v128, v128
mavv 60,204,184
tr 192,237,256
v_add_f32 v228, v228, v128
mavv 56,204,176
tr 194,237,8704
mavv 52,204,168
v_exp_f32 v129, v129
mavv 48,204,160
tr 196,237,288
v_add_f32 v228, v228, v129
mavv 64,208,160
tr 198,237,8736
pk 128,128,129
mavv 68,208,168
v_exp_f32 v130, v130
mavv 72,208,176
tr 200,237,320
v_add_f32 v228, v228, v130
mavv 76,208,184
tr 202,237,8768
mavv 92,212,184
v_exp_f32 v131, v131
mavv 88,212,176
tr 204,237,352
v_lshrrev_b32 v239, 6, v240
mavv 84,212,168
tr 206,237,8800
v_mul_u32_u24 v239, s95, v239
mavv 80,212,160
s_waitcnt lgkmcnt(4)
v_bfe_u32 v238, v240, 4, 2
v_lshl_add_u32 v238, v238, 7, v239
mavv 96,216,160
tr 208,237,384
v_add_f32 v228, v228, v131
mavv 100,216,168
tr 210,237,8832
pk 129,130,131
mavv 104,216,176
s_mov_b32 m0, s73
v_exp_f32 v132, v132
mavv 108,216,184
tr 212,237,416
v_add_f32 v228, v228, v132
mavv 124,220,184
tr 214,237,8864
mavv 120,220,176
buffer_load_dword v238, s[84:87], s94 offen lds
mavv 116,220,168
tr 216,237,448
mavv 112,220,160
tr 218,237,8896
mavv 128,192,160
v_exp_f32 v133, v133
mavv 132,192,168
tr 220,237,480
v_add_f32 v228, v228, v133
mavv 136,192,176
tr 222,237,8928
pk 130,132,133
mavv 140,192,184
v_exp_f32 v134, v134
mavv 156,196,184
v_exp_f32 v135, v135
mavv 152,196,176
v_exp_f32 v136, v136
mavv 148,196,168
v_exp_f32 v137, v137
mavv 144,196,160
s_waitcnt lgkmcnt(2)
v_exp_f32 v138, v138
mavv 160,200,160
v_exp_f32 v139, v139
mavv 164,200,168
v_exp_f32 v140, v140
mavv 168,200,176
v_exp_f32 v141, v141
mavv 172,200,184
v_add_u32 v236, s40, v232
v_add_f32 v228, v228, v134
mavv 188,204,184
s_add_u32 s40, s40, s42
s_cmp_eq_u32 s40, s43
s_cselect_b32 s40, 0, s40
mavv 184,204,176
v_exp_f32 v142, v142
mavv 180,204,168
v_exp_f32 v143, v143
mavv 176,204,160
s_waitcnt vmcnt(21) lgkmcnt(0)
s_barrier
v_add_f32 v228, v228, v135
mavv 192,208,160
s_add_u32 m0, s41, s49
s_add_u32 s41, s41, s42
ds_read_b128 v[192:195], v236 offset:0
mavv 196,208,168
s_cmp_eq_u32 s41, s43
s_cselect_b32 s41, 0, s41
pk 131,134,135
mavv 200,208,176
ds_read_b128 v[196:199], v236 offset:64
v_add_f32 v229, v229, v136
mavv 204,208,184
buffer_load_dwordx4 v242, s[20:23], s47 offen lds
mavv 220,212,184
s_add_u32 s47, s47, s59
s_add_u32 m0, m0, s61
ds_read_b128 v[200:203], v236 offset:128
mavv 216,212,176
v_exp_f32 v144, v144
mavv 212,212,168
ds_read_b128 v[204:207], v236 offset:192
v_add_f32 v229, v229, v137
mavv 208,212,160
buffer_load_dwordx4 v242, s[20:23], s47 offen lds
mavv 224,216,160
s_add_u32 s47, s47, s59
s_add_u32 m0, m0, s62
pk 136,136,137
mavv 228,216,168
v_exp_f32 v145, v145
mavv 232,216,176
v_exp_f32 v146, v146
mavv 236,216,184
buffer_load_dwordx4 v242, s[20:23], s47 offen lds
mavv 252,220,184
s_add_u32 s47, s47, s59
s_add_u32 m0, m0, s61
v_add_f32 v229, v229, v138
mavv 248,220,176
v_exp_f32 v147, v147
mavv 244,220,168
s_waitcnt lgkmcnt(0)
v_exp_f32 v148, v148
mavv 240,220,160
buffer_load_dwordx4 v242, s[20:23], s47 offen lds
mvvvz 160,192,0
s_add_u32 s47, s47, s60
s_add_u32 m0, s41, s50
ds_read_b128 v[208:211], v236 offset:256
mvvv 160,196,16
s_cmp_eq_u32 s47, s83
s_cselect_b32 s47, s76, s47
s_add_u32 s41, s41, s42
mvvv 160,200,32
s_cmp_eq_u32 s41, s43
s_cselect_b32 s41, 0, s41
ds_read_b128 v[212:215], v236 offset:320
mvvv 160,204,48
buffer_load_dwordx4 v241, s[16:19], s46 offen lds
mvvvz 168,204,52
s_add_u32 s46, s46, s55
s_add_u32 m0, m0, s53
ds_read_b128 v[216:219], v236 offset:384
mvvv 168,200,36
v_exp_f32 v149, v149
mvvv 168,196,20
ds_read_b128 v[220:223], v236 offset:448
v_add_f32 v229, v229, v139
mvvv 168,192,4
v_exp_f32 v150, v150
mvvvz 176,192,8
v_exp_f32 v151, v151
mvvv 176,196,24
v_exp_f32 v152, v152
mvvv 176,200,40
v_exp_f32 v153, v153
mvvv 176,204,56
buffer_load_dwordx4 v241, s[16:19], s46 offen lds
mvvvz 184,204,60
s_add_u32 s46, s46, s56
s_add_u32 m0, m0, s54
pk 137,138,139
mvvv 184,200,44
v_exp_f32 v154, v154
mvvv 184,196,28
v_exp_f32 v155, v155
mvvv 184,192,12
s_waitcnt lgkmcnt(0)
v_exp_f32 v156, v156
mvvv 160,208,64
ds_read_b128 v[192:195], v236 offset:8448
v_add_f32 v229, v229, v140
mvvv 160,212,80
v_exp_f32 v157, v157
mvvv 160,216,96
ds_read_b128 v[196:199], v236 offset:8512
v_add_f32 v229, v229, v141
mvvv 160,220,112
buffer_load_dwordx4 v241, s[16:19], s46 offen lds
mvvv 168,220,116
s_add_u32 s46, s46, s55
s_add_u32 m0, m0, s53
ds_read_b128 v[200:203], v236 offset:8576
mvvv 168,216,100
v_exp_f32 v158, v158
mvvv 168,212,84
ds_read_b128 v[204:207], v236 offset:8640
v_fma_f32 v160, v160, s38, v224
mvvv 168,208,68
v_fma_f32 v161, v161, s38, v224
v_max_f32 v243, v160, v161
mvvv 176,208,72
v_fma_f32 v162, v162, s38, v224
v_fma_f32 v163, v163, s38, v224
mvvv 176,212,88
v_max3_f32 v243, v243, v162, v163
pk 138,140,141
mvvv 176,216,104
v_fma_f32 v168, v168, s38, v225
v_fma_f32 v169, v169, s38, v225
mvvv 176,220,120
buffer_load_dwordx4 v241, s[16:19], s46 offen lds
mvvv 184,220,124
s_add_u32 s46, s46, s57
s_cmp_eq_u32 s46, s82
s_cselect_b32 s46, s58, s46
mvvv 184,216,108
v_lshrrev_b32 v239, 6, v240
v_mul_u32_u24 v239, s95, v239
mvvv 184,212,92
v_bfe_u32 v238, v240, 4, 2
v_lshl_add_u32 v238, v238, 7, v239
mvvv 184,208,76
s_waitcnt lgkmcnt(0)
v_max3_f32 v243, v243, v168, v169
v_fma_f32 v170, v170, s38, v225
mvvvz 164,192,0
s_mov_b32 m0, s73
ds_read_b128 v[208:211], v236 offset:8704
v_fma_f32 v171, v171, s38, v225
mvvv 164,196,16
v_max3_f32 v243, v243, v170, v171
v_fma_f32 v176, v176, s38, v226
mvvv 164,200,32
ds_read_b128 v[212:215], v236 offset:8768
v_fma_f32 v177, v177, s38, v226
mvvv 164,204,48
buffer_load_dword v238, s[84:87], s64 offen lds
mvvvz 172,204,52
s_mov_b32 s84, s34
s_mov_b32 s85, s35
ds_read_b128 v[216:219], v236 offset:8832
mvvv 172,200,36
s_cmp_eq_u32 s4, 0
s_cselect_b32 s86, 4, 0
v_mov_b32 v239, s51
mvvv 172,196,20
ds_read_b128 v[220:223], v236 offset:8896
v_max3_f32 v243, v243, v176, v177
mvvv 172,192,4
v_fma_f32 v178, v178, s38, v226
v_fma_f32 v179, v179, s38, v226
mvvvz 180,192,8
v_max3_f32 v243, v243, v178, v179
v_fma_f32 v184, v184, s38, v227
mvvv 180,196,24
v_fma_f32 v185, v185, s38, v227
v_max3_f32 v243, v243, v184, v185
mvvv 180,200,40
v_fma_f32 v186, v186, s38, v227
v_fma_f32 v187, v187, s38, v227
mvvv 180,204,56
v_add_u32 v237, s40, v233
v_max3_f32 v243, v243, v186, v187
mvvvz 188,204,60
s_add_u32 s40, s40, s42
s_cmp_eq_u32 s40, s43
s_cselect_b32 s40, 0, s40
mvvv 188,200,44
v_exp_f32 v159, v159
mvvv 188,196,28
buffer_atomic_add v239, v240, s[84:87], 0 offen
mvvv 188,192,12
s_waitcnt lgkmcnt(0)
s_mov_b32 s84, s78
s_mov_b32 s85, s79
mvvv 164,208,64
s_mov_b32 s86, L_code_end-L_code_pf
tr 192,237,0
v_add_f32 v229, v229, v142
mvvv 164,212,80
tr 194,237,8448
v_add_f32 v229, v229, v143
mvvv 164,216,96
tr 196,237,32
pk 139,142,143
mvvv 164,220,112
v_add_f32 v230, v230, v144
v_add_f32 v230, v230, v145
mvvv 172,220,116
tr 198,237,8480
pk 144,144,145
mvvv 172,216,100
tr 200,237,64
v_add_f32 v230, v230, v146
mvvv 172,212,84
tr 202,237,8512
v_add_f32 v230, v230, v147
mvvv 172,208,68
pk 145,146,147
v_add_f32 v230, v230, v148
v_add_f32 v230, v230, v149
mvvv 180,208,72
tr 204,237,96
v_fma_f32 v164, v164, s38, v224
pk 146,148,149
mvvv 180,212,88
tr 206,237,8544
v_fma_f32 v165, v165, s38, v224
v_add_f32 v230, v230, v150
mvvv 180,216,104
v_max3_f32 v243, v243, v164, v165
v_fma_f32 v166, v166, s38, v224
v_add_f32 v230, v230, v151
mvvv 180,220,120
v_fma_f32 v167, v167, s38, v224
v_max3_f32 v243, v243, v166, v167
pk 147,150,151
mvvv 188,220,124
v_fma_f32 v172, v172, s38, v225
v_fma_f32 v173, v173, s38, v225
v_add_f32 v231, v231, v152
mvvv 188,216,108
v_max3_f32 v243, v243, v172, v173
v_fma_f32 v174, v174, s38, v225
v_add_f32 v231, v231, v153
mvvv 188,212,92
v_fma_f32 v175, v175, s38, v225
v_max3_f32 v243, v243, v174, v175
pk 152,152,153
v_add_f32 v231, v231, v154
v_add_f32 v231, v231, v155
pk 153,154,155
v_add_f32 v231, v231, v156
v_add_f32 v231, v231, v157
pk 154,156,157
v_add_f32 v231, v231, v158
v_add_f32 v231, v231, v159
pk 155,158,159
mvvv 188,208,76
s_waitcnt lgkmcnt(1)
v_fma_f32 v180, v180, s38, v226
v_fma_f32 v181, v181, s38, v226
mavv 0,192,128
s_mov_b32 s63, 15
tr 208,237,128
v_max3_f32 v243, v243, v180, v181
mavv 4,192,136
tr 210,237,8576
v_fma_f32 v182, v182, s38, v226
mavv 8,192,144
v_fma_f32 v183, v183, s38, v226
v_max3_f32 v243, v243, v182, v183
mavv 12,192,152
tr 212,237,160
v_fma_f32 v188, v188, s38, v227
mavv 28,196,152
tr 214,237,8608
v_fma_f32 v189, v189, s38, v227
mavv 24,196,144
v_max3_f32 v243, v243, v188, v189
v_fma_f32 v190, v190, s38, v227
mavv 20,196,136
tr 216,237,192
v_fma_f32 v191, v191, s38, v227
mavv 16,196,128
tr 218,237,8640
v_max3_f32 v243, v243, v190, v191
mavv 32,200,128
v_cmp_lt_f32 vcc, s39, v243
mavv 36,200,136
tr 220,237,224
mavv 40,200,144
s_cbranch_vccnz L_rare1
L_ret15:
tr 222,237,8672
mavv 44,200,152
s_waitcnt lgkmcnt(4)
v_exp_f32 v160, v160
mavv 60,204,152
tr 192,237,256
mavv 56,204,144
tr 194,237,8704
mavv 52,204,136
v_exp_f32 v161, v161
mavv 48,204,128
tr 196,237,288
v_add_f32 v228, v228, v160
mavv 64,208,128
tr 198,237,8736
mavv 68,208,136
v_exp_f32 v162, v162
mavv 72,208,144
tr 200,237,320
v_add_f32 v228, v228, v161
mavv 76,208,152
tr 202,237,8768
pk 160,160,161
mavv 92,212,152
v_exp_f32 v163, v163
mavv 88,212,144
tr 204,237,352
v_add_f32 v228, v228, v162
mavv 84,212,136
tr 206,237,8800
mavv 80,212,128
s_waitcnt lgkmcnt(4)
v_exp_f32 v164, v164
mavv 96,216,128
tr 208,237,384
v_add_f32 v228, v228, v163
mavv 100,216,136
tr 210,237,8832
pk 161,162,163
mavv 104,216,144
v_exp_f32 v165, v165
mavv 108,216,152
tr 212,237,416
v_add_f32 v228, v228, v164
mavv 124,220,152
tr 214,237,8864
mavv 120,220,144
v_exp_f32 v166, v166
mavv 116,220,136
tr 216,237,448
v_add_f32 v228, v228, v165
mavv 112,220,128
tr 218,237,8896
pk 162,164,165
mavv 128,192,128
v_exp_f32 v167, v167
mavv 132,192,136
tr 220,237,480
v_add_f32 v228, v228, v166
mavv 136,192,144
tr 222,237,8928
mavv 140,192,152
L_padC2:
s_cbranch_vccnz L_hop_a
v_exp_f32 v168, v168
mavv 156,196,152
v_add_f32 v228, v228, v167
pk 163,166,167
mavv 152,196,144
v_exp_f32 v169, v169
mavv 148,196,136
v_add_f32 v229, v229, v168
mavv 144,196,128
s_waitcnt lgkmcnt(2)
v_exp_f32 v170, v170
mavv 160,200,128
v_add_f32 v229, v229, v169
pk 168,168,169
mavv 164,200,136
v_exp_f32 v171, v171
mavv 168,200,144
v_add_f32 v229, v229, v170
mavv 172,200,152
v_add_u32 v237, s40, v233
mavv 188,204,152
s_add_u32 s40, s40, s42
s_cmp_eq_u32 s40, s43
s_cselect_b32 s40, 0, s40
mavv 184,204,144
v_exp_f32 v172, v172
mavv 180,204,136
v_add_f32 v229, v229, v171
pk 169,170,171
mavv 176,204,128
s_waitcnt vmcnt(27) lgkmcnt(0)
s_barrier
mavv 192,208,128
s_add_u32 m0, s41, s49
s_add_u32 s41, s41, s42
tr 192,237,0
mavv 196,208,136
s_cmp_eq_u32 s41, s43
s_cselect_b32 s41, 0, s41
tr 194,237,8448
mavv 200,208,144
tr 196,237,32
mavv 204,208,152
buffer_load_dwordx4 v242, s[20:23], s47 offen lds
mavv 220,212,152
s_add_u32 s47, s47, s59
s_add_u32 m0, m0, s61
tr 198,237,8480
mavv 216,212,144
tr 200,237,64
mavv 212,212,136
tr 202,237,8512
mavv 208,212,128
buffer_load_dwordx4 v242, s[20:23], s47 offen lds
mavv 224,216,128
s_add_u32 s47, s47, s59
s_add_u32 m0, m0, s62
tr 204,237,96
mavv 228,216,136
tr 206,237,8544
mavv 232,216,144
v_exp_f32 v173, v173
mavv 236,216,152
buffer_load_dwordx4 v242, s[20:23], s47 offen lds
mavv 252,220,152
s_add_u32 s47, s47, s59
s_add_u32 m0, m0, s61
v_add_f32 v229, v229, v172
mavv 248,220,144
v_exp_f32 v174, v174
mavv 244,220,136
v_add_f32 v229, v229, v173
pk 170,172,173
mavv 240,220,128
buffer_load_dwordx4 v242, s[20:23], s47 offen lds
s_waitcnt lgkmcnt(6)
s_add_u32 s47, s47, s59
s_add_u32 m0, s41, s49
s_add_u32 s41, s41, s42
s_cmp_eq_u32 s41, s43
s_cselect_b32 s41, 0, s41
v_exp_f32 v175, v175
v_add_f32 v229, v229, v174
v_exp_f32 v176, v176
v_add_f32 v229, v229, v175
pk 171,174,175
v_exp_f32 v177, v177
v_add_f32 v230, v230, v176
v_exp_f32 v178, v178
v_add_f32 v230, v230, v177
pk 176,176,177
v_exp_f32 v179, v179
v_add_f32 v230, v230, v178
v_exp_f32 v180, v180
v_add_f32 v230, v230, v179
pk 177,178,179
v_exp_f32 v181, v181
v_add_f32 v230, v230, v180
v_exp_f32 v182, v182
v_add_f32 v230, v230, v181
pk 178,180,181
v_exp_f32 v183, v183
v_add_f32 v230, v230, v182
v_exp_f32 v184, v184
v_add_f32 v230, v230, v183
pk 179,182,183
v_exp_f32 v185, v185
v_add_f32 v231, v231, v184
v_exp_f32 v186, v186
v_add_f32 v231, v231, v185
pk 184,184,185
v_exp_f32 v187, v187
v_add_f32 v231, v231, v186
v_exp_f32 v188, v188
v_add_f32 v231, v231, v187
pk 185,186,187
v_exp_f32 v189, v189
v_add_f32 v231, v231, v188
v_exp_f32 v190, v190
v_add_f32 v231, v231, v189
pk 186,188,189
v_exp_f32 v191, v191
v_add_f32 v231, v231, v190
s_nop 0
v_add_f32 v231, v231, v191
pk 187,190,191
s_nop 1
mavv 0,192,160
tr 208,237,128
v_mov_b32 v244, v228
v_mov_b32 v245, v229
mavv 4,192,168
tr 210,237,8576
v_mov_b32 v246, v230
v_mov_b32 v247, v231
mavv 8,192,176
buffer_load_dwordx4 v242, s[20:23], s47 offen lds
v_permlane32_swap_b32 v228, v244
v_permlane32_swap_b32 v229, v245
mavv 12,192,184
s_waitcnt lgkmcnt(2)
s_add_u32 s47, s47, s59
tr 212,237,160
v_permlane32_swap_b32 v230, v246
mavv 28,196,184
s_add_u32 m0, m0, s61
tr 214,237,8608
v_permlane32_swap_b32 v231, v247
v_add_f32 v228, v228, v244
v_add_f32 v229, v229, v245
mavv 24,196,176
v_add_f32 v230, v230, v246
v_add_f32 v231, v231, v247
v_mov_b32 v244, v228
mavv 20,196,168
tr 216,237,192
v_mov_b32 v245, v229
v_mov_b32 v246, v230
mavv 16,196,160
tr 218,237,8640
v_mov_b32 v247, v231
v_permlane16_swap_b32 v228, v244
v_permlane16_swap_b32 v229, v245
mavv 32,200,160
buffer_load_dwordx4 v242, s[20:23], s47 offen lds
v_permlane16_swap_b32 v230, v246
mavv 36,200,168
s_add_u32 s47, s47, s59
s_add_u32 m0, m0, s62
tr 220,237,224
v_permlane16_swap_b32 v231, v247
v_add_f32 v228, v228, v244
mavv 40,200,176
tr 222,237,8672
v_add_f32 v229, v229, v245
v_add_f32 v230, v230, v246
mavv 44,200,184
v_add_f32 v231, v231, v247
v_rcp_f32 v250, v228
mavv 60,204,184
tr 192,237,256
v_rcp_f32 v251, v229
mavv 56,204,176
tr 194,237,8704
v_rcp_f32 v252, v230
mavv 52,204,168
buffer_load_dwordx4 v242, s[20:23], s47 offen lds
v_rcp_f32 v253, v231
mavv 48,204,160
s_waitcnt lgkmcnt(4)
s_add_u32 s47, s47, s59
tr 196,237,288
mavv 64,208,160
s_add_u32 m0, m0, s61
tr 198,237,8736
v_accvgpr_read_b32 v64, a0
v_accvgpr_read_b32 v65, a1
mavv 68,208,168
v_accvgpr_read_b32 v66, a2
v_accvgpr_read_b32 v67, a3
v_accvgpr_read_b32 v68, a16
mavv 72,208,176
tr 200,237,320
v_accvgpr_read_b32 v69, a17
mavv 76,208,184
tr 202,237,8768
v_accvgpr_read_b32 v70, a18
v_accvgpr_read_b32 v71, a19
mavv 92,212,184
buffer_load_dwordx4 v242, s[20:23], s47 offen lds
v_mul_f32 v64, v64, v250
mavv 88,212,176
s_add_u32 s47, s47, s60
tr 204,237,352
v_mul_f32 v65, v65, v250
mavv 84,212,168
s_cmp_eq_u32 s47, s83
s_cselect_b32 s47, s76, s47
tr 206,237,8800
v_mul_f32 v66, v66, v250
mavv 80,212,160
v_mul_f32 v67, v67, v250
v_mul_f32 v68, v68, v250
v_mul_f32 v69, v69, v250
mavv 96,216,160
tr 208,237,384
v_mul_f32 v70, v70, v250
v_mul_f32 v71, v71, v250
mavv 100,216,168
tr 210,237,8832
pk 16,64,65
mavv 104,216,176
pk 17,66,67
pk 18,68,69
pk 19,70,71
mavv 108,216,184
s_waitcnt lgkmcnt(4)
tr 212,237,416
v_accvgpr_read_b32 v72, a4
v_accvgpr_read_b32 v73, a5
mavv 124,220,184
tr 214,237,8864
v_accvgpr_read_b32 v74, a6
mavv 120,220,176
v_accvgpr_read_b32 v75, a7
v_accvgpr_read_b32 v76, a20
v_accvgpr_read_b32 v77, a21
mavv 116,220,168
tr 216,237,448
v_accvgpr_read_b32 v78, a22
v_accvgpr_read_b32 v79, a23
v_accvgpr_read_b32 v80, a8
mavv 112,220,160
tr 218,237,8896
v_mul_f32 v72, v72, v251
v_accvgpr_read_b32 v81, a9
v_accvgpr_read_b32 v82, a10
v_accvgpr_read_b32 v83, a11
mavv 128,192,160
buffer_store_dwordx4 v[16:19], v240, s[24:27], s48 offen nt
v_mul_f32 v73, v73, v251
v_accvgpr_read_b32 v84, a24
mavv 132,192,168
tr 220,237,480
v_mul_f32 v74, v74, v251
v_mul_f32 v75, v75, v251
v_accvgpr_read_b32 v85, a25
v_accvgpr_read_b32 v86, a26
mavv 136,192,176
tr 222,237,8928
v_mul_f32 v76, v76, v251
v_mul_f32 v77, v77, v251
v_accvgpr_read_b32 v87, a27
v_mul_f32 v80, v80, v252
mavv 140,192,184
v_mul_f32 v78, v78, v251
v_mul_f32 v79, v79, v251
v_mul_f32 v81, v81, v252
v_mul_f32 v82, v82, v252
mavv 156,196,184
v_add_u32 v239, s40, v235
pk 20,72,73
pk 21,74,75
v_mul_f32 v83, v83, v252
v_mul_f32 v84, v84, v252
mavv 152,196,176
s_add_u32 s40, s40, s42
s_cmp_eq_u32 s40, s43
s_cselect_b32 s40, 0, s40
pk 22,76,77
v_mul_f32 v85, v85, v252
mavv 148,196,168
pk 23,78,79
v_mul_f32 v86, v86, v252
v_mul_f32 v87, v87, v252
pk 24,80,81
pk 25,82,83
mavv 144,196,160
s_waitcnt vmcnt(15) lgkmcnt(0)
s_barrier
pk 26,84,85
pk 27,86,87
v_accvgpr_read_b32 v88, a12
v_accvgpr_read_b32 v89, a13
mavv 160,200,160
s_add_u32 m0, s41, s50
s_add_u32 s41, s41, s42
ds_read_b128 a[0:3], v239 offset:0
v_accvgpr_read_b32 v90, a14
v_accvgpr_read_b32 v91, a15
mavv 164,200,168
s_cmp_eq_u32 s41, s43
s_cselect_b32 s41, 0, s41
ds_read_b128 a[16:19], v239 offset:64
v_accvgpr_read_b32 v92, a28
v_accvgpr_read_b32 v93, a29
v_accvgpr_read_b32 v94, a30
mavv 168,200,176
buffer_load_dwordx4 v241, s[16:19], s46 offen lds
v_accvgpr_read_b32 v95, a31
v_mul_f32 v88, v88, v253
mavv 172,200,184
s_add_u32 s46, s46, s55
s_add_u32 m0, m0, s53
ds_read_b128 a[4:7], v239 offset:2112
v_mul_f32 v89, v89, v253
v_mul_f32 v90, v90, v253
v_mul_f32 v91, v91, v253
mavv 188,204,184
ds_read_b128 a[20:23], v239 offset:2176
v_add_u32 v239, s40, v235
v_mul_f32 v92, v92, v253
v_mul_f32 v93, v93, v253
v_mul_f32 v94, v94, v253
mavv 184,204,176
buffer_store_dwordx4 v[20:23], v240, s[24:27], s48 offen offset:1024 nt
v_mul_f32 v95, v95, v253
pk 28,88,89
mavv 180,204,168
buffer_load_dwordx4 v241, s[16:19], s46 offen lds
pk 29,90,91
pk 30,92,93
pk 31,94,95
mavv 176,204,160
s_add_u32 s46, s46, s56
s_add_u32 m0, m0, s54
ds_read_b128 a[8:11], v239 offset:0
v_accvgpr_read_b32 v96, a32
v_accvgpr_read_b32 v97, a33
mavv 192,208,160
s_add_u32 s40, s40, s42
ds_read_b128 a[24:27], v239 offset:64
v_accvgpr_read_b32 v98, a34
v_accvgpr_read_b32 v99, a35
v_accvgpr_read_b32 v100, a48
mavv 196,208,168
s_cmp_eq_u32 s40, s43
s_cselect_b32 s40, 0, s40
ds_read_b128 a[12:15], v239 offset:2112
v_accvgpr_read_b32 v101, a49
mavv 200,208,176
ds_read_b128 a[28:31], v239 offset:2176
v_add_u32 v238, s40, v234
v_accvgpr_read_b32 v102, a50
v_accvgpr_read_b32 v103, a51
mavv 204,208,184
buffer_load_dwordx4 v241, s[16:19], s46 offen lds
v_mul_f32 v96, v96, v250
v_mul_f32 v97, v97, v250
mavv 220,212,184
s_add_u32 s46, s46, s55
s_add_u32 m0, m0, s53
tr 192,238,0
v_mul_f32 v98, v98, v250
v_mul_f32 v99, v99, v250
mavv 216,212,176
s_add_u32 s40, s40, s42
tr 194,238,256
v_mul_f32 v100, v100, v250
v_mul_f32 v101, v101, v250
v_mul_f32 v102, v102, v250
mavv 212,212,168
s_cmp_eq_u32 s40, s43
s_cselect_b32 s40, 0, s40
tr 196,238,8448
v_mul_f32 v103, v103, v250
mavv 208,212,160
buffer_load_dwordx4 v241, s[16:19], s46 offen lds
pk 32,96,97
pk 33,98,99
mavv 224,216,160
s_add_u32 s46, s46, s57
tr 198,238,8704
pk 34,100,101
pk 35,102,103
v_accvgpr_read_b32 v104, a36
mavv 228,216,168
s_cmp_eq_u32 s46, s82
s_cselect_b32 s46, s58, s46
tr 200,238,8
v_accvgpr_read_b32 v105, a37
v_accvgpr_read_b32 v106, a38
mavv 232,216,176
tr 202,238,264
v_accvgpr_read_b32 v107, a39
v_accvgpr_read_b32 v108, a52
v_accvgpr_read_b32 v109, a53
mavv 236,216,184
tr 204,238,8456
v_accvgpr_read_b32 v110, a54
v_accvgpr_read_b32 v111, a55
mavv 252,220,184
tr 206,238,8712
v_mul_f32 v104, v104, v251
v_mul_f32 v105, v105, v251
v_mul_f32 v106, v106, v251
mavv 248,220,176
v_mul_f32 v107, v107, v251
v_mul_f32 v108, v108, v251
v_mul_f32 v109, v109, v251
v_mul_f32 v110, v110, v251
mavv 244,220,168
buffer_store_dwordx4 v[24:27], v240, s[24:27], s48 offen offset:2048 nt
v_mul_f32 v111, v111, v251
pk 36,104,105
mavv 240,220,160
s_waitcnt lgkmcnt(4)
s_or_b32 s98, s48, s93
pk 37,106,107
pk 38,108,109
pk 39,110,111
mvvaz 64,192,0
tr 208,238,64
v_accvgpr_read_b32 v228, a40
v_accvgpr_read_b32 v229, a41
mvva 64,196,16
tr 210,238,320
v_accvgpr_read_b32 v230, a42
v_accvgpr_read_b32 v231, a43
mvvaz 72,196,20
tr 212,238,8512
v_accvgpr_read_b32 v243, a56
v_accvgpr_read_b32 v236, a57
mvva 72,192,4
v_accvgpr_read_b32 v237, a58
v_accvgpr_read_b32 v248, a59
v_mul_f32 v228, v228, v252
mvvaz 80,192,8
tr 214,238,8768
v_mul_f32 v229, v229, v252
v_mul_f32 v230, v230, v252
mvva 80,196,24
tr 216,238,72
v_mul_f32 v231, v231, v252
v_mul_f32 v243, v243, v252
mvvaz 88,196,28
tr 218,238,328
v_add_u32 v239, s40, v235
v_mul_f32 v236, v236, v252
mvva 88,192,12
s_waitcnt lgkmcnt(0)
s_barrier
s_add_u32 s40, s40, s42
v_mul_f32 v237, v237, v252
mvvaz 68,200,0
s_add_u32 m0, s41, s49
s_add_u32 s41, s41, s42
tr 220,238,8520
v_mul_f32 v248, v248, v252
mvva 68,204,16
s_cmp_eq_u32 s41, s43
s_cselect_b32 s41, 0, s41
tr 222,238,8776
pk 40,228,229
pk 41,230,231
mvvaz 76,204,20
s_cmp_eq_u32 s40, s43
s_cselect_b32 s40, 0, s40
ds_read_b128 a[32:35], v239 offset:0
pk 42,243,236
mvva 76,200,4
buffer_load_dwordx4 v242, s[20:23], s47 offen lds
pk 43,237,248
mvvaz 84,200,8
s_add_u32 s47, s47, s59
s_add_u32 m0, m0, s61
ds_read_b128 a[48:51], v239 offset:64
v_accvgpr_read_b32 v249, a44
mvva 84,204,24
ds_read_b128 a[36:39], v239 offset:2112
v_accvgpr_read_b32 v228, a45
v_accvgpr_read_b32 v229, a46
mvvaz 92,204,28
ds_read_b128 a[52:55], v239 offset:2176
v_accvgpr_read_b32 v230, a47
v_accvgpr_read_b32 v231, a60
mvva 92,200,12
buffer_load_dwordx4 v242, s[20:23], s47 offen lds
v_accvgpr_read_b32 v243, a61
mvvaz 96,208,0
s_add_u32 s47, s47, s59
s_add_u32 m0, m0, s62
tr 192,238,128
v_accvgpr_read_b32 v236, a62
mvva 96,212,16
tr 194,238,384
v_accvgpr_read_b32 v237, a63
v_mul_f32 v249, v249, v253
mvvaz 104,212,20
tr 196,238,8576
v_mul_f32 v228, v228, v253
v_mul_f32 v229, v229, v253
mvva 104,208,4
buffer_load_dwordx4 v242, s[20:23], s47 offen lds
v_mul_f32 v230, v230, v253
v_mul_f32 v231, v231, v253
mvvaz 112,208,8
s_add_u32 s47, s47, s59
s_add_u32 m0, m0, s61
tr 198,238,8832
v_mul_f32 v243, v243, v253
mvva 112,212,24
tr 200,238,136
v_mul_f32 v236, v236, v253
v_mul_f32 v237, v237, v253
mvvaz 120,212,28
tr 202,238,392
v_add_u32 v239, s40, v235
pk 44,249,228
mvva 120,208,12
buffer_load_dwordx4 v242, s[20:23], s47 offen lds
pk 45,229,230
mvvaz 100,216,0
s_waitcnt lgkmcnt(4)
s_add_u32 s47, s47, s59
tr 204,238,8584
pk 46,231,243
mvva 100,220,16
s_add_u32 m0, s41, s49
s_add_u32 s41, s41, s42
tr 206,238,8840
pk 47,236,237
mvvaz 108,220,20
s_cmp_eq_u32 s41, s43
s_cselect_b32 s41, 0, s41
ds_read_b128 a[40:43], v239 offset:0
mvva 108,216,4
buffer_load_dwordx4 v242, s[20:23], s47 offen lds
v_accvgpr_read_b32 v248, a64
mvvaz 116,216,8
s_add_u32 s47, s47, s59
s_add_u32 m0, m0, s61
ds_read_b128 a[56:59], v239 offset:64
v_accvgpr_read_b32 v249, a65
mvva 116,220,24
s_add_u32 s40, s40, s42
ds_read_b128 a[44:47], v239 offset:2112
v_accvgpr_read_b32 v228, a66
v_accvgpr_read_b32 v229, a67
mvvaz 124,220,28
s_cmp_eq_u32 s40, s43
s_cselect_b32 s40, 0, s40
ds_read_b128 a[60:63], v239 offset:2176
v_accvgpr_read_b32 v230, a80
mvva 124,216,12
buffer_load_dwordx4 v242, s[20:23], s47 offen lds
v_accvgpr_read_b32 v231, a81
mvvaz 128,192,0
s_waitcnt lgkmcnt(4)
s_add_u32 s47, s47, s59
tr 208,238,192
v_accvgpr_read_b32 v243, a82
mvva 128,196,16
s_add_u32 m0, m0, s62
tr 210,238,448
v_accvgpr_read_b32 v236, a83
v_mul_f32 v248, v248, v250
mvvaz 136,196,20
tr 212,238,8640
v_mul_f32 v249, v249, v250
v_mul_f32 v228, v228, v250
mvva 136,192,4
buffer_load_dwordx4 v242, s[20:23], s47 offen lds
v_mul_f32 v229, v229, v250
mvvaz 144,192,8
s_add_u32 s47, s47, s59
s_add_u32 m0, m0, s61
tr 214,238,8896
mvva 144,196,24
tr 216,238,200
v_mul_f32 v230, v230, v250
v_mul_f32 v231, v231, v250
mvvaz 152,196,28
tr 218,238,456
v_mul_f32 v243, v243, v250
v_mul_f32 v236, v236, v250
mvva 152,192,12
buffer_load_dwordx4 v242, s[20:23], s47 offen lds
pk 48,248,249
mvvaz 132,200,0
s_add_u32 s47, s47, s60
tr 220,238,8648
pk 49,228,229
pk 50,230,231
mvva 132,204,16
s_cmp_eq_u32 s47, s83
s_cselect_b32 s47, s76, s47
tr 222,238,8904
pk 51,243,236
mvvaz 140,204,20
buffer_store_dwordx4 v[28:31], v240, s[24:27], s98 offen offset:3072 nt
v_accvgpr_read_b32 v237, a68
mvva 140,200,4
s_add_u32 s48, s48, s72
v_add_u32 v238, s40, v234
v_accvgpr_read_b32 v248, a69
v_accvgpr_read_b32 v249, a70
mvvaz 148,200,8
s_add_u32 s40, s40, s42
s_cmp_eq_u32 s40, s43
s_cselect_b32 s40, 0, s40
v_accvgpr_read_b32 v228, a71
mvva 148,204,24
buffer_store_dwordx4 v[32:35], v240, s[24:27], s48 offen nt
v_accvgpr_read_b32 v229, a84
mvvaz 156,204,28
v_accvgpr_read_b32 v230, a85
v_accvgpr_read_b32 v231, a86
mvva 156,200,12
s_waitcnt vmcnt(17) lgkmcnt(0)
s_barrier
v_accvgpr_read_b32 v243, a87
v_mul_f32 v237, v237, v251
mvvaz 160,208,0
s_add_u32 m0, s41, s50
s_add_u32 s41, s41, s42
tr 192,238,0
v_mul_f32 v248, v248, v251
mvva 160,212,16
s_cmp_eq_u32 s41, s43
s_cselect_b32 s41, 0, s41
tr 194,238,256
v_mul_f32 v249, v249, v251
mvvaz 168,212,20
L_padC3:
s_cbranch_vccnz L_hop_a
tr 196,238,8448
v_mul_f32 v228, v228, v251
v_mul_f32 v229, v229, v251
mvva 168,208,4
buffer_load_dwordx4 v241, s[16:19], s46 offen lds
v_mul_f32 v230, v230, v251
mvvaz 176,208,8
s_add_u32 s46, s46, s55
s_add_u32 m0, m0, s53
tr 198,238,8704
v_mul_f32 v231, v231, v251
mvva 176,212,24
tr 200,238,8
v_mul_f32 v243, v243, v251
pk 52,237,248
mvvaz 184,212,28
tr 202,238,264
pk 53,249,228
pk 54,229,230
mvva 184,208,12
buffer_load_dwordx4 v241, s[16:19], s46 offen lds
pk 55,231,243
mvvaz 164,216,0
s_add_u32 s46, s46, s56
s_add_u32 m0, m0, s54
tr 204,238,8456
mvva 164,220,16
tr 206,238,8712
v_accvgpr_read_b32 v236, a72
v_accvgpr_read_b32 v237, a73
mvvaz 172,220,20
v_accvgpr_read_b32 v248, a74
v_accvgpr_read_b32 v249, a75
v_accvgpr_read_b32 v228, a88
mvva 172,216,4
buffer_load_dwordx4 v241, s[16:19], s46 offen lds
v_accvgpr_read_b32 v229, a89
mvvaz 180,216,8
s_add_u32 s46, s46, s55
s_add_u32 m0, m0, s53
v_accvgpr_read_b32 v230, a90
v_accvgpr_read_b32 v231, a91
mvva 180,220,24
buffer_store_dwordx4 v[36:39], v240, s[24:27], s48 offen offset:1024 nt
v_mul_f32 v236, v236, v252
mvvaz 188,220,28
s_waitcnt lgkmcnt(1)
v_mul_f32 v237, v237, v252
v_mul_f32 v248, v248, v252
v_mul_f32 v249, v249, v252
mvva 188,216,12
buffer_load_dwordx4 v241, s[16:19], s46 offen lds
v_mul_f32 v228, v228, v252
mvva 64,192,32
s_add_u32 s46, s46, s57
s_add_u32 m0, s41, s49
tr 208,238,64
v_mul_f32 v229, v229, v252
mvva 64,196,48
s_cmp_eq_u32 s46, s82
s_cselect_b32 s46, s58, s46
tr 210,238,320
v_mul_f32 v230, v230, v252
mvva 72,196,52
s_add_u32 s41, s41, s42
tr 212,238,8512
v_mul_f32 v231, v231, v252
mvva 72,192,36
buffer_load_dwordx4 v242, s[20:23], s47 offen lds
pk 56,236,237
mvva 80,192,40
s_add_u32 s47, s47, s59
s_add_u32 m0, m0, s61
tr 214,238,8768
pk 57,248,249
mvva 80,196,56
s_cmp_eq_u32 s41, s43
s_cselect_b32 s41, 0, s41
tr 216,238,72
pk 58,228,229
mvva 88,196,60
tr 218,238,328
v_add_u32 v239, s40, v235
pk 59,230,231
mvva 88,192,44
buffer_load_dwordx4 v242, s[20:23], s47 offen lds
v_accvgpr_read_b32 v243, a76
mvva 68,200,32
s_waitcnt lgkmcnt(4)
s_add_u32 s47, s47, s59
tr 220,238,8520
v_accvgpr_read_b32 v236, a77
mvva 68,204,48
s_add_u32 m0, m0, s62
s_add_u32 s40, s40, s42
tr 222,238,8776
v_accvgpr_read_b32 v237, a78
mvva 76,204,52
s_cmp_eq_u32 s40, s43
s_cselect_b32 s40, 0, s40
ds_read_b128 a[64:67], v239 offset:0
v_accvgpr_read_b32 v248, a79
mvva 76,200,36
buffer_load_dwordx4 v242, s[20:23], s47 offen lds
v_accvgpr_read_b32 v249, a92
mvva 84,200,40
s_add_u32 s47, s47, s59
s_add_u32 m0, m0, s61
ds_read_b128 a[80:83], v239 offset:64
mvva 84,204,56
ds_read_b128 a[68:71], v239 offset:2112
v_accvgpr_read_b32 v228, a93
v_accvgpr_read_b32 v229, a94
mvva 92,204,60
ds_read_b128 a[84:87], v239 offset:2176
v_accvgpr_read_b32 v230, a95
v_mul_f32 v243, v243, v253
mvva 92,200,44
buffer_load_dwordx4 v242, s[20:23], s47 offen lds
v_mul_f32 v236, v236, v253
mvva 96,208,32
s_waitcnt lgkmcnt(4)
s_add_u32 s47, s47, s59
tr 192,238,128
v_mul_f32 v237, v237, v253
mvva 96,212,48
s_add_u32 m0, s41, s49
s_add_u32 s41, s41, s42
tr 194,238,384
v_mul_f32 v248, v248, v253
mvva 104,212,52
s_cmp_eq_u32 s41, s43
s_cselect_b32 s41, 0, s41
tr 196,238,8576
v_mul_f32 v249, v249, v253
mvva 104,208,36
buffer_load_dwordx4 v242, s[20:23], s47 offen lds
v_mul_f32 v228, v228, v253
mvva 112,208,40
s_add_u32 s47, s47, s59
s_add_u32 m0, m0, s61
tr 198,238,8832
v_mul_f32 v229, v229, v253
mvva 112,212,56
tr 200,238,136
v_mul_f32 v230, v230, v253
pk 60,243,236
mvva 120,212,60
tr 202,238,392
v_add_u32 v239, s40, v235
mvva 120,208,44
buffer_load_dwordx4 v242, s[20:23], s47 offen lds
pk 61,237,248
mvva 100,216,32
s_add_u32 s47, s47, s59
s_add_u32 m0, m0, s62
tr 204,238,8584
pk 62,249,228
mvva 100,220,48
s_add_u32 s40, s40, s42
tr 206,238,8840
pk 63,229,230
mvva 108,220,52
s_cmp_eq_u32 s40, s43
s_cselect_b32 s40, 0, s40
ds_read_b128 a[72:75], v239 offset:0
mvva 108,216,36
buffer_load_dwordx4 v242, s[20:23], s47 offen lds
v_accvgpr_read_b32 v231, a96
mvva 116,216,40
s_add_u32 s47, s47, s59
s_add_u32 m0, m0, s61
ds_read_b128 a[88:91], v239 offset:64
v_accvgpr_read_b32 v243, a97
mvva 116,220,56
ds_read_b128 a[76:79], v239 offset:2112
v_accvgpr_read_b32 v236, a98
v_accvgpr_read_b32 v237, a99
mvva 124,220,60
s_waitcnt lgkmcnt(4)
ds_read_b128 a[92:95], v239 offset:2176
v_accvgpr_read_b32 v248, a112
v_accvgpr_read_b32 v249, a113
mvva 124,216,44
buffer_load_dwordx4 v242, s[20:23], s47 offen lds
mvva 128,192,32
s_add_u32 s47, s47, s60
tr 208,238,192
v_accvgpr_read_b32 v228, a114
v_accvgpr_read_b32 v229, a115
mvva 128,196,48
s_cmp_eq_u32 s47, s83
s_cselect_b32 s47, s76, s47
tr 210,238,448
v_mul_f32 v231, v231, v250
mvva 136,196,52
tr 212,238,8640
v_mul_f32 v243, v243, v250
v_mul_f32 v236, v236, v250
mvva 136,192,36
buffer_store_dwordx4 v[40:43], v240, s[24:27], s48 offen offset:2048 nt
v_mul_f32 v237, v237, v250
mvva 144,192,40
s_or_b32 s98, s48, s93
tr 214,238,8896
v_mul_f32 v248, v248, v250
mvva 144,196,56
tr 216,238,200
v_mul_f32 v249, v249, v250
v_mul_f32 v228, v228, v250
mvva 152,196,60
tr 218,238,456
v_mul_f32 v229, v229, v250
pk 0,231,243
mvva 152,192,44
pk 1,236,237
pk 2,248,249
pk 3,228,229
mvva 132,200,32
s_waitcnt lgkmcnt(4)
tr 220,238,8648
v_accvgpr_read_b32 v230, a100
v_accvgpr_read_b32 v231, a101
mvva 132,204,48
tr 222,238,8904
v_accvgpr_read_b32 v243, a102
mvva 140,204,52
v_accvgpr_read_b32 v236, a103
v_accvgpr_read_b32 v237, a116
v_accvgpr_read_b32 v248, a117
mvva 140,200,36
v_add_u32 v238, s40, v234
v_accvgpr_read_b32 v249, a118
v_accvgpr_read_b32 v228, a119
mvva 148,200,40
buffer_store_dwordx4 v[44:47], v240, s[24:27], s98 offen offset:3072 nt
v_mul_f32 v230, v230, v251
mvva 148,204,56
s_add_u32 s40, s40, s42
s_cmp_eq_u32 s40, s43
s_cselect_b32 s40, 0, s40
s_add_u32 s48, s48, s72
mvva 156,204,60
v_mul_f32 v231, v231, v251
v_mul_f32 v243, v243, v251
mvva 156,200,44
s_waitcnt vmcnt(17) lgkmcnt(0)
s_barrier
v_mul_f32 v236, v236, v251
v_mul_f32 v237, v237, v251
mvva 160,208,32
s_add_u32 m0, s41, s50
s_add_u32 s41, s41, s42
tr 192,238,0
v_mul_f32 v248, v248, v251
mvva 160,212,48
s_cmp_eq_u32 s41, s43
s_cselect_b32 s41, 0, s41
tr 194,238,256
v_mul_f32 v249, v249, v251
mvva 168,212,52
tr 196,238,8448
v_mul_f32 v228, v228, v251
pk 4,230,231
mvva 168,208,36
buffer_load_dwordx4 v241, s[16:19], s46 offen lds
mvva 176,208,40
s_add_u32 s46, s46, s55
s_add_u32 m0, m0, s53
tr 198,238,8704
pk 5,243,236
mvva 176,212,56
tr 200,238,8
pk 6,237,248
pk 7,249,228
mvva 184,212,60
tr 202,238,264
v_accvgpr_read_b32 v229, a104
v_accvgpr_read_b32 v230, a105
mvva 184,208,44
buffer_load_dwordx4 v241, s[16:19], s46 offen lds
v_accvgpr_read_b32 v231, a106
mvva 164,216,32
s_add_u32 s46, s46, s56
s_add_u32 m0, m0, s54
tr 204,238,8456
mvva 164,220,48
tr 206,238,8712
v_accvgpr_read_b32 v243, a107
v_accvgpr_read_b32 v236, a120
mvva 172,220,52
v_accvgpr_read_b32 v237, a121
v_accvgpr_read_b32 v248, a122
v_accvgpr_read_b32 v249, a123
mvva 172,216,36
buffer_load_dwordx4 v241, s[16:19], s46 offen lds
v_mul_f32 v229, v229, v252
mvva 180,216,40
s_add_u32 s46, s46, s55
s_add_u32 m0, m0, s53
v_mul_f32 v230, v230, v252
v_mul_f32 v231, v231, v252
mvva 180,220,56
buffer_store_dwordx4 v[48:51], v240, s[24:27], s48 offen nt
mvva 188,220,60
s_waitcnt lgkmcnt(1)
v_mul_f32 v243, v243, v252
v_mul_f32 v236, v236, v252
v_mul_f32 v237, v237, v252
mvva 188,216,44
buffer_load_dwordx4 v241, s[16:19], s46 offen lds
v_mul_f32 v248, v248, v252
mvva 64,192,64
s_add_u32 s46, s46, s57
s_add_u32 m0, s41, s49
tr 208,238,64
v_mul_f32 v249, v249, v252
mvva 64,196,80
s_cmp_eq_u32 s46, s82
s_cselect_b32 s46, s58, s46
tr 210,238,320
pk 8,229,230
mvva 72,196,84
s_add_u32 s41, s41, s42
tr 212,238,8512
pk 9,231,243
mvva 72,192,68
buffer_load_dwordx4 v242, s[20:23], s47 offen lds
pk 10,236,237
mvva 80,192,72
s_add_u32 s47, s47, s59
s_add_u32 m0, m0, s61
tr 214,238,8768
pk 11,248,249
mvva 80,196,88
s_cmp_eq_u32 s41, s43
s_cselect_b32 s41, 0, s41
tr 216,238,72
v_accvgpr_read_b32 v228, a108
mvva 88,196,92
tr 218,238,328
v_add_u32 v239, s40, v235
v_accvgpr_read_b32 v229, a109
mvva 88,192,76
buffer_load_dwordx4 v242, s[20:23], s47 offen lds
mvva 68,200,64
s_waitcnt lgkmcnt(4)
s_add_u32 s47, s47, s59
tr 220,238,8520
v_accvgpr_read_b32 v230, a110
mvva 68,204,80
s_add_u32 m0, m0, s62
s_add_u32 s40, s40, s42
tr 222,238,8776
v_accvgpr_read_b32 v231, a111
mvva 76,204,84
s_cmp_eq_u32 s40, s43
s_cselect_b32 s40, 0, s40
ds_read_b128 a[96:99], v239 offset:0
v_accvgpr_read_b32 v243, a124
mvva 76,200,68
buffer_load_dwordx4 v242, s[20:23], s47 offen lds
v_accvgpr_read_b32 v236, a125
mvva 84,200,72
s_add_u32 s47, s47, s59
s_add_u32 m0, m0, s61
ds_read_b128 a[112:115], v239 offset:64
mvva 84,204,88
ds_read_b128 a[100:103], v239 offset:2112
v_accvgpr_read_b32 v237, a126
v_accvgpr_read_b32 v248, a127
mvva 92,204,92
ds_read_b128 a[116:119], v239 offset:2176
v_mul_f32 v228, v228, v253
v_mul_f32 v229, v229, v253
mvva 92,200,76
buffer_load_dwordx4 v242, s[20:23], s47 offen lds
v_mul_f32 v230, v230, v253
mvva 96,208,64
s_waitcnt lgkmcnt(4)
s_add_u32 s47, s47, s59
tr 192,238,128
v_mul_f32 v231, v231, v253
mvva 96,212,80
s_add_u32 m0, s41, s49
s_add_u32 s41, s41, s42
tr 194,238,384
mvva 104,212,84
s_cmp_eq_u32 s41, s43
s_cselect_b32 s41, 0, s41
tr 196,238,8576
v_mul_f32 v243, v243, v253
mvva 104,208,68
buffer_load_dwordx4 v242, s[20:23], s47 offen lds
v_mul_f32 v236, v236, v253
mvva 112,208,72
s_add_u32 s47, s47, s59
s_add_u32 m0, m0, s61
tr 198,238,8832
v_mul_f32 v237, v237, v253
mvva 112,212,88
tr 200,238,136
v_mul_f32 v248, v248, v253
pk 12,228,229
mvva 120,212,92
tr 202,238,392
v_add_u32 v239, s40, v235
mvva 120,208,76
buffer_load_dwordx4 v242, s[20:23], s47 offen lds
pk 13,230,231
mvva 100,216,64
s_add_u32 s47, s47, s59
s_add_u32 m0, m0, s62
tr 204,238,8584
pk 14,243,236
mvva 100,220,80
s_add_u32 s40, s40, s42
tr 206,238,8840
pk 15,237,248
mvva 108,220,84
s_cmp_eq_u32 s40, s43
s_cselect_b32 s40, 0, s40
ds_read_b128 a[104:107], v239 offset:0
mvva 108,216,68
buffer_load_dwordx4 v242, s[20:23], s47 offen lds
v_accvgpr_read_b32 v249, a128
mvva 116,216,72
s_add_u32 s47, s47, s59
s_add_u32 m0, m0, s61
ds_read_b128 a[120:123], v239 offset:64
v_accvgpr_read_b32 v228, a129
mvva 116,220,88
ds_read_b128 a[108:111], v239 offset:2112
v_accvgpr_read_b32 v229, a130
v_accvgpr_read_b32 v230, a131
mvva 124,220,92
s_waitcnt lgkmcnt(4)
ds_read_b128 a[124:127], v239 offset:2176
v_accvgpr_read_b32 v231, a144
v_accvgpr_read_b32 v243, a145
mvva 124,216,76
buffer_load_dwordx4 v242, s[20:23], s47 offen lds
mvva 128,192,64
s_add_u32 s47, s47, s60
tr 208,238,192
v_accvgpr_read_b32 v236, a146
v_accvgpr_read_b32 v237, a147
mvva 128,196,80
s_cmp_eq_u32 s47, s83
s_cselect_b32 s47, s76, s47
tr 210,238,448
v_mul_f32 v249, v249, v250
mvva 136,196,84
tr 212,238,8640
v_mul_f32 v228, v228, v250
v_mul_f32 v229, v229, v250
mvva 136,192,68
buffer_store_dwordx4 v[52:55], v240, s[24:27], s48 offen offset:1024 nt
v_mul_f32 v230, v230, v250
mvva 144,192,72
tr 214,238,8896
v_mul_f32 v231, v231, v250
mvva 144,196,88
tr 216,238,200
v_mul_f32 v243, v243, v250
v_mul_f32 v236, v236, v250
mvva 152,196,92
tr 218,238,456
v_mul_f32 v237, v237, v250
pk 16,249,228
mvva 152,192,76
pk 17,229,230
pk 18,231,243
pk 19,236,237
mvva 132,200,64
s_waitcnt lgkmcnt(4)
tr 220,238,8648
v_accvgpr_read_b32 v248, a132
v_accvgpr_read_b32 v249, a133
mvva 132,204,80
tr 222,238,8904
v_accvgpr_read_b32 v228, a134
mvva 140,204,84
v_accvgpr_read_b32 v229, a135
v_accvgpr_read_b32 v230, a148
v_accvgpr_read_b32 v231, a149
mvva 140,200,68
v_add_u32 v238, s40, v234
v_accvgpr_read_b32 v243, a150
v_accvgpr_read_b32 v236, a151
mvva 148,200,72
buffer_store_dwordx4 v[56:59], v240, s[24:27], s48 offen offset:2048 nt
v_mul_f32 v248, v248, v251
mvva 148,204,88
s_add_u32 s40, s40, s42
s_cmp_eq_u32 s40, s43
s_cselect_b32 s40, 0, s40
v_mul_f32 v249, v249, v251
mvva 156,204,92
s_or_b32 s98, s48, s93
v_mul_f32 v228, v228, v251
v_mul_f32 v229, v229, v251
mvva 156,200,76
s_waitcnt vmcnt(17) lgkmcnt(0)
s_barrier
v_mul_f32 v230, v230, v251
v_mul_f32 v231, v231, v251
mvva 160,208,64
s_add_u32 m0, s41, s50
s_add_u32 s41, s41, s42
tr 192,238,0
v_mul_f32 v243, v243, v251
mvva 160,212,80
s_cmp_eq_u32 s41, s43
s_cselect_b32 s41, 0, s41
tr 194,238,256
v_mul_f32 v236, v236, v251
mvva 168,212,84
tr 196,238,8448
pk 20,248,249
pk 21,228,229
mvva 168,208,68
buffer_load_dwordx4 v241, s[16:19], s46 offen lds
mvva 176,208,72
s_add_u32 s46, s46, s55
s_add_u32 m0, m0, s53
tr 198,238,8704
pk 22,230,231
mvva 176,212,88
tr 200,238,8
pk 23,243,236
v_accvgpr_read_b32 v237, a136
mvva 184,212,92
tr 202,238,264
v_accvgpr_read_b32 v248, a137
v_accvgpr_read_b32 v249, a138
mvva 184,208,76
buffer_load_dwordx4 v241, s[16:19], s46 offen lds
v_accvgpr_read_b32 v228, a139
mvva 164,216,64
s_add_u32 s46, s46, s56
s_add_u32 m0, m0, s54
tr 204,238,8456
mvva 164,220,80
tr 206,238,8712
v_accvgpr_read_b32 v229, a152
v_accvgpr_read_b32 v230, a153
mvva 172,220,84
v_accvgpr_read_b32 v231, a154
v_accvgpr_read_b32 v243, a155
v_mul_f32 v237, v237, v252
mvva 172,216,68
buffer_load_dwordx4 v241, s[16:19], s46 offen lds
v_mul_f32 v248, v248, v252
mvva 180,216,72
s_add_u32 s46, s46, s55
s_add_u32 m0, m0, s53
v_mul_f32 v249, v249, v252
v_mul_f32 v228, v228, v252
mvva 180,220,88
buffer_store_dwordx4 v[60:63], v240, s[24:27], s98 offen offset:3072 nt
mvva 188,220,92
s_waitcnt lgkmcnt(1)
s_add_u32 s48, s48, s72
v_mul_f32 v229, v229, v252
v_mul_f32 v230, v230, v252
mvva 188,216,76
buffer_load_dwordx4 v241, s[16:19], s46 offen lds
v_mul_f32 v231, v231, v252
mvva 64,192,96
s_add_u32 s46, s46, s57
s_add_u32 m0, s41, s49
tr 208,238,64
v_mul_f32 v243, v243, v252
mvva 64,196,112
s_cmp_eq_u32 s46, s82
s_cselect_b32 s46, s58, s46
tr 210,238,320
pk 24,237,248
mvva 72,196,116
s_add_u32 s41, s41, s42
tr 212,238,8512
pk 25,249,228
mvva 72,192,100
buffer_load_dwordx4 v242, s[20:23], s47 offen lds
pk 26,229,230
mvva 80,192,104
s_add_u32 s47, s47, s59
s_add_u32 m0, m0, s61
tr 214,238,8768
pk 27,231,243
mvva 80,196,120
s_cmp_eq_u32 s41, s43
s_cselect_b32 s41, 0, s41
tr 216,238,72
v_accvgpr_read_b32 v236, a140
mvva 88,196,124
tr 218,238,328
v_add_u32 v239, s40, v235
v_accvgpr_read_b32 v237, a141
mvva 88,192,108
buffer_load_dwordx4 v242, s[20:23], s47 offen lds
mvva 68,200,96
s_waitcnt lgkmcnt(4)
s_add_u32 s47, s47, s59
tr 220,238,8520
v_accvgpr_read_b32 v248, a142
mvva 68,204,112
s_add_u32 m0, m0, s62
s_add_u32 s40, s40, s42
tr 222,238,8776
v_accvgpr_read_b32 v249, a143
mvva 76,204,116
s_cmp_eq_u32 s40, s43
s_cselect_b32 s40, 0, s40
ds_read_b128 a[128:131], v239 offset:0
v_accvgpr_read_b32 v228, a156
mvva 76,200,100
buffer_load_dwordx4 v242, s[20:23], s47 offen lds
v_accvgpr_read_b32 v229, a157
mvva 84,200,104
L_padC4:
s_cbranch_vccnz L_hop_a
s_add_u32 s47, s47, s59
s_add_u32 m0, m0, s61
ds_read_b128 a[144:147], v239 offset:64
mvva 84,204,120
ds_read_b128 a[132:135], v239 offset:2112
v_accvgpr_read_b32 v230, a158
v_accvgpr_read_b32 v231, a159
mvva 92,204,124
ds_read_b128 a[148:151], v239 offset:2176
v_mul_f32 v236, v236, v253
v_mul_f32 v237, v237, v253
mvva 92,200,108
buffer_load_dwordx4 v242, s[20:23], s47 offen lds
v_mul_f32 v248, v248, v253
mvva 96,208,96
s_waitcnt lgkmcnt(4)
s_add_u32 s47, s47, s59
tr 192,238,128
v_mul_f32 v249, v249, v253
mvva 96,212,112
s_add_u32 m0, s41, s49
s_add_u32 s41, s41, s42
tr 194,238,384
mvva 104,212,116
s_cmp_eq_u32 s41, s43
s_cselect_b32 s41, 0, s41
tr 196,238,8576
v_mul_f32 v228, v228, v253
mvva 104,208,100
buffer_load_dwordx4 v242, s[20:23], s47 offen lds
v_mul_f32 v229, v229, v253
mvva 112,208,104
s_add_u32 s47, s47, s59
s_add_u32 m0, m0, s61
tr 198,238,8832
v_mul_f32 v230, v230, v253
mvva 112,212,120
tr 200,238,136
v_mul_f32 v231, v231, v253
pk 28,236,237
mvva 120,212,124
tr 202,238,392
v_add_u32 v239, s40, v235
mvva 120,208,108
buffer_load_dwordx4 v242, s[20:23], s47 offen lds
pk 29,248,249
mvva 100,216,96
s_add_u32 s47, s47, s59
s_add_u32 m0, m0, s62
tr 204,238,8584
pk 30,228,229
mvva 100,220,112
s_add_u32 s40, s40, s42
tr 206,238,8840
pk 31,230,231
mvva 108,220,116
s_cmp_eq_u32 s40, s43
s_cselect_b32 s40, 0, s40
ds_read_b128 a[136:139], v239 offset:0
mvva 108,216,100
buffer_load_dwordx4 v242, s[20:23], s47 offen lds
v_accvgpr_read_b32 v243, a160
mvva 116,216,104
s_add_u32 s47, s47, s59
s_add_u32 m0, m0, s61
ds_read_b128 a[152:155], v239 offset:64
mvva 116,220,120
ds_read_b128 a[140:143], v239 offset:2112
v_accvgpr_read_b32 v236, a161
v_accvgpr_read_b32 v237, a162
mvva 124,220,124
s_waitcnt lgkmcnt(4)
ds_read_b128 a[156:159], v239 offset:2176
v_accvgpr_read_b32 v248, a163
v_accvgpr_read_b32 v249, a176
mvva 124,216,108
buffer_load_dwordx4 v242, s[20:23], s47 offen lds
mvva 128,192,96
s_add_u32 s47, s47, s60
tr 208,238,192
v_accvgpr_read_b32 v228, a177
v_accvgpr_read_b32 v229, a178
mvva 128,196,112
s_cmp_eq_u32 s47, s83
s_cselect_b32 s47, s76, s47
tr 210,238,448
mvva 136,196,116
tr 212,238,8640
v_accvgpr_read_b32 v230, a179
v_mul_f32 v243, v243, v250
mvva 136,192,100
buffer_store_dwordx4 v[0:3], v240, s[24:27], s48 offen nt
v_mul_f32 v236, v236, v250
mvva 144,192,104
tr 214,238,8896
v_mul_f32 v237, v237, v250
mvva 144,196,120
tr 216,238,200
v_mul_f32 v248, v248, v250
v_mul_f32 v249, v249, v250
mvva 152,196,124
tr 218,238,456
v_mul_f32 v228, v228, v250
mvva 152,192,108
v_mul_f32 v229, v229, v250
v_mul_f32 v230, v230, v250
pk 32,243,236
mvva 132,200,96
s_waitcnt lgkmcnt(4)
tr 220,238,8648
pk 33,237,248
pk 34,249,228
mvva 132,204,112
tr 222,238,8904
pk 35,229,230
mvva 140,204,116
v_accvgpr_read_b32 v231, a164
v_accvgpr_read_b32 v243, a165
v_accvgpr_read_b32 v236, a166
mvva 140,200,100
v_add_u32 v238, s40, v234
v_accvgpr_read_b32 v237, a167
mvva 148,200,104
buffer_store_dwordx4 v[4:7], v240, s[24:27], s48 offen offset:1024 nt
v_accvgpr_read_b32 v248, a180
mvva 148,204,120
s_add_u32 s40, s40, s42
s_cmp_eq_u32 s40, s43
s_cselect_b32 s40, 0, s40
v_accvgpr_read_b32 v249, a181
mvva 156,204,124
v_accvgpr_read_b32 v228, a182
v_accvgpr_read_b32 v229, a183
mvva 156,200,108
s_waitcnt vmcnt(17) lgkmcnt(0)
s_barrier
v_mul_f32 v231, v231, v251
v_mul_f32 v243, v243, v251
mvva 160,208,96
s_add_u32 m0, s41, s50
s_add_u32 s41, s41, s42
tr 192,238,0
mvva 160,212,112
s_cmp_eq_u32 s41, s43
s_cselect_b32 s41, 0, s41
tr 194,238,256
v_mul_f32 v236, v236, v251
mvva 168,212,116
tr 196,238,8448
v_mul_f32 v237, v237, v251
v_mul_f32 v248, v248, v251
mvva 168,208,100
buffer_load_dwordx4 v241, s[16:19], s46 offen lds
mvva 176,208,104
s_add_u32 s46, s46, s55
s_add_u32 m0, m0, s53
tr 198,238,8704
v_mul_f32 v249, v249, v251
mvva 176,212,120
tr 200,238,8
v_mul_f32 v228, v228, v251
mvva 184,212,124
tr 202,238,264
v_mul_f32 v229, v229, v251
pk 36,231,243
mvva 184,208,108
pk 37,236,237
pk 38,248,249
pk 39,228,229
mvva 164,216,96
tr 204,238,8456
v_accvgpr_read_b32 v230, a168
mvva 164,220,112
tr 206,238,8712
v_accvgpr_read_b32 v231, a169
v_accvgpr_read_b32 v243, a170
mvva 172,220,116
v_accvgpr_read_b32 v236, a171
v_accvgpr_read_b32 v237, a184
mvva 172,216,100
buffer_load_dwordx4 v241, s[16:19], s46 offen lds
v_accvgpr_read_b32 v248, a185
mvva 180,216,104
s_add_u32 s46, s46, s56
s_add_u32 m0, m0, s54
v_accvgpr_read_b32 v249, a186
v_accvgpr_read_b32 v228, a187
mvva 180,220,120
buffer_store_dwordx4 v[8:11], v240, s[24:27], s48 offen offset:2048 nt
mvva 188,220,124
s_or_b32 s98, s48, s93
v_mul_f32 v230, v230, v252
v_mul_f32 v231, v231, v252
v_mul_f32 v243, v243, v252
mvva 188,216,108
s_waitcnt lgkmcnt(1)
v_mul_f32 v236, v236, v252
v_mul_f32 v237, v237, v252
mvva 64,192,128
tr 208,238,64
v_mul_f32 v248, v248, v252
v_mul_f32 v249, v249, v252
mvva 64,196,144
tr 210,238,320
v_mul_f32 v228, v228, v252
pk 40,230,231
mvva 72,196,148
tr 212,238,8512
pk 41,243,236
mvva 72,192,132
buffer_load_dwordx4 v241, s[16:19], s46 offen lds
pk 42,237,248
mvva 80,192,136
s_add_u32 s46, s46, s55
s_add_u32 m0, m0, s53
tr 214,238,8768
mvva 80,196,152
tr 216,238,72
pk 43,249,228
v_accvgpr_read_b32 v229, a172
mvva 88,196,156
tr 218,238,328
v_add_u32 v239, s40, v235
v_accvgpr_read_b32 v230, a173
mvva 88,192,140
s_add_u32 s40, s40, s42
s_cmp_eq_u32 s40, s43
s_cselect_b32 s40, 0, s40
mvva 68,200,128
s_waitcnt lgkmcnt(4)
tr 220,238,8520
v_accvgpr_read_b32 v231, a174
v_accvgpr_read_b32 v243, a175
mvva 68,204,144
tr 222,238,8776
v_accvgpr_read_b32 v236, a188
mvva 76,204,148
ds_read_b128 a[160:163], v239 offset:0
v_accvgpr_read_b32 v237, a189
v_accvgpr_read_b32 v248, a190
mvva 76,200,132
buffer_load_dwordx4 v241, s[16:19], s46 offen lds
v_accvgpr_read_b32 v249, a191
mvva 84,200,136
s_add_u32 s46, s46, s57
ds_read_b128 a[176:179], v239 offset:64
v_mul_f32 v229, v229, v253
mvva 84,204,152
s_cmp_eq_u32 s46, s82
s_cselect_b32 s46, s58, s46
ds_read_b128 a[164:167], v239 offset:2112
v_mul_f32 v230, v230, v253
mvva 92,204,156
s_addk_i32 s46, 256
s_addk_i32 s82, 256
s_addk_i32 s58, 256
ds_read_b128 a[180:183], v239 offset:2176
mvva 92,200,140
buffer_store_dwordx4 v[12:15], v240, s[24:27], s98 offen offset:3072 nt
v_mul_f32 v231, v231, v253
mvva 96,208,128
s_waitcnt lgkmcnt(4)
s_add_u32 m0, s41, s50
s_add_u32 s48, s48, s72
tr 192,238,128
mvva 96,212,144
s_add_u32 s41, s41, s42
tr 194,238,384
v_mul_f32 v243, v243, v253
mvva 104,212,148
s_cmp_eq_u32 s41, s43
s_cselect_b32 s41, 0, s41
tr 196,238,8576
v_mul_f32 v236, v236, v253
mvva 104,208,132
buffer_load_dwordx4 v241, s[16:19], s46 offen lds
mvva 112,208,136
s_add_u32 s46, s46, s55
s_add_u32 m0, m0, s53
tr 198,238,8832
v_mul_f32 v237, v237, v253
mvva 112,212,152
tr 200,238,136
v_mul_f32 v248, v248, v253
v_mul_f32 v249, v249, v253
mvva 120,212,156
tr 202,238,392
v_add_u32 v239, s40, v235
mvva 120,208,140
s_add_u32 s40, s40, s42
s_cmp_eq_u32 s40, s43
s_cselect_b32 s40, 0, s40
pk 44,229,230
mvva 100,216,128
tr 204,238,8584
pk 45,231,243
mvva 100,220,144
tr 206,238,8840
pk 46,236,237
pk 47,248,249
mvva 108,220,148
ds_read_b128 a[168:171], v239 offset:0
v_accvgpr_read_b32 v228, a192
mvva 108,216,132
buffer_load_dwordx4 v241, s[16:19], s46 offen lds
v_accvgpr_read_b32 v229, a193
mvva 116,216,136
s_add_u32 s46, s46, s56
s_add_u32 m0, m0, s54
ds_read_b128 a[184:187], v239 offset:64
v_accvgpr_read_b32 v230, a194
mvva 116,220,152
ds_read_b128 a[172:175], v239 offset:2112
v_accvgpr_read_b32 v231, a195
mvva 124,220,156
s_waitcnt lgkmcnt(4)
ds_read_b128 a[188:191], v239 offset:2176
v_accvgpr_read_b32 v243, a208
v_accvgpr_read_b32 v236, a209
mvva 124,216,140
buffer_store_dwordx4 v[16:19], v240, s[24:27], s48 offen nt
v_accvgpr_read_b32 v237, a210
mvva 128,192,128
tr 208,238,192
v_accvgpr_read_b32 v248, a211
mvva 128,196,144
tr 210,238,448
v_mul_f32 v228, v228, v250
v_mul_f32 v229, v229, v250
mvva 136,196,148
tr 212,238,8640
v_mul_f32 v230, v230, v250
v_mul_f32 v231, v231, v250
mvva 136,192,132
buffer_load_dwordx4 v241, s[16:19], s46 offen lds
v_mul_f32 v243, v243, v250
mvva 144,192,136
s_add_u32 s46, s46, s55
s_add_u32 m0, m0, s53
tr 214,238,8896
mvva 144,196,152
tr 216,238,200
v_mul_f32 v236, v236, v250
v_mul_f32 v237, v237, v250
mvva 152,196,156
tr 218,238,456
v_mul_f32 v248, v248, v250
pk 48,228,229
mvva 152,192,140
pk 49,230,231
pk 50,243,236
mvva 132,200,128
s_waitcnt lgkmcnt(4)
tr 220,238,8648
pk 51,237,248
v_accvgpr_read_b32 v249, a196
mvva 132,204,144
tr 222,238,8904
v_accvgpr_read_b32 v228, a197
v_accvgpr_read_b32 v229, a198
mvva 140,204,148
v_accvgpr_read_b32 v230, a199
v_accvgpr_read_b32 v231, a212
mvva 140,200,132
buffer_load_dwordx4 v241, s[16:19], s46 offen lds
v_add_u32 v238, s40, v234
mvva 148,200,136
s_add_u32 s46, s46, s57
s_cmp_eq_u32 s46, s82
s_cselect_b32 s46, s58, s46
v_accvgpr_read_b32 v243, a213
mvva 148,204,152
buffer_store_dwordx4 v[20:23], v240, s[24:27], s48 offen offset:1024 nt
v_accvgpr_read_b32 v236, a214
mvva 156,204,156
s_add_u32 s40, s40, s42
s_cmp_eq_u32 s40, s43
s_cselect_b32 s40, 0, s40
mvva 156,200,140
s_waitcnt vmcnt(14) lgkmcnt(0)
s_barrier
v_accvgpr_read_b32 v237, a215
v_mul_f32 v249, v249, v251
mvva 160,208,128
s_add_u32 m0, s41, s50
s_add_u32 s41, s41, s42
tr 192,238,0
v_mul_f32 v228, v228, v251
mvva 160,212,144
s_cmp_eq_u32 s41, s43
s_cselect_b32 s41, 0, s41
tr 194,238,256
mvva 168,212,148
tr 196,238,8448
v_mul_f32 v229, v229, v251
v_mul_f32 v230, v230, v251
mvva 168,208,132
buffer_load_dwordx4 v241, s[16:19], s46 offen lds
v_mul_f32 v231, v231, v251
mvva 176,208,136
s_add_u32 s46, s46, s55
s_add_u32 m0, m0, s53
tr 198,238,8704
mvva 176,212,152
tr 200,238,8
v_mul_f32 v243, v243, v251
v_mul_f32 v236, v236, v251
mvva 184,212,156
tr 202,238,264
v_mul_f32 v237, v237, v251
pk 52,249,228
mvva 184,208,140
pk 53,229,230
pk 54,231,243
pk 55,236,237
mvva 164,216,128
tr 204,238,8456
v_accvgpr_read_b32 v248, a200
mvva 164,220,144
tr 206,238,8712
v_accvgpr_read_b32 v249, a201
v_accvgpr_read_b32 v228, a202
mvva 172,220,148
v_accvgpr_read_b32 v229, a203
v_accvgpr_read_b32 v230, a216
v_accvgpr_read_b32 v231, a217
mvva 172,216,132
buffer_load_dwordx4 v241, s[16:19], s46 offen lds
mvva 180,216,136
s_add_u32 s46, s46, s56
s_add_u32 m0, m0, s54
v_accvgpr_read_b32 v243, a218
v_accvgpr_read_b32 v236, a219
mvva 180,220,152
v_mul_f32 v248, v248, v252
v_mul_f32 v249, v249, v252
v_mul_f32 v228, v228, v252
mvva 188,220,156
buffer_store_dwordx4 v[24:27], v240, s[24:27], s48 offen offset:2048 nt
mvva 188,216,140
s_waitcnt lgkmcnt(6)
s_or_b32 s98, s48, s93
v_mul_f32 v229, v229, v252
v_mul_f32 v230, v230, v252
s_mov_b32 s5, 1
s_mov_b64 vcc, -1
s_cmp_eq_u32 s4, 0
s_cbranch_scc1 L_padB0
s_cmp_eq_u32 s4, 1
s_cbranch_scc1 L_padB1
s_cmp_eq_u32 s4, 2
s_cbranch_scc1 L_padB2
s_branch L_padB3
L_hop_body:
s_cmp_eq_u32 s5, 0
s_cbranch_scc1 L_hop_done
L_hop_body2:
s_cmp_eq_u32 s4, 3
s_cbranch_scc1 L_ret_bodyw
L_ret_body:
s_mov_b64 vcc, 0
s_branch L_body
.fill 1018, 4, 0xbf800000
L_tail_b:
L_pre_b:
s_mov_b64 vcc, -1
s_cmp_eq_u32 s4, 0
s_cbranch_scc1 L_padD0
s_cmp_eq_u32 s4, 1
s_cbranch_scc1 L_padD1
s_cmp_eq_u32 s4, 2
s_cbranch_scc1 L_padD2
s_branch L_padD3
L_hop_b:
s_cmp_eq_u32 s4, 3
s_cbranch_scc1 L_ret_bw
L_ret_b:
s_mov_b64 vcc, 0
mvvvz 128,192,0
s_add_u32 s45, s45, s52
s_add_u32 m0, s41, s49
ds_read_b128 v[208:211], v236 offset:256
mvvv 128,196,16
s_add_u32 s41, s41, s42
s_cmp_eq_u32 s41, s43
s_cselect_b32 s41, 0, s41
mvvv 128,200,32
ds_read_b128 v[212:215], v236 offset:320
v_add_f32 v229, v229, v172
mvvv 128,204,48
buffer_load_dwordx4 v240, s[8:11], s44 offen nt lds
mvvvz 136,204,52
s_add_u32 m0, m0, 32
ds_read_b128 v[216:219], v236 offset:384
v_add_f32 v229, v229, v173
mvvv 136,200,36
v_exp_f32 v185, v185
mvvv 136,196,20
ds_read_b128 v[220:223], v236 offset:448
pk 170,172,173
mvvv 136,192,4
v_exp_f32 v186, v186
mvvvz 144,192,8
v_exp_f32 v187, v187
mvvv 144,196,24
v_exp_f32 v188, v188
mvvv 144,200,40
v_exp_f32 v189, v189
mvvv 144,204,56
buffer_load_dwordx4 v240, s[8:11], s44 offen offset:1024 nt lds
mvvvz 152,204,60
s_add_u32 m0, m0, 32
v_exp_f32 v190, v190
mvvv 152,200,44
v_exp_f32 v191, v191
mvvv 152,196,28
v_add_f32 v229, v229, v174
v_add_f32 v229, v229, v175
mvvv 152,192,12
s_waitcnt lgkmcnt(0)
pk 171,174,175
v_add_f32 v230, v230, v176
mvvv 128,208,64
ds_read_b128 v[192:195], v236 offset:8448
v_add_f32 v230, v230, v177
mvvv 128,212,80
pk 176,176,177
v_add_f32 v230, v230, v178
mvvv 128,216,96
ds_read_b128 v[196:199], v236 offset:8512
v_add_f32 v230, v230, v179
mvvv 128,220,112
buffer_load_dwordx4 v240, s[8:11], s44 offen offset:2048 nt lds
mvvv 136,220,116
s_add_u32 m0, m0, 32
ds_read_b128 v[200:203], v236 offset:8576
pk 177,178,179
mvvv 136,216,100
v_add_f32 v230, v230, v180
v_add_f32 v230, v230, v181
mvvv 136,212,84
ds_read_b128 v[204:207], v236 offset:8640
pk 178,180,181
mvvv 136,208,68
v_fma_f32 v128, v128, s38, v224
v_fma_f32 v129, v129, s38, v224
mvvv 144,208,72
v_max_f32 v243, v128, v129
v_fma_f32 v130, v130, s38, v224
mvvv 144,212,88
v_fma_f32 v131, v131, s38, v224
v_max3_f32 v243, v243, v130, v131
mvvv 144,216,104
v_fma_f32 v136, v136, s38, v225
v_fma_f32 v137, v137, s38, v225
mvvv 144,220,120
buffer_load_dwordx4 v240, s[8:11], s44 offen offset:3072 nt lds
mvvv 152,220,124
s_add_u32 s44, s44, s52
v_max3_f32 v243, v243, v136, v137
v_fma_f32 v138, v138, s38, v225
mvvv 152,216,108
s_mov_b32 s16, s30
v_fma_f32 v139, v139, s38, v225
v_max3_f32 v243, v243, v138, v139
mvvv 152,212,92
s_mov_b32 s17, s31
v_lshrrev_b32 v239, 7, v240
v_mul_u32_u24 v239, s59, v239
mvvv 152,208,76
s_waitcnt lgkmcnt(0)
s_mov_b32 s18, 0x70000
v_and_b32 v242, 0x70, v240
mvvvz 132,192,0
s_mov_b32 m0, s73
ds_read_b128 v[208:211], v236 offset:8704
v_lshlrev_b32 v238, 2, v240
mvvv 132,196,16
s_add_u32 s46, s71, s74
v_add_u32 v242, v242, v239
v_lshrrev_b32 v239, 9, v240
mvvv 132,200,32
s_add_u32 s77, s71, 0x380
ds_read_b128 v[212:215], v236 offset:8768
v_mul_u32_u24 v239, 0x180, v239
mvvv 132,204,48
buffer_load_dword v238, s[84:87], s88 offen lds
mvvvz 140,204,52
s_movk_i32 s53, 160
ds_read_b128 v[216:219], v236 offset:8832
v_sub_u32 v235, v233, v239
mvvv 140,200,36
s_mov_b32 s55, 114688
v_add_u32 v234, s49, v240
v_fma_f32 v144, v144, s38, v226
mvvv 140,196,20
s_mov_b32 s56, 0xfffac000
ds_read_b128 v[220:223], v236 offset:8896
v_fma_f32 v145, v145, s38, v226
mvvv 140,192,4
s_mov_b32 s57, 114816
v_max3_f32 v243, v243, v144, v145
v_fma_f32 v146, v146, s38, v226
mvvvz 148,192,8
s_mov_b32 s48, s70
v_fma_f32 v147, v147, s38, v226
v_max3_f32 v243, v243, v146, v147
mvvv 148,196,24
v_fma_f32 v152, v152, s38, v227
v_fma_f32 v153, v153, s38, v227
mvvv 148,200,40
v_max3_f32 v243, v243, v152, v153
v_fma_f32 v154, v154, s38, v227
mvvv 148,204,56
v_add_u32 v237, s40, v233
v_fma_f32 v155, v155, s38, v227
mvvvz 156,204,60
s_add_u32 s40, s40, s42
s_cmp_eq_u32 s40, s43
s_cselect_b32 s40, 0, s40
mvvv 156,200,44
v_max3_f32 v243, v243, v154, v155
v_add_f32 v230, v230, v182
mvvv 156,196,28
v_add_f32 v230, v230, v183
pk 179,182,183
mvvv 156,192,12
s_waitcnt lgkmcnt(0)
v_add_f32 v231, v231, v184
v_add_f32 v231, v231, v185
mvvv 132,208,64
tr 192,237,0
pk 184,184,185
mvvv 132,212,80
L_padD0:
s_cbranch_vccnz L_padD4
tr 194,237,8448
v_add_f32 v231, v231, v186
mvvv 132,216,96
tr 196,237,32
v_add_f32 v231, v231, v187
mvvv 132,220,112
pk 185,186,187
v_add_f32 v231, v231, v188
mvvv 140,220,116
tr 198,237,8480
v_add_f32 v231, v231, v189
mvvv 140,216,100
tr 200,237,64
pk 186,188,189
mvvv 140,212,84
tr 202,237,8512
v_add_f32 v231, v231, v190
mvvv 140,208,68
v_add_f32 v231, v231, v191
pk 187,190,191
mvvv 148,208,72
tr 204,237,96
v_fma_f32 v132, v132, s38, v224
mvvv 148,212,88
tr 206,237,8544
v_fma_f32 v133, v133, s38, v224
mvvv 148,216,104
v_max3_f32 v243, v243, v132, v133
v_fma_f32 v134, v134, s38, v224
mvvv 148,220,120
v_fma_f32 v135, v135, s38, v224
v_max3_f32 v243, v243, v134, v135
mvvv 156,220,124
v_fma_f32 v140, v140, s38, v225
v_fma_f32 v141, v141, s38, v225
mvvv 156,216,108
v_max3_f32 v243, v243, v140, v141
v_fma_f32 v142, v142, s38, v225
mvvv 156,212,92
v_fma_f32 v143, v143, s38, v225
v_max3_f32 v243, v243, v142, v143
mvvv 156,208,76
s_waitcnt lgkmcnt(1)
v_fma_f32 v148, v148, s38, v226
v_fma_f32 v149, v149, s38, v226
mavv 0,192,160
s_mov_b32 s63, 28
tr 208,237,128
v_max3_f32 v243, v243, v148, v149
mavv 4,192,168
tr 210,237,8576
v_fma_f32 v150, v150, s38, v226
mavv 8,192,176
v_fma_f32 v151, v151, s38, v226
v_max3_f32 v243, v243, v150, v151
mavv 12,192,184
tr 212,237,160
v_fma_f32 v156, v156, s38, v227
mavv 28,196,184
tr 214,237,8608
v_fma_f32 v157, v157, s38, v227
mavv 24,196,176
v_max3_f32 v243, v243, v156, v157
v_fma_f32 v158, v158, s38, v227
mavv 20,196,168
tr 216,237,192
v_fma_f32 v159, v159, s38, v227
mavv 16,196,160
tr 218,237,8640
v_max3_f32 v243, v243, v158, v159
mavv 32,200,160
v_cmp_lt_f32 vcc, s39, v243
mavv 36,200,168
tr 220,237,224
mavv 40,200,176
s_cbranch_vccnz L_rare0
L_ret28:
tr 222,237,8672
mavv 44,200,184
s_waitcnt lgkmcnt(4)
v_exp_f32 v128, v128
mavv 60,204,184
tr 192,237,256
v_add_f32 v228, v228, v128
mavv 56,204,176
tr 194,237,8704
mavv 52,204,168
v_exp_f32 v129, v129
mavv 48,204,160
tr 196,237,288
v_add_f32 v228, v228, v129
mavv 64,208,160
tr 198,237,8736
pk 128,128,129
mavv 68,208,168
v_exp_f32 v130, v130
mavv 72,208,176
tr 200,237,320
v_add_f32 v228, v228, v130
mavv 76,208,184
tr 202,237,8768
mavv 92,212,184
v_exp_f32 v131, v131
mavv 88,212,176
tr 204,237,352
v_add_f32 v228, v228, v131
mavv 84,212,168
tr 206,237,8800
pk 129,130,131
mavv 80,212,160
s_waitcnt lgkmcnt(4)
v_exp_f32 v132, v132
mavv 96,216,160
tr 208,237,384
v_add_f32 v228, v228, v132
mavv 100,216,168
tr 210,237,8832
mavv 104,216,176
v_exp_f32 v133, v133
mavv 108,216,184
tr 212,237,416
v_add_f32 v228, v228, v133
mavv 124,220,184
tr 214,237,8864
pk 130,132,133
mavv 120,220,176
v_exp_f32 v134, v134
mavv 116,220,168
tr 216,237,448
v_add_f32 v228, v228, v134
mavv 112,220,160
tr 218,237,8896
mavv 128,192,160
v_exp_f32 v135, v135
mavv 132,192,168
tr 220,237,480
v_add_f32 v228, v228, v135
mavv 136,192,176
tr 222,237,8928
pk 131,134,135
mavv 140,192,184
v_exp_f32 v136, v136
mavv 156,196,184
v_exp_f32 v137, v137
mavv 152,196,176
v_exp_f32 v138, v138
mavv 148,196,168
v_exp_f32 v139, v139
mavv 144,196,160
s_waitcnt lgkmcnt(2)
v_exp_f32 v140, v140
mavv 160,200,160
v_exp_f32 v141, v141
mavv 164,200,168
v_exp_f32 v142, v142
mavv 168,200,176
v_exp_f32 v143, v143
mavv 172,200,184
v_add_u32 v236, s40, v232
v_add_f32 v229, v229, v136
mavv 188,204,184
s_add_u32 s40, s40, s42
s_cmp_eq_u32 s40, s43
s_cselect_b32 s40, 0, s40
mavv 184,204,176
v_exp_f32 v144, v144
mavv 180,204,168
v_exp_f32 v145, v145
mavv 176,204,160
s_waitcnt vmcnt(13) lgkmcnt(0)
s_barrier
v_add_f32 v229, v229, v137
mavv 192,208,160
s_add_u32 m0, s41, s49
s_add_u32 s41, s41, s42
ds_read_b128 v[192:195], v236 offset:0
mavv 196,208,168
s_cmp_eq_u32 s41, s43
s_cselect_b32 s41, 0, s41
pk 136,136,137
mavv 200,208,176
ds_read_b128 v[196:199], v236 offset:64
v_add_f32 v229, v229, v138
mavv 204,208,184
buffer_load_dwordx4 v240, s[12:15], s45 offen nt lds
mavv 220,212,184
s_add_u32 m0, m0, 32
ds_read_b128 v[200:203], v236 offset:128
v_add_f32 v229, v229, v139
mavv 216,212,176
v_exp_f32 v146, v146
mavv 212,212,168
ds_read_b128 v[204:207], v236 offset:192
pk 137,138,139
mavv 208,212,160
buffer_load_dwordx4 v240, s[12:15], s45 offen offset:1024 nt lds
mavv 224,216,160
s_add_u32 m0, m0, 32
v_exp_f32 v147, v147
mavv 228,216,168
v_exp_f32 v148, v148
mavv 232,216,176
v_exp_f32 v149, v149
mavv 236,216,184
buffer_load_dwordx4 v240, s[12:15], s45 offen offset:2048 nt lds
mavv 252,220,184
s_add_u32 m0, m0, 32
v_exp_f32 v150, v150
mavv 248,220,176
v_exp_f32 v151, v151
mavv 244,220,168
s_waitcnt lgkmcnt(0)
v_exp_f32 v152, v152
mavv 240,220,160
buffer_load_dwordx4 v240, s[12:15], s45 offen offset:3072 nt lds
mvvvz 160,192,0
s_add_u32 s45, s45, s52
s_add_u32 m0, s41, s49
ds_read_b128 v[208:211], v236 offset:256
mvvv 160,196,16
s_add_u32 s41, s41, s42
s_cmp_eq_u32 s41, s43
s_cselect_b32 s41, 0, s41
mvvv 160,200,32
ds_read_b128 v[212:215], v236 offset:320
v_add_f32 v229, v229, v140
mvvv 160,204,48
buffer_load_dwordx4 v240, s[12:15], s45 offen nt lds
mvvvz 168,204,52
s_add_u32 m0, m0, 32
ds_read_b128 v[216:219], v236 offset:384
v_add_f32 v229, v229, v141
mvvv 168,200,36
v_exp_f32 v153, v153
mvvv 168,196,20
ds_read_b128 v[220:223], v236 offset:448
pk 138,140,141
mvvv 168,192,4
v_exp_f32 v154, v154
mvvvz 176,192,8
v_exp_f32 v155, v155
mvvv 176,196,24
v_exp_f32 v156, v156
mvvv 176,200,40
v_exp_f32 v157, v157
mvvv 176,204,56
buffer_load_dwordx4 v240, s[12:15], s45 offen offset:1024 nt lds
mvvvz 184,204,60
s_add_u32 m0, m0, 32
v_exp_f32 v158, v158
mvvv 184,200,44
v_exp_f32 v159, v159
mvvv 184,196,28
v_add_f32 v229, v229, v142
v_add_f32 v229, v229, v143
mvvv 184,192,12
s_waitcnt lgkmcnt(0)
pk 139,142,143
v_add_f32 v230, v230, v144
mvvv 160,208,64
ds_read_b128 v[192:195], v236 offset:8448
v_add_f32 v230, v230, v145
mvvv 160,212,80
pk 144,144,145
v_add_f32 v230, v230, v146
mvvv 160,216,96
ds_read_b128 v[196:199], v236 offset:8512
v_add_f32 v230, v230, v147
mvvv 160,220,112
buffer_load_dwordx4 v240, s[12:15], s45 offen offset:2048 nt lds
mvvv 168,220,116
s_add_u32 m0, m0, 32
ds_read_b128 v[200:203], v236 offset:8576
pk 145,146,147
mvvv 168,216,100
v_add_f32 v230, v230, v148
v_add_f32 v230, v230, v149
mvvv 168,212,84
ds_read_b128 v[204:207], v236 offset:8640
pk 146,148,149
mvvv 168,208,68
v_fma_f32 v160, v160, s38, v224
v_fma_f32 v161, v161, s38, v224
mvvv 176,208,72
v_max_f32 v243, v160, v161
v_fma_f32 v162, v162, s38, v224
mvvv 176,212,88
v_fma_f32 v163, v163, s38, v224
v_max3_f32 v243, v243, v162, v163
mvvv 176,216,104
v_fma_f32 v168, v168, s38, v225
v_fma_f32 v169, v169, s38, v225
mvvv 176,220,120
buffer_load_dwordx4 v240, s[12:15], s45 offen offset:3072 nt lds
mvvv 184,220,124
s_add_u32 s45, s45, s52
s_add_u32 m0, s41, s49
s_add_u32 s41, s41, s42
mvvv 184,216,108
s_cmp_eq_u32 s41, s43
s_cselect_b32 s41, 0, s41
v_max3_f32 v243, v243, v168, v169
mvvv 184,212,92
s_waitcnt lgkmcnt(0)
v_fma_f32 v170, v170, s38, v225
v_fma_f32 v171, v171, s38, v225
mvvv 184,208,76
buffer_load_dwordx4 v242, s[16:19], s46 offen lds
mvvvz 164,192,0
s_add_u32 m0, m0, s53
ds_read_b128 v[208:211], v236 offset:8704
v_max3_f32 v243, v243, v170, v171
mvvv 164,196,16
v_fma_f32 v176, v176, s38, v226
v_fma_f32 v177, v177, s38, v226
mvvv 164,200,32
ds_read_b128 v[212:215], v236 offset:8768
v_max3_f32 v243, v243, v176, v177
mvvv 164,204,48
buffer_load_dwordx4 v242, s[16:19], s46 offen offset:896 lds
mvvvz 172,204,52
s_add_u32 m0, m0, s53
ds_read_b128 v[216:219], v236 offset:8832
v_fma_f32 v178, v178, s38, v226
mvvv 172,200,36
v_fma_f32 v179, v179, s38, v226
v_max3_f32 v243, v243, v178, v179
mvvv 172,196,20
ds_read_b128 v[220:223], v236 offset:8896
v_fma_f32 v184, v184, s38, v227
mvvv 172,192,4
buffer_load_dwordx4 v242, s[16:19], s46 offen offset:1792 lds
mvvvz 180,192,8
s_add_u32 m0, m0, s53
v_fma_f32 v185, v185, s38, v227
v_max3_f32 v243, v243, v184, v185
mvvv 180,196,24
v_fma_f32 v186, v186, s38, v227
v_fma_f32 v187, v187, s38, v227
mvvv 180,200,40
v_max3_f32 v243, v243, v186, v187
v_add_f32 v230, v230, v150
mvvv 180,204,56
v_add_u32 v237, s40, v233
v_add_f32 v230, v230, v151
mvvvz 188,204,60
s_add_u32 s40, s40, s42
s_cmp_eq_u32 s40, s43
s_cselect_b32 s40, 0, s40
mvvv 188,200,44
buffer_load_dwordx4 v242, s[16:19], s46 offen offset:2688 lds
mvvv 188,196,28
s_add_u32 s46, s46, s55
pk 147,150,151
v_add_f32 v231, v231, v152
mvvv 188,192,12
s_waitcnt lgkmcnt(0)
v_add_f32 v231, v231, v153
pk 152,152,153
mvvv 164,208,64
tr 192,237,0
v_add_f32 v231, v231, v154
mvvv 164,212,80
tr 194,237,8448
v_add_f32 v231, v231, v155
mvvv 164,216,96
tr 196,237,32
pk 153,154,155
mvvv 164,220,112
v_add_f32 v231, v231, v156
v_add_f32 v231, v231, v157
mvvv 172,220,116
tr 198,237,8480
pk 154,156,157
mvvv 172,216,100
tr 200,237,64
v_add_f32 v231, v231, v158
mvvv 172,212,84
tr 202,237,8512
v_add_f32 v231, v231, v159
mvvv 172,208,68
pk 155,158,159
mvvv 180,208,72
tr 204,237,96
v_fma_f32 v164, v164, s38, v224
mvvv 180,212,88
tr 206,237,8544
v_fma_f32 v165, v165, s38, v224
mvvv 180,216,104
v_max3_f32 v243, v243, v164, v165
v_fma_f32 v166, v166, s38, v224
mvvv 180,220,120
v_fma_f32 v167, v167, s38, v224
v_max3_f32 v243, v243, v166, v167
mvvv 188,220,124
v_fma_f32 v172, v172, s38, v225
v_fma_f32 v173, v173, s38, v225
mvvv 188,216,108
v_max3_f32 v243, v243, v172, v173
v_fma_f32 v174, v174, s38, v225
mvvv 188,212,92
v_fma_f32 v175, v175, s38, v225
v_max3_f32 v243, v243, v174, v175
mvvv 188,208,76
s_waitcnt lgkmcnt(1)
v_fma_f32 v180, v180, s38, v226
v_fma_f32 v181, v181, s38, v226
mavv 0,192,128
s_mov_b32 s63, 29
tr 208,237,128
v_max3_f32 v243, v243, v180, v181
mavv 4,192,136
tr 210,237,8576
v_fma_f32 v182, v182, s38, v226
mavv 8,192,144
v_fma_f32 v183, v183, s38, v226
v_max3_f32 v243, v243, v182, v183
mavv 12,192,152
tr 212,237,160
v_fma_f32 v188, v188, s38, v227
mavv 28,196,152
tr 214,237,8608
v_fma_f32 v189, v189, s38, v227
mavv 24,196,144
v_max3_f32 v243, v243, v188, v189
v_fma_f32 v190, v190, s38, v227
mavv 20,196,136
tr 216,237,192
v_fma_f32 v191, v191, s38, v227
mavv 16,196,128
tr 218,237,8640
v_max3_f32 v243, v243, v190, v191
mavv 32,200,128
v_cmp_lt_f32 vcc, s39, v243
mavv 36,200,136
tr 220,237,224
mavv 40,200,144
s_cbranch_vccnz L_rare1
L_ret29:
tr 222,237,8672
mavv 44,200,152
s_waitcnt lgkmcnt(4)
v_exp_f32 v160, v160
mavv 60,204,152
tr 192,237,256
v_add_f32 v228, v228, v160
mavv 56,204,144
tr 194,237,8704
mavv 52,204,136
v_exp_f32 v161, v161
mavv 48,204,128
tr 196,237,288
v_add_f32 v228, v228, v161
mavv 64,208,128
tr 198,237,8736
pk 160,160,161
mavv 68,208,136
v_exp_f32 v162, v162
mavv 72,208,144
tr 200,237,320
v_add_f32 v228, v228, v162
mavv 76,208,152
tr 202,237,8768
mavv 92,212,152
v_exp_f32 v163, v163
mavv 88,212,144
tr 204,237,352
v_add_f32 v228, v228, v163
mavv 84,212,136
tr 206,237,8800
pk 161,162,163
mavv 80,212,128
s_waitcnt lgkmcnt(4)
v_exp_f32 v164, v164
mavv 96,216,128
tr 208,237,384
v_add_f32 v228, v228, v164
mavv 100,216,136
tr 210,237,8832
mavv 104,216,144
v_exp_f32 v165, v165
mavv 108,216,152
tr 212,237,416
v_add_f32 v228, v228, v165
mavv 124,220,152
tr 214,237,8864
pk 162,164,165
mavv 120,220,144
v_exp_f32 v166, v166
mavv 116,220,136
tr 216,237,448
v_add_f32 v228, v228, v166
mavv 112,220,128
tr 218,237,8896
mavv 128,192,128
v_exp_f32 v167, v167
mavv 132,192,136
tr 220,237,480
v_add_f32 v228, v228, v167
mavv 136,192,144
tr 222,237,8928
pk 163,166,167
mavv 140,192,152
v_exp_f32 v168, v168
mavv 156,196,152
v_exp_f32 v169, v169
mavv 152,196,144
v_exp_f32 v170, v170
mavv 148,196,136
v_exp_f32 v171, v171
mavv 144,196,128
s_waitcnt lgkmcnt(2)
v_exp_f32 v172, v172
mavv 160,200,128
v_exp_f32 v173, v173
mavv 164,200,136
v_exp_f32 v174, v174
mavv 168,200,144
v_exp_f32 v175, v175
mavv 172,200,152
v_add_u32 v236, s40, v232
v_add_f32 v229, v229, v168
mavv 188,204,152
s_add_u32 s40, s40, s42
s_cmp_eq_u32 s40, s43
s_cselect_b32 s40, 0, s40
mavv 184,204,144
v_exp_f32 v176, v176
mavv 180,204,136
v_exp_f32 v177, v177
mavv 176,204,128
s_waitcnt vmcnt(17) lgkmcnt(0)
s_barrier
v_add_f32 v229, v229, v169
mavv 192,208,128
s_add_u32 m0, s41, s49
s_add_u32 s41, s41, s42
ds_read_b128 v[192:195], v236 offset:0
mavv 196,208,136
s_cmp_eq_u32 s41, s43
s_cselect_b32 s41, 0, s41
pk 168,168,169
mavv 200,208,144
ds_read_b128 v[196:199], v236 offset:64
v_add_f32 v229, v229, v170
mavv 204,208,152
buffer_load_dwordx4 v240, s[24:27], s48 offen lds
mavv 220,212,152
s_add_u32 m0, m0, 32
ds_read_b128 v[200:203], v236 offset:128
v_add_f32 v229, v229, v171
mavv 216,212,144
v_exp_f32 v178, v178
mavv 212,212,136
ds_read_b128 v[204:207], v236 offset:192
pk 169,170,171
mavv 208,212,128
buffer_load_dwordx4 v240, s[24:27], s48 offen offset:1024 lds
mavv 224,216,128
s_add_u32 m0, m0, 32
v_exp_f32 v179, v179
mavv 228,216,136
v_exp_f32 v180, v180
mavv 232,216,144
v_exp_f32 v181, v181
mavv 236,216,152
buffer_load_dwordx4 v240, s[24:27], s48 offen offset:2048 lds
mavv 252,220,152
s_or_b32 s48, s48, s93
s_add_u32 m0, m0, 32
v_add_f32 v229, v229, v172
mavv 248,220,144
v_exp_f32 v182, v182
mavv 244,220,136
s_waitcnt lgkmcnt(0)
v_exp_f32 v183, v183
mavv 240,220,128
buffer_load_dwordx4 v240, s[24:27], s48 offen offset:3072 lds
mvvvz 128,192,0
s_bitset0_b32 s48, 30
s_add_u32 s48, s48, s72
ds_read_b128 v[208:211], v236 offset:256
mvvv 128,196,16
s_add_u32 m0, s41, s49
s_add_u32 s41, s41, s42
s_mov_b32 s10, 0x200000
mvvv 128,200,32
s_cmp_eq_u32 s41, s43
s_cselect_b32 s41, 0, s41
ds_read_b128 v[212:215], v236 offset:320
mvvv 128,204,48
buffer_load_dwordx4 v240, s[24:27], s48 offen lds
mvvvz 136,204,52
s_add_u32 m0, m0, 32
s_lshl_b32 s36, s65, 15
ds_read_b128 v[216:219], v236 offset:384
mvvv 136,200,36
s_sub_u32 s36, s24, s36
s_subb_u32 s37, s25, 0
v_exp_f32 v184, v184
mvvv 136,196,20
s_add_u32 s5, s3, 0x380
ds_read_b128 v[220:223], v236 offset:448
v_add_f32 v229, v229, v173
mvvv 136,192,4
s_add_u32 s3, s3, s74
v_exp_f32 v185, v185
mvvvz 144,192,8
L_padD1:
s_cbranch_vccnz L_padD5
s_sub_u32 s74, s5, 0x380
v_exp_f32 v186, v186
mvvv 144,196,24
s_lshl_b32 s76, s51, 3
v_exp_f32 v187, v187
mvvv 144,200,40
s_mov_b32 s12, s32
v_exp_f32 v188, v188
mvvv 144,204,56
buffer_load_dwordx4 v240, s[24:27], s48 offen offset:1024 lds
mvvvz 152,204,60
s_add_u32 m0, m0, 32
s_mov_b32 s13, s33
pk 170,172,173
mvvv 152,200,44
s_mov_b32 s14, 429184
v_exp_f32 v189, v189
mvvv 152,196,28
s_mov_b32 s20, s96
v_exp_f32 v190, v190
mvvv 152,192,12
s_waitcnt lgkmcnt(0)
s_mov_b32 s21, s97
v_add_f32 v229, v229, v174
mvvv 128,208,64
s_movk_i32 s22, 160
ds_read_b128 v[192:195], v236 offset:8448
v_add_f32 v229, v229, v175
mvvv 128,212,80
s_movk_i32 s95, 255
v_exp_f32 v191, v191
mvvv 128,216,96
s_mov_b32 s98, 0x40000
ds_read_b128 v[196:199], v236 offset:8512
pk 171,174,175
mvvv 128,220,112
buffer_load_dwordx4 v240, s[24:27], s48 offen offset:2048 lds
mvvv 136,220,116
s_or_b32 s48, s48, s93
s_add_u32 m0, m0, 32
ds_read_b128 v[200:203], v236 offset:8576
mvvv 136,216,100
s_mov_b32 s84, s34
v_add_f32 v230, v230, v176
v_add_f32 v230, v230, v177
mvvv 136,212,84
s_mov_b32 s85, s35
ds_read_b128 v[204:207], v236 offset:8640
v_fma_f32 v128, v128, s38, v224
mvvv 136,208,68
s_mov_b32 s86, 4
v_fma_f32 v129, v129, s38, v224
v_max_f32 v243, v128, v129
mvvv 144,208,72
v_fma_f32 v130, v130, s38, v224
v_fma_f32 v131, v131, s38, v224
mvvv 144,212,88
v_max3_f32 v243, v243, v130, v131
pk 176,176,177
mvvv 144,216,104
v_fma_f32 v136, v136, s38, v225
v_fma_f32 v137, v137, s38, v225
mvvv 144,220,120
buffer_load_dwordx4 v240, s[24:27], s48 offen offset:3072 lds
mvvv 152,220,124
s_bitset0_b32 s48, 30
s_add_u32 s48, s48, s72
s_add_u32 m0, s41, s49
mvvv 152,216,108
s_add_u32 s41, s41, s42
s_cmp_eq_u32 s41, s43
s_cselect_b32 s41, 0, s41
mvvv 152,212,92
s_waitcnt lgkmcnt(0)
v_max3_f32 v243, v243, v136, v137
v_fma_f32 v138, v138, s38, v225
mvvv 152,208,76
buffer_load_dwordx4 v240, s[24:27], s48 offen lds
mvvvz 132,192,0
s_add_u32 m0, m0, 32
ds_read_b128 v[208:211], v236 offset:8704
v_fma_f32 v139, v139, s38, v225
mvvv 132,196,16
v_max3_f32 v243, v243, v138, v139
v_fma_f32 v144, v144, s38, v226
mvvv 132,200,32
ds_read_b128 v[212:215], v236 offset:8768
v_fma_f32 v145, v145, s38, v226
mvvv 132,204,48
buffer_load_dwordx4 v240, s[24:27], s48 offen offset:1024 lds
mvvvz 140,204,52
s_add_u32 m0, m0, 32
ds_read_b128 v[216:219], v236 offset:8832
v_max3_f32 v243, v243, v144, v145
mvvv 140,200,36
v_fma_f32 v146, v146, s38, v226
v_fma_f32 v147, v147, s38, v226
mvvv 140,196,20
ds_read_b128 v[220:223], v236 offset:8896
v_max3_f32 v243, v243, v146, v147
mvvv 140,192,4
buffer_load_dwordx4 v240, s[24:27], s48 offen offset:2048 lds
mvvvz 148,192,8
s_or_b32 s48, s48, s93
s_add_u32 m0, m0, 32
v_fma_f32 v152, v152, s38, v227
mvvv 148,196,24
v_fma_f32 v153, v153, s38, v227
v_max3_f32 v243, v243, v152, v153
mvvv 148,200,40
v_fma_f32 v154, v154, s38, v227
v_fma_f32 v155, v155, s38, v227
mvvv 148,204,56
v_add_u32 v237, s40, v233
v_max3_f32 v243, v243, v154, v155
mvvvz 156,204,60
s_add_u32 s40, s40, s42
s_cmp_eq_u32 s40, s43
s_cselect_b32 s40, 0, s40
mvvv 156,200,44
buffer_load_dwordx4 v240, s[24:27], s48 offen offset:3072 lds
mvvv 156,196,28
s_bitset0_b32 s48, 30
s_add_u32 s48, s48, s72
v_add_f32 v230, v230, v178
mvvv 156,192,12
s_waitcnt lgkmcnt(0)
v_add_f32 v230, v230, v179
pk 177,178,179
mvvv 132,208,64
tr 192,237,0
v_add_f32 v230, v230, v180
mvvv 132,212,80
tr 194,237,8448
v_add_f32 v230, v230, v181
mvvv 132,216,96
tr 196,237,32
pk 178,180,181
mvvv 132,220,112
v_add_f32 v230, v230, v182
v_add_f32 v230, v230, v183
mvvv 140,220,116
tr 198,237,8480
pk 179,182,183
mvvv 140,216,100
tr 200,237,64
v_add_f32 v231, v231, v184
mvvv 140,212,84
tr 202,237,8512
v_add_f32 v231, v231, v185
mvvv 140,208,68
pk 184,184,185
v_add_f32 v231, v231, v186
v_add_f32 v231, v231, v187
mvvv 148,208,72
tr 204,237,96
v_fma_f32 v132, v132, s38, v224
pk 185,186,187
mvvv 148,212,88
tr 206,237,8544
v_fma_f32 v133, v133, s38, v224
v_add_f32 v231, v231, v188
mvvv 148,216,104
v_max3_f32 v243, v243, v132, v133
v_fma_f32 v134, v134, s38, v224
v_add_f32 v231, v231, v189
mvvv 148,220,120
v_fma_f32 v135, v135, s38, v224
v_max3_f32 v243, v243, v134, v135
pk 186,188,189
mvvv 156,220,124
v_fma_f32 v140, v140, s38, v225
v_fma_f32 v141, v141, s38, v225
v_add_f32 v231, v231, v190
mvvv 156,216,108
v_max3_f32 v243, v243, v140, v141
v_fma_f32 v142, v142, s38, v225
v_add_f32 v231, v231, v191
mvvv 156,212,92
v_fma_f32 v143, v143, s38, v225
v_max3_f32 v243, v243, v142, v143
pk 187,190,191
mvvv 156,208,76
s_waitcnt lgkmcnt(1)
v_fma_f32 v148, v148, s38, v226
v_fma_f32 v149, v149, s38, v226
mavv 0,192,160
s_mov_b32 s63, 30
tr 208,237,128
v_max3_f32 v243, v243, v148, v149
mavv 4,192,168
tr 210,237,8576
v_fma_f32 v150, v150, s38, v226
mavv 8,192,176
v_fma_f32 v151, v151, s38, v226
v_max3_f32 v243, v243, v150, v151
mavv 12,192,184
tr 212,237,160
v_fma_f32 v156, v156, s38, v227
mavv 28,196,184
tr 214,237,8608
v_fma_f32 v157, v157, s38, v227
mavv 24,196,176
v_max3_f32 v243, v243, v156, v157
v_fma_f32 v158, v158, s38, v227
mavv 20,196,168
tr 216,237,192
v_fma_f32 v159, v159, s38, v227
mavv 16,196,160
tr 218,237,8640
v_max3_f32 v243, v243, v158, v159
mavv 32,200,160
v_cmp_lt_f32 vcc, s39, v243
mavv 36,200,168
tr 220,237,224
mavv 40,200,176
s_cbranch_vccnz L_rare0
L_ret30:
tr 222,237,8672
mavv 44,200,184
s_waitcnt lgkmcnt(4)
v_exp_f32 v128, v128
mavv 60,204,184
tr 192,237,256
v_add_f32 v228, v228, v128
mavv 56,204,176
tr 194,237,8704
mavv 52,204,168
v_exp_f32 v129, v129
mavv 48,204,160
tr 196,237,288
v_add_f32 v228, v228, v129
mavv 64,208,160
tr 198,237,8736
pk 128,128,129
mavv 68,208,168
v_exp_f32 v130, v130
mavv 72,208,176
tr 200,237,320
v_add_f32 v228, v228, v130
mavv 76,208,184
tr 202,237,8768
mavv 92,212,184
v_exp_f32 v131, v131
mavv 88,212,176
tr 204,237,352
v_add_f32 v228, v228, v131
mavv 84,212,168
tr 206,237,8800
pk 129,130,131
mavv 80,212,160
s_waitcnt lgkmcnt(4)
v_exp_f32 v132, v132
mavv 96,216,160
tr 208,237,384
v_add_f32 v228, v228, v132
mavv 100,216,168
tr 210,237,8832
mavv 104,216,176
v_exp_f32 v133, v133
mavv 108,216,184
tr 212,237,416
v_add_f32 v228, v228, v133
mavv 124,220,184
tr 214,237,8864
pk 130,132,133
mavv 120,220,176
v_exp_f32 v134, v134
mavv 116,220,168
tr 216,237,448
v_add_f32 v228, v228, v134
mavv 112,220,160
tr 218,237,8896
mavv 128,192,160
v_exp_f32 v135, v135
mavv 132,192,168
tr 220,237,480
v_add_f32 v228, v228, v135
mavv 136,192,176
tr 222,237,8928
pk 131,134,135
mavv 140,192,184
v_exp_f32 v136, v136
mavv 156,196,184
v_exp_f32 v137, v137
mavv 152,196,176
v_exp_f32 v138, v138
mavv 148,196,168
buffer_load_dword v241, v240, s[84:87], 0 offen sc1
mavv 144,196,160
s_waitcnt lgkmcnt(2)
v_exp_f32 v139, v139
mavv 160,200,160
v_exp_f32 v140, v140
mavv 164,200,168
v_exp_f32 v141, v141
mavv 168,200,176
v_exp_f32 v142, v142
mavv 172,200,184
v_add_u32 v236, s40, v232
v_add_f32 v229, v229, v136
mavv 188,204,184
s_add_u32 s40, s40, s42
s_cmp_eq_u32 s40, s43
s_cselect_b32 s40, 0, s40
mavv 184,204,176
v_exp_f32 v143, v143
mavv 180,204,168
v_exp_f32 v144, v144
mavv 176,204,160
s_waitcnt vmcnt(21) lgkmcnt(0)
s_barrier
v_add_f32 v229, v229, v137
mavv 192,208,160
s_add_u32 m0, s41, s49
s_add_u32 s41, s41, s42
ds_read_b128 v[192:195], v236 offset:0
mavv 196,208,168
s_cmp_eq_u32 s41, s43
s_cselect_b32 s41, 0, s41
pk 136,136,137
mavv 200,208,176
ds_read_b128 v[196:199], v236 offset:64
v_add_f32 v229, v229, v138
mavv 204,208,184
buffer_load_dwordx4 v240, s[24:27], s48 offen lds
mavv 220,212,184
s_add_u32 m0, m0, 32
ds_read_b128 v[200:203], v236 offset:128
v_add_f32 v229, v229, v139
mavv 216,212,176
v_exp_f32 v145, v145
mavv 212,212,168
ds_read_b128 v[204:207], v236 offset:192
pk 137,138,139
mavv 208,212,160
buffer_load_dwordx4 v240, s[24:27], s48 offen offset:1024 lds
mavv 224,216,160
s_add_u32 m0, m0, 32
v_exp_f32 v146, v146
mavv 228,216,168
v_exp_f32 v147, v147
mavv 232,216,176
v_exp_f32 v148, v148
mavv 236,216,184
buffer_load_dwordx4 v240, s[24:27], s48 offen offset:2048 lds
mavv 252,220,184
s_or_b32 s48, s48, s93
s_add_u32 m0, m0, 32
v_add_f32 v229, v229, v140
mavv 248,220,176
v_exp_f32 v149, v149
mavv 244,220,168
s_waitcnt lgkmcnt(0)
v_exp_f32 v150, v150
mavv 240,220,160
buffer_load_dwordx4 v240, s[24:27], s48 offen offset:3072 lds
mvvvz 160,192,0
s_bitset0_b32 s48, 30
s_add_u32 s48, s48, s72
ds_read_b128 v[208:211], v236 offset:256
mvvv 160,196,16
s_add_u32 m0, s41, s49
s_add_u32 s41, s41, s42
v_add_f32 v229, v229, v141
mvvv 160,200,32
s_cmp_eq_u32 s41, s43
s_cselect_b32 s41, 0, s41
ds_read_b128 v[212:215], v236 offset:320
mvvv 160,204,48
buffer_load_dwordx4 v242, s[16:19], s46 offen lds
mvvvz 168,204,52
s_add_u32 m0, m0, s53
ds_read_b128 v[216:219], v236 offset:384
pk 138,140,141
mvvv 168,200,36
v_exp_f32 v151, v151
mvvv 168,196,20
ds_read_b128 v[220:223], v236 offset:448
v_add_f32 v229, v229, v142
mvvv 168,192,4
v_exp_f32 v152, v152
mvvvz 176,192,8
v_exp_f32 v153, v153
mvvv 176,196,24
v_exp_f32 v154, v154
mvvv 176,200,40
v_exp_f32 v155, v155
mvvv 176,204,56
buffer_load_dwordx4 v242, s[16:19], s46 offen offset:896 lds
mvvvz 184,204,60
s_add_u32 m0, m0, s53
v_exp_f32 v156, v156
mvvv 184,200,44
v_exp_f32 v157, v157
mvvv 184,196,28
v_exp_f32 v158, v158
mvvv 184,192,12
s_waitcnt lgkmcnt(0)
v_exp_f32 v159, v159
mvvv 160,208,64
ds_read_b128 v[192:195], v236 offset:8448
v_add_f32 v229, v229, v143
mvvv 160,212,80
pk 139,142,143
v_add_f32 v230, v230, v144
mvvv 160,216,96
ds_read_b128 v[196:199], v236 offset:8512
v_add_f32 v230, v230, v145
mvvv 160,220,112
buffer_load_dwordx4 v242, s[16:19], s46 offen offset:1792 lds
mvvv 168,220,116
s_add_u32 m0, m0, s53
ds_read_b128 v[200:203], v236 offset:8576
pk 144,144,145
mvvv 168,216,100
v_add_f32 v230, v230, v146
v_add_f32 v230, v230, v147
mvvv 168,212,84
ds_read_b128 v[204:207], v236 offset:8640
pk 145,146,147
mvvv 168,208,68
v_fma_f32 v160, v160, s38, v224
v_fma_f32 v161, v161, s38, v224
mvvv 176,208,72
v_max_f32 v243, v160, v161
v_fma_f32 v162, v162, s38, v224
mvvv 176,212,88
v_fma_f32 v163, v163, s38, v224
v_max3_f32 v243, v243, v162, v163
mvvv 176,216,104
v_fma_f32 v168, v168, s38, v225
v_fma_f32 v169, v169, s38, v225
mvvv 176,220,120
buffer_load_dwordx4 v242, s[16:19], s46 offen offset:2688 lds
mvvv 184,220,124
s_add_u32 s46, s46, s56
v_max3_f32 v243, v243, v168, v169
v_fma_f32 v170, v170, s38, v225
mvvv 184,216,108
v_fma_f32 v171, v171, s38, v225
v_max3_f32 v243, v243, v170, v171
mvvv 184,212,92
v_fma_f32 v176, v176, s38, v226
v_fma_f32 v177, v177, s38, v226
mvvv 184,208,76
s_waitcnt lgkmcnt(0)
s_waitcnt vmcnt(8)
v_max3_f32 v243, v243, v176, v177
mvvvz 164,192,0
ds_read_b128 v[208:211], v236 offset:8704
v_readfirstlane_b32 s94, v241
mvvv 164,196,16
v_fma_f32 v178, v178, s38, v226
v_fma_f32 v179, v179, s38, v226
mvvv 164,200,32
ds_read_b128 v[212:215], v236 offset:8768
v_max3_f32 v243, v243, v178, v179
mvvv 164,204,48
v_fma_f32 v184, v184, s38, v227
v_fma_f32 v185, v185, s38, v227
mvvvz 172,204,52
ds_read_b128 v[216:219], v236 offset:8832
v_max3_f32 v243, v243, v184, v185
mvvv 172,200,36
v_fma_f32 v186, v186, s38, v227
v_fma_f32 v187, v187, s38, v227
mvvv 172,196,20
ds_read_b128 v[220:223], v236 offset:8896
v_max3_f32 v243, v243, v186, v187
mvvv 172,192,4
v_add_f32 v230, v230, v148
v_add_f32 v230, v230, v149
mvvvz 180,192,8
pk 146,148,149
v_add_f32 v230, v230, v150
mvvv 180,196,24
s_bitcmp0_b32 s94, 3
s_cbranch_scc1 L_spin_clear
L_cleared:
v_add_f32 v230, v230, v151
mvvv 180,200,40
pk 147,150,151
v_add_f32 v231, v231, v152
mvvv 180,204,56
s_mov_b32 s61, 0x70000000
v_add_u32 v237, s40, v233
v_add_f32 v231, v231, v153
mvvvz 188,204,60
s_add_u32 s54, s65, 0
s_add_u32 s40, s40, s42
pk 152,152,153
mvvv 188,200,44
s_add_u32 s62, s65, 0x80
s_cmp_eq_u32 s40, s43
s_cselect_b32 s40, 0, s40
mvvv 188,196,28
s_mov_b32 s44, 0xfff20000
v_add_f32 v231, v231, v154
v_add_f32 v231, v231, v155
mvvv 188,192,12
s_waitcnt lgkmcnt(0)
s_mov_b32 s58, 0x20000
pk 153,154,155
mvvv 164,208,64
s_cmp_eq_u32 s94, s76
s_cselect_b32 s75, 0, 1
tr 192,237,0
mvvv 164,212,80
s_cmp_eq_u32 s94, s76
s_cselect_b32 s60, 0xfffff000, s72
tr 194,237,8448
mvvv 164,216,96
s_cmp_eq_u32 s94, s76
s_cselect_b32 s44, s44, 0xffe42000
tr 196,237,32
mvvv 164,220,112
s_cmp_eq_u32 s94, s76
s_cselect_b32 s58, s58, 0x40000
v_add_f32 v231, v231, v156
v_add_f32 v231, v231, v157
mvvv 172,220,116
s_cmp_eq_u32 s94, s76
s_cselect_b32 s64, s61, s62
tr 198,237,8480
pk 154,156,157
mvvv 172,216,100
s_cmp_eq_u32 s94, s76
s_cselect_b32 s54, s54, s61
tr 200,237,64
v_add_f32 v231, v231, v158
mvvv 172,212,84
s_cmp_eq_u32 s94, s76
s_cselect_b32 s62, 0, 0x80
tr 202,237,8512
v_add_f32 v231, v231, v159
mvvv 172,208,68
s_cmp_eq_u32 s94, s76
s_cselect_b32 s8, s36, s28
v_fma_f32 v164, v164, s38, v224
pk 155,158,159
mvvv 180,208,72
s_cmp_eq_u32 s94, s76
s_cselect_b32 s9, s37, s29
tr 204,237,96
mvvv 180,212,88
s_cmp_eq_u32 s94, s76
s_cselect_b32 s6, s6, s7
tr 206,237,8544
mvvv 180,216,104
s_cmp_eq_u32 s94, s76
s_cselect_b32 s66, s66, s68
v_fma_f32 v165, v165, s38, v224
mvvv 180,220,120
s_cmp_eq_u32 s94, s76
s_cselect_b32 s67, s67, s69
v_max3_f32 v243, v243, v164, v165
mvvv 188,220,124
s_cmp_eq_u32 s4, 0
s_cselect_b32 s61, s64, s61
v_fma_f32 v166, v166, s38, v224
mvvv 188,216,108
s_mov_b32 s94, 1
v_fma_f32 v167, v167, s38, v224
v_max3_f32 v243, v243, v166, v167
mvvv 188,212,92
s_addk_i32 s3, -128
v_fma_f32 v172, v172, s38, v225
v_fma_f32 v173, v173, s38, v225
mvvv 188,208,76
s_waitcnt lgkmcnt(1)
s_bitset1_b32 s3, 31
v_max3_f32 v243, v243, v172, v173
mavv 0,192,128
tr 208,237,128
v_fma_f32 v174, v174, s38, v225
mavv 4,192,136
tr 210,237,8576
v_fma_f32 v175, v175, s38, v225
mavv 8,192,144
v_max3_f32 v243, v243, v174, v175
v_fma_f32 v180, v180, s38, v226
mavv 12,192,152
s_mov_b32 s63, 31
tr 212,237,160
v_fma_f32 v181, v181, s38, v226
mavv 28,196,152
tr 214,237,8608
v_max3_f32 v243, v243, v180, v181
mavv 24,196,144
v_fma_f32 v182, v182, s38, v226
v_fma_f32 v183, v183, s38, v226
mavv 20,196,136
tr 216,237,192
v_max3_f32 v243, v243, v182, v183
mavv 16,196,128
tr 218,237,8640
v_fma_f32 v188, v188, s38, v227
mavv 32,200,128
v_fma_f32 v189, v189, s38, v227
v_max3_f32 v243, v243, v188, v189
mavv 36,200,136
tr 220,237,224
v_fma_f32 v190, v190, s38, v227
mavv 40,200,144
tr 222,237,8672
v_fma_f32 v191, v191, s38, v227
mavv 44,200,152
s_waitcnt lgkmcnt(4)
v_max3_f32 v243, v243, v190, v191
v_cmp_lt_f32 vcc, s39, v243
mavv 60,204,152
tr 192,237,256
mavv 56,204,144
s_cbranch_vccnz L_rare1
L_ret31:
tr 194,237,8704
mavv 52,204,136
L_padD2:
s_cbranch_vccnz L_hop_b
v_exp_f32 v160, v160
mavv 48,204,128
tr 196,237,288
mavv 64,208,128
tr 198,237,8736
mavv 68,208,136
v_exp_f32 v161, v161
mavv 72,208,144
tr 200,237,320
v_add_f32 v228, v228, v160
mavv 76,208,152
tr 202,237,8768
mavv 92,212,152
v_exp_f32 v162, v162
mavv 88,212,144
tr 204,237,352
v_add_f32 v228, v228, v161
mavv 84,212,136
tr 206,237,8800
pk 160,160,161
mavv 80,212,128
s_waitcnt lgkmcnt(4)
v_exp_f32 v163, v163
mavv 96,216,128
tr 208,237,384
v_add_f32 v228, v228, v162
mavv 100,216,136
tr 210,237,8832
mavv 104,216,144
v_exp_f32 v164, v164
mavv 108,216,152
tr 212,237,416
v_add_f32 v228, v228, v163
mavv 124,220,152
tr 214,237,8864
pk 161,162,163
mavv 120,220,144
v_exp_f32 v165, v165
mavv 116,220,136
tr 216,237,448
v_add_f32 v228, v228, v164
mavv 112,220,128
tr 218,237,8896
mavv 128,192,128
v_exp_f32 v166, v166
mavv 132,192,136
tr 220,237,480
v_add_f32 v228, v228, v165
mavv 136,192,144
tr 222,237,8928
pk 162,164,165
mavv 140,192,152
v_exp_f32 v167, v167
mavv 156,196,152
v_add_f32 v228, v228, v166
mavv 152,196,144
v_exp_f32 v168, v168
mavv 148,196,136
v_add_f32 v228, v228, v167
pk 163,166,167
mavv 144,196,128
s_waitcnt lgkmcnt(2)
v_exp_f32 v169, v169
mavv 160,200,128
v_add_f32 v229, v229, v168
mavv 164,200,136
v_exp_f32 v170, v170
mavv 168,200,144
v_add_f32 v229, v229, v169
pk 168,168,169
mavv 172,200,152
v_add_u32 v237, s40, v233
mavv 188,204,152
s_add_u32 s40, s40, s42
s_cmp_eq_u32 s40, s43
s_cselect_b32 s40, 0, s40
mavv 184,204,144
v_exp_f32 v171, v171
mavv 180,204,136
v_add_f32 v229, v229, v170
mavv 176,204,128
s_waitcnt vmcnt(25) lgkmcnt(0)
s_barrier
mavv 192,208,128
s_add_u32 m0, s41, s49
s_add_u32 s41, s41, s42
tr 192,237,0
mavv 196,208,136
s_cmp_eq_u32 s41, s43
s_cselect_b32 s41, 0, s41
tr 194,237,8448
mavv 200,208,144
tr 196,237,32
mavv 204,208,152
buffer_load_dwordx4 v240, s[24:27], s48 offen lds
mavv 220,212,152
s_add_u32 m0, m0, 32
tr 198,237,8480
mavv 216,212,144
tr 200,237,64
mavv 212,212,136
tr 202,237,8512
mavv 208,212,128
buffer_load_dwordx4 v240, s[24:27], s48 offen offset:1024 lds
mavv 224,216,128
s_add_u32 m0, m0, 32
tr 204,237,96
mavv 228,216,136
tr 206,237,8544
mavv 232,216,144
v_exp_f32 v172, v172
mavv 236,216,152
buffer_load_dwordx4 v240, s[24:27], s48 offen offset:2048 lds
mavv 252,220,152
s_or_b32 s48, s48, s93
s_add_u32 m0, m0, 32
v_add_f32 v229, v229, v171
mavv 248,220,144
pk 169,170,171
mavv 244,220,136
v_exp_f32 v173, v173
mavv 240,220,128
buffer_load_dwordx4 v240, s[24:27], s48 offen offset:3072 lds
s_waitcnt lgkmcnt(6)
s_bitset0_b32 s48, 30
s_add_u32 s48, s48, s72
s_add_u32 m0, s41, s49
s_add_u32 s41, s41, s42
s_cmp_eq_u32 s41, s43
s_cselect_b32 s41, 0, s41
v_add_f32 v229, v229, v172
v_exp_f32 v174, v174
v_add_f32 v229, v229, v173
pk 170,172,173
v_exp_f32 v175, v175
v_add_f32 v229, v229, v174
v_exp_f32 v176, v176
v_add_f32 v229, v229, v175
pk 171,174,175
v_exp_f32 v177, v177
v_add_f32 v230, v230, v176
v_exp_f32 v178, v178
v_add_f32 v230, v230, v177
pk 176,176,177
v_exp_f32 v179, v179
v_add_f32 v230, v230, v178
v_exp_f32 v180, v180
v_add_f32 v230, v230, v179
pk 177,178,179
v_exp_f32 v181, v181
v_add_f32 v230, v230, v180
v_exp_f32 v182, v182
v_add_f32 v230, v230, v181
pk 178,180,181
v_exp_f32 v183, v183
v_add_f32 v230, v230, v182
v_exp_f32 v184, v184
v_add_f32 v230, v230, v183
pk 179,182,183
v_exp_f32 v185, v185
v_add_f32 v231, v231, v184
v_exp_f32 v186, v186
v_add_f32 v231, v231, v185
pk 184,184,185
v_exp_f32 v187, v187
v_add_f32 v231, v231, v186
v_exp_f32 v188, v188
v_add_f32 v231, v231, v187
pk 185,186,187
v_exp_f32 v189, v189
v_add_f32 v231, v231, v188
v_exp_f32 v190, v190
v_add_f32 v231, v231, v189
pk 186,188,189
v_exp_f32 v191, v191
v_add_f32 v231, v231, v190
s_nop 0
v_add_f32 v231, v231, v191
pk 187,190,191
s_nop 1
mavv 0,192,160
tr 208,237,128
mavv 4,192,168
tr 210,237,8576
mavv 8,192,176
buffer_load_dwordx4 v240, s[24:27], s48 offen lds
mavv 12,192,184
s_waitcnt lgkmcnt(2)
s_add_u32 m0, m0, 32
tr 212,237,160
mavv 28,196,184
tr 214,237,8608
mavv 24,196,176
mavv 20,196,168
tr 216,237,192
mavv 16,196,160
tr 218,237,8640
mavv 32,200,160
buffer_load_dwordx4 v240, s[24:27], s48 offen offset:1024 lds
mavv 36,200,168
s_add_u32 m0, m0, 32
tr 220,237,224
mavv 40,200,176
tr 222,237,8672
v_accvgpr_read_b32 v128, a0
mavv 44,200,184
v_accvgpr_read_b32 v129, a1
v_accvgpr_read_b32 v130, a2
mavv 60,204,184
tr 192,237,256
v_accvgpr_read_b32 v131, a3
mavv 56,204,176
tr 194,237,8704
v_accvgpr_read_b32 v132, a16
mavv 52,204,168
buffer_load_dwordx4 v240, s[24:27], s48 offen offset:2048 lds
mavv 48,204,160
s_waitcnt lgkmcnt(4)
s_or_b32 s48, s48, s93
tr 196,237,288
mavv 64,208,160
s_add_u32 m0, m0, 32
tr 198,237,8736
v_accvgpr_read_b32 v133, a17
mavv 68,208,168
v_accvgpr_read_b32 v134, a18
v_accvgpr_read_b32 v135, a19
mavv 72,208,176
tr 200,237,320
pk 0,128,129
mavv 76,208,184
tr 202,237,8768
pk 1,130,131
mavv 92,212,184
buffer_load_dwordx4 v240, s[24:27], s48 offen offset:3072 lds
mavv 88,212,176
s_bitset0_b32 s48, 30
s_add_u32 s48, s48, s72
tr 204,237,352
mavv 84,212,168
tr 206,237,8800
pk 2,132,133
mavv 80,212,160
pk 3,134,135
v_accvgpr_read_b32 v136, a4
mavv 96,216,160
tr 208,237,384
v_accvgpr_read_b32 v137, a5
mavv 100,216,168
tr 210,237,8832
v_accvgpr_read_b32 v138, a6
mavv 104,216,176
v_accvgpr_read_b32 v139, a7
v_accvgpr_read_b32 v140, a20
mavv 108,216,184
s_waitcnt lgkmcnt(4)
tr 212,237,416
v_accvgpr_read_b32 v141, a21
mavv 124,220,184
tr 214,237,8864
v_accvgpr_read_b32 v142, a22
mavv 120,220,176
v_accvgpr_read_b32 v143, a23
pk 4,136,137
mavv 116,220,168
tr 216,237,448
pk 5,138,139
mavv 112,220,160
tr 218,237,8896
pk 6,140,141
mavv 128,192,160
pk 7,142,143
v_accvgpr_read_b32 v144, a8
mavv 132,192,168
tr 220,237,480
v_accvgpr_read_b32 v145, a9
mavv 136,192,176
tr 222,237,8928
v_accvgpr_read_b32 v146, a10
mavv 140,192,184
v_accvgpr_read_b32 v147, a11
v_accvgpr_read_b32 v148, a24
mavv 156,196,184
v_accvgpr_read_b32 v149, a25
v_accvgpr_read_b32 v150, a26
mavv 152,196,176
v_accvgpr_read_b32 v151, a27
pk 8,144,145
mavv 148,196,168
pk 9,146,147
pk 10,148,149
mavv 144,196,160
s_waitcnt vmcnt(12) lgkmcnt(0)
s_barrier
pk 11,150,151
mavv 160,200,160
s_add_u32 m0, s41, s49
s_add_u32 s41, s41, s42
v_accvgpr_read_b32 v152, a12
mavv 164,200,168
s_cmp_eq_u32 s41, s43
s_cselect_b32 s41, 0, s41
v_accvgpr_read_b32 v153, a13
mavv 168,200,176
buffer_load_dwordx4 v240, s[24:27], s48 offen lds
mavv 172,200,184
s_add_u32 m0, m0, 32
v_add_u32 v239, s40, v235
v_accvgpr_read_b32 v154, a14
mavv 188,204,184
s_add_u32 s40, s40, s42
s_cmp_eq_u32 s40, s43
s_cselect_b32 s40, 0, s40
mavv 184,204,176
v_accvgpr_read_b32 v155, a15
v_accvgpr_read_b32 v156, a28
mavv 180,204,168
buffer_load_dwordx4 v240, s[24:27], s48 offen offset:1024 lds
mavv 176,204,160
s_add_u32 m0, m0, 32
v_accvgpr_read_b32 v157, a29
v_accvgpr_read_b32 v158, a30
mavv 192,208,160
tr 192,239,0
v_accvgpr_read_b32 v159, a31
mavv 196,208,168
tr 194,239,256
pk 12,152,153
mavv 200,208,176
tr 196,239,512
pk 13,154,155
mavv 204,208,184
buffer_load_dwordx4 v240, s[24:27], s48 offen offset:2048 lds
mavv 220,212,184
s_or_b32 s48, s48, s93
s_add_u32 m0, m0, 32
tr 198,239,768
mavv 216,212,176
tr 200,239,8448
pk 14,156,157
mavv 212,212,168
tr 202,239,8704
pk 15,158,159
mavv 208,212,160
buffer_load_dwordx4 v240, s[24:27], s48 offen offset:3072 lds
mavv 224,216,160
s_bitset0_b32 s48, 30
s_add_u32 s48, s48, s72
tr 204,239,8960
mavv 228,216,168
tr 206,239,9216
v_accvgpr_read_b32 v128, a32
mavv 232,216,176
v_accvgpr_read_b32 v129, a33
v_accvgpr_read_b32 v130, a34
mavv 236,216,184
v_accvgpr_read_b32 v131, a35
v_accvgpr_read_b32 v132, a48
mavv 252,220,184
v_accvgpr_read_b32 v133, a49
v_accvgpr_read_b32 v134, a50
mavv 248,220,176
v_accvgpr_read_b32 v135, a51
pk 16,128,129
mavv 244,220,168
pk 17,130,131
pk 18,132,133
mavv 240,220,160
pk 19,134,135
v_accvgpr_read_b32 v136, a36
s_waitcnt lgkmcnt(6)
v_accvgpr_read_b32 v137, a37
v_accvgpr_read_b32 v138, a38
v_accvgpr_read_b32 v139, a39
v_accvgpr_read_b32 v140, a52
v_accvgpr_read_b32 v141, a53
v_accvgpr_read_b32 v142, a54
v_accvgpr_read_b32 v143, a55
pk 20,136,137
pk 21,138,139
pk 22,140,141
pk 23,142,143
v_accvgpr_read_b32 v144, a40
v_accvgpr_read_b32 v145, a41
v_accvgpr_read_b32 v146, a42
v_accvgpr_read_b32 v147, a43
v_accvgpr_read_b32 v148, a56
v_accvgpr_read_b32 v149, a57
v_accvgpr_read_b32 v150, a58
v_accvgpr_read_b32 v151, a59
pk 24,144,145
pk 25,146,147
pk 26,148,149
pk 27,150,151
v_accvgpr_read_b32 v152, a44
v_accvgpr_read_b32 v153, a45
v_accvgpr_read_b32 v154, a46
v_accvgpr_read_b32 v155, a47
v_accvgpr_read_b32 v156, a60
v_accvgpr_read_b32 v157, a61
v_accvgpr_read_b32 v158, a62
v_accvgpr_read_b32 v159, a63
pk 28,152,153
pk 29,154,155
pk 30,156,157
pk 31,158,159
v_accvgpr_read_b32 v128, a64
v_accvgpr_read_b32 v129, a65
v_accvgpr_read_b32 v130, a66
v_accvgpr_read_b32 v131, a67
v_accvgpr_read_b32 v132, a80
v_accvgpr_read_b32 v133, a81
v_accvgpr_read_b32 v134, a82
v_accvgpr_read_b32 v135, a83
pk 32,128,129
pk 33,130,131
pk 34,132,133
pk 35,134,135
v_accvgpr_read_b32 v136, a68
v_accvgpr_read_b32 v137, a69
v_accvgpr_read_b32 v138, a70
v_accvgpr_read_b32 v139, a71
v_accvgpr_read_b32 v140, a84
v_accvgpr_read_b32 v141, a85
v_accvgpr_read_b32 v142, a86
v_accvgpr_read_b32 v143, a87
pk 36,136,137
pk 37,138,139
pk 38,140,141
pk 39,142,143
v_accvgpr_read_b32 v144, a72
v_accvgpr_read_b32 v145, a73
v_accvgpr_read_b32 v146, a74
v_accvgpr_read_b32 v147, a75
v_accvgpr_read_b32 v148, a88
v_accvgpr_read_b32 v149, a89
v_accvgpr_read_b32 v150, a90
v_accvgpr_read_b32 v151, a91
pk 40,144,145
pk 41,146,147
pk 42,148,149
pk 43,150,151
v_accvgpr_read_b32 v152, a76
v_accvgpr_read_b32 v153, a77
v_accvgpr_read_b32 v154, a78
v_accvgpr_read_b32 v155, a79
v_accvgpr_read_b32 v156, a92
v_accvgpr_read_b32 v157, a93
v_accvgpr_read_b32 v158, a94
v_accvgpr_read_b32 v159, a95
pk 44,152,153
pk 45,154,155
pk 46,156,157
pk 47,158,159
v_accvgpr_read_b32 v128, a96
v_accvgpr_read_b32 v129, a97
v_accvgpr_read_b32 v130, a98
v_accvgpr_read_b32 v131, a99
v_accvgpr_read_b32 v132, a112
v_accvgpr_read_b32 v133, a113
v_accvgpr_read_b32 v134, a114
v_accvgpr_read_b32 v135, a115
pk 48,128,129
pk 49,130,131
pk 50,132,133
pk 51,134,135
v_accvgpr_read_b32 v136, a100
v_accvgpr_read_b32 v137, a101
v_accvgpr_read_b32 v138, a102
v_accvgpr_read_b32 v139, a103
v_accvgpr_read_b32 v140, a116
v_accvgpr_read_b32 v141, a117
v_accvgpr_read_b32 v142, a118
v_accvgpr_read_b32 v143, a119
pk 52,136,137
pk 53,138,139
pk 54,140,141
pk 55,142,143
v_accvgpr_read_b32 v144, a104
v_accvgpr_read_b32 v145, a105
v_accvgpr_read_b32 v146, a106
v_accvgpr_read_b32 v147, a107
v_accvgpr_read_b32 v148, a120
v_accvgpr_read_b32 v149, a121
v_accvgpr_read_b32 v150, a122
v_accvgpr_read_b32 v151, a123
pk 56,144,145
pk 57,146,147
pk 58,148,149
pk 59,150,151
v_accvgpr_read_b32 v152, a108
v_accvgpr_read_b32 v153, a109
v_accvgpr_read_b32 v154, a110
v_accvgpr_read_b32 v155, a111
v_accvgpr_read_b32 v156, a124
v_accvgpr_read_b32 v157, a125
v_accvgpr_read_b32 v158, a126
v_accvgpr_read_b32 v159, a127
pk 60,152,153
pk 61,154,155
pk 62,156,157
pk 63,158,159
s_nop 1
mvvvz 128,192,0
s_waitcnt lgkmcnt(0)
tr 208,239,32
v_accvgpr_read_b32 v232, a128
v_accvgpr_read_b32 v236, a129
v_accvgpr_read_b32 v241, a130
mvvv 128,196,16
tr 210,239,288
v_accvgpr_read_b32 v243, a131
v_accvgpr_read_b32 v237, a144
v_accvgpr_read_b32 v233, a145
mvvv 128,200,32
tr 212,239,544
v_accvgpr_read_b32 v244, a146
v_accvgpr_read_b32 v245, a147
pk 64,232,236
mvvv 128,204,48
buffer_load_dwordx4 a[112:115], v240, s[24:27], s48 offen offset:0
pk 65,241,243
pk 66,237,233
pk 67,244,245
mvvvz 136,204,52
tr 214,239,800
v_accvgpr_read_b32 v246, a132
v_accvgpr_read_b32 v247, a133
v_accvgpr_read_b32 v248, a134
mvvv 136,200,36
tr 216,239,8480
v_accvgpr_read_b32 v249, a135
v_accvgpr_read_b32 v232, a148
v_accvgpr_read_b32 v236, a149
mvvv 136,196,20
tr 218,239,8736
v_accvgpr_read_b32 v241, a150
v_accvgpr_read_b32 v243, a151
pk 68,246,247
pk 69,248,249
mvvv 136,192,4
v_add_u32 v238, s40, v234
pk 70,232,236
pk 71,241,243
v_accvgpr_read_b32 v237, a136
mvvvz 144,192,8
s_add_u32 s40, s40, s42
tr 220,239,8992
v_accvgpr_read_b32 v233, a137
v_accvgpr_read_b32 v244, a138
v_accvgpr_read_b32 v245, a139
mvvv 144,196,24
s_cmp_eq_u32 s40, s43
s_cselect_b32 s40, 0, s40
tr 222,239,9248
v_accvgpr_read_b32 v246, a152
v_accvgpr_read_b32 v247, a153
v_accvgpr_read_b32 v248, a154
mvvv 144,200,40
ds_read_b128 a[0:3], v238 offset:0
v_accvgpr_read_b32 v249, a155
pk 72,237,233
pk 73,244,245
mvvv 144,204,56
buffer_load_dwordx4 a[116:119], v240, s[24:27], s48 offen offset:1024
pk 74,246,247
pk 75,248,249
mvvvz 152,204,60
L_padD3:
s_cbranch_vccnz L_hop_b
ds_read_b128 a[4:7], v238 offset:1056
v_accvgpr_read_b32 v232, a140
v_accvgpr_read_b32 v236, a141
v_accvgpr_read_b32 v241, a142
mvvv 152,200,44
ds_read_b128 a[8:11], v238 offset:2112
v_accvgpr_read_b32 v243, a143
v_accvgpr_read_b32 v237, a156
v_accvgpr_read_b32 v233, a157
v_accvgpr_read_b32 v244, a158
mvvv 152,196,28
ds_read_b128 a[12:15], v238 offset:3168
v_accvgpr_read_b32 v245, a159
pk 76,232,236
pk 77,241,243
mvvv 152,192,12
s_waitcnt lgkmcnt(5)
v_add_u32 v238, s40, v234
pk 78,237,233
pk 79,244,245
v_accvgpr_read_b32 v246, a160
mvvvz 132,208,0
s_add_u32 s40, s40, s42
tr 192,239,64
v_accvgpr_read_b32 v247, a161
v_accvgpr_read_b32 v248, a162
v_accvgpr_read_b32 v249, a163
v_accvgpr_read_b32 v232, a176
mvvv 132,212,16
s_cmp_eq_u32 s40, s43
s_cselect_b32 s40, 0, s40
tr 194,239,320
v_accvgpr_read_b32 v236, a177
v_accvgpr_read_b32 v241, a178
mvvv 132,216,32
s_waitcnt lgkmcnt(5)
tr 196,239,576
v_accvgpr_read_b32 v243, a179
pk 80,246,247
pk 81,248,249
mvvv 132,220,48
ds_read_b128 a[16:19], v238 offset:0
pk 82,232,236
pk 83,241,243
v_accvgpr_read_b32 v237, a164
v_accvgpr_read_b32 v233, a165
mvvvz 140,220,52
tr 198,239,832
v_accvgpr_read_b32 v244, a166
v_accvgpr_read_b32 v245, a167
v_accvgpr_read_b32 v246, a180
mvvv 140,216,36
tr 200,239,8512
v_accvgpr_read_b32 v247, a181
v_accvgpr_read_b32 v248, a182
v_accvgpr_read_b32 v249, a183
mvvv 140,212,20
tr 202,239,8768
pk 84,237,233
pk 85,244,245
pk 86,246,247
mvvv 140,208,4
ds_read_b128 a[20:23], v238 offset:1056
pk 87,248,249
v_accvgpr_read_b32 v232, a168
v_accvgpr_read_b32 v236, a169
v_accvgpr_read_b32 v241, a170
mvvvz 148,208,8
tr 204,239,9024
v_accvgpr_read_b32 v243, a171
v_accvgpr_read_b32 v237, a184
v_accvgpr_read_b32 v233, a185
mvvv 148,212,24
tr 206,239,9280
v_accvgpr_read_b32 v244, a186
v_accvgpr_read_b32 v245, a187
pk 88,232,236
mvvv 148,216,40
ds_read_b128 a[24:27], v238 offset:2112
pk 89,241,243
pk 90,237,233
pk 91,244,245
v_accvgpr_read_b32 v246, a172
mvvv 148,220,56
ds_read_b128 a[28:31], v238 offset:3168
v_add_u32 v238, s40, v234
v_accvgpr_read_b32 v247, a173
v_accvgpr_read_b32 v248, a174
mvvvz 156,220,60
s_add_u32 s40, s40, s42
ds_read_b128 a[32:35], v238 offset:0
v_accvgpr_read_b32 v249, a175
v_accvgpr_read_b32 v232, a188
v_accvgpr_read_b32 v236, a189
mvvv 156,216,44
s_cmp_eq_u32 s40, s43
s_cselect_b32 s40, 0, s40
ds_read_b128 a[36:39], v238 offset:1056
v_accvgpr_read_b32 v241, a190
v_accvgpr_read_b32 v243, a191
pk 92,246,247
mvvv 156,212,28
ds_read_b128 a[40:43], v238 offset:2112
pk 93,248,249
pk 94,232,236
pk 95,241,243
mvvv 156,208,12
s_waitcnt lgkmcnt(6)
ds_read_b128 a[44:47], v238 offset:3168
v_accvgpr_read_b32 v237, a192
v_accvgpr_read_b32 v233, a193
v_accvgpr_read_b32 v244, a194
mvvvz 160,192,0
tr 208,239,96
v_accvgpr_read_b32 v245, a195
v_accvgpr_read_b32 v246, a208
v_accvgpr_read_b32 v247, a209
mvvv 160,196,16
tr 210,239,352
v_add_u32 v238, s40, v234
v_accvgpr_read_b32 v248, a210
v_accvgpr_read_b32 v249, a211
pk 96,237,233
mvvv 160,200,32
s_waitcnt lgkmcnt(6)
s_add_u32 s40, s40, s42
tr 212,239,608
pk 97,244,245
pk 98,246,247
mvvv 160,204,48
s_cmp_eq_u32 s40, s43
s_cselect_b32 s40, 0, s40
ds_read_b128 a[48:51], v238 offset:0
pk 99,248,249
v_accvgpr_read_b32 v232, a196
mvvvz 168,204,52
tr 214,239,864
v_accvgpr_read_b32 v236, a197
v_accvgpr_read_b32 v241, a198
v_accvgpr_read_b32 v243, a199
v_accvgpr_read_b32 v237, a212
mvvv 168,200,36
tr 216,239,8544
v_accvgpr_read_b32 v233, a213
v_accvgpr_read_b32 v244, a214
v_accvgpr_read_b32 v245, a215
mvvv 168,196,20
tr 218,239,8800
pk 100,232,236
pk 101,241,243
pk 102,237,233
mvvv 168,192,4
ds_read_b128 a[52:55], v238 offset:1056
pk 103,244,245
v_accvgpr_read_b32 v246, a200
v_accvgpr_read_b32 v247, a201
v_accvgpr_read_b32 v248, a202
mvvvz 176,192,8
tr 220,239,9056
v_accvgpr_read_b32 v249, a203
v_accvgpr_read_b32 v232, a216
v_accvgpr_read_b32 v236, a217
mvvv 176,196,24
tr 222,239,9312
v_accvgpr_read_b32 v241, a218
v_accvgpr_read_b32 v243, a219
pk 104,246,247
mvvv 176,200,40
ds_read_b128 a[56:59], v238 offset:2112
pk 105,248,249
pk 106,232,236
pk 107,241,243
mvvv 176,204,56
ds_read_b128 a[60:63], v238 offset:3168
v_add_u32 v239, s40, v235
v_accvgpr_read_b32 v237, a204
v_accvgpr_read_b32 v233, a205
v_accvgpr_read_b32 v244, a206
mvvvz 184,204,60
buffer_load_dwordx4 a[120:123], v240, s[24:27], s48 offen offset:2048
v_accvgpr_read_b32 v245, a207
v_accvgpr_read_b32 v246, a220
mvvv 184,200,44
s_add_u32 s40, s40, s42
s_cmp_eq_u32 s40, s43
s_cselect_b32 s40, 0, s40
s_or_b32 s48, s48, s93
v_accvgpr_read_b32 v247, a221
mvvv 184,196,28
buffer_load_dwordx4 a[124:127], v240, s[24:27], s48 offen offset:3072
v_accvgpr_read_b32 v248, a222
v_accvgpr_read_b32 v249, a223
pk 108,237,233
mvvv 184,192,12
s_waitcnt vmcnt(4) lgkmcnt(0)
s_barrier
pk 109,244,245
pk 110,246,247
pk 111,248,249
mvvvz 164,208,0
s_add_u32 m0, s41, s49
s_add_u32 s41, s41, s42
tr 192,239,0
v_accvgpr_read_b32 v232, a224
v_accvgpr_read_b32 v236, a225
mvvv 164,212,16
s_cmp_eq_u32 s41, s43
s_cselect_b32 s41, 0, s41
tr 194,239,256
v_accvgpr_read_b32 v241, a226
v_accvgpr_read_b32 v243, a227
v_accvgpr_read_b32 v237, a240
mvvv 164,216,32
tr 196,239,512
v_accvgpr_read_b32 v233, a241
v_accvgpr_read_b32 v244, a242
v_accvgpr_read_b32 v245, a243
mvvv 164,220,48
buffer_load_dwordx4 v242, s[16:19], s46 offen lds
pk 112,232,236
pk 113,241,243
mvvvz 172,220,52
s_add_u32 m0, m0, s53
tr 198,239,768
pk 114,237,233
pk 115,244,245
v_accvgpr_read_b32 v246, a228
mvvv 172,216,36
tr 200,239,8448
v_accvgpr_read_b32 v247, a229
v_accvgpr_read_b32 v248, a230
v_accvgpr_read_b32 v249, a231
v_accvgpr_read_b32 v232, a244
mvvv 172,212,20
tr 202,239,8704
v_accvgpr_read_b32 v236, a245
v_accvgpr_read_b32 v241, a246
v_accvgpr_read_b32 v243, a247
mvvv 172,208,4
buffer_load_dwordx4 v242, s[16:19], s46 offen offset:896 lds
pk 116,246,247
pk 117,248,249
mvvvz 180,208,8
s_add_u32 m0, m0, s53
tr 204,239,8960
pk 118,232,236
pk 119,241,243
v_accvgpr_read_b32 v237, a232
v_accvgpr_read_b32 v233, a233
mvvv 180,212,24
tr 206,239,9216
v_accvgpr_read_b32 v244, a234
v_accvgpr_read_b32 v245, a235
v_accvgpr_read_b32 v246, a248
mvvv 180,216,40
v_accvgpr_read_b32 v247, a249
v_accvgpr_read_b32 v248, a250
v_accvgpr_read_b32 v249, a251
pk 120,237,233
mvvv 180,220,56
buffer_load_dwordx4 v242, s[16:19], s46 offen offset:1792 lds
pk 121,244,245
pk 122,246,247
pk 123,248,249
mvvvz 188,220,60
s_add_u32 m0, m0, s53
v_accvgpr_read_b32 v232, a236
v_accvgpr_read_b32 v236, a237
v_accvgpr_read_b32 v241, a238
v_accvgpr_read_b32 v243, a239
mvvv 188,216,44
v_accvgpr_read_b32 v237, a252
v_accvgpr_read_b32 v233, a253
v_accvgpr_read_b32 v244, a254
v_accvgpr_read_b32 v245, a255
mvvv 188,212,28
s_waitcnt lgkmcnt(1)
pk 124,232,236
pk 125,241,243
pk 126,237,233
pk 127,244,245
mvvv 188,208,12
buffer_load_dwordx4 v242, s[16:19], s46 offen offset:2688 lds
mvvv 128,192,64
s_add_u32 s46, s46, s55
s_add_u32 m0, s41, s49
tr 208,239,32
mvvv 128,196,80
s_add_u32 s41, s41, s42
tr 210,239,288
v_mov_b32 v244, v228
v_mov_b32 v245, v229
mvvv 128,200,96
s_waitcnt lgkmcnt(2)
tr 212,239,544
v_mov_b32 v246, v230
mvvv 128,204,112
buffer_load_dwordx4 v242, s[16:19], s46 offen lds
v_mov_b32 v247, v231
mvvv 136,204,116
s_cmp_eq_u32 s41, s43
s_cselect_b32 s41, 0, s41
tr 214,239,800
mvvv 136,200,100
s_add_u32 m0, m0, s53
tr 216,239,8480
v_permlane32_swap_b32 v228, v244
v_permlane32_swap_b32 v229, v245
mvvv 136,196,84
tr 218,239,8736
v_permlane32_swap_b32 v230, v246
mvvv 136,192,68
buffer_load_dwordx4 v242, s[16:19], s46 offen offset:896 lds
v_permlane32_swap_b32 v231, v247
mvvv 144,192,72
s_add_u32 m0, m0, s53
tr 220,239,8992
v_add_u32 v238, s40, v234
mvvv 144,196,88
s_add_u32 s40, s40, s42
tr 222,239,9248
v_add_f32 v228, v228, v244
v_add_f32 v229, v229, v245
mvvv 144,200,104
s_cmp_eq_u32 s40, s43
s_cselect_b32 s40, 0, s40
ds_read_b128 a[64:67], v238 offset:0
mvvv 144,204,120
buffer_load_dwordx4 v242, s[16:19], s46 offen offset:1792 lds
v_add_f32 v230, v230, v246
mvvv 152,204,124
s_add_u32 m0, m0, s53
ds_read_b128 a[68:71], v238 offset:1056
v_add_f32 v231, v231, v247
mvvv 152,200,108
ds_read_b128 a[72:75], v238 offset:2112
v_mov_b32 v244, v228
v_mov_b32 v245, v229
mvvv 152,196,92
s_waitcnt lgkmcnt(4)
ds_read_b128 a[76:79], v238 offset:3168
v_mov_b32 v246, v230
mvvv 152,192,76
buffer_load_dwordx4 v242, s[16:19], s46 offen offset:2688 lds
v_mov_b32 v247, v231
mvvv 132,208,64
s_add_u32 s46, s46, s57
tr 192,239,64
v_add_u32 v238, s40, v234
mvvv 132,212,80
s_cmp_eq_u32 s46, s77
s_cselect_b32 s46, s71, s46
tr 194,239,320
v_permlane16_swap_b32 v228, v244
mvvv 132,216,96
s_waitcnt lgkmcnt(5)
s_add_u32 s40, s40, s42
tr 196,239,576
mvvv 132,220,112
s_cmp_eq_u32 s40, s43
s_cselect_b32 s40, 0, s40
ds_read_b128 a[80:83], v238 offset:0
v_permlane16_swap_b32 v229, v245
mvvv 140,220,116
tr 198,239,832
v_permlane16_swap_b32 v230, v246
mvvv 140,216,100
tr 200,239,8512
v_permlane16_swap_b32 v231, v247
v_add_f32 v228, v228, v244
mvvv 140,212,84
tr 202,239,8768
v_add_f32 v229, v229, v245
mvvv 140,208,68
ds_read_b128 a[84:87], v238 offset:1056
v_add_f32 v230, v230, v246
v_add_f32 v231, v231, v247
mvvv 148,208,72
tr 204,239,9024
mvvv 148,212,88
tr 206,239,9280
v_rcp_f32 v224, v228
mvvv 148,216,104
ds_read_b128 a[88:91], v238 offset:2112
mvvv 148,220,120
ds_read_b128 a[92:95], v238 offset:3168
v_add_u32 v238, s40, v234
mvvv 156,220,124
s_add_u32 s40, s40, s42
ds_read_b128 a[96:99], v238 offset:0
mvvv 156,216,108
s_cmp_eq_u32 s40, s43
s_cselect_b32 s40, 0, s40
ds_read_b128 a[100:103], v238 offset:1056
mvvv 156,212,92
ds_read_b128 a[104:107], v238 offset:2112
mvvv 156,208,76
s_waitcnt lgkmcnt(6)
ds_read_b128 a[108:111], v238 offset:3168
v_rcp_f32 v225, v229
mvvv 160,192,64
tr 208,239,96
mvvv 160,196,80
tr 210,239,352
v_rcp_f32 v226, v230
mvvv 160,200,96
s_waitcnt lgkmcnt(6)
tr 212,239,608
mvvv 160,204,112
v_rcp_f32 v227, v231
mvvv 168,204,116
tr 214,239,864
v_mul_f32 v128, v128, v224
mvvv 168,200,100
tr 216,239,8544
v_mul_f32 v129, v129, v224
mvvv 168,196,84
tr 218,239,8800
v_mul_f32 v130, v130, v224
mvvv 168,192,68
v_mul_f32 v131, v131, v224
v_mul_f32 v136, v136, v225
mvvv 176,192,72
tr 220,239,9056
v_mul_f32 v137, v137, v225
mvvv 176,196,88
tr 222,239,9312
v_mul_f32 v138, v138, v225
mvvv 176,200,104
v_mul_f32 v139, v139, v225
v_mul_f32 v144, v144, v226
mvvv 176,204,120
v_add_u32 v239, s40, v235
v_mul_f32 v145, v145, v226
mvvv 184,204,124
s_add_u32 s40, s40, s42
s_cmp_eq_u32 s40, s43
s_cselect_b32 s40, 0, s40
mvvv 184,200,108
v_mul_f32 v146, v146, v226
v_mul_f32 v147, v147, v226
mvvv 184,196,92
v_mul_f32 v152, v152, v227
v_mul_f32 v153, v153, v227
mvvv 184,192,76
s_waitcnt vmcnt(4) lgkmcnt(0)
s_barrier
v_mul_f32 v154, v154, v227
mvvv 164,208,64
s_add_u32 m0, s41, s49
s_add_u32 s41, s41, s42
tr 192,239,0
mvvv 164,212,80
s_cmp_eq_u32 s41, s43
s_cselect_b32 s41, 0, s41
tr 194,239,256
mvvv 164,216,96
tr 196,239,512
v_mul_f32 v155, v155, v227
mvvv 164,220,112
buffer_load_dwordx4 v242, s[16:19], s46 offen lds
mvvv 172,220,116
s_add_u32 m0, m0, s53
tr 198,239,768
v_mul_f32 v132, v132, v224
mvvv 172,216,100
tr 200,239,8448
v_mul_f32 v133, v133, v224
mvvv 172,212,84
tr 202,239,8704
v_mul_f32 v134, v134, v224
mvvv 172,208,68
buffer_load_dwordx4 v242, s[16:19], s46 offen offset:896 lds
mvvv 180,208,72
s_add_u32 m0, m0, s53
tr 204,239,8960
v_mul_f32 v135, v135, v224
mvvv 180,212,88
tr 206,239,9216
v_mul_f32 v140, v140, v225
mvvv 180,216,104
v_mul_f32 v141, v141, v225
v_mul_f32 v142, v142, v225
mvvv 180,220,120
buffer_load_dwordx4 v242, s[16:19], s46 offen offset:1792 lds
mvvv 188,220,124
s_add_u32 m0, m0, s53
v_mul_f32 v143, v143, v225
v_mul_f32 v148, v148, v226
mvvv 188,216,108
v_mul_f32 v149, v149, v226
v_mul_f32 v150, v150, v226
mvvv 188,212,92
s_waitcnt lgkmcnt(1)
v_mul_f32 v151, v151, v226
v_mul_f32 v156, v156, v227
mvvv 188,208,76
buffer_load_dwordx4 v242, s[16:19], s46 offen offset:2688 lds
mvva 128,192,0
s_add_u32 s46, s46, s55
s_add_u32 m0, s41, s49
tr 208,239,32
mvva 128,196,16
s_add_u32 s41, s41, s42
tr 210,239,288
v_mul_f32 v157, v157, v227
mvva 128,200,32
s_waitcnt lgkmcnt(2)
tr 212,239,544
v_mul_f32 v158, v158, v227
mvva 128,204,48
buffer_load_dwordx4 v242, s[16:19], s46 offen lds
mvva 136,204,52
s_cmp_eq_u32 s41, s43
s_cselect_b32 s41, 0, s41
tr 214,239,800
mvva 136,200,36
s_add_u32 m0, m0, s53
tr 216,239,8480
v_mul_f32 v159, v159, v227
mvva 136,196,20
tr 218,239,8736
v_mul_f32 v160, v160, v224
mvva 136,192,4
buffer_load_dwordx4 v242, s[16:19], s46 offen offset:896 lds
mvva 144,192,8
s_add_u32 m0, m0, s53
tr 220,239,8992
v_mul_f32 v161, v161, v224
mvva 144,196,24
tr 222,239,9248
v_mul_f32 v162, v162, v224
mvva 144,200,40
v_mul_f32 v163, v163, v224
v_mul_f32 v168, v168, v225
mvva 144,204,56
buffer_load_dwordx4 v242, s[16:19], s46 offen offset:1792 lds
mvva 152,204,60
s_add_u32 m0, m0, s53
v_mul_f32 v169, v169, v225
v_mul_f32 v170, v170, v225
mvva 152,200,44
v_mul_f32 v171, v171, v225
v_mul_f32 v176, v176, v226
mvva 152,196,28
s_waitcnt lgkmcnt(1)
v_mul_f32 v177, v177, v226
v_mul_f32 v178, v178, v226
mvva 152,192,12
buffer_load_dwordx4 v242, s[16:19], s46 offen offset:2688 lds
mvva 132,208,0
s_add_u32 s46, s46, s56
s_add_u32 m0, s41, s49
tr 192,239,64
mvva 132,212,16
s_add_u32 s41, s41, s42
tr 194,239,320
v_mul_f32 v179, v179, v226
mvva 132,216,32
s_waitcnt lgkmcnt(2)
tr 196,239,576
v_mul_f32 v184, v184, v227
mvva 132,220,48
buffer_load_dwordx4 v242, s[16:19], s46 offen lds
mvva 140,220,52
s_cmp_eq_u32 s41, s43
s_cselect_b32 s41, 0, s41
tr 198,239,832
mvva 140,216,36
s_add_u32 m0, m0, s53
tr 200,239,8512
v_mul_f32 v185, v185, v227
mvva 140,212,20
tr 202,239,8768
v_mul_f32 v186, v186, v227
mvva 140,208,4
buffer_load_dwordx4 v242, s[16:19], s46 offen offset:896 lds
mvva 148,208,8
s_add_u32 m0, m0, s53
tr 204,239,9024
v_mul_f32 v187, v187, v227
mvva 148,212,24
tr 206,239,9280
v_mul_f32 v164, v164, v224
mvva 148,216,40
v_mul_f32 v165, v165, v224
v_mul_f32 v166, v166, v224
mvva 148,220,56
buffer_load_dwordx4 v242, s[16:19], s46 offen offset:1792 lds
mvva 156,220,60
s_add_u32 m0, m0, s53
v_mul_f32 v167, v167, v224
v_mul_f32 v172, v172, v225
mvva 156,216,44
v_mul_f32 v173, v173, v225
v_mul_f32 v174, v174, v225
mvva 156,212,28
L_padD4:
s_cbranch_vccnz L_hop_b
s_waitcnt lgkmcnt(1)
v_mul_f32 v175, v175, v225
v_mul_f32 v180, v180, v226
mvva 156,208,12
buffer_load_dwordx4 v242, s[16:19], s46 offen offset:2688 lds
mvva 160,192,0
s_add_u32 s46, s46, s55
tr 208,239,96
v_mul_f32 v181, v181, v226
mvva 160,196,16
tr 210,239,352
v_mul_f32 v182, v182, v226
mvva 160,200,32
s_waitcnt lgkmcnt(2)
tr 212,239,608
v_mul_f32 v183, v183, v226
mvva 160,204,48
v_mul_f32 v188, v188, v227
v_mul_f32 v189, v189, v227
mvva 168,204,52
tr 214,239,864
v_mul_f32 v190, v190, v227
mvva 168,200,36
tr 216,239,8544
v_mul_f32 v191, v191, v227
mvva 168,196,20
tr 218,239,8800
mvva 168,192,4
mvva 176,192,8
tr 220,239,9056
v_lshrrev_b32 v232, 2, v240
mvva 176,196,24
tr 222,239,9312
v_lshlrev_b32 v237, 4, v240
mvva 176,200,40
v_lshrrev_b32 v244, 4, v240
v_and_b32 v245, 15, v244
mvva 176,204,56
v_add_u32 v239, s40, v235
v_mul_u32_u24 v245, 0x700, v245
mvva 184,204,60
s_add_u32 s40, s40, s42
s_cmp_eq_u32 s40, s43
s_cselect_b32 s40, 0, s40
mvva 184,200,44
v_and_b32 v246, 48, v244
v_add_u32 v249, v245, v246
mvva 184,196,28
v_lshrrev_b32 v245, 4, v244
v_bfe_u32 v246, v244, 2, 1
mvva 184,192,12
s_waitcnt vmcnt(12) lgkmcnt(0)
s_barrier
v_lshlrev_b32 v246, 1, v246
mvva 164,208,0
s_add_u32 m0, s41, s49
s_add_u32 s41, s41, s42
tr 192,239,0
mvva 164,212,16
s_cmp_eq_u32 s41, s43
s_cselect_b32 s41, 0, s41
tr 194,239,256
mvva 164,216,32
tr 196,239,512
v_sub_u32 v245, v245, v246
mvva 164,220,48
buffer_load_dwordx4 v242, s[16:19], s46 offen lds
mvva 172,220,52
s_add_u32 m0, m0, s53
tr 198,239,768
v_bfe_u32 v246, v244, 3, 1
mvva 172,216,36
tr 200,239,8448
v_lshl_add_u32 v245, v245, 1, v246
mvva 172,212,20
tr 202,239,8704
v_bfe_u32 v246, v244, 1, 1
mvva 172,208,4
buffer_load_dwordx4 v242, s[16:19], s46 offen offset:896 lds
mvva 180,208,8
s_add_u32 m0, m0, s53
tr 204,239,8960
v_lshl_add_u32 v245, v245, 1, v246
mvva 180,212,24
tr 206,239,9216
v_lshlrev_b32 v245, v245, 1
mvva 180,216,40
v_and_b32 v246, 1, v244
v_lshlrev_b32 v246, 4, v246
mvva 180,220,56
buffer_load_dwordx4 v242, s[16:19], s46 offen offset:1792 lds
mvva 188,220,60
s_add_u32 m0, m0, s53
v_mov_b32 v247, 0x3f80
v_lshlrev_b32 v246, v246, v247
mvva 188,216,44
v_bfe_i32 v247, v245, 0, 1
v_and_b32 v247, v247, v246
mvva 188,212,28
s_waitcnt lgkmcnt(1)
v_accvgpr_write_b32 a160, v247
v_bfe_i32 v247, v245, 1, 1
mvva 188,208,12
buffer_load_dwordx4 v242, s[16:19], s46 offen offset:2688 lds
mvva 128,192,64
s_add_u32 s46, s46, s57
s_add_u32 m0, s41, s49
tr 208,239,32
mvva 128,196,80
s_cmp_eq_u32 s46, s77
s_cselect_b32 s46, s71, s46
tr 210,239,288
mvva 128,200,96
s_waitcnt lgkmcnt(2)
s_add_u32 s41, s41, s42
tr 212,239,544
mvva 128,204,112
buffer_load_dwordx4 v242, s[16:19], s46 offen lds
mvva 136,204,116
s_cmp_eq_u32 s41, s43
s_cselect_b32 s41, 0, s41
tr 214,239,800
mvva 136,200,100
s_add_u32 m0, m0, s53
tr 216,239,8480
v_and_b32 v247, v247, v246
mvva 136,196,84
tr 218,239,8736
v_accvgpr_write_b32 a161, v247
mvva 136,192,68
buffer_load_dwordx4 v242, s[16:19], s46 offen offset:896 lds
mvva 144,192,72
s_add_u32 m0, m0, s53
tr 220,239,8992
v_bfe_i32 v247, v245, 2, 1
mvva 144,196,88
tr 222,239,9248
v_and_b32 v247, v247, v246
mvva 144,200,104
v_accvgpr_write_b32 a162, v247
v_bfe_i32 v247, v245, 3, 1
mvva 144,204,120
buffer_load_dwordx4 v242, s[16:19], s46 offen offset:1792 lds
mvva 152,204,124
s_add_u32 m0, m0, s53
v_and_b32 v247, v247, v246
v_accvgpr_write_b32 a163, v247
mvva 152,200,108
v_bfe_i32 v247, v245, 4, 1
v_and_b32 v247, v247, v246
mvva 152,196,92
s_waitcnt lgkmcnt(1)
v_accvgpr_write_b32 a164, v247
v_bfe_i32 v247, v245, 5, 1
mvva 152,192,76
buffer_load_dwordx4 v242, s[16:19], s46 offen offset:2688 lds
mvva 132,208,64
s_add_u32 s46, s46, s55
tr 192,239,64
v_and_b32 v247, v247, v246
mvva 132,212,80
tr 194,239,320
v_accvgpr_write_b32 a165, v247
mvva 132,216,96
s_waitcnt lgkmcnt(2)
tr 196,239,576
v_bfe_i32 v247, v245, 6, 1
mvva 132,220,112
v_and_b32 v247, v247, v246
v_accvgpr_write_b32 a166, v247
mvva 140,220,116
tr 198,239,832
v_bfe_i32 v247, v245, 7, 1
mvva 140,216,100
tr 200,239,8512
v_and_b32 v247, v247, v246
mvva 140,212,84
tr 202,239,8768
v_accvgpr_write_b32 a167, v247
mvva 140,208,68
pk 128,128,129
pk 129,130,131
mvva 148,208,72
tr 204,239,9024
pk 130,132,133
mvva 148,212,88
tr 206,239,9280
pk 131,134,135
mvva 148,216,104
buffer_store_dwordx4 v[128:131], v240, s[8:11], s66 offen offset:0
mvva 148,220,120
mvva 156,220,124
mvva 156,216,108
pk 136,136,137
pk 137,138,139
mvva 156,212,92
pk 138,140,141
pk 139,142,143
mvva 156,208,76
s_waitcnt lgkmcnt(1)
mvva 160,192,64
tr 208,239,96
mvva 160,196,80
tr 210,239,352
mvva 160,200,96
s_waitcnt lgkmcnt(2)
tr 212,239,608
mvva 160,204,112
buffer_store_dwordx4 v[136:139], v240, s[8:11], s66 offen offset:1024
mvva 168,204,116
tr 214,239,864
pk 144,144,145
pk 145,146,147
mvva 168,200,100
tr 216,239,8544
pk 146,148,149
mvva 168,196,84
tr 218,239,8800
pk 147,150,151
mvva 168,192,68
buffer_store_dwordx4 v[144:147], v240, s[8:11], s66 offen offset:2048
mvva 176,192,72
s_add_u32 s66, s66, s72
tr 220,239,9056
pk 152,152,153
mvva 176,196,88
tr 222,239,9312
pk 153,154,155
pk 154,156,157
mvva 176,200,104
pk 155,158,159
mvva 176,204,120
v_add_u32 v239, s40, v235
mvva 184,204,124
s_add_u32 s40, s40, s42
s_cmp_eq_u32 s40, s43
s_cselect_b32 s40, 0, s40
mvva 184,200,108
buffer_store_dwordx4 v[152:155], v240, s[8:11], s67 offen offset:3072
mvva 184,196,92
s_add_u32 s67, s67, s72
mvva 184,192,76
s_waitcnt vmcnt(20) lgkmcnt(0)
s_barrier
mvva 164,208,64
tr 192,239,0
mvva 164,212,80
tr 194,239,256
mvva 164,216,96
tr 196,239,512
mvva 164,220,112
mvva 172,220,116
tr 198,239,768
mvva 172,216,100
tr 200,239,8448
mvva 172,212,84
tr 202,239,8704
mvva 172,208,68
mvva 180,208,72
tr 204,239,8960
pk 160,160,161
mvva 180,212,88
tr 206,239,9216
pk 161,162,163
mvva 180,216,104
pk 162,164,165
pk 163,166,167
mvva 180,220,120
buffer_store_dwordx4 v[160:163], v240, s[8:11], s66 offen offset:0
mvva 188,220,124
mvva 188,216,108
pk 168,168,169
pk 169,170,171
mvva 188,212,92
pk 170,172,173
pk 171,174,175
mvva 188,208,76
s_waitcnt lgkmcnt(6)
s_nop 7
buffer_store_dwordx4 v[168:171], v240, s[8:11], s66 offen offset:1024
pk 176,176,177
pk 177,178,179
pk 178,180,181
pk 179,182,183
buffer_store_dwordx4 v[176:179], v240, s[8:11], s66 offen offset:2048
pk 184,184,185
pk 185,186,187
pk 186,188,189
pk 187,190,191
buffer_store_dwordx4 v[184:187], v240, s[8:11], s67 offen offset:3072
s_add_u32 s66, s66, s60
s_add_u32 s67, s67, s60
s_mov_b32 s64, 6
L_oploop:
mvvvz 128,192,0
s_waitcnt lgkmcnt(4)
tr 208,239,32
mvvv 128,196,16
s_waitcnt lgkmcnt(3)
s_add_u32 m0, s41, s49
tr 210,239,288
mvvv 128,200,32
s_waitcnt lgkmcnt(2)
s_add_u32 s41, s41, s42
tr 212,239,544
mvvv 128,204,48
s_cmp_eq_u32 s41, s43
s_cselect_b32 s41, 0, s41
mvvvz 136,204,52
tr 214,239,800
mvvv 136,200,36
tr 216,239,8480
mvvv 136,196,20
tr 218,239,8736
mvvv 136,192,4
buffer_load_dwordx4 v242, s[16:19], s46 offen lds
mvvvz 144,192,8
s_add_u32 m0, m0, s53
tr 220,239,8992
mvvv 144,196,24
tr 222,239,9248
mvvv 144,200,40
buffer_load_dwordx4 v242, s[16:19], s46 offen offset:896 lds
mvvv 144,204,56
s_add_u32 m0, m0, s53
mvvvz 152,204,60
buffer_load_dwordx4 v242, s[16:19], s46 offen offset:1792 lds
mvvv 152,200,44
s_add_u32 m0, m0, s53
mvvv 152,196,28
buffer_load_dwordx4 v242, s[16:19], s46 offen offset:2688 lds
mvvv 152,192,12
s_waitcnt lgkmcnt(1)
s_add_u32 s46, s46, s56
s_add_u32 m0, s41, s49
mvvvz 132,208,0
s_add_u32 s41, s41, s42
tr 192,239,64
mvvv 132,212,16
s_cmp_eq_u32 s41, s43
s_cselect_b32 s41, 0, s41
tr 194,239,320
mvvv 132,216,32
s_waitcnt lgkmcnt(2)
tr 196,239,576
mvvv 132,220,48
buffer_load_dwordx4 v242, s[16:19], s46 offen lds
mvvvz 140,220,52
s_add_u32 m0, m0, s53
tr 198,239,832
mvvv 140,216,36
tr 200,239,8512
mvvv 140,212,20
tr 202,239,8768
mvvv 140,208,4
buffer_load_dwordx4 v242, s[16:19], s46 offen offset:896 lds
mvvvz 148,208,8
s_add_u32 m0, m0, s53
tr 204,239,9024
mvvv 148,212,24
tr 206,239,9280
mvvv 148,216,40
buffer_load_dwordx4 v242, s[16:19], s46 offen offset:1792 lds
mvvv 148,220,56
s_add_u32 m0, m0, s53
mvvvz 156,220,60
buffer_load_dwordx4 v242, s[16:19], s46 offen offset:2688 lds
mvvv 156,216,44
s_add_u32 s46, s46, s55
pk 244,244,245
pk 245,246,247
mvvv 156,212,28
pk 246,228,229
pk 247,230,231
mvvv 156,208,12
s_waitcnt lgkmcnt(1)
mvvvz 160,192,0
tr 208,239,96
mvvv 160,196,16
tr 210,239,352
mvvv 160,200,32
s_waitcnt lgkmcnt(2)
tr 212,239,608
mvvv 160,204,48
mvvvz 168,204,52
tr 214,239,864
mvvv 168,200,36
tr 216,239,8544
mvvv 168,196,20
tr 218,239,8800
mvvv 168,192,4
mvvvz 176,192,8
tr 220,239,9056
v_mov_b32 v233, s94
mvvv 176,196,24
tr 222,239,9312
mvvv 176,200,40
mvvv 176,204,56
v_add_u32 v239, s40, v235
mvvvz 184,204,60
s_add_u32 s40, s40, s42
s_cmp_eq_u32 s40, s43
s_cselect_b32 s40, 0, s40
mvvv 184,200,44
mvvv 184,196,28
s_waitcnt vmcnt(8)
s_barrier
mvvv 184,192,12
s_waitcnt lgkmcnt(1)
s_cmp_lt_u32 s61, s95
s_cbranch_scc1 L_release
L_rel0:
mvvvz 164,208,0
tr 192,239,0
mvvv 164,212,16
tr 194,239,256
mvvv 164,216,32
s_waitcnt lgkmcnt(2)
tr 196,239,512
mvvv 164,220,48
buffer_store_dword v233, v237, s[20:23], s54 offen
mvvvz 172,220,52
tr 198,239,768
mvvv 172,216,36
tr 200,239,8448
mvvv 172,212,20
tr 202,239,8704
mvvv 172,208,4
buffer_store_dword v233, v237, s[20:23], s61 offen sc1
mvvvz 180,208,8
tr 204,239,8960
mvvv 180,212,24
tr 206,239,9216
mvvv 180,216,40
mvvv 180,220,56
mvvvz 188,220,60
mvvv 188,216,44
mvvv 188,212,28
mvvv 188,208,12
s_waitcnt lgkmcnt(1)
mvvv 128,192,64
tr 208,239,32
mvvv 128,196,80
tr 210,239,288
mvvv 128,200,96
s_waitcnt lgkmcnt(2)
tr 212,239,544
mvvv 128,204,112
mvvv 136,204,116
tr 214,239,800
mvvv 136,200,100
tr 216,239,8480
mvvv 136,196,84
tr 218,239,8736
mvvv 136,192,68
mvvv 144,192,72
tr 220,239,8992
v_mul_f32 v128, v128, v224
mvvv 144,196,88
tr 222,239,9248
v_mul_f32 v129, v129, v224
mvvv 144,200,104
v_mul_f32 v130, v130, v224
v_mul_f32 v131, v131, v224
mvvv 144,204,120
v_mul_f32 v136, v136, v225
v_mul_f32 v137, v137, v225
mvvv 152,204,124
v_mul_f32 v138, v138, v225
v_mul_f32 v139, v139, v225
mvvv 152,200,108
mvvv 152,196,92
buffer_load_dword v248, v232, s[20:23], s62 offen sc1
mvvv 152,192,76
s_waitcnt lgkmcnt(1)
v_mul_f32 v144, v144, v226
v_mul_f32 v145, v145, v226
mvvv 132,208,64
tr 192,239,64
v_mul_f32 v146, v146, v226
mvvv 132,212,80
tr 194,239,320
v_mul_f32 v147, v147, v226
mvvv 132,216,96
s_waitcnt lgkmcnt(2)
tr 196,239,576
v_mul_f32 v152, v152, v227
mvvv 132,220,112
v_mul_f32 v153, v153, v227
v_mul_f32 v154, v154, v227
mvvv 140,220,116
tr 198,239,832
v_mul_f32 v155, v155, v227
mvvv 140,216,100
tr 200,239,8512
mvvv 140,212,84
tr 202,239,8768
v_mul_f32 v132, v132, v224
mvvv 140,208,68
v_mul_f32 v133, v133, v224
v_mul_f32 v134, v134, v224
mvvv 148,208,72
tr 204,239,9024
v_mul_f32 v135, v135, v224
mvvv 148,212,88
tr 206,239,9280
mvvv 148,216,104
s_waitcnt vmcnt(0)
v_cmp_gt_u32 vcc, s94, v248
v_mul_f32 v140, v140, v225
mvvv 148,220,120
v_mul_f32 v141, v141, v225
v_mul_f32 v142, v142, v225
mvvv 156,220,124
s_and_b32 vcc_lo, vcc_lo, s95
s_or_b32 vcc_lo, vcc_lo, s75
s_cbranch_scc1 L_spin
L_back0:
mvvv 156,216,108
s_mov_b64 vcc, 0
s_add_u32 s94, s94, 1
v_mul_f32 v143, v143, v225
v_mul_f32 v148, v148, v226
mvvv 156,212,92
s_waitcnt lgkmcnt(1)
v_mul_f32 v149, v149, v226
v_mul_f32 v150, v150, v226
mvvv 156,208,76
buffer_load_dwordx4 a[128:131], v240, s[8:11], s6 offen sc1
mvvv 160,192,64
s_add_u32 s6, s6, s58
tr 208,239,96
v_mul_f32 v151, v151, v226
mvvv 160,196,80
tr 210,239,352
mvvv 160,200,96
s_waitcnt lgkmcnt(2)
tr 212,239,608
v_mul_f32 v156, v156, v227
mvvv 160,204,112
buffer_load_dwordx4 a[132:135], v240, s[8:11], s6 offen sc1
mvvv 168,204,116
s_add_u32 s6, s6, s58
tr 214,239,864
v_mul_f32 v157, v157, v227
mvvv 168,200,100
tr 216,239,8544
v_mul_f32 v158, v158, v227
mvvv 168,196,84
tr 218,239,8800
v_mul_f32 v159, v159, v227
mvvv 168,192,68
buffer_load_dwordx4 a[136:139], v240, s[8:11], s6 offen sc1
mvvv 176,192,72
s_add_u32 s6, s6, s58
tr 220,239,9056
v_mul_f32 v160, v160, v224
mvvv 176,196,88
tr 222,239,9312
v_mul_f32 v161, v161, v224
mvvv 176,200,104
buffer_load_dwordx4 a[140:143], v240, s[8:11], s6 offen sc1
mvvv 176,204,120
s_add_u32 s6, s6, s58
v_add_u32 v239, s40, v235
v_mul_f32 v162, v162, v224
mvvv 184,204,124
s_add_u32 s40, s40, s42
s_cmp_eq_u32 s40, s43
s_cselect_b32 s40, 0, s40
mvvv 184,200,108
buffer_load_dwordx4 a[144:147], v240, s[8:11], s6 offen sc1
mvvv 184,196,92
s_add_u32 s6, s6, s58
v_mul_f32 v163, v163, v224
v_mul_f32 v168, v168, v225
mvvv 184,192,76
s_waitcnt lgkmcnt(1)
v_mul_f32 v169, v169, v225
v_mul_f32 v170, v170, v225
mvvv 164,208,64
tr 192,239,0
v_mul_f32 v171, v171, v225
mvvv 164,212,80
tr 194,239,256
v_mul_f32 v176, v176, v226
mvvv 164,216,96
s_waitcnt lgkmcnt(2)
tr 196,239,512
v_mul_f32 v177, v177, v226
mvvv 164,220,112
buffer_load_dwordx4 a[148:151], v240, s[8:11], s6 offen sc1
mvvv 172,220,116
s_add_u32 s6, s6, s58
tr 198,239,768
v_mul_f32 v178, v178, v226
mvvv 172,216,100
tr 200,239,8448
v_mul_f32 v179, v179, v226
mvvv 172,212,84
tr 202,239,8704
v_mul_f32 v184, v184, v227
mvvv 172,208,68
buffer_load_dwordx4 a[152:155], v240, s[8:11], s6 offen sc1
mvvv 180,208,72
L_padD5:
s_cbranch_vccnz L_hop_b
s_add_u32 s6, s6, s58
tr 204,239,8960
v_mul_f32 v185, v185, v227
mvvv 180,212,88
tr 206,239,9216
v_mul_f32 v186, v186, v227
mvvv 180,216,104
v_mul_f32 v187, v187, v227
v_mul_f32 v164, v164, v224
mvvv 180,220,120
buffer_load_dwordx4 a[156:159], v240, s[8:11], s6 offen sc1
mvvv 188,220,124
s_add_u32 s6, s6, s44
v_mul_f32 v165, v165, v224
v_mul_f32 v166, v166, v224
mvvv 188,216,108
v_mul_f32 v167, v167, v224
v_mul_f32 v172, v172, v225
mvvv 188,212,92
v_mul_f32 v173, v173, v225
v_mul_f32 v174, v174, v225
mvvv 188,208,76
s_waitcnt lgkmcnt(1)
v_mul_f32 v175, v175, v225
v_mul_f32 v180, v180, v226
mvva 128,192,0
tr 208,239,32
v_mul_f32 v181, v181, v226
mvva 128,196,16
tr 210,239,288
v_mul_f32 v182, v182, v226
mvva 128,200,32
s_waitcnt lgkmcnt(2)
tr 212,239,544
v_mul_f32 v183, v183, v226
mvva 128,204,48
v_mul_f32 v188, v188, v227
v_mul_f32 v189, v189, v227
mvva 136,204,52
tr 214,239,800
v_mul_f32 v190, v190, v227
mvva 136,200,36
tr 216,239,8480
v_mul_f32 v191, v191, v227
mvva 136,196,20
tr 218,239,8736
mvva 136,192,4
buffer_store_dwordx4 v[244:247], v249, s[12:15], s3 offen nt
mvva 144,192,8
s_addk_i32 s3, 128
tr 220,239,8992
mvva 144,196,24
s_cmp_eq_u32 s3, s5
s_cselect_b32 s3, s74, s3
tr 222,239,9248
mvva 144,200,40
s_bitset0_b32 s3, 31
mvva 144,204,56
mvva 152,204,60
mvva 152,200,44
mvva 152,196,28
mvva 152,192,12
s_waitcnt lgkmcnt(1)
mvva 132,208,0
tr 192,239,64
mvva 132,212,16
tr 194,239,320
mvva 132,216,32
s_waitcnt lgkmcnt(2)
tr 196,239,576
mvva 132,220,48
mvva 140,220,52
tr 198,239,832
mvva 140,216,36
tr 200,239,8512
mvva 140,212,20
tr 202,239,8768
mvva 140,208,4
mvva 148,208,8
tr 204,239,9024
v_mov_b32 v233, s94
mvva 148,212,24
tr 206,239,9280
mvva 148,216,40
mvva 148,220,56
mvva 156,220,60
mvva 156,216,44
mvva 156,212,28
s_waitcnt vmcnt(1)
s_barrier
mvva 156,208,12
s_waitcnt lgkmcnt(1)
mvva 160,192,0
tr 208,239,96
mvva 160,196,16
tr 210,239,352
mvva 160,200,32
s_waitcnt lgkmcnt(2)
tr 212,239,608
mvva 160,204,48
buffer_store_dword v233, v237, s[20:23], s54 offen
mvva 168,204,52
tr 214,239,864
mvva 168,200,36
tr 216,239,8544
mvva 168,196,20
tr 218,239,8800
mvva 168,192,4
buffer_store_dword v233, v237, s[20:23], s61 offen sc1
mvva 176,192,8
tr 220,239,9056
mvva 176,196,24
tr 222,239,9312
mvva 176,200,40
mvva 176,204,56
v_add_u32 v239, s40, v235
mvva 184,204,60
s_add_u32 s40, s40, s42
s_cmp_eq_u32 s40, s43
s_cselect_b32 s40, 0, s40
mvva 184,200,44
mvva 184,196,28
mvva 184,192,12
s_waitcnt lgkmcnt(1)
mvva 164,208,0
tr 192,239,0
mvva 164,212,16
tr 194,239,256
mvva 164,216,32
s_waitcnt lgkmcnt(2)
tr 196,239,512
mvva 164,220,48
mvva 172,220,52
tr 198,239,768
mvva 172,216,36
tr 200,239,8448
mvva 172,212,20
tr 202,239,8704
mvva 172,208,4
mvva 180,208,8
tr 204,239,8960
mvva 180,212,24
tr 206,239,9216
mvva 180,216,40
mvva 180,220,56
mvva 188,220,60
mvva 188,216,44
buffer_load_dword v248, v232, s[20:23], s62 offen sc1
mvva 188,212,28
mvva 188,208,12
s_waitcnt lgkmcnt(1)
mvva 128,192,64
tr 208,239,32
mvva 128,196,80
tr 210,239,288
mvva 128,200,96
s_waitcnt lgkmcnt(2)
tr 212,239,544
mvva 128,204,112
mvva 136,204,116
tr 214,239,800
mvva 136,200,100
tr 216,239,8480
mvva 136,196,84
tr 218,239,8736
mvva 136,192,68
mvva 144,192,72
s_add_u32 m0, s41, s49
s_add_u32 s41, s41, s42
tr 220,239,8992
mvva 144,196,88
s_cmp_eq_u32 s41, s43
s_cselect_b32 s41, 0, s41
tr 222,239,9248
mvva 144,200,104
s_waitcnt vmcnt(0)
v_cmp_gt_u32 vcc, s94, v248
mvva 144,204,120
mvva 152,204,124
s_and_b32 vcc_lo, vcc_lo, s95
s_or_b32 vcc_lo, vcc_lo, s75
s_cbranch_scc1 L_spin
L_back1:
mvva 152,200,108
s_mov_b64 vcc, 0
s_add_u32 s94, s94, 1
mvva 152,196,92
buffer_load_dwordx4 v242, s[16:19], s46 offen lds
mvva 152,192,76
s_waitcnt lgkmcnt(1)
s_add_u32 m0, m0, s53
mvva 132,208,64
tr 192,239,64
mvva 132,212,80
tr 194,239,320
mvva 132,216,96
s_waitcnt lgkmcnt(2)
tr 196,239,576
mvva 132,220,112
buffer_load_dwordx4 v242, s[16:19], s46 offen offset:896 lds
mvva 140,220,116
s_add_u32 m0, m0, s53
tr 198,239,832
mvva 140,216,100
tr 200,239,8512
mvva 140,212,84
tr 202,239,8768
pk 128,128,129
mvva 140,208,68
buffer_load_dwordx4 v242, s[16:19], s46 offen offset:1792 lds
mvva 148,208,72
s_add_u32 m0, m0, s53
tr 204,239,9024
pk 129,130,131
mvva 148,212,88
tr 206,239,9280
pk 130,132,133
mvva 148,216,104
buffer_load_dwordx4 v242, s[16:19], s46 offen offset:2688 lds
mvva 148,220,120
s_add_u32 s46, s46, s57
s_cmp_eq_u32 s46, s77
s_cselect_b32 s46, s71, s46
mvva 156,220,124
s_add_u32 m0, s41, s49
s_add_u32 s41, s41, s42
pk 131,134,135
mvva 156,216,108
s_cmp_eq_u32 s41, s43
s_cselect_b32 s41, 0, s41
mvva 156,212,92
s_waitcnt lgkmcnt(1)
s_cmp_ge_u32 s94, 11
s_cselect_b32 s18, 0, s18
mvva 156,208,76
buffer_load_dwordx4 v242, s[16:19], s46 offen lds
mvva 160,192,64
s_add_u32 m0, m0, s53
tr 208,239,96
mvva 160,196,80
tr 210,239,352
mvva 160,200,96
s_waitcnt lgkmcnt(2)
tr 212,239,608
mvva 160,204,112
buffer_load_dwordx4 v242, s[16:19], s46 offen offset:896 lds
mvva 168,204,116
s_add_u32 m0, m0, s53
tr 214,239,864
mvva 168,200,100
tr 216,239,8544
mvva 168,196,84
tr 218,239,8800
mvva 168,192,68
buffer_store_dwordx4 v[128:131], v240, s[8:11], s66 offen offset:0
mvva 176,192,72
tr 220,239,9056
pk 136,136,137
mvva 176,196,88
tr 222,239,9312
pk 137,138,139
mvva 176,200,104
buffer_load_dwordx4 v242, s[16:19], s46 offen offset:1792 lds
mvva 176,204,120
s_add_u32 m0, m0, s53
v_add_u32 v239, s40, v235
pk 138,140,141
mvva 184,204,124
s_add_u32 s40, s40, s42
s_cmp_eq_u32 s40, s43
s_cselect_b32 s40, 0, s40
mvva 184,200,108
buffer_load_dwordx4 v242, s[16:19], s46 offen offset:2688 lds
mvva 184,196,92
s_add_u32 s46, s46, s55
pk 139,142,143
mvva 184,192,76
s_waitcnt lgkmcnt(1)
mvva 164,208,64
tr 192,239,0
mvva 164,212,80
tr 194,239,256
mvva 164,216,96
s_waitcnt lgkmcnt(2)
tr 196,239,512
mvva 164,220,112
buffer_store_dwordx4 v[136:139], v240, s[8:11], s66 offen offset:1024
mvva 172,220,116
tr 198,239,768
pk 144,144,145
mvva 172,216,100
tr 200,239,8448
pk 145,146,147
mvva 172,212,84
tr 202,239,8704
pk 146,148,149
mvva 172,208,68
pk 147,150,151
pk 160,160,161
mvva 180,208,72
tr 204,239,8960
pk 161,162,163
mvva 180,212,88
tr 206,239,9216
pk 162,164,165
mvva 180,216,104
buffer_store_dwordx4 v[144:147], v240, s[8:11], s66 offen offset:2048
mvva 180,220,120
s_add_u32 s66, s66, s72
pk 152,152,153
pk 153,154,155
mvva 188,220,124
pk 154,156,157
pk 155,158,159
mvva 188,216,108
buffer_store_dwordx4 v[152:155], v240, s[8:11], s67 offen offset:3072
mvva 188,212,92
s_add_u32 s67, s67, s72
pk 163,166,167
mvva 188,208,76
buffer_store_dwordx4 v[160:163], v240, s[8:11], s66 offen offset:0
mvaaz 244,160,128
pk 168,168,169
pk 169,170,171
mvaaz 228,164,128
pk 170,172,173
pk 171,174,175
mvaa 244,160,132
buffer_store_dwordx4 v[168:171], v240, s[8:11], s66 offen offset:1024
mvaa 228,164,132
pk 176,176,177
pk 177,178,179
mvaa 244,160,136
pk 178,180,181
pk 179,182,183
mvaa 228,164,136
buffer_store_dwordx4 v[176:179], v240, s[8:11], s66 offen offset:2048
mvaa 244,160,140
s_add_u32 s66, s66, s60
mvaa 228,164,140
pk 184,184,185
pk 185,186,187
mvaa 244,160,144
pk 186,188,189
pk 187,190,191
mvaa 228,164,144
buffer_store_dwordx4 v[184:187], v240, s[8:11], s67 offen offset:3072
mvaa 244,160,148
s_add_u32 s67, s67, s60
mvaa 228,164,148
mvaa 244,160,152
mvaa 228,164,152
mvaa 244,160,156
mvaa 228,164,156
s_waitcnt lgkmcnt(6)
s_sub_u32 s64, s64, 1
s_cmp_lg_u32 s64, 0
s_cbranch_scc1 L_oploop
s_nop 3
s_waitcnt vmcnt(0)
s_barrier
v_mov_b32 v233, s94
s_cmp_lt_u32 s61, s95
s_cbranch_scc1 L_release
L_rel1:
buffer_store_dword v233, v237, s[20:23], s54 offen
buffer_store_dword v233, v237, s[20:23], s61 offen sc1
buffer_load_dword v248, v232, s[20:23], s62 offen sc1
pk 244,244,245
pk 245,246,247
pk 246,228,229
pk 247,230,231
s_waitcnt vmcnt(0)
v_cmp_gt_u32 vcc, s94, v248
s_nop 1
s_and_b32 vcc_lo, vcc_lo, s95
s_or_b32 vcc_lo, vcc_lo, s75
s_cbranch_scc1 L_spin
L_back2:
buffer_load_dwordx4 a[128:131], v240, s[8:11], s6 offen sc1
s_add_u32 s6, s6, s58
buffer_load_dwordx4 a[132:135], v240, s[8:11], s6 offen sc1
s_add_u32 s6, s6, s58
buffer_load_dwordx4 a[136:139], v240, s[8:11], s6 offen sc1
s_add_u32 s6, s6, s58
buffer_load_dwordx4 a[140:143], v240, s[8:11], s6 offen sc1
s_add_u32 s6, s6, s58
buffer_load_dwordx4 a[144:147], v240, s[8:11], s6 offen sc1
s_add_u32 s6, s6, s58
buffer_load_dwordx4 a[148:151], v240, s[8:11], s6 offen sc1
s_add_u32 s6, s6, s58
buffer_load_dwordx4 a[152:155], v240, s[8:11], s6 offen sc1
s_add_u32 s6, s6, s58
buffer_load_dwordx4 a[156:159], v240, s[8:11], s6 offen sc1
s_add_u32 s6, s6, s44
buffer_store_dwordx4 v[244:247], v249, s[12:15], s3 offen nt
s_addk_i32 s3, 128
s_cmp_eq_u32 s3, s5
s_cselect_b32 s3, s74, s3
s_bitset0_b32 s3, 31
s_waitcnt vmcnt(7)
mvaaz 244,160,128
mvaaz 228,164,128
mvaa 244,160,132
mvaa 228,164,132
s_waitcnt vmcnt(5)
mvaa 244,160,136
mvaa 228,164,136
mvaa 244,160,140
mvaa 228,164,140
s_waitcnt vmcnt(3)
mvaa 244,160,144
mvaa 228,164,144
mvaa 244,160,148
mvaa 228,164,148
s_waitcnt vmcnt(1)
mvaa 244,160,152
mvaa 228,164,152
mvaa 244,160,156
mvaa 228,164,156
s_nop 7
pk 244,244,245
pk 245,246,247
pk 246,228,229
pk 247,230,231
buffer_store_dwordx4 v[244:247], v249, s[12:15], s3 offen nt
L_end:
s_endpgm
L_spin:
buffer_load_dword v248, v232, s[20:23], s62 offen sc1
s_waitcnt vmcnt(0)
v_cmp_gt_u32 vcc, s94, v248
s_cmp_eq_u32 s98, 0
s_cbranch_scc1 L_spin_out
s_sub_u32 s98, s98, 1
s_and_b32 vcc_lo, vcc_lo, s95
s_cbranch_scc0 L_spin_out
s_sleep 1
s_branch L_spin
L_spin_out:
s_cmp_eq_u32 s75, 0
s_cbranch_scc1 L_acquired
buffer_inv sc1
s_waitcnt vmcnt(0)
L_acquired:
s_cmp_eq_u32 s94, 13
s_cbranch_scc1 L_back2
s_bitcmp1_b32 s94, 0
s_cbranch_scc1 L_back0
s_branch L_back1
L_release:
buffer_wbl2 sc1
s_waitcnt vmcnt(0)
s_cmp_eq_u32 s94, 13
s_cbranch_scc1 L_rel1
s_branch L_rel0
L_spin_clear:
s_sleep 1
buffer_load_dword v241, v240, s[84:87], 0 offen sc1
s_waitcnt vmcnt(0)
v_readfirstlane_b32 s94, v241
s_cmp_eq_u32 s98, 0
s_cbranch_scc1 L_cleared
s_sub_u32 s98, s98, 1
s_bitcmp0_b32 s94, 3
s_cbranch_scc1 L_spin_clear
s_branch L_cleared
L_rare0:
s_nop 7
v_max3_f32 v243, v128, v129, v130
v_max3_f32 v243, v243, v131, v132
v_max3_f32 v243, v243, v133, v134
v_max_f32 v243, v243, v135
v_mov_b32 v238, v243
s_nop 1
v_permlane32_swap_b32 v243, v238
s_nop 1
v_max_f32 v243, v243, v238
v_mov_b32 v238, v243
s_nop 1
v_permlane16_swap_b32 v243, v238
s_nop 1
v_max_f32 v243, v243, v238
v_ceil_f32 v243, v243
v_max_f32 v243, 0, v243
v_sub_f32 v128, v128, v243
v_sub_f32 v129, v129, v243
v_sub_f32 v130, v130, v243
v_sub_f32 v131, v131, v243
v_sub_f32 v132, v132, v243
v_sub_f32 v133, v133, v243
v_sub_f32 v134, v134, v243
v_sub_f32 v135, v135, v243
v_sub_f32 v224, v224, v243
v_cvt_i32_f32 v239, -v243
v_ldexp_f32 v228, v228, v239
s_cmp_eq_u32 s63, 0
s_cbranch_scc1 L_rare0_q0
v_lshlrev_b32 v243, 16, v160
v_and_b32 v238, s81, v160
v_ldexp_f32 v243, v243, v239
v_ldexp_f32 v238, v238, v239
pk 160,243,238
v_lshlrev_b32 v243, 16, v161
v_and_b32 v238, s81, v161
v_ldexp_f32 v243, v243, v239
v_ldexp_f32 v238, v238, v239
pk 161,243,238
v_lshlrev_b32 v243, 16, v162
v_and_b32 v238, s81, v162
v_ldexp_f32 v243, v243, v239
v_ldexp_f32 v238, v238, v239
pk 162,243,238
v_lshlrev_b32 v243, 16, v163
v_and_b32 v238, s81, v163
v_ldexp_f32 v243, v243, v239
v_ldexp_f32 v238, v238, v239
pk 163,243,238
v_accvgpr_read_b32 v243, a0
v_ldexp_f32 v243, v243, v239
v_accvgpr_write_b32 a0, v243
v_accvgpr_read_b32 v238, a1
v_ldexp_f32 v238, v238, v239
v_accvgpr_write_b32 a1, v238
v_accvgpr_read_b32 v243, a2
v_ldexp_f32 v243, v243, v239
v_accvgpr_write_b32 a2, v243
v_accvgpr_read_b32 v238, a3
v_ldexp_f32 v238, v238, v239
v_accvgpr_write_b32 a3, v238
v_accvgpr_read_b32 v243, a16
v_ldexp_f32 v243, v243, v239
v_accvgpr_write_b32 a16, v243
v_accvgpr_read_b32 v238, a17
v_ldexp_f32 v238, v238, v239
v_accvgpr_write_b32 a17, v238
v_accvgpr_read_b32 v243, a18
v_ldexp_f32 v243, v243, v239
v_accvgpr_write_b32 a18, v243
v_accvgpr_read_b32 v238, a19
v_ldexp_f32 v238, v238, v239
v_accvgpr_write_b32 a19, v238
v_accvgpr_read_b32 v243, a32
v_ldexp_f32 v243, v243, v239
v_accvgpr_write_b32 a32, v243
v_accvgpr_read_b32 v238, a33
v_ldexp_f32 v238, v238, v239
v_accvgpr_write_b32 a33, v238
v_accvgpr_read_b32 v243, a34
v_ldexp_f32 v243, v243, v239
v_accvgpr_write_b32 a34, v243
v_accvgpr_read_b32 v238, a35
v_ldexp_f32 v238, v238, v239
v_accvgpr_write_b32 a35, v238
v_accvgpr_read_b32 v243, a48
v_ldexp_f32 v243, v243, v239
v_accvgpr_write_b32 a48, v243
v_accvgpr_read_b32 v238, a49
v_ldexp_f32 v238, v238, v239
v_accvgpr_write_b32 a49, v238
v_accvgpr_read_b32 v243, a50
v_ldexp_f32 v243, v243, v239
v_accvgpr_write_b32 a50, v243
v_accvgpr_read_b32 v238, a51
v_ldexp_f32 v238, v238, v239
v_accvgpr_write_b32 a51, v238
v_accvgpr_read_b32 v243, a64
v_ldexp_f32 v243, v243, v239
v_accvgpr_write_b32 a64, v243
v_accvgpr_read_b32 v238, a65
v_ldexp_f32 v238, v238, v239
v_accvgpr_write_b32 a65, v238
v_accvgpr_read_b32 v243, a66
v_ldexp_f32 v243, v243, v239
v_accvgpr_write_b32 a66, v243
v_accvgpr_read_b32 v238, a67
v_ldexp_f32 v238, v238, v239
v_accvgpr_write_b32 a67, v238
v_accvgpr_read_b32 v243, a80
v_ldexp_f32 v243, v243, v239
v_accvgpr_write_b32 a80, v243
v_accvgpr_read_b32 v238, a81
v_ldexp_f32 v238, v238, v239
v_accvgpr_write_b32 a81, v238
v_accvgpr_read_b32 v243, a82
v_ldexp_f32 v243, v243, v239
v_accvgpr_write_b32 a82, v243
v_accvgpr_read_b32 v238, a83
v_ldexp_f32 v238, v238, v239
v_accvgpr_write_b32 a83, v238
v_accvgpr_read_b32 v243, a96
v_ldexp_f32 v243, v243, v239
v_accvgpr_write_b32 a96, v243
v_accvgpr_read_b32 v238, a97
v_ldexp_f32 v238, v238, v239
v_accvgpr_write_b32 a97, v238
v_accvgpr_read_b32 v243, a98
v_ldexp_f32 v243, v243, v239
v_accvgpr_write_b32 a98, v243
v_accvgpr_read_b32 v238, a99
v_ldexp_f32 v238, v238, v239
v_accvgpr_write_b32 a99, v238
v_accvgpr_read_b32 v243, a112
v_ldexp_f32 v243, v243, v239
v_accvgpr_write_b32 a112, v243
v_accvgpr_read_b32 v238, a113
v_ldexp_f32 v238, v238, v239
v_accvgpr_write_b32 a113, v238
v_accvgpr_read_b32 v243, a114
v_ldexp_f32 v243, v243, v239
v_accvgpr_write_b32 a114, v243
v_accvgpr_read_b32 v238, a115
v_ldexp_f32 v238, v238, v239
v_accvgpr_write_b32 a115, v238
v_accvgpr_read_b32 v243, a128
v_ldexp_f32 v243, v243, v239
v_accvgpr_write_b32 a128, v243
v_accvgpr_read_b32 v238, a129
v_ldexp_f32 v238, v238, v239
v_accvgpr_write_b32 a129, v238
v_accvgpr_read_b32 v243, a130
v_ldexp_f32 v243, v243, v239
v_accvgpr_write_b32 a130, v243
v_accvgpr_read_b32 v238, a131
v_ldexp_f32 v238, v238, v239
v_accvgpr_write_b32 a131, v238
v_accvgpr_read_b32 v243, a144
v_ldexp_f32 v243, v243, v239
v_accvgpr_write_b32 a144, v243
v_accvgpr_read_b32 v238, a145
v_ldexp_f32 v238, v238, v239
v_accvgpr_write_b32 a145, v238
v_accvgpr_read_b32 v243, a146
v_ldexp_f32 v243, v243, v239
v_accvgpr_write_b32 a146, v243
v_accvgpr_read_b32 v238, a147
v_ldexp_f32 v238, v238, v239
v_accvgpr_write_b32 a147, v238
v_accvgpr_read_b32 v243, a160
v_ldexp_f32 v243, v243, v239
v_accvgpr_write_b32 a160, v243
v_accvgpr_read_b32 v238, a161
v_ldexp_f32 v238, v238, v239
v_accvgpr_write_b32 a161, v238
v_accvgpr_read_b32 v243, a162
v_ldexp_f32 v243, v243, v239
v_accvgpr_write_b32 a162, v243
v_accvgpr_read_b32 v238, a163
v_ldexp_f32 v238, v238, v239
v_accvgpr_write_b32 a163, v238
v_accvgpr_read_b32 v243, a176
v_ldexp_f32 v243, v243, v239
v_accvgpr_write_b32 a176, v243
v_accvgpr_read_b32 v238, a177
v_ldexp_f32 v238, v238, v239
v_accvgpr_write_b32 a177, v238
v_accvgpr_read_b32 v243, a178
v_ldexp_f32 v243, v243, v239
v_accvgpr_write_b32 a178, v243
v_accvgpr_read_b32 v238, a179
v_ldexp_f32 v238, v238, v239
v_accvgpr_write_b32 a179, v238
v_accvgpr_read_b32 v243, a192
v_ldexp_f32 v243, v243, v239
v_accvgpr_write_b32 a192, v243
v_accvgpr_read_b32 v238, a193
v_ldexp_f32 v238, v238, v239
v_accvgpr_write_b32 a193, v238
v_accvgpr_read_b32 v243, a194
v_ldexp_f32 v243, v243, v239
v_accvgpr_write_b32 a194, v243
v_accvgpr_read_b32 v238, a195
v_ldexp_f32 v238, v238, v239
v_accvgpr_write_b32 a195, v238
v_accvgpr_read_b32 v243, a208
v_ldexp_f32 v243, v243, v239
v_accvgpr_write_b32 a208, v243
v_accvgpr_read_b32 v238, a209
v_ldexp_f32 v238, v238, v239
v_accvgpr_write_b32 a209, v238
v_accvgpr_read_b32 v243, a210
v_ldexp_f32 v243, v243, v239
v_accvgpr_write_b32 a210, v243
v_accvgpr_read_b32 v238, a211
v_ldexp_f32 v238, v238, v239
v_accvgpr_write_b32 a211, v238
v_accvgpr_read_b32 v243, a224
v_ldexp_f32 v243, v243, v239
v_accvgpr_write_b32 a224, v243
v_accvgpr_read_b32 v238, a225
v_ldexp_f32 v238, v238, v239
v_accvgpr_write_b32 a225, v238
v_accvgpr_read_b32 v243, a226
v_ldexp_f32 v243, v243, v239
v_accvgpr_write_b32 a226, v243
v_accvgpr_read_b32 v238, a227
v_ldexp_f32 v238, v238, v239
v_accvgpr_write_b32 a227, v238
v_accvgpr_read_b32 v243, a240
v_ldexp_f32 v243, v243, v239
v_accvgpr_write_b32 a240, v243
v_accvgpr_read_b32 v238, a241
v_ldexp_f32 v238, v238, v239
v_accvgpr_write_b32 a241, v238
v_accvgpr_read_b32 v243, a242
v_ldexp_f32 v243, v243, v239
v_accvgpr_write_b32 a242, v243
v_accvgpr_read_b32 v238, a243
v_ldexp_f32 v238, v238, v239
v_accvgpr_write_b32 a243, v238
L_rare0_q0:
v_max3_f32 v243, v136, v137, v138
v_max3_f32 v243, v243, v139, v140
v_max3_f32 v243, v243, v141, v142
v_max_f32 v243, v243, v143
v_mov_b32 v238, v243
s_nop 1
v_permlane32_swap_b32 v243, v238
s_nop 1
v_max_f32 v243, v243, v238
v_mov_b32 v238, v243
s_nop 1
v_permlane16_swap_b32 v243, v238
s_nop 1
v_max_f32 v243, v243, v238
v_ceil_f32 v243, v243
v_max_f32 v243, 0, v243
v_sub_f32 v136, v136, v243
v_sub_f32 v137, v137, v243
v_sub_f32 v138, v138, v243
v_sub_f32 v139, v139, v243
v_sub_f32 v140, v140, v243
v_sub_f32 v141, v141, v243
v_sub_f32 v142, v142, v243
v_sub_f32 v143, v143, v243
v_sub_f32 v225, v225, v243
v_cvt_i32_f32 v239, -v243
v_ldexp_f32 v229, v229, v239
s_cmp_eq_u32 s63, 0
s_cbranch_scc1 L_rare0_q1
v_lshlrev_b32 v243, 16, v168
v_and_b32 v238, s81, v168
v_ldexp_f32 v243, v243, v239
v_ldexp_f32 v238, v238, v239
pk 168,243,238
v_lshlrev_b32 v243, 16, v169
v_and_b32 v238, s81, v169
v_ldexp_f32 v243, v243, v239
v_ldexp_f32 v238, v238, v239
pk 169,243,238
v_lshlrev_b32 v243, 16, v170
v_and_b32 v238, s81, v170
v_ldexp_f32 v243, v243, v239
v_ldexp_f32 v238, v238, v239
pk 170,243,238
v_lshlrev_b32 v243, 16, v171
v_and_b32 v238, s81, v171
v_ldexp_f32 v243, v243, v239
v_ldexp_f32 v238, v238, v239
pk 171,243,238
v_accvgpr_read_b32 v243, a4
v_ldexp_f32 v243, v243, v239
v_accvgpr_write_b32 a4, v243
v_accvgpr_read_b32 v238, a5
v_ldexp_f32 v238, v238, v239
v_accvgpr_write_b32 a5, v238
v_accvgpr_read_b32 v243, a6
v_ldexp_f32 v243, v243, v239
v_accvgpr_write_b32 a6, v243
v_accvgpr_read_b32 v238, a7
v_ldexp_f32 v238, v238, v239
v_accvgpr_write_b32 a7, v238
v_accvgpr_read_b32 v243, a20
v_ldexp_f32 v243, v243, v239
v_accvgpr_write_b32 a20, v243
v_accvgpr_read_b32 v238, a21
v_ldexp_f32 v238, v238, v239
v_accvgpr_write_b32 a21, v238
v_accvgpr_read_b32 v243, a22
v_ldexp_f32 v243, v243, v239
v_accvgpr_write_b32 a22, v243
v_accvgpr_read_b32 v238, a23
v_ldexp_f32 v238, v238, v239
v_accvgpr_write_b32 a23, v238
v_accvgpr_read_b32 v243, a36
v_ldexp_f32 v243, v243, v239
v_accvgpr_write_b32 a36, v243
v_accvgpr_read_b32 v238, a37
v_ldexp_f32 v238, v238, v239
v_accvgpr_write_b32 a37, v238
v_accvgpr_read_b32 v243, a38
v_ldexp_f32 v243, v243, v239
v_accvgpr_write_b32 a38, v243
v_accvgpr_read_b32 v238, a39
v_ldexp_f32 v238, v238, v239
v_accvgpr_write_b32 a39, v238
v_accvgpr_read_b32 v243, a52
v_ldexp_f32 v243, v243, v239
v_accvgpr_write_b32 a52, v243
v_accvgpr_read_b32 v238, a53
v_ldexp_f32 v238, v238, v239
v_accvgpr_write_b32 a53, v238
v_accvgpr_read_b32 v243, a54
v_ldexp_f32 v243, v243, v239
v_accvgpr_write_b32 a54, v243
v_accvgpr_read_b32 v238, a55
v_ldexp_f32 v238, v238, v239
v_accvgpr_write_b32 a55, v238
v_accvgpr_read_b32 v243, a68
v_ldexp_f32 v243, v243, v239
v_accvgpr_write_b32 a68, v243
v_accvgpr_read_b32 v238, a69
v_ldexp_f32 v238, v238, v239
v_accvgpr_write_b32 a69, v238
v_accvgpr_read_b32 v243, a70
v_ldexp_f32 v243, v243, v239
v_accvgpr_write_b32 a70, v243
v_accvgpr_read_b32 v238, a71
v_ldexp_f32 v238, v238, v239
v_accvgpr_write_b32 a71, v238
v_accvgpr_read_b32 v243, a84
v_ldexp_f32 v243, v243, v239
v_accvgpr_write_b32 a84, v243
v_accvgpr_read_b32 v238, a85
v_ldexp_f32 v238, v238, v239
v_accvgpr_write_b32 a85, v238
v_accvgpr_read_b32 v243, a86
v_ldexp_f32 v243, v243, v239
v_accvgpr_write_b32 a86, v243
v_accvgpr_read_b32 v238, a87
v_ldexp_f32 v238, v238, v239
v_accvgpr_write_b32 a87, v238
v_accvgpr_read_b32 v243, a100
v_ldexp_f32 v243, v243, v239
v_accvgpr_write_b32 a100, v243
v_accvgpr_read_b32 v238, a101
v_ldexp_f32 v238, v238, v239
v_accvgpr_write_b32 a101, v238
v_accvgpr_read_b32 v243, a102
v_ldexp_f32 v243, v243, v239
v_accvgpr_write_b32 a102, v243
v_accvgpr_read_b32 v238, a103
v_ldexp_f32 v238, v238, v239
v_accvgpr_write_b32 a103, v238
v_accvgpr_read_b32 v243, a116
v_ldexp_f32 v243, v243, v239
v_accvgpr_write_b32 a116, v243
v_accvgpr_read_b32 v238, a117
v_ldexp_f32 v238, v238, v239
v_accvgpr_write_b32 a117, v238
v_accvgpr_read_b32 v243, a118
v_ldexp_f32 v243, v243, v239
v_accvgpr_write_b32 a118, v243
v_accvgpr_read_b32 v238, a119
v_ldexp_f32 v238, v238, v239
v_accvgpr_write_b32 a119, v238
v_accvgpr_read_b32 v243, a132
v_ldexp_f32 v243, v243, v239
v_accvgpr_write_b32 a132, v243
v_accvgpr_read_b32 v238, a133
v_ldexp_f32 v238, v238, v239
v_accvgpr_write_b32 a133, v238
v_accvgpr_read_b32 v243, a134
v_ldexp_f32 v243, v243, v239
v_accvgpr_write_b32 a134, v243
v_accvgpr_read_b32 v238, a135
v_ldexp_f32 v238, v238, v239
v_accvgpr_write_b32 a135, v238
v_accvgpr_read_b32 v243, a148
v_ldexp_f32 v243, v243, v239
v_accvgpr_write_b32 a148, v243
v_accvgpr_read_b32 v238, a149
v_ldexp_f32 v238, v238, v239
v_accvgpr_write_b32 a149, v238
v_accvgpr_read_b32 v243, a150
v_ldexp_f32 v243, v243, v239
v_accvgpr_write_b32 a150, v243
v_accvgpr_read_b32 v238, a151
v_ldexp_f32 v238, v238, v239
v_accvgpr_write_b32 a151, v238
v_accvgpr_read_b32 v243, a164
v_ldexp_f32 v243, v243, v239
v_accvgpr_write_b32 a164, v243
v_accvgpr_read_b32 v238, a165
v_ldexp_f32 v238, v238, v239
v_accvgpr_write_b32 a165, v238
v_accvgpr_read_b32 v243, a166
v_ldexp_f32 v243, v243, v239
v_accvgpr_write_b32 a166, v243
v_accvgpr_read_b32 v238, a167
v_ldexp_f32 v238, v238, v239
v_accvgpr_write_b32 a167, v238
v_accvgpr_read_b32 v243, a180
v_ldexp_f32 v243, v243, v239
v_accvgpr_write_b32 a180, v243
v_accvgpr_read_b32 v238, a181
v_ldexp_f32 v238, v238, v239
v_accvgpr_write_b32 a181, v238
v_accvgpr_read_b32 v243, a182
v_ldexp_f32 v243, v243, v239
v_accvgpr_write_b32 a182, v243
v_accvgpr_read_b32 v238, a183
v_ldexp_f32 v238, v238, v239
v_accvgpr_write_b32 a183, v238
v_accvgpr_read_b32 v243, a196
v_ldexp_f32 v243, v243, v239
v_accvgpr_write_b32 a196, v243
v_accvgpr_read_b32 v238, a197
v_ldexp_f32 v238, v238, v239
v_accvgpr_write_b32 a197, v238
v_accvgpr_read_b32 v243, a198
v_ldexp_f32 v243, v243, v239
v_accvgpr_write_b32 a198, v243
v_accvgpr_read_b32 v238, a199
v_ldexp_f32 v238, v238, v239
v_accvgpr_write_b32 a199, v238
v_accvgpr_read_b32 v243, a212
v_ldexp_f32 v243, v243, v239
v_accvgpr_write_b32 a212, v243
v_accvgpr_read_b32 v238, a213
v_ldexp_f32 v238, v238, v239
v_accvgpr_write_b32 a213, v238
v_accvgpr_read_b32 v243, a214
v_ldexp_f32 v243, v243, v239
v_accvgpr_write_b32 a214, v243
v_accvgpr_read_b32 v238, a215
v_ldexp_f32 v238, v238, v239
v_accvgpr_write_b32 a215, v238
v_accvgpr_read_b32 v243, a228
v_ldexp_f32 v243, v243, v239
v_accvgpr_write_b32 a228, v243
v_accvgpr_read_b32 v238, a229
v_ldexp_f32 v238, v238, v239
v_accvgpr_write_b32 a229, v238
v_accvgpr_read_b32 v243, a230
v_ldexp_f32 v243, v243, v239
v_accvgpr_write_b32 a230, v243
v_accvgpr_read_b32 v238, a231
v_ldexp_f32 v238, v238, v239
v_accvgpr_write_b32 a231, v238
v_accvgpr_read_b32 v243, a244
v_ldexp_f32 v243, v243, v239
v_accvgpr_write_b32 a244, v243
v_accvgpr_read_b32 v238, a245
v_ldexp_f32 v238, v238, v239
v_accvgpr_write_b32 a245, v238
v_accvgpr_read_b32 v243, a246
v_ldexp_f32 v243, v243, v239
v_accvgpr_write_b32 a246, v243
v_accvgpr_read_b32 v238, a247
v_ldexp_f32 v238, v238, v239
v_accvgpr_write_b32 a247, v238
L_rare0_q1:
v_max3_f32 v243, v144, v145, v146
v_max3_f32 v243, v243, v147, v148
v_max3_f32 v243, v243, v149, v150
v_max_f32 v243, v243, v151
v_mov_b32 v238, v243
s_nop 1
v_permlane32_swap_b32 v243, v238
s_nop 1
v_max_f32 v243, v243, v238
v_mov_b32 v238, v243
s_nop 1
v_permlane16_swap_b32 v243, v238
s_nop 1
v_max_f32 v243, v243, v238
v_ceil_f32 v243, v243
v_max_f32 v243, 0, v243
v_sub_f32 v144, v144, v243
v_sub_f32 v145, v145, v243
v_sub_f32 v146, v146, v243
v_sub_f32 v147, v147, v243
v_sub_f32 v148, v148, v243
v_sub_f32 v149, v149, v243
v_sub_f32 v150, v150, v243
v_sub_f32 v151, v151, v243
v_sub_f32 v226, v226, v243
v_cvt_i32_f32 v239, -v243
v_ldexp_f32 v230, v230, v239
s_cmp_eq_u32 s63, 0
s_cbranch_scc1 L_rare0_q2
v_lshlrev_b32 v243, 16, v176
v_and_b32 v238, s81, v176
v_ldexp_f32 v243, v243, v239
v_ldexp_f32 v238, v238, v239
pk 176,243,238
v_lshlrev_b32 v243, 16, v177
v_and_b32 v238, s81, v177
v_ldexp_f32 v243, v243, v239
v_ldexp_f32 v238, v238, v239
pk 177,243,238
v_lshlrev_b32 v243, 16, v178
v_and_b32 v238, s81, v178
v_ldexp_f32 v243, v243, v239
v_ldexp_f32 v238, v238, v239
pk 178,243,238
v_lshlrev_b32 v243, 16, v179
v_and_b32 v238, s81, v179
v_ldexp_f32 v243, v243, v239
v_ldexp_f32 v238, v238, v239
pk 179,243,238
v_accvgpr_read_b32 v243, a8
v_ldexp_f32 v243, v243, v239
v_accvgpr_write_b32 a8, v243
v_accvgpr_read_b32 v238, a9
v_ldexp_f32 v238, v238, v239
v_accvgpr_write_b32 a9, v238
v_accvgpr_read_b32 v243, a10
v_ldexp_f32 v243, v243, v239
v_accvgpr_write_b32 a10, v243
v_accvgpr_read_b32 v238, a11
v_ldexp_f32 v238, v238, v239
v_accvgpr_write_b32 a11, v238
v_accvgpr_read_b32 v243, a24
v_ldexp_f32 v243, v243, v239
v_accvgpr_write_b32 a24, v243
v_accvgpr_read_b32 v238, a25
v_ldexp_f32 v238, v238, v239
v_accvgpr_write_b32 a25, v238
v_accvgpr_read_b32 v243, a26
v_ldexp_f32 v243, v243, v239
v_accvgpr_write_b32 a26, v243
v_accvgpr_read_b32 v238, a27
v_ldexp_f32 v238, v238, v239
v_accvgpr_write_b32 a27, v238
v_accvgpr_read_b32 v243, a40
v_ldexp_f32 v243, v243, v239
v_accvgpr_write_b32 a40, v243
v_accvgpr_read_b32 v238, a41
v_ldexp_f32 v238, v238, v239
v_accvgpr_write_b32 a41, v238
v_accvgpr_read_b32 v243, a42
v_ldexp_f32 v243, v243, v239
v_accvgpr_write_b32 a42, v243
v_accvgpr_read_b32 v238, a43
v_ldexp_f32 v238, v238, v239
v_accvgpr_write_b32 a43, v238
v_accvgpr_read_b32 v243, a56
v_ldexp_f32 v243, v243, v239
v_accvgpr_write_b32 a56, v243
v_accvgpr_read_b32 v238, a57
v_ldexp_f32 v238, v238, v239
v_accvgpr_write_b32 a57, v238
v_accvgpr_read_b32 v243, a58
v_ldexp_f32 v243, v243, v239
v_accvgpr_write_b32 a58, v243
v_accvgpr_read_b32 v238, a59
v_ldexp_f32 v238, v238, v239
v_accvgpr_write_b32 a59, v238
v_accvgpr_read_b32 v243, a72
v_ldexp_f32 v243, v243, v239
v_accvgpr_write_b32 a72, v243
v_accvgpr_read_b32 v238, a73
v_ldexp_f32 v238, v238, v239
v_accvgpr_write_b32 a73, v238
v_accvgpr_read_b32 v243, a74
v_ldexp_f32 v243, v243, v239
v_accvgpr_write_b32 a74, v243
v_accvgpr_read_b32 v238, a75
v_ldexp_f32 v238, v238, v239
v_accvgpr_write_b32 a75, v238
v_accvgpr_read_b32 v243, a88
v_ldexp_f32 v243, v243, v239
v_accvgpr_write_b32 a88, v243
v_accvgpr_read_b32 v238, a89
v_ldexp_f32 v238, v238, v239
v_accvgpr_write_b32 a89, v238
v_accvgpr_read_b32 v243, a90
v_ldexp_f32 v243, v243, v239
v_accvgpr_write_b32 a90, v243
v_accvgpr_read_b32 v238, a91
v_ldexp_f32 v238, v238, v239
v_accvgpr_write_b32 a91, v238
v_accvgpr_read_b32 v243, a104
v_ldexp_f32 v243, v243, v239
v_accvgpr_write_b32 a104, v243
v_accvgpr_read_b32 v238, a105
v_ldexp_f32 v238, v238, v239
v_accvgpr_write_b32 a105, v238
v_accvgpr_read_b32 v243, a106
v_ldexp_f32 v243, v243, v239
v_accvgpr_write_b32 a106, v243
v_accvgpr_read_b32 v238, a107
v_ldexp_f32 v238, v238, v239
v_accvgpr_write_b32 a107, v238
v_accvgpr_read_b32 v243, a120
v_ldexp_f32 v243, v243, v239
v_accvgpr_write_b32 a120, v243
v_accvgpr_read_b32 v238, a121
v_ldexp_f32 v238, v238, v239
v_accvgpr_write_b32 a121, v238
v_accvgpr_read_b32 v243, a122
v_ldexp_f32 v243, v243, v239
v_accvgpr_write_b32 a122, v243
v_accvgpr_read_b32 v238, a123
v_ldexp_f32 v238, v238, v239
v_accvgpr_write_b32 a123, v238
v_accvgpr_read_b32 v243, a136
v_ldexp_f32 v243, v243, v239
v_accvgpr_write_b32 a136, v243
v_accvgpr_read_b32 v238, a137
v_ldexp_f32 v238, v238, v239
v_accvgpr_write_b32 a137, v238
v_accvgpr_read_b32 v243, a138
v_ldexp_f32 v243, v243, v239
v_accvgpr_write_b32 a138, v243
v_accvgpr_read_b32 v238, a139
v_ldexp_f32 v238, v238, v239
v_accvgpr_write_b32 a139, v238
v_accvgpr_read_b32 v243, a152
v_ldexp_f32 v243, v243, v239
v_accvgpr_write_b32 a152, v243
v_accvgpr_read_b32 v238, a153
v_ldexp_f32 v238, v238, v239
v_accvgpr_write_b32 a153, v238
v_accvgpr_read_b32 v243, a154
v_ldexp_f32 v243, v243, v239
v_accvgpr_write_b32 a154, v243
v_accvgpr_read_b32 v238, a155
v_ldexp_f32 v238, v238, v239
v_accvgpr_write_b32 a155, v238
v_accvgpr_read_b32 v243, a168
v_ldexp_f32 v243, v243, v239
v_accvgpr_write_b32 a168, v243
v_accvgpr_read_b32 v238, a169
v_ldexp_f32 v238, v238, v239
v_accvgpr_write_b32 a169, v238
v_accvgpr_read_b32 v243, a170
v_ldexp_f32 v243, v243, v239
v_accvgpr_write_b32 a170, v243
v_accvgpr_read_b32 v238, a171
v_ldexp_f32 v238, v238, v239
v_accvgpr_write_b32 a171, v238
v_accvgpr_read_b32 v243, a184
v_ldexp_f32 v243, v243, v239
v_accvgpr_write_b32 a184, v243
v_accvgpr_read_b32 v238, a185
v_ldexp_f32 v238, v238, v239
v_accvgpr_write_b32 a185, v238
v_accvgpr_read_b32 v243, a186
v_ldexp_f32 v243, v243, v239
v_accvgpr_write_b32 a186, v243
v_accvgpr_read_b32 v238, a187
v_ldexp_f32 v238, v238, v239
v_accvgpr_write_b32 a187, v238
v_accvgpr_read_b32 v243, a200
v_ldexp_f32 v243, v243, v239
v_accvgpr_write_b32 a200, v243
v_accvgpr_read_b32 v238, a201
v_ldexp_f32 v238, v238, v239
v_accvgpr_write_b32 a201, v238
v_accvgpr_read_b32 v243, a202
v_ldexp_f32 v243, v243, v239
v_accvgpr_write_b32 a202, v243
v_accvgpr_read_b32 v238, a203
v_ldexp_f32 v238, v238, v239
v_accvgpr_write_b32 a203, v238
v_accvgpr_read_b32 v243, a216
v_ldexp_f32 v243, v243, v239
v_accvgpr_write_b32 a216, v243
v_accvgpr_read_b32 v238, a217
v_ldexp_f32 v238, v238, v239
v_accvgpr_write_b32 a217, v238
v_accvgpr_read_b32 v243, a218
v_ldexp_f32 v243, v243, v239
v_accvgpr_write_b32 a218, v243
v_accvgpr_read_b32 v238, a219
v_ldexp_f32 v238, v238, v239
v_accvgpr_write_b32 a219, v238
v_accvgpr_read_b32 v243, a232
v_ldexp_f32 v243, v243, v239
v_accvgpr_write_b32 a232, v243
v_accvgpr_read_b32 v238, a233
v_ldexp_f32 v238, v238, v239
v_accvgpr_write_b32 a233, v238
v_accvgpr_read_b32 v243, a234
v_ldexp_f32 v243, v243, v239
v_accvgpr_write_b32 a234, v243
v_accvgpr_read_b32 v238, a235
v_ldexp_f32 v238, v238, v239
v_accvgpr_write_b32 a235, v238
v_accvgpr_read_b32 v243, a248
v_ldexp_f32 v243, v243, v239
v_accvgpr_write_b32 a248, v243
v_accvgpr_read_b32 v238, a249
v_ldexp_f32 v238, v238, v239
v_accvgpr_write_b32 a249, v238
v_accvgpr_read_b32 v243, a250
v_ldexp_f32 v243, v243, v239
v_accvgpr_write_b32 a250, v243
v_accvgpr_read_b32 v238, a251
v_ldexp_f32 v238, v238, v239
v_accvgpr_write_b32 a251, v238
L_rare0_q2:
v_max3_f32 v243, v152, v153, v154
v_max3_f32 v243, v243, v155, v156
v_max3_f32 v243, v243, v157, v158
v_max_f32 v243, v243, v159
v_mov_b32 v238, v243
s_nop 1
v_permlane32_swap_b32 v243, v238
s_nop 1
v_max_f32 v243, v243, v238
v_mov_b32 v238, v243
s_nop 1
v_permlane16_swap_b32 v243, v238
s_nop 1
v_max_f32 v243, v243, v238
v_ceil_f32 v243, v243
v_max_f32 v243, 0, v243
v_sub_f32 v152, v152, v243
v_sub_f32 v153, v153, v243
v_sub_f32 v154, v154, v243
v_sub_f32 v155, v155, v243
v_sub_f32 v156, v156, v243
v_sub_f32 v157, v157, v243
v_sub_f32 v158, v158, v243
v_sub_f32 v159, v159, v243
v_sub_f32 v227, v227, v243
v_cvt_i32_f32 v239, -v243
v_ldexp_f32 v231, v231, v239
s_cmp_eq_u32 s63, 0
s_cbranch_scc1 L_rare0_q3
v_lshlrev_b32 v243, 16, v184
v_and_b32 v238, s81, v184
v_ldexp_f32 v243, v243, v239
v_ldexp_f32 v238, v238, v239
pk 184,243,238
v_lshlrev_b32 v243, 16, v185
v_and_b32 v238, s81, v185
v_ldexp_f32 v243, v243, v239
v_ldexp_f32 v238, v238, v239
pk 185,243,238
v_lshlrev_b32 v243, 16, v186
v_and_b32 v238, s81, v186
v_ldexp_f32 v243, v243, v239
v_ldexp_f32 v238, v238, v239
pk 186,243,238
v_lshlrev_b32 v243, 16, v187
v_and_b32 v238, s81, v187
v_ldexp_f32 v243, v243, v239
v_ldexp_f32 v238, v238, v239
pk 187,243,238
v_accvgpr_read_b32 v243, a12
v_ldexp_f32 v243, v243, v239
v_accvgpr_write_b32 a12, v243
v_accvgpr_read_b32 v238, a13
v_ldexp_f32 v238, v238, v239
v_accvgpr_write_b32 a13, v238
v_accvgpr_read_b32 v243, a14
v_ldexp_f32 v243, v243, v239
v_accvgpr_write_b32 a14, v243
v_accvgpr_read_b32 v238, a15
v_ldexp_f32 v238, v238, v239
v_accvgpr_write_b32 a15, v238
v_accvgpr_read_b32 v243, a28
v_ldexp_f32 v243, v243, v239
v_accvgpr_write_b32 a28, v243
v_accvgpr_read_b32 v238, a29
v_ldexp_f32 v238, v238, v239
v_accvgpr_write_b32 a29, v238
v_accvgpr_read_b32 v243, a30
v_ldexp_f32 v243, v243, v239
v_accvgpr_write_b32 a30, v243
v_accvgpr_read_b32 v238, a31
v_ldexp_f32 v238, v238, v239
v_accvgpr_write_b32 a31, v238
v_accvgpr_read_b32 v243, a44
v_ldexp_f32 v243, v243, v239
v_accvgpr_write_b32 a44, v243
v_accvgpr_read_b32 v238, a45
v_ldexp_f32 v238, v238, v239
v_accvgpr_write_b32 a45, v238
v_accvgpr_read_b32 v243, a46
v_ldexp_f32 v243, v243, v239
v_accvgpr_write_b32 a46, v243
v_accvgpr_read_b32 v238, a47
v_ldexp_f32 v238, v238, v239
v_accvgpr_write_b32 a47, v238
v_accvgpr_read_b32 v243, a60
v_ldexp_f32 v243, v243, v239
v_accvgpr_write_b32 a60, v243
v_accvgpr_read_b32 v238, a61
v_ldexp_f32 v238, v238, v239
v_accvgpr_write_b32 a61, v238
v_accvgpr_read_b32 v243, a62
v_ldexp_f32 v243, v243, v239
v_accvgpr_write_b32 a62, v243
v_accvgpr_read_b32 v238, a63
v_ldexp_f32 v238, v238, v239
v_accvgpr_write_b32 a63, v238
v_accvgpr_read_b32 v243, a76
v_ldexp_f32 v243, v243, v239
v_accvgpr_write_b32 a76, v243
v_accvgpr_read_b32 v238, a77
v_ldexp_f32 v238, v238, v239
v_accvgpr_write_b32 a77, v238
v_accvgpr_read_b32 v243, a78
v_ldexp_f32 v243, v243, v239
v_accvgpr_write_b32 a78, v243
v_accvgpr_read_b32 v238, a79
v_ldexp_f32 v238, v238, v239
v_accvgpr_write_b32 a79, v238
v_accvgpr_read_b32 v243, a92
v_ldexp_f32 v243, v243, v239
v_accvgpr_write_b32 a92, v243
v_accvgpr_read_b32 v238, a93
v_ldexp_f32 v238, v238, v239
v_accvgpr_write_b32 a93, v238
v_accvgpr_read_b32 v243, a94
v_ldexp_f32 v243, v243, v239
v_accvgpr_write_b32 a94, v243
v_accvgpr_read_b32 v238, a95
v_ldexp_f32 v238, v238, v239
v_accvgpr_write_b32 a95, v238
v_accvgpr_read_b32 v243, a108
v_ldexp_f32 v243, v243, v239
v_accvgpr_write_b32 a108, v243
v_accvgpr_read_b32 v238, a109
v_ldexp_f32 v238, v238, v239
v_accvgpr_write_b32 a109, v238
v_accvgpr_read_b32 v243, a110
v_ldexp_f32 v243, v243, v239
v_accvgpr_write_b32 a110, v243
v_accvgpr_read_b32 v238, a111
v_ldexp_f32 v238, v238, v239
v_accvgpr_write_b32 a111, v238
v_accvgpr_read_b32 v243, a124
v_ldexp_f32 v243, v243, v239
v_accvgpr_write_b32 a124, v243
v_accvgpr_read_b32 v238, a125
v_ldexp_f32 v238, v238, v239
v_accvgpr_write_b32 a125, v238
v_accvgpr_read_b32 v243, a126
v_ldexp_f32 v243, v243, v239
v_accvgpr_write_b32 a126, v243
v_accvgpr_read_b32 v238, a127
v_ldexp_f32 v238, v238, v239
v_accvgpr_write_b32 a127, v238
v_accvgpr_read_b32 v243, a140
v_ldexp_f32 v243, v243, v239
v_accvgpr_write_b32 a140, v243
v_accvgpr_read_b32 v238, a141
v_ldexp_f32 v238, v238, v239
v_accvgpr_write_b32 a141, v238
v_accvgpr_read_b32 v243, a142
v_ldexp_f32 v243, v243, v239
v_accvgpr_write_b32 a142, v243
v_accvgpr_read_b32 v238, a143
v_ldexp_f32 v238, v238, v239
v_accvgpr_write_b32 a143, v238
v_accvgpr_read_b32 v243, a156
v_ldexp_f32 v243, v243, v239
v_accvgpr_write_b32 a156, v243
v_accvgpr_read_b32 v238, a157
v_ldexp_f32 v238, v238, v239
v_accvgpr_write_b32 a157, v238
v_accvgpr_read_b32 v243, a158
v_ldexp_f32 v243, v243, v239
v_accvgpr_write_b32 a158, v243
v_accvgpr_read_b32 v238, a159
v_ldexp_f32 v238, v238, v239
v_accvgpr_write_b32 a159, v238
v_accvgpr_read_b32 v243, a172
v_ldexp_f32 v243, v243, v239
v_accvgpr_write_b32 a172, v243
v_accvgpr_read_b32 v238, a173
v_ldexp_f32 v238, v238, v239
v_accvgpr_write_b32 a173, v238
v_accvgpr_read_b32 v243, a174
v_ldexp_f32 v243, v243, v239
v_accvgpr_write_b32 a174, v243
v_accvgpr_read_b32 v238, a175
v_ldexp_f32 v238, v238, v239
v_accvgpr_write_b32 a175, v238
v_accvgpr_read_b32 v243, a188
v_ldexp_f32 v243, v243, v239
v_accvgpr_write_b32 a188, v243
v_accvgpr_read_b32 v238, a189
v_ldexp_f32 v238, v238, v239
v_accvgpr_write_b32 a189, v238
v_accvgpr_read_b32 v243, a190
v_ldexp_f32 v243, v243, v239
v_accvgpr_write_b32 a190, v243
v_accvgpr_read_b32 v238, a191
v_ldexp_f32 v238, v238, v239
v_accvgpr_write_b32 a191, v238
v_accvgpr_read_b32 v243, a204
v_ldexp_f32 v243, v243, v239
v_accvgpr_write_b32 a204, v243
v_accvgpr_read_b32 v238, a205
v_ldexp_f32 v238, v238, v239
v_accvgpr_write_b32 a205, v238
v_accvgpr_read_b32 v243, a206
v_ldexp_f32 v243, v243, v239
v_accvgpr_write_b32 a206, v243
v_accvgpr_read_b32 v238, a207
v_ldexp_f32 v238, v238, v239
v_accvgpr_write_b32 a207, v238
v_accvgpr_read_b32 v243, a220
v_ldexp_f32 v243, v243, v239
v_accvgpr_write_b32 a220, v243
v_accvgpr_read_b32 v238, a221
v_ldexp_f32 v238, v238, v239
v_accvgpr_write_b32 a221, v238
v_accvgpr_read_b32 v243, a222
v_ldexp_f32 v243, v243, v239
v_accvgpr_write_b32 a222, v243
v_accvgpr_read_b32 v238, a223
v_ldexp_f32 v238, v238, v239
v_accvgpr_write_b32 a223, v238
v_accvgpr_read_b32 v243, a236
v_ldexp_f32 v243, v243, v239
v_accvgpr_write_b32 a236, v243
v_accvgpr_read_b32 v238, a237
v_ldexp_f32 v238, v238, v239
v_accvgpr_write_b32 a237, v238
v_accvgpr_read_b32 v243, a238
v_ldexp_f32 v243, v243, v239
v_accvgpr_write_b32 a238, v243
v_accvgpr_read_b32 v238, a239
v_ldexp_f32 v238, v238, v239
v_accvgpr_write_b32 a239, v238
v_accvgpr_read_b32 v243, a252
v_ldexp_f32 v243, v243, v239
v_accvgpr_write_b32 a252, v243
v_accvgpr_read_b32 v238, a253
v_ldexp_f32 v238, v238, v239
v_accvgpr_write_b32 a253, v238
v_accvgpr_read_b32 v243, a254
v_ldexp_f32 v243, v243, v239
v_accvgpr_write_b32 a254, v243
v_accvgpr_read_b32 v238, a255
v_ldexp_f32 v238, v238, v239
v_accvgpr_write_b32 a255, v238
L_rare0_q3:
s_mov_b64 vcc, 0
s_nop 0
s_cmp_eq_u32 s63, 0
s_cbranch_scc1 L_ret0
s_cmp_eq_u32 s63, 2
s_cbranch_scc1 L_ret2
s_cmp_eq_u32 s63, 12
s_cbranch_scc1 L_ret12
s_cmp_eq_u32 s63, 14
s_cbranch_scc1 L_ret14
s_cmp_eq_u32 s63, 28
s_cbranch_scc1 L_ret28
s_branch L_ret30
L_rare1:
s_nop 7
v_max3_f32 v243, v160, v161, v162
v_max3_f32 v243, v243, v163, v164
v_max3_f32 v243, v243, v165, v166
v_max_f32 v243, v243, v167
v_mov_b32 v238, v243
s_nop 1
v_permlane32_swap_b32 v243, v238
s_nop 1
v_max_f32 v243, v243, v238
v_mov_b32 v238, v243
s_nop 1
v_permlane16_swap_b32 v243, v238
s_nop 1
v_max_f32 v243, v243, v238
v_ceil_f32 v243, v243
v_max_f32 v243, 0, v243
v_sub_f32 v160, v160, v243
v_sub_f32 v161, v161, v243
v_sub_f32 v162, v162, v243
v_sub_f32 v163, v163, v243
v_sub_f32 v164, v164, v243
v_sub_f32 v165, v165, v243
v_sub_f32 v166, v166, v243
v_sub_f32 v167, v167, v243
v_sub_f32 v224, v224, v243
v_cvt_i32_f32 v239, -v243
v_ldexp_f32 v228, v228, v239
v_lshlrev_b32 v243, 16, v128
v_and_b32 v238, s81, v128
v_ldexp_f32 v243, v243, v239
v_ldexp_f32 v238, v238, v239
pk 128,243,238
v_lshlrev_b32 v243, 16, v129
v_and_b32 v238, s81, v129
v_ldexp_f32 v243, v243, v239
v_ldexp_f32 v238, v238, v239
pk 129,243,238
v_lshlrev_b32 v243, 16, v130
v_and_b32 v238, s81, v130
v_ldexp_f32 v243, v243, v239
v_ldexp_f32 v238, v238, v239
pk 130,243,238
v_lshlrev_b32 v243, 16, v131
v_and_b32 v238, s81, v131
v_ldexp_f32 v243, v243, v239
v_ldexp_f32 v238, v238, v239
pk 131,243,238
v_accvgpr_read_b32 v243, a0
v_ldexp_f32 v243, v243, v239
v_accvgpr_write_b32 a0, v243
v_accvgpr_read_b32 v238, a1
v_ldexp_f32 v238, v238, v239
v_accvgpr_write_b32 a1, v238
v_accvgpr_read_b32 v243, a2
v_ldexp_f32 v243, v243, v239
v_accvgpr_write_b32 a2, v243
v_accvgpr_read_b32 v238, a3
v_ldexp_f32 v238, v238, v239
v_accvgpr_write_b32 a3, v238
v_accvgpr_read_b32 v243, a16
v_ldexp_f32 v243, v243, v239
v_accvgpr_write_b32 a16, v243
v_accvgpr_read_b32 v238, a17
v_ldexp_f32 v238, v238, v239
v_accvgpr_write_b32 a17, v238
v_accvgpr_read_b32 v243, a18
v_ldexp_f32 v243, v243, v239
v_accvgpr_write_b32 a18, v243
v_accvgpr_read_b32 v238, a19
v_ldexp_f32 v238, v238, v239
v_accvgpr_write_b32 a19, v238
v_accvgpr_read_b32 v243, a32
v_ldexp_f32 v243, v243, v239
v_accvgpr_write_b32 a32, v243
v_accvgpr_read_b32 v238, a33
v_ldexp_f32 v238, v238, v239
v_accvgpr_write_b32 a33, v238
v_accvgpr_read_b32 v243, a34
v_ldexp_f32 v243, v243, v239
v_accvgpr_write_b32 a34, v243
v_accvgpr_read_b32 v238, a35
v_ldexp_f32 v238, v238, v239
v_accvgpr_write_b32 a35, v238
v_accvgpr_read_b32 v243, a48
v_ldexp_f32 v243, v243, v239
v_accvgpr_write_b32 a48, v243
v_accvgpr_read_b32 v238, a49
v_ldexp_f32 v238, v238, v239
v_accvgpr_write_b32 a49, v238
v_accvgpr_read_b32 v243, a50
v_ldexp_f32 v243, v243, v239
v_accvgpr_write_b32 a50, v243
v_accvgpr_read_b32 v238, a51
v_ldexp_f32 v238, v238, v239
v_accvgpr_write_b32 a51, v238
v_accvgpr_read_b32 v243, a64
v_ldexp_f32 v243, v243, v239
v_accvgpr_write_b32 a64, v243
v_accvgpr_read_b32 v238, a65
v_ldexp_f32 v238, v238, v239
v_accvgpr_write_b32 a65, v238
v_accvgpr_read_b32 v243, a66
v_ldexp_f32 v243, v243, v239
v_accvgpr_write_b32 a66, v243
v_accvgpr_read_b32 v238, a67
v_ldexp_f32 v238, v238, v239
v_accvgpr_write_b32 a67, v238
v_accvgpr_read_b32 v243, a80
v_ldexp_f32 v243, v243, v239
v_accvgpr_write_b32 a80, v243
v_accvgpr_read_b32 v238, a81
v_ldexp_f32 v238, v238, v239
v_accvgpr_write_b32 a81, v238
v_accvgpr_read_b32 v243, a82
v_ldexp_f32 v243, v243, v239
v_accvgpr_write_b32 a82, v243
v_accvgpr_read_b32 v238, a83
v_ldexp_f32 v238, v238, v239
v_accvgpr_write_b32 a83, v238
v_accvgpr_read_b32 v243, a96
v_ldexp_f32 v243, v243, v239
v_accvgpr_write_b32 a96, v243
v_accvgpr_read_b32 v238, a97
v_ldexp_f32 v238, v238, v239
v_accvgpr_write_b32 a97, v238
v_accvgpr_read_b32 v243, a98
v_ldexp_f32 v243, v243, v239
v_accvgpr_write_b32 a98, v243
v_accvgpr_read_b32 v238, a99
v_ldexp_f32 v238, v238, v239
v_accvgpr_write_b32 a99, v238
v_accvgpr_read_b32 v243, a112
v_ldexp_f32 v243, v243, v239
v_accvgpr_write_b32 a112, v243
v_accvgpr_read_b32 v238, a113
v_ldexp_f32 v238, v238, v239
v_accvgpr_write_b32 a113, v238
v_accvgpr_read_b32 v243, a114
v_ldexp_f32 v243, v243, v239
v_accvgpr_write_b32 a114, v243
v_accvgpr_read_b32 v238, a115
v_ldexp_f32 v238, v238, v239
v_accvgpr_write_b32 a115, v238
v_accvgpr_read_b32 v243, a128
v_ldexp_f32 v243, v243, v239
v_accvgpr_write_b32 a128, v243
v_accvgpr_read_b32 v238, a129
v_ldexp_f32 v238, v238, v239
v_accvgpr_write_b32 a129, v238
v_accvgpr_read_b32 v243, a130
v_ldexp_f32 v243, v243, v239
v_accvgpr_write_b32 a130, v243
v_accvgpr_read_b32 v238, a131
v_ldexp_f32 v238, v238, v239
v_accvgpr_write_b32 a131, v238
v_accvgpr_read_b32 v243, a144
v_ldexp_f32 v243, v243, v239
v_accvgpr_write_b32 a144, v243
v_accvgpr_read_b32 v238, a145
v_ldexp_f32 v238, v238, v239
v_accvgpr_write_b32 a145, v238
v_accvgpr_read_b32 v243, a146
v_ldexp_f32 v243, v243, v239
v_accvgpr_write_b32 a146, v243
v_accvgpr_read_b32 v238, a147
v_ldexp_f32 v238, v238, v239
v_accvgpr_write_b32 a147, v238
v_accvgpr_read_b32 v243, a160
v_ldexp_f32 v243, v243, v239
v_accvgpr_write_b32 a160, v243
v_accvgpr_read_b32 v238, a161
v_ldexp_f32 v238, v238, v239
v_accvgpr_write_b32 a161, v238
v_accvgpr_read_b32 v243, a162
v_ldexp_f32 v243, v243, v239
v_accvgpr_write_b32 a162, v243
v_accvgpr_read_b32 v238, a163
v_ldexp_f32 v238, v238, v239
v_accvgpr_write_b32 a163, v238
v_accvgpr_read_b32 v243, a176
v_ldexp_f32 v243, v243, v239
v_accvgpr_write_b32 a176, v243
v_accvgpr_read_b32 v238, a177
v_ldexp_f32 v238, v238, v239
v_accvgpr_write_b32 a177, v238
v_accvgpr_read_b32 v243, a178
v_ldexp_f32 v243, v243, v239
v_accvgpr_write_b32 a178, v243
v_accvgpr_read_b32 v238, a179
v_ldexp_f32 v238, v238, v239
v_accvgpr_write_b32 a179, v238
v_accvgpr_read_b32 v243, a192
v_ldexp_f32 v243, v243, v239
v_accvgpr_write_b32 a192, v243
v_accvgpr_read_b32 v238, a193
v_ldexp_f32 v238, v238, v239
v_accvgpr_write_b32 a193, v238
v_accvgpr_read_b32 v243, a194
v_ldexp_f32 v243, v243, v239
v_accvgpr_write_b32 a194, v243
v_accvgpr_read_b32 v238, a195
v_ldexp_f32 v238, v238, v239
v_accvgpr_write_b32 a195, v238
v_accvgpr_read_b32 v243, a208
v_ldexp_f32 v243, v243, v239
v_accvgpr_write_b32 a208, v243
v_accvgpr_read_b32 v238, a209
v_ldexp_f32 v238, v238, v239
v_accvgpr_write_b32 a209, v238
v_accvgpr_read_b32 v243, a210
v_ldexp_f32 v243, v243, v239
v_accvgpr_write_b32 a210, v243
v_accvgpr_read_b32 v238, a211
v_ldexp_f32 v238, v238, v239
v_accvgpr_write_b32 a211, v238
v_accvgpr_read_b32 v243, a224
v_ldexp_f32 v243, v243, v239
v_accvgpr_write_b32 a224, v243
v_accvgpr_read_b32 v238, a225
v_ldexp_f32 v238, v238, v239
v_accvgpr_write_b32 a225, v238
v_accvgpr_read_b32 v243, a226
v_ldexp_f32 v243, v243, v239
v_accvgpr_write_b32 a226, v243
v_accvgpr_read_b32 v238, a227
v_ldexp_f32 v238, v238, v239
v_accvgpr_write_b32 a227, v238
v_accvgpr_read_b32 v243, a240
v_ldexp_f32 v243, v243, v239
v_accvgpr_write_b32 a240, v243
v_accvgpr_read_b32 v238, a241
v_ldexp_f32 v238, v238, v239
v_accvgpr_write_b32 a241, v238
v_accvgpr_read_b32 v243, a242
v_ldexp_f32 v243, v243, v239
v_accvgpr_write_b32 a242, v243
v_accvgpr_read_b32 v238, a243
v_ldexp_f32 v238, v238, v239
v_accvgpr_write_b32 a243, v238
v_max3_f32 v243, v168, v169, v170
v_max3_f32 v243, v243, v171, v172
v_max3_f32 v243, v243, v173, v174
v_max_f32 v243, v243, v175
v_mov_b32 v238, v243
s_nop 1
v_permlane32_swap_b32 v243, v238
s_nop 1
v_max_f32 v243, v243, v238
v_mov_b32 v238, v243
s_nop 1
v_permlane16_swap_b32 v243, v238
s_nop 1
v_max_f32 v243, v243, v238
v_ceil_f32 v243, v243
v_max_f32 v243, 0, v243
v_sub_f32 v168, v168, v243
v_sub_f32 v169, v169, v243
v_sub_f32 v170, v170, v243
v_sub_f32 v171, v171, v243
v_sub_f32 v172, v172, v243
v_sub_f32 v173, v173, v243
v_sub_f32 v174, v174, v243
v_sub_f32 v175, v175, v243
v_sub_f32 v225, v225, v243
v_cvt_i32_f32 v239, -v243
v_ldexp_f32 v229, v229, v239
v_lshlrev_b32 v243, 16, v136
v_and_b32 v238, s81, v136
v_ldexp_f32 v243, v243, v239
v_ldexp_f32 v238, v238, v239
pk 136,243,238
v_lshlrev_b32 v243, 16, v137
v_and_b32 v238, s81, v137
v_ldexp_f32 v243, v243, v239
v_ldexp_f32 v238, v238, v239
pk 137,243,238
v_lshlrev_b32 v243, 16, v138
v_and_b32 v238, s81, v138
v_ldexp_f32 v243, v243, v239
v_ldexp_f32 v238, v238, v239
pk 138,243,238
v_lshlrev_b32 v243, 16, v139
v_and_b32 v238, s81, v139
v_ldexp_f32 v243, v243, v239
v_ldexp_f32 v238, v238, v239
pk 139,243,238
v_accvgpr_read_b32 v243, a4
v_ldexp_f32 v243, v243, v239
v_accvgpr_write_b32 a4, v243
v_accvgpr_read_b32 v238, a5
v_ldexp_f32 v238, v238, v239
v_accvgpr_write_b32 a5, v238
v_accvgpr_read_b32 v243, a6
v_ldexp_f32 v243, v243, v239
v_accvgpr_write_b32 a6, v243
v_accvgpr_read_b32 v238, a7
v_ldexp_f32 v238, v238, v239
v_accvgpr_write_b32 a7, v238
v_accvgpr_read_b32 v243, a20
v_ldexp_f32 v243, v243, v239
v_accvgpr_write_b32 a20, v243
v_accvgpr_read_b32 v238, a21
v_ldexp_f32 v238, v238, v239
v_accvgpr_write_b32 a21, v238
v_accvgpr_read_b32 v243, a22
v_ldexp_f32 v243, v243, v239
v_accvgpr_write_b32 a22, v243
v_accvgpr_read_b32 v238, a23
v_ldexp_f32 v238, v238, v239
v_accvgpr_write_b32 a23, v238
v_accvgpr_read_b32 v243, a36
v_ldexp_f32 v243, v243, v239
v_accvgpr_write_b32 a36, v243
v_accvgpr_read_b32 v238, a37
v_ldexp_f32 v238, v238, v239
v_accvgpr_write_b32 a37, v238
v_accvgpr_read_b32 v243, a38
v_ldexp_f32 v243, v243, v239
v_accvgpr_write_b32 a38, v243
v_accvgpr_read_b32 v238, a39
v_ldexp_f32 v238, v238, v239
v_accvgpr_write_b32 a39, v238
v_accvgpr_read_b32 v243, a52
v_ldexp_f32 v243, v243, v239
v_accvgpr_write_b32 a52, v243
v_accvgpr_read_b32 v238, a53
v_ldexp_f32 v238, v238, v239
v_accvgpr_write_b32 a53, v238
v_accvgpr_read_b32 v243, a54
v_ldexp_f32 v243, v243, v239
v_accvgpr_write_b32 a54, v243
v_accvgpr_read_b32 v238, a55
v_ldexp_f32 v238, v238, v239
v_accvgpr_write_b32 a55, v238
v_accvgpr_read_b32 v243, a68
v_ldexp_f32 v243, v243, v239
v_accvgpr_write_b32 a68, v243
v_accvgpr_read_b32 v238, a69
v_ldexp_f32 v238, v238, v239
v_accvgpr_write_b32 a69, v238
v_accvgpr_read_b32 v243, a70
v_ldexp_f32 v243, v243, v239
v_accvgpr_write_b32 a70, v243
v_accvgpr_read_b32 v238, a71
v_ldexp_f32 v238, v238, v239
v_accvgpr_write_b32 a71, v238
v_accvgpr_read_b32 v243, a84
v_ldexp_f32 v243, v243, v239
v_accvgpr_write_b32 a84, v243
v_accvgpr_read_b32 v238, a85
v_ldexp_f32 v238, v238, v239
v_accvgpr_write_b32 a85, v238
v_accvgpr_read_b32 v243, a86
v_ldexp_f32 v243, v243, v239
v_accvgpr_write_b32 a86, v243
v_accvgpr_read_b32 v238, a87
v_ldexp_f32 v238, v238, v239
v_accvgpr_write_b32 a87, v238
v_accvgpr_read_b32 v243, a100
v_ldexp_f32 v243, v243, v239
v_accvgpr_write_b32 a100, v243
v_accvgpr_read_b32 v238, a101
v_ldexp_f32 v238, v238, v239
v_accvgpr_write_b32 a101, v238
v_accvgpr_read_b32 v243, a102
v_ldexp_f32 v243, v243, v239
v_accvgpr_write_b32 a102, v243
v_accvgpr_read_b32 v238, a103
v_ldexp_f32 v238, v238, v239
v_accvgpr_write_b32 a103, v238
v_accvgpr_read_b32 v243, a116
v_ldexp_f32 v243, v243, v239
v_accvgpr_write_b32 a116, v243
v_accvgpr_read_b32 v238, a117
v_ldexp_f32 v238, v238, v239
v_accvgpr_write_b32 a117, v238
v_accvgpr_read_b32 v243, a118
v_ldexp_f32 v243, v243, v239
v_accvgpr_write_b32 a118, v243
v_accvgpr_read_b32 v238, a119
v_ldexp_f32 v238, v238, v239
v_accvgpr_write_b32 a119, v238
v_accvgpr_read_b32 v243, a132
v_ldexp_f32 v243, v243, v239
v_accvgpr_write_b32 a132, v243
v_accvgpr_read_b32 v238, a133
v_ldexp_f32 v238, v238, v239
v_accvgpr_write_b32 a133, v238
v_accvgpr_read_b32 v243, a134
v_ldexp_f32 v243, v243, v239
v_accvgpr_write_b32 a134, v243
v_accvgpr_read_b32 v238, a135
v_ldexp_f32 v238, v238, v239
v_accvgpr_write_b32 a135, v238
v_accvgpr_read_b32 v243, a148
v_ldexp_f32 v243, v243, v239
v_accvgpr_write_b32 a148, v243
v_accvgpr_read_b32 v238, a149
v_ldexp_f32 v238, v238, v239
v_accvgpr_write_b32 a149, v238
v_accvgpr_read_b32 v243, a150
v_ldexp_f32 v243, v243, v239
v_accvgpr_write_b32 a150, v243
v_accvgpr_read_b32 v238, a151
v_ldexp_f32 v238, v238, v239
v_accvgpr_write_b32 a151, v238
v_accvgpr_read_b32 v243, a164
v_ldexp_f32 v243, v243, v239
v_accvgpr_write_b32 a164, v243
v_accvgpr_read_b32 v238, a165
v_ldexp_f32 v238, v238, v239
v_accvgpr_write_b32 a165, v238
v_accvgpr_read_b32 v243, a166
v_ldexp_f32 v243, v243, v239
v_accvgpr_write_b32 a166, v243
v_accvgpr_read_b32 v238, a167
v_ldexp_f32 v238, v238, v239
v_accvgpr_write_b32 a167, v238
v_accvgpr_read_b32 v243, a180
v_ldexp_f32 v243, v243, v239
v_accvgpr_write_b32 a180, v243
v_accvgpr_read_b32 v238, a181
v_ldexp_f32 v238, v238, v239
v_accvgpr_write_b32 a181, v238
v_accvgpr_read_b32 v243, a182
v_ldexp_f32 v243, v243, v239
v_accvgpr_write_b32 a182, v243
v_accvgpr_read_b32 v238, a183
v_ldexp_f32 v238, v238, v239
v_accvgpr_write_b32 a183, v238
v_accvgpr_read_b32 v243, a196
v_ldexp_f32 v243, v243, v239
v_accvgpr_write_b32 a196, v243
v_accvgpr_read_b32 v238, a197
v_ldexp_f32 v238, v238, v239
v_accvgpr_write_b32 a197, v238
v_accvgpr_read_b32 v243, a198
v_ldexp_f32 v243, v243, v239
v_accvgpr_write_b32 a198, v243
v_accvgpr_read_b32 v238, a199
v_ldexp_f32 v238, v238, v239
v_accvgpr_write_b32 a199, v238
v_accvgpr_read_b32 v243, a212
v_ldexp_f32 v243, v243, v239
v_accvgpr_write_b32 a212, v243
v_accvgpr_read_b32 v238, a213
v_ldexp_f32 v238, v238, v239
v_accvgpr_write_b32 a213, v238
v_accvgpr_read_b32 v243, a214
v_ldexp_f32 v243, v243, v239
v_accvgpr_write_b32 a214, v243
v_accvgpr_read_b32 v238, a215
v_ldexp_f32 v238, v238, v239
v_accvgpr_write_b32 a215, v238
v_accvgpr_read_b32 v243, a228
v_ldexp_f32 v243, v243, v239
v_accvgpr_write_b32 a228, v243
v_accvgpr_read_b32 v238, a229
v_ldexp_f32 v238, v238, v239
v_accvgpr_write_b32 a229, v238
v_accvgpr_read_b32 v243, a230
v_ldexp_f32 v243, v243, v239
v_accvgpr_write_b32 a230, v243
v_accvgpr_read_b32 v238, a231
v_ldexp_f32 v238, v238, v239
v_accvgpr_write_b32 a231, v238
v_accvgpr_read_b32 v243, a244
v_ldexp_f32 v243, v243, v239
v_accvgpr_write_b32 a244, v243
v_accvgpr_read_b32 v238, a245
v_ldexp_f32 v238, v238, v239
v_accvgpr_write_b32 a245, v238
v_accvgpr_read_b32 v243, a246
v_ldexp_f32 v243, v243, v239
v_accvgpr_write_b32 a246, v243
v_accvgpr_read_b32 v238, a247
v_ldexp_f32 v238, v238, v239
v_accvgpr_write_b32 a247, v238
v_max3_f32 v243, v176, v177, v178
v_max3_f32 v243, v243, v179, v180
v_max3_f32 v243, v243, v181, v182
v_max_f32 v243, v243, v183
v_mov_b32 v238, v243
s_nop 1
v_permlane32_swap_b32 v243, v238
s_nop 1
v_max_f32 v243, v243, v238
v_mov_b32 v238, v243
s_nop 1
v_permlane16_swap_b32 v243, v238
s_nop 1
v_max_f32 v243, v243, v238
v_ceil_f32 v243, v243
v_max_f32 v243, 0, v243
v_sub_f32 v176, v176, v243
v_sub_f32 v177, v177, v243
v_sub_f32 v178, v178, v243
v_sub_f32 v179, v179, v243
v_sub_f32 v180, v180, v243
v_sub_f32 v181, v181, v243
v_sub_f32 v182, v182, v243
v_sub_f32 v183, v183, v243
v_sub_f32 v226, v226, v243
v_cvt_i32_f32 v239, -v243
v_ldexp_f32 v230, v230, v239
v_lshlrev_b32 v243, 16, v144
v_and_b32 v238, s81, v144
v_ldexp_f32 v243, v243, v239
v_ldexp_f32 v238, v238, v239
pk 144,243,238
v_lshlrev_b32 v243, 16, v145
v_and_b32 v238, s81, v145
v_ldexp_f32 v243, v243, v239
v_ldexp_f32 v238, v238, v239
pk 145,243,238
v_lshlrev_b32 v243, 16, v146
v_and_b32 v238, s81, v146
v_ldexp_f32 v243, v243, v239
v_ldexp_f32 v238, v238, v239
pk 146,243,238
v_lshlrev_b32 v243, 16, v147
v_and_b32 v238, s81, v147
v_ldexp_f32 v243, v243, v239
v_ldexp_f32 v238, v238, v239
pk 147,243,238
v_accvgpr_read_b32 v243, a8
v_ldexp_f32 v243, v243, v239
v_accvgpr_write_b32 a8, v243
v_accvgpr_read_b32 v238, a9
v_ldexp_f32 v238, v238, v239
v_accvgpr_write_b32 a9, v238
v_accvgpr_read_b32 v243, a10
v_ldexp_f32 v243, v243, v239
v_accvgpr_write_b32 a10, v243
v_accvgpr_read_b32 v238, a11
v_ldexp_f32 v238, v238, v239
v_accvgpr_write_b32 a11, v238
v_accvgpr_read_b32 v243, a24
v_ldexp_f32 v243, v243, v239
v_accvgpr_write_b32 a24, v243
v_accvgpr_read_b32 v238, a25
v_ldexp_f32 v238, v238, v239
v_accvgpr_write_b32 a25, v238
v_accvgpr_read_b32 v243, a26
v_ldexp_f32 v243, v243, v239
v_accvgpr_write_b32 a26, v243
v_accvgpr_read_b32 v238, a27
v_ldexp_f32 v238, v238, v239
v_accvgpr_write_b32 a27, v238
v_accvgpr_read_b32 v243, a40
v_ldexp_f32 v243, v243, v239
v_accvgpr_write_b32 a40, v243
v_accvgpr_read_b32 v238, a41
v_ldexp_f32 v238, v238, v239
v_accvgpr_write_b32 a41, v238
v_accvgpr_read_b32 v243, a42
v_ldexp_f32 v243, v243, v239
v_accvgpr_write_b32 a42, v243
v_accvgpr_read_b32 v238, a43
v_ldexp_f32 v238, v238, v239
v_accvgpr_write_b32 a43, v238
v_accvgpr_read_b32 v243, a56
v_ldexp_f32 v243, v243, v239
v_accvgpr_write_b32 a56, v243
v_accvgpr_read_b32 v238, a57
v_ldexp_f32 v238, v238, v239
v_accvgpr_write_b32 a57, v238
v_accvgpr_read_b32 v243, a58
v_ldexp_f32 v243, v243, v239
v_accvgpr_write_b32 a58, v243
v_accvgpr_read_b32 v238, a59
v_ldexp_f32 v238, v238, v239
v_accvgpr_write_b32 a59, v238
v_accvgpr_read_b32 v243, a72
v_ldexp_f32 v243, v243, v239
v_accvgpr_write_b32 a72, v243
v_accvgpr_read_b32 v238, a73
v_ldexp_f32 v238, v238, v239
v_accvgpr_write_b32 a73, v238
v_accvgpr_read_b32 v243, a74
v_ldexp_f32 v243, v243, v239
v_accvgpr_write_b32 a74, v243
v_accvgpr_read_b32 v238, a75
v_ldexp_f32 v238, v238, v239
v_accvgpr_write_b32 a75, v238
v_accvgpr_read_b32 v243, a88
v_ldexp_f32 v243, v243, v239
v_accvgpr_write_b32 a88, v243
v_accvgpr_read_b32 v238, a89
v_ldexp_f32 v238, v238, v239
v_accvgpr_write_b32 a89, v238
v_accvgpr_read_b32 v243, a90
v_ldexp_f32 v243, v243, v239
v_accvgpr_write_b32 a90, v243
v_accvgpr_read_b32 v238, a91
v_ldexp_f32 v238, v238, v239
v_accvgpr_write_b32 a91, v238
v_accvgpr_read_b32 v243, a104
v_ldexp_f32 v243, v243, v239
v_accvgpr_write_b32 a104, v243
v_accvgpr_read_b32 v238, a105
v_ldexp_f32 v238, v238, v239
v_accvgpr_write_b32 a105, v238
v_accvgpr_read_b32 v243, a106
v_ldexp_f32 v243, v243, v239
v_accvgpr_write_b32 a106, v243
v_accvgpr_read_b32 v238, a107
v_ldexp_f32 v238, v238, v239
v_accvgpr_write_b32 a107, v238
v_accvgpr_read_b32 v243, a120
v_ldexp_f32 v243, v243, v239
v_accvgpr_write_b32 a120, v243
v_accvgpr_read_b32 v238, a121
v_ldexp_f32 v238, v238, v239
v_accvgpr_write_b32 a121, v238
v_accvgpr_read_b32 v243, a122
v_ldexp_f32 v243, v243, v239
v_accvgpr_write_b32 a122, v243
v_accvgpr_read_b32 v238, a123
v_ldexp_f32 v238, v238, v239
v_accvgpr_write_b32 a123, v238
v_accvgpr_read_b32 v243, a136
v_ldexp_f32 v243, v243, v239
v_accvgpr_write_b32 a136, v243
v_accvgpr_read_b32 v238, a137
v_ldexp_f32 v238, v238, v239
v_accvgpr_write_b32 a137, v238
v_accvgpr_read_b32 v243, a138
v_ldexp_f32 v243, v243, v239
v_accvgpr_write_b32 a138, v243
v_accvgpr_read_b32 v238, a139
v_ldexp_f32 v238, v238, v239
v_accvgpr_write_b32 a139, v238
v_accvgpr_read_b32 v243, a152
v_ldexp_f32 v243, v243, v239
v_accvgpr_write_b32 a152, v243
v_accvgpr_read_b32 v238, a153
v_ldexp_f32 v238, v238, v239
v_accvgpr_write_b32 a153, v238
v_accvgpr_read_b32 v243, a154
v_ldexp_f32 v243, v243, v239
v_accvgpr_write_b32 a154, v243
v_accvgpr_read_b32 v238, a155
v_ldexp_f32 v238, v238, v239
v_accvgpr_write_b32 a155, v238
v_accvgpr_read_b32 v243, a168
v_ldexp_f32 v243, v243, v239
v_accvgpr_write_b32 a168, v243
v_accvgpr_read_b32 v238, a169
v_ldexp_f32 v238, v238, v239
v_accvgpr_write_b32 a169, v238
v_accvgpr_read_b32 v243, a170
v_ldexp_f32 v243, v243, v239
v_accvgpr_write_b32 a170, v243
v_accvgpr_read_b32 v238, a171
v_ldexp_f32 v238, v238, v239
v_accvgpr_write_b32 a171, v238
v_accvgpr_read_b32 v243, a184
v_ldexp_f32 v243, v243, v239
v_accvgpr_write_b32 a184, v243
v_accvgpr_read_b32 v238, a185
v_ldexp_f32 v238, v238, v239
v_accvgpr_write_b32 a185, v238
v_accvgpr_read_b32 v243, a186
v_ldexp_f32 v243, v243, v239
v_accvgpr_write_b32 a186, v243
v_accvgpr_read_b32 v238, a187
v_ldexp_f32 v238, v238, v239
v_accvgpr_write_b32 a187, v238
v_accvgpr_read_b32 v243, a200
v_ldexp_f32 v243, v243, v239
v_accvgpr_write_b32 a200, v243
v_accvgpr_read_b32 v238, a201
v_ldexp_f32 v238, v238, v239
v_accvgpr_write_b32 a201, v238
v_accvgpr_read_b32 v243, a202
v_ldexp_f32 v243, v243, v239
v_accvgpr_write_b32 a202, v243
v_accvgpr_read_b32 v238, a203
v_ldexp_f32 v238, v238, v239
v_accvgpr_write_b32 a203, v238
v_accvgpr_read_b32 v243, a216
v_ldexp_f32 v243, v243, v239
v_accvgpr_write_b32 a216, v243
v_accvgpr_read_b32 v238, a217
v_ldexp_f32 v238, v238, v239
v_accvgpr_write_b32 a217, v238
v_accvgpr_read_b32 v243, a218
v_ldexp_f32 v243, v243, v239
v_accvgpr_write_b32 a218, v243
v_accvgpr_read_b32 v238, a219
v_ldexp_f32 v238, v238, v239
v_accvgpr_write_b32 a219, v238
v_accvgpr_read_b32 v243, a232
v_ldexp_f32 v243, v243, v239
v_accvgpr_write_b32 a232, v243
v_accvgpr_read_b32 v238, a233
v_ldexp_f32 v238, v238, v239
v_accvgpr_write_b32 a233, v238
v_accvgpr_read_b32 v243, a234
v_ldexp_f32 v243, v243, v239
v_accvgpr_write_b32 a234, v243
v_accvgpr_read_b32 v238, a235
v_ldexp_f32 v238, v238, v239
v_accvgpr_write_b32 a235, v238
v_accvgpr_read_b32 v243, a248
v_ldexp_f32 v243, v243, v239
v_accvgpr_write_b32 a248, v243
v_accvgpr_read_b32 v238, a249
v_ldexp_f32 v238, v238, v239
v_accvgpr_write_b32 a249, v238
v_accvgpr_read_b32 v243, a250
v_ldexp_f32 v243, v243, v239
v_accvgpr_write_b32 a250, v243
v_accvgpr_read_b32 v238, a251
v_ldexp_f32 v238, v238, v239
v_accvgpr_write_b32 a251, v238
v_max3_f32 v243, v184, v185, v186
v_max3_f32 v243, v243, v187, v188
v_max3_f32 v243, v243, v189, v190
v_max_f32 v243, v243, v191
v_mov_b32 v238, v243
s_nop 1
v_permlane32_swap_b32 v243, v238
s_nop 1
v_max_f32 v243, v243, v238
v_mov_b32 v238, v243
s_nop 1
v_permlane16_swap_b32 v243, v238
s_nop 1
v_max_f32 v243, v243, v238
v_ceil_f32 v243, v243
v_max_f32 v243, 0, v243
v_sub_f32 v184, v184, v243
v_sub_f32 v185, v185, v243
v_sub_f32 v186, v186, v243
v_sub_f32 v187, v187, v243
v_sub_f32 v188, v188, v243
v_sub_f32 v189, v189, v243
v_sub_f32 v190, v190, v243
v_sub_f32 v191, v191, v243
v_sub_f32 v227, v227, v243
v_cvt_i32_f32 v239, -v243
v_ldexp_f32 v231, v231, v239
v_lshlrev_b32 v243, 16, v152
v_and_b32 v238, s81, v152
v_ldexp_f32 v243, v243, v239
v_ldexp_f32 v238, v238, v239
pk 152,243,238
v_lshlrev_b32 v243, 16, v153
v_and_b32 v238, s81, v153
v_ldexp_f32 v243, v243, v239
v_ldexp_f32 v238, v238, v239
pk 153,243,238
v_lshlrev_b32 v243, 16, v154
v_and_b32 v238, s81, v154
v_ldexp_f32 v243, v243, v239
v_ldexp_f32 v238, v238, v239
pk 154,243,238
v_lshlrev_b32 v243, 16, v155
v_and_b32 v238, s81, v155
v_ldexp_f32 v243, v243, v239
v_ldexp_f32 v238, v238, v239
pk 155,243,238
v_accvgpr_read_b32 v243, a12
v_ldexp_f32 v243, v243, v239
v_accvgpr_write_b32 a12, v243
v_accvgpr_read_b32 v238, a13
v_ldexp_f32 v238, v238, v239
v_accvgpr_write_b32 a13, v238
v_accvgpr_read_b32 v243, a14
v_ldexp_f32 v243, v243, v239
v_accvgpr_write_b32 a14, v243
v_accvgpr_read_b32 v238, a15
v_ldexp_f32 v238, v238, v239
v_accvgpr_write_b32 a15, v238
v_accvgpr_read_b32 v243, a28
v_ldexp_f32 v243, v243, v239
v_accvgpr_write_b32 a28, v243
v_accvgpr_read_b32 v238, a29
v_ldexp_f32 v238, v238, v239
v_accvgpr_write_b32 a29, v238
v_accvgpr_read_b32 v243, a30
v_ldexp_f32 v243, v243, v239
v_accvgpr_write_b32 a30, v243
v_accvgpr_read_b32 v238, a31
v_ldexp_f32 v238, v238, v239
v_accvgpr_write_b32 a31, v238
v_accvgpr_read_b32 v243, a44
v_ldexp_f32 v243, v243, v239
v_accvgpr_write_b32 a44, v243
v_accvgpr_read_b32 v238, a45
v_ldexp_f32 v238, v238, v239
v_accvgpr_write_b32 a45, v238
v_accvgpr_read_b32 v243, a46
v_ldexp_f32 v243, v243, v239
v_accvgpr_write_b32 a46, v243
v_accvgpr_read_b32 v238, a47
v_ldexp_f32 v238, v238, v239
v_accvgpr_write_b32 a47, v238
v_accvgpr_read_b32 v243, a60
v_ldexp_f32 v243, v243, v239
v_accvgpr_write_b32 a60, v243
v_accvgpr_read_b32 v238, a61
v_ldexp_f32 v238, v238, v239
v_accvgpr_write_b32 a61, v238
v_accvgpr_read_b32 v243, a62
v_ldexp_f32 v243, v243, v239
v_accvgpr_write_b32 a62, v243
v_accvgpr_read_b32 v238, a63
v_ldexp_f32 v238, v238, v239
v_accvgpr_write_b32 a63, v238
v_accvgpr_read_b32 v243, a76
v_ldexp_f32 v243, v243, v239
v_accvgpr_write_b32 a76, v243
v_accvgpr_read_b32 v238, a77
v_ldexp_f32 v238, v238, v239
v_accvgpr_write_b32 a77, v238
v_accvgpr_read_b32 v243, a78
v_ldexp_f32 v243, v243, v239
v_accvgpr_write_b32 a78, v243
v_accvgpr_read_b32 v238, a79
v_ldexp_f32 v238, v238, v239
v_accvgpr_write_b32 a79, v238
v_accvgpr_read_b32 v243, a92
v_ldexp_f32 v243, v243, v239
v_accvgpr_write_b32 a92, v243
v_accvgpr_read_b32 v238, a93
v_ldexp_f32 v238, v238, v239
v_accvgpr_write_b32 a93, v238
v_accvgpr_read_b32 v243, a94
v_ldexp_f32 v243, v243, v239
v_accvgpr_write_b32 a94, v243
v_accvgpr_read_b32 v238, a95
v_ldexp_f32 v238, v238, v239
v_accvgpr_write_b32 a95, v238
v_accvgpr_read_b32 v243, a108
v_ldexp_f32 v243, v243, v239
v_accvgpr_write_b32 a108, v243
v_accvgpr_read_b32 v238, a109
v_ldexp_f32 v238, v238, v239
v_accvgpr_write_b32 a109, v238
v_accvgpr_read_b32 v243, a110
v_ldexp_f32 v243, v243, v239
v_accvgpr_write_b32 a110, v243
v_accvgpr_read_b32 v238, a111
v_ldexp_f32 v238, v238, v239
v_accvgpr_write_b32 a111, v238
v_accvgpr_read_b32 v243, a124
v_ldexp_f32 v243, v243, v239
v_accvgpr_write_b32 a124, v243
v_accvgpr_read_b32 v238, a125
v_ldexp_f32 v238, v238, v239
v_accvgpr_write_b32 a125, v238
v_accvgpr_read_b32 v243, a126
v_ldexp_f32 v243, v243, v239
v_accvgpr_write_b32 a126, v243
v_accvgpr_read_b32 v238, a127
v_ldexp_f32 v238, v238, v239
v_accvgpr_write_b32 a127, v238
v_accvgpr_read_b32 v243, a140
v_ldexp_f32 v243, v243, v239
v_accvgpr_write_b32 a140, v243
v_accvgpr_read_b32 v238, a141
v_ldexp_f32 v238, v238, v239
v_accvgpr_write_b32 a141, v238
v_accvgpr_read_b32 v243, a142
v_ldexp_f32 v243, v243, v239
v_accvgpr_write_b32 a142, v243
v_accvgpr_read_b32 v238, a143
v_ldexp_f32 v238, v238, v239
v_accvgpr_write_b32 a143, v238
v_accvgpr_read_b32 v243, a156
v_ldexp_f32 v243, v243, v239
v_accvgpr_write_b32 a156, v243
v_accvgpr_read_b32 v238, a157
v_ldexp_f32 v238, v238, v239
v_accvgpr_write_b32 a157, v238
v_accvgpr_read_b32 v243, a158
v_ldexp_f32 v243, v243, v239
v_accvgpr_write_b32 a158, v243
v_accvgpr_read_b32 v238, a159
v_ldexp_f32 v238, v238, v239
v_accvgpr_write_b32 a159, v238
v_accvgpr_read_b32 v243, a172
v_ldexp_f32 v243, v243, v239
v_accvgpr_write_b32 a172, v243
v_accvgpr_read_b32 v238, a173
v_ldexp_f32 v238, v238, v239
v_accvgpr_write_b32 a173, v238
v_accvgpr_read_b32 v243, a174
v_ldexp_f32 v243, v243, v239
v_accvgpr_write_b32 a174, v243
v_accvgpr_read_b32 v238, a175
v_ldexp_f32 v238, v238, v239
v_accvgpr_write_b32 a175, v238
v_accvgpr_read_b32 v243, a188
v_ldexp_f32 v243, v243, v239
v_accvgpr_write_b32 a188, v243
v_accvgpr_read_b32 v238, a189
v_ldexp_f32 v238, v238, v239
v_accvgpr_write_b32 a189, v238
v_accvgpr_read_b32 v243, a190
v_ldexp_f32 v243, v243, v239
v_accvgpr_write_b32 a190, v243
v_accvgpr_read_b32 v238, a191
v_ldexp_f32 v238, v238, v239
v_accvgpr_write_b32 a191, v238
v_accvgpr_read_b32 v243, a204
v_ldexp_f32 v243, v243, v239
v_accvgpr_write_b32 a204, v243
v_accvgpr_read_b32 v238, a205
v_ldexp_f32 v238, v238, v239
v_accvgpr_write_b32 a205, v238
v_accvgpr_read_b32 v243, a206
v_ldexp_f32 v243, v243, v239
v_accvgpr_write_b32 a206, v243
v_accvgpr_read_b32 v238, a207
v_ldexp_f32 v238, v238, v239
v_accvgpr_write_b32 a207, v238
v_accvgpr_read_b32 v243, a220
v_ldexp_f32 v243, v243, v239
v_accvgpr_write_b32 a220, v243
v_accvgpr_read_b32 v238, a221
v_ldexp_f32 v238, v238, v239
v_accvgpr_write_b32 a221, v238
v_accvgpr_read_b32 v243, a222
v_ldexp_f32 v243, v243, v239
v_accvgpr_write_b32 a222, v243
v_accvgpr_read_b32 v238, a223
v_ldexp_f32 v238, v238, v239
v_accvgpr_write_b32 a223, v238
v_accvgpr_read_b32 v243, a236
v_ldexp_f32 v243, v243, v239
v_accvgpr_write_b32 a236, v243
v_accvgpr_read_b32 v238, a237
v_ldexp_f32 v238, v238, v239
v_accvgpr_write_b32 a237, v238
v_accvgpr_read_b32 v243, a238
v_ldexp_f32 v243, v243, v239
v_accvgpr_write_b32 a238, v243
v_accvgpr_read_b32 v238, a239
v_ldexp_f32 v238, v238, v239
v_accvgpr_write_b32 a239, v238
v_accvgpr_read_b32 v243, a252
v_ldexp_f32 v243, v243, v239
v_accvgpr_write_b32 a252, v243
v_accvgpr_read_b32 v238, a253
v_ldexp_f32 v238, v238, v239
v_accvgpr_write_b32 a253, v238
v_accvgpr_read_b32 v243, a254
v_ldexp_f32 v243, v243, v239
v_accvgpr_write_b32 a254, v243
v_accvgpr_read_b32 v238, a255
v_ldexp_f32 v238, v238, v239
v_accvgpr_write_b32 a255, v238
s_mov_b64 vcc, 0
s_nop 0
s_cmp_eq_u32 s63, 1
s_cbranch_scc1 L_ret1
s_cmp_eq_u32 s63, 3
s_cbranch_scc1 L_ret3
s_cmp_eq_u32 s63, 13
s_cbranch_scc1 L_ret13
s_cmp_eq_u32 s63, 15
s_cbranch_scc1 L_ret15
s_cmp_eq_u32 s63, 29
s_cbranch_scc1 L_ret29
s_branch L_ret31
.p2align 12
.fill 419, 4, 0xbf800000
L_mainw:
mvvaz 64,192,0
s_waitcnt lgkmcnt(4)
tr 208,238,64
mvva 64,196,16
s_add_u32 m0, s41, s50
s_add_u32 s41, s41, s42
tr 210,238,320
mvvaz 72,196,20
s_cmp_eq_u32 s41, s43
s_cselect_b32 s41, 0, s41
tr 212,238,8512
mvva 72,192,4
buffer_load_dwordx4 v241, s[16:19], s46 offen lds
mvvaz 80,192,8
s_add_u32 s46, s46, s55
s_add_u32 m0, m0, s53
tr 214,238,8768
mvva 80,196,24
tr 216,238,72
s_waitcnt lgkmcnt(7)
tr 218,238,328
v_add_u32 v239, s40, v235
buffer_load_dwordx4 v241, s[16:19], s46 offen lds
mvvaz 68,200,0
s_waitcnt lgkmcnt(4)
s_add_u32 s46, s46, s56
tr 220,238,8520
mvva 68,204,16
s_waitcnt vmcnt(18)
s_add_u32 m0, m0, s54
tr 222,238,8776
mvvaz 76,204,20
s_add_u32 s40, s40, s42
ds_read_b128 a[32:35], v239 offset:0
mvva 76,200,4
buffer_load_dwordx4 v241, s[16:19], s46 offen lds
mvvaz 84,200,8
s_add_u32 s46, s46, s55
s_add_u32 m0, m0, s53
ds_read_b128 a[48:51], v239 offset:64
mvva 84,204,24
s_cmp_eq_u32 s40, s43
s_cselect_b32 s40, 0, s40
ds_read_b128 a[36:39], v239 offset:2112
ds_read_b128 a[52:55], v239 offset:2176
buffer_load_dwordx4 v241, s[16:19], s46 offen lds
mvvaz 96,208,0
s_waitcnt lgkmcnt(4)
s_add_u32 s46, s46, s57
tr 192,238,128
mvva 96,212,16
s_cmp_eq_u32 s46, s82
s_cselect_b32 s46, s58, s46
tr 194,238,384
mvvaz 104,212,20
tr 196,238,8576
mvva 104,208,4
mvvaz 112,208,8
tr 198,238,8832
mvva 112,212,24
tr 200,238,136
tr 202,238,392
v_add_u32 v239, s40, v235
s_add_u32 s40, s40, s42
s_cmp_eq_u32 s40, s43
s_cselect_b32 s40, 0, s40
mvvaz 100,216,0
tr 204,238,8584
mvva 100,220,16
s_waitcnt vmcnt(16)
tr 206,238,8840
mvvaz 108,220,20
ds_read_b128 a[40:43], v239 offset:0
mvva 108,216,4
mvvaz 116,216,8
ds_read_b128 a[56:59], v239 offset:64
mvva 116,220,24
ds_read_b128 a[44:47], v239 offset:2112
ds_read_b128 a[60:63], v239 offset:2176
s_waitcnt lgkmcnt(5)
mvvaz 128,192,0
tr 208,238,192
mvva 128,196,16
tr 210,238,448
mvvaz 136,196,20
tr 212,238,8640
mvva 136,192,4
mvvaz 144,192,8
tr 214,238,8896
mvva 144,196,24
tr 216,238,200
tr 218,238,456
mvvaz 132,200,0
s_waitcnt lgkmcnt(4)
tr 220,238,8648
mvva 132,204,16
tr 222,238,8904
mvvaz 140,204,20
mvva 140,200,4
v_add_u32 v238, s40, v234
mvvaz 148,200,8
s_add_u32 s40, s40, s42
s_cmp_eq_u32 s40, s43
s_cselect_b32 s40, 0, s40
mvva 148,204,24
s_waitcnt vmcnt(4) lgkmcnt(0)
s_barrier
mvvaz 160,208,0
s_add_u32 m0, s41, s49
s_add_u32 s41, s41, s42
tr 192,238,0
mvva 160,212,16
s_cmp_eq_u32 s41, s43
s_cselect_b32 s41, 0, s41
tr 194,238,256
mvvaz 168,212,20
tr 196,238,8448
mvva 168,208,4
buffer_load_dwordx4 v242, s[20:23], s47 offen lds
mvvaz 176,208,8
s_add_u32 s47, s47, s59
s_add_u32 m0, m0, s61
tr 198,238,8704
mvva 176,212,24
tr 200,238,8
tr 202,238,264
buffer_load_dwordx4 v242, s[20:23], s47 offen lds
mvvaz 164,216,0
s_add_u32 s47, s47, s59
s_add_u32 m0, m0, s62
tr 204,238,8456
mvva 164,220,16
tr 206,238,8712
mvvaz 172,220,20
mvva 172,216,4
buffer_load_dwordx4 v242, s[20:23], s47 offen lds
mvvaz 180,216,8
s_add_u32 s47, s47, s59
s_add_u32 m0, m0, s61
mvva 180,220,24
s_waitcnt lgkmcnt(1)
buffer_load_dwordx4 v242, s[20:23], s47 offen lds
mvva 64,192,32
s_add_u32 s47, s47, s59
s_add_u32 m0, s41, s49
tr 208,238,64
mvva 64,196,48
s_add_u32 s41, s41, s42
tr 210,238,320
mvva 72,196,52
s_cmp_eq_u32 s41, s43
s_cselect_b32 s41, 0, s41
tr 212,238,8512
mvva 72,192,36
buffer_load_dwordx4 v242, s[20:23], s47 offen lds
mvva 80,192,40
s_add_u32 s47, s47, s59
s_add_u32 m0, m0, s61
tr 214,238,8768
mvva 80,196,56
tr 216,238,72
tr 218,238,328
v_add_u32 v239, s40, v235
buffer_load_dwordx4 v242, s[20:23], s47 offen lds
mvva 68,200,32
s_waitcnt lgkmcnt(4)
s_add_u32 s47, s47, s59
tr 220,238,8520
mvva 68,204,48
s_add_u32 m0, m0, s62
s_add_u32 s40, s40, s42
tr 222,238,8776
mvva 76,204,52
s_cmp_eq_u32 s40, s43
s_cselect_b32 s40, 0, s40
ds_read_b128 a[64:67], v239 offset:0
mvva 76,200,36
buffer_load_dwordx4 v242, s[20:23], s47 offen lds
mvva 84,200,40
s_add_u32 s47, s47, s59
s_add_u32 m0, m0, s61
ds_read_b128 a[80:83], v239 offset:64
mvva 84,204,56
ds_read_b128 a[68:71], v239 offset:2112
ds_read_b128 a[84:87], v239 offset:2176
buffer_load_dwordx4 v242, s[20:23], s47 offen lds
mvva 96,208,32
s_waitcnt lgkmcnt(4)
s_add_u32 s47, s47, s60
tr 192,238,128
mvva 96,212,48
s_cmp_eq_u32 s47, s83
s_cselect_b32 s47, s76, s47
tr 194,238,384
mvva 104,212,52
s_add_u32 m0, s41, s50
s_add_u32 s41, s41, s42
tr 196,238,8576
mvva 104,208,36
buffer_load_dwordx4 v241, s[16:19], s46 offen lds
mvva 112,208,40
s_add_u32 s46, s46, s55
s_add_u32 m0, m0, s53
tr 198,238,8832
mvva 112,212,56
s_cmp_eq_u32 s41, s43
s_cselect_b32 s41, 0, s41
tr 200,238,136
tr 202,238,392
v_add_u32 v239, s40, v235
buffer_load_dwordx4 v241, s[16:19], s46 offen lds
mvva 100,216,32
s_add_u32 s46, s46, s56
s_add_u32 m0, m0, s54
tr 204,238,8584
mvva 100,220,48
s_add_u32 s40, s40, s42
tr 206,238,8840
mvva 108,220,52
s_cmp_eq_u32 s40, s43
s_cselect_b32 s40, 0, s40
ds_read_b128 a[72:75], v239 offset:0
mvva 108,216,36
buffer_load_dwordx4 v241, s[16:19], s46 offen lds
mvva 116,216,40
s_add_u32 s46, s46, s55
s_add_u32 m0, m0, s53
ds_read_b128 a[88:91], v239 offset:64
mvva 116,220,56
ds_read_b128 a[76:79], v239 offset:2112
s_waitcnt lgkmcnt(4)
ds_read_b128 a[92:95], v239 offset:2176
buffer_load_dwordx4 v241, s[16:19], s46 offen lds
mvva 128,192,32
s_add_u32 s46, s46, s57
s_add_u32 m0, s41, s49
tr 208,238,192
mvva 128,196,48
s_cmp_eq_u32 s46, s82
s_cselect_b32 s46, s58, s46
tr 210,238,448
mvva 136,196,52
s_add_u32 s41, s41, s42
tr 212,238,8640
mvva 136,192,36
buffer_load_dwordx4 v242, s[20:23], s47 offen lds
mvva 144,192,40
s_add_u32 s47, s47, s59
s_add_u32 m0, m0, s61
tr 214,238,8896
mvva 144,196,56
s_cmp_eq_u32 s41, s43
s_cselect_b32 s41, 0, s41
tr 216,238,200
tr 218,238,456
buffer_load_dwordx4 v242, s[20:23], s47 offen lds
mvva 132,200,32
s_waitcnt lgkmcnt(4)
s_add_u32 s47, s47, s59
tr 220,238,8648
mvva 132,204,48
s_add_u32 m0, m0, s62
tr 222,238,8904
mvva 140,204,52
buffer_load_dwordx4 v242, s[20:23], s47 offen lds
mvva 140,200,36
s_add_u32 s47, s47, s59
s_add_u32 m0, m0, s61
v_add_u32 v238, s40, v234
mvva 148,200,40
s_add_u32 s40, s40, s42
s_cmp_eq_u32 s40, s43
s_cselect_b32 s40, 0, s40
mvva 148,204,56
buffer_load_dwordx4 v242, s[20:23], s47 offen lds
s_add_u32 s47, s47, s59
s_waitcnt vmcnt(8) lgkmcnt(0)
s_barrier
mvva 160,208,32
s_add_u32 m0, s41, s49
s_add_u32 s41, s41, s42
tr 192,238,0
mvva 160,212,48
s_cmp_eq_u32 s41, s43
s_cselect_b32 s41, 0, s41
tr 194,238,256
mvva 168,212,52
tr 196,238,8448
mvva 168,208,36
buffer_load_dwordx4 v242, s[20:23], s47 offen lds
mvva 176,208,40
s_add_u32 s47, s47, s59
s_add_u32 m0, m0, s61
tr 198,238,8704
mvva 176,212,56
tr 200,238,8
tr 202,238,264
buffer_load_dwordx4 v242, s[20:23], s47 offen lds
mvva 164,216,32
s_add_u32 s47, s47, s59
s_add_u32 m0, m0, s62
tr 204,238,8456
mvva 164,220,48
tr 206,238,8712
mvva 172,220,52
mvva 172,216,36
buffer_load_dwordx4 v242, s[20:23], s47 offen lds
mvva 180,216,40
s_add_u32 s47, s47, s59
s_add_u32 m0, m0, s61
mvva 180,220,56
s_waitcnt lgkmcnt(1)
buffer_load_dwordx4 v242, s[20:23], s47 offen lds
mvva 64,192,64
s_add_u32 s47, s47, s60
s_add_u32 m0, s41, s50
tr 208,238,64
mvva 64,196,80
s_cmp_eq_u32 s47, s83
s_cselect_b32 s47, s76, s47
tr 210,238,320
mvva 72,196,84
s_add_u32 s41, s41, s42
tr 212,238,8512
mvva 72,192,68
buffer_load_dwordx4 v241, s[16:19], s46 offen lds
mvva 80,192,72
s_add_u32 s46, s46, s55
s_add_u32 m0, m0, s53
tr 214,238,8768
mvva 80,196,88
s_cmp_eq_u32 s41, s43
s_cselect_b32 s41, 0, s41
tr 216,238,72
tr 218,238,328
v_add_u32 v239, s40, v235
buffer_load_dwordx4 v241, s[16:19], s46 offen lds
mvva 68,200,64
s_waitcnt lgkmcnt(4)
s_add_u32 s46, s46, s56
tr 220,238,8520
mvva 68,204,80
s_add_u32 m0, m0, s54
s_add_u32 s40, s40, s42
tr 222,238,8776
mvva 76,204,84
s_cmp_eq_u32 s40, s43
s_cselect_b32 s40, 0, s40
ds_read_b128 a[96:99], v239 offset:0
mvva 76,200,68
buffer_load_dwordx4 v241, s[16:19], s46 offen lds
mvva 84,200,72
s_add_u32 s46, s46, s55
s_add_u32 m0, m0, s53
ds_read_b128 a[112:115], v239 offset:64
mvva 84,204,88
ds_read_b128 a[100:103], v239 offset:2112
ds_read_b128 a[116:119], v239 offset:2176
buffer_load_dwordx4 v241, s[16:19], s46 offen lds
mvva 96,208,64
s_waitcnt lgkmcnt(4)
s_add_u32 s46, s46, s57
tr 192,238,128
mvva 96,212,80
s_cmp_eq_u32 s46, s82
s_cselect_b32 s46, s58, s46
tr 194,238,384
mvva 104,212,84
s_add_u32 m0, s41, s49
s_add_u32 s41, s41, s42
tr 196,238,8576
mvva 104,208,68
buffer_load_dwordx4 v242, s[20:23], s47 offen lds
mvva 112,208,72
s_add_u32 s47, s47, s59
s_add_u32 m0, m0, s61
tr 198,238,8832
mvva 112,212,88
s_cmp_eq_u32 s41, s43
s_cselect_b32 s41, 0, s41
tr 200,238,136
tr 202,238,392
v_add_u32 v239, s40, v235
buffer_load_dwordx4 v242, s[20:23], s47 offen lds
mvva 100,216,64
s_add_u32 s47, s47, s59
s_add_u32 m0, m0, s62
tr 204,238,8584
mvva 100,220,80
s_add_u32 s40, s40, s42
tr 206,238,8840
mvva 108,220,84
s_cmp_eq_u32 s40, s43
s_cselect_b32 s40, 0, s40
ds_read_b128 a[104:107], v239 offset:0
mvva 108,216,68
buffer_load_dwordx4 v242, s[20:23], s47 offen lds
mvva 116,216,72
s_add_u32 s47, s47, s59
s_add_u32 m0, m0, s61
ds_read_b128 a[120:123], v239 offset:64
mvva 116,220,88
ds_read_b128 a[108:111], v239 offset:2112
s_waitcnt lgkmcnt(4)
ds_read_b128 a[124:127], v239 offset:2176
buffer_load_dwordx4 v242, s[20:23], s47 offen lds
mvva 128,192,64
s_add_u32 s47, s47, s59
s_add_u32 m0, s41, s49
tr 208,238,192
mvva 128,196,80
s_add_u32 s41, s41, s42
tr 210,238,448
mvva 136,196,84
s_cmp_eq_u32 s41, s43
s_cselect_b32 s41, 0, s41
tr 212,238,8640
mvva 136,192,68
buffer_load_dwordx4 v242, s[20:23], s47 offen lds
mvva 144,192,72
s_add_u32 s47, s47, s59
s_add_u32 m0, m0, s61
tr 214,238,8896
mvva 144,196,88
tr 216,238,200
tr 218,238,456
buffer_load_dwordx4 v242, s[20:23], s47 offen lds
mvva 132,200,64
s_waitcnt lgkmcnt(4)
s_add_u32 s47, s47, s59
tr 220,238,8648
mvva 132,204,80
s_add_u32 m0, m0, s62
tr 222,238,8904
mvva 140,204,84
buffer_load_dwordx4 v242, s[20:23], s47 offen lds
mvva 140,200,68
s_add_u32 s47, s47, s59
s_add_u32 m0, m0, s61
v_add_u32 v238, s40, v234
mvva 148,200,72
s_add_u32 s40, s40, s42
s_cmp_eq_u32 s40, s43
s_cselect_b32 s40, 0, s40
mvva 148,204,88
buffer_load_dwordx4 v242, s[20:23], s47 offen lds
s_add_u32 s47, s47, s60
s_cmp_eq_u32 s47, s83
s_cselect_b32 s47, s76, s47
s_waitcnt vmcnt(12) lgkmcnt(0)
s_barrier
mvva 160,208,64
s_add_u32 m0, s41, s50
s_add_u32 s41, s41, s42
tr 192,238,0
mvva 160,212,80
s_cmp_eq_u32 s41, s43
s_cselect_b32 s41, 0, s41
tr 194,238,256
mvva 168,212,84
tr 196,238,8448
mvva 168,208,68
buffer_load_dwordx4 v241, s[16:19], s46 offen lds
mvva 176,208,72
s_add_u32 s46, s46, s55
s_add_u32 m0, m0, s53
tr 198,238,8704
mvva 176,212,88
tr 200,238,8
tr 202,238,264
buffer_load_dwordx4 v241, s[16:19], s46 offen lds
mvva 164,216,64
s_add_u32 s46, s46, s56
s_add_u32 m0, m0, s54
tr 204,238,8456
mvva 164,220,80
tr 206,238,8712
mvva 172,220,84
mvva 172,216,68
buffer_load_dwordx4 v241, s[16:19], s46 offen lds
mvva 180,216,72
s_add_u32 s46, s46, s55
s_add_u32 m0, m0, s53
mvva 180,220,88
s_waitcnt lgkmcnt(1)
buffer_load_dwordx4 v241, s[16:19], s46 offen lds
mvva 64,192,96
s_add_u32 s46, s46, s57
s_add_u32 m0, s41, s49
tr 208,238,64
mvva 64,196,112
s_cmp_eq_u32 s46, s82
s_cselect_b32 s46, s58, s46
tr 210,238,320
mvva 72,196,116
s_add_u32 s41, s41, s42
tr 212,238,8512
mvva 72,192,100
buffer_load_dwordx4 v242, s[20:23], s47 offen lds
mvva 80,192,104
s_add_u32 s47, s47, s59
s_add_u32 m0, m0, s61
tr 214,238,8768
mvva 80,196,120
s_cmp_eq_u32 s41, s43
s_cselect_b32 s41, 0, s41
tr 216,238,72
tr 218,238,328
v_add_u32 v239, s40, v235
buffer_load_dwordx4 v242, s[20:23], s47 offen lds
mvva 68,200,96
s_waitcnt lgkmcnt(4)
s_add_u32 s47, s47, s59
tr 220,238,8520
mvva 68,204,112
s_add_u32 m0, m0, s62
s_add_u32 s40, s40, s42
tr 222,238,8776
mvva 76,204,116
s_cmp_eq_u32 s40, s43
s_cselect_b32 s40, 0, s40
ds_read_b128 a[128:131], v239 offset:0
mvva 76,200,100
buffer_load_dwordx4 v242, s[20:23], s47 offen lds
mvva 84,200,104
s_add_u32 s47, s47, s59
s_add_u32 m0, m0, s61
ds_read_b128 a[144:147], v239 offset:64
mvva 84,204,120
ds_read_b128 a[132:135], v239 offset:2112
ds_read_b128 a[148:151], v239 offset:2176
buffer_load_dwordx4 v242, s[20:23], s47 offen lds
mvva 96,208,96
s_waitcnt lgkmcnt(4)
s_add_u32 s47, s47, s59
tr 192,238,128
mvva 96,212,112
s_add_u32 m0, s41, s49
s_add_u32 s41, s41, s42
tr 194,238,384
mvva 104,212,116
s_cmp_eq_u32 s41, s43
s_cselect_b32 s41, 0, s41
tr 196,238,8576
mvva 104,208,100
buffer_load_dwordx4 v242, s[20:23], s47 offen lds
mvva 112,208,104
s_add_u32 s47, s47, s59
s_add_u32 m0, m0, s61
tr 198,238,8832
mvva 112,212,120
tr 200,238,136
tr 202,238,392
v_add_u32 v239, s40, v235
buffer_load_dwordx4 v242, s[20:23], s47 offen lds
mvva 100,216,96
s_add_u32 s47, s47, s59
s_add_u32 m0, m0, s62
tr 204,238,8584
mvva 100,220,112
s_add_u32 s40, s40, s42
tr 206,238,8840
mvva 108,220,116
s_cmp_eq_u32 s40, s43
s_cselect_b32 s40, 0, s40
ds_read_b128 a[136:139], v239 offset:0
mvva 108,216,100
buffer_load_dwordx4 v242, s[20:23], s47 offen lds
mvva 116,216,104
s_add_u32 s47, s47, s59
s_add_u32 m0, m0, s61
ds_read_b128 a[152:155], v239 offset:64
mvva 116,220,120
ds_read_b128 a[140:143], v239 offset:2112
s_waitcnt lgkmcnt(4)
ds_read_b128 a[156:159], v239 offset:2176
buffer_load_dwordx4 v242, s[20:23], s47 offen lds
mvva 128,192,96
s_add_u32 s47, s47, s60
tr 208,238,192
mvva 128,196,112
s_cmp_eq_u32 s47, s83
s_cselect_b32 s47, s76, s47
tr 210,238,448
mvva 136,196,116
tr 212,238,8640
mvva 136,192,100
mvva 144,192,104
tr 214,238,8896
mvva 144,196,120
tr 216,238,200
tr 218,238,456
mvva 132,200,96
s_waitcnt lgkmcnt(4)
tr 220,238,8648
mvva 132,204,112
tr 222,238,8904
mvva 140,204,116
mvva 140,200,100
v_add_u32 v238, s40, v234
mvva 148,200,104
s_add_u32 s40, s40, s42
s_cmp_eq_u32 s40, s43
s_cselect_b32 s40, 0, s40
mvva 148,204,120
s_waitcnt vmcnt(12) lgkmcnt(0)
s_barrier
mvva 160,208,96
s_add_u32 m0, s41, s50
s_add_u32 s41, s41, s42
tr 192,238,0
mvva 160,212,112
s_cmp_eq_u32 s41, s43
s_cselect_b32 s41, 0, s41
tr 194,238,256
mvva 168,212,116
tr 196,238,8448
mvva 168,208,100
buffer_load_dwordx4 v241, s[16:19], s46 offen lds
mvva 176,208,104
s_add_u32 s46, s46, s55
s_add_u32 m0, m0, s53
tr 198,238,8704
mvva 176,212,120
tr 200,238,8
tr 202,238,264
mvva 164,216,96
tr 204,238,8456
mvva 164,220,112
tr 206,238,8712
mvva 172,220,116
mvva 172,216,100
buffer_load_dwordx4 v241, s[16:19], s46 offen lds
mvva 180,216,104
s_add_u32 s46, s46, s56
s_add_u32 m0, m0, s54
mvva 180,220,120
s_waitcnt lgkmcnt(1)
mvva 64,192,128
tr 208,238,64
mvva 64,196,144
tr 210,238,320
mvva 72,196,148
tr 212,238,8512
mvva 72,192,132
buffer_load_dwordx4 v241, s[16:19], s46 offen lds
mvva 80,192,136
s_add_u32 s46, s46, s55
s_add_u32 m0, m0, s53
tr 214,238,8768
mvva 80,196,152
tr 216,238,72
tr 218,238,328
v_add_u32 v239, s40, v235
s_add_u32 s40, s40, s42
s_cmp_eq_u32 s40, s43
s_cselect_b32 s40, 0, s40
mvva 68,200,128
s_waitcnt lgkmcnt(4)
tr 220,238,8520
mvva 68,204,144
tr 222,238,8776
mvva 76,204,148
ds_read_b128 a[160:163], v239 offset:0
mvva 76,200,132
buffer_load_dwordx4 v241, s[16:19], s46 offen lds
mvva 84,200,136
s_add_u32 s46, s46, s57
ds_read_b128 a[176:179], v239 offset:64
mvva 84,204,152
s_cmp_eq_u32 s46, s82
s_cselect_b32 s46, s58, s46
ds_read_b128 a[164:167], v239 offset:2112
s_addk_i32 s46, 256
s_addk_i32 s82, 256
s_addk_i32 s58, 256
ds_read_b128 a[180:183], v239 offset:2176
s_add_u32 m0, s41, s50
s_add_u32 s41, s41, s42
mvva 96,208,128
s_waitcnt lgkmcnt(4)
tr 192,238,128
mvva 96,212,144
s_cmp_eq_u32 s41, s43
s_cselect_b32 s41, 0, s41
tr 194,238,384
mvva 104,212,148
tr 196,238,8576
mvva 104,208,132
buffer_load_dwordx4 v241, s[16:19], s46 offen lds
mvva 112,208,136
s_add_u32 s46, s46, s55
s_add_u32 m0, m0, s53
tr 198,238,8832
mvva 112,212,152
tr 200,238,136
tr 202,238,392
v_add_u32 v239, s40, v235
s_add_u32 s40, s40, s42
s_cmp_eq_u32 s40, s43
s_cselect_b32 s40, 0, s40
mvva 100,216,128
tr 204,238,8584
mvva 100,220,144
tr 206,238,8840
mvva 108,220,148
ds_read_b128 a[168:171], v239 offset:0
mvva 108,216,132
buffer_load_dwordx4 v241, s[16:19], s46 offen lds
mvva 116,216,136
s_add_u32 s46, s46, s56
s_add_u32 m0, m0, s54
ds_read_b128 a[184:187], v239 offset:64
mvva 116,220,152
ds_read_b128 a[172:175], v239 offset:2112
ds_read_b128 a[188:191], v239 offset:2176
s_waitcnt lgkmcnt(5)
mvva 128,192,128
tr 208,238,192
mvva 128,196,144
tr 210,238,448
mvva 136,196,148
tr 212,238,8640
mvva 136,192,132
buffer_load_dwordx4 v241, s[16:19], s46 offen lds
mvva 144,192,136
s_add_u32 s46, s46, s55
s_add_u32 m0, m0, s53
tr 214,238,8896
mvva 144,196,152
tr 216,238,200
tr 218,238,456
mvva 132,200,128
s_waitcnt lgkmcnt(4)
tr 220,238,8648
mvva 132,204,144
tr 222,238,8904
mvva 140,204,148
mvva 140,200,132
buffer_load_dwordx4 v241, s[16:19], s46 offen lds
mvva 148,200,136
s_add_u32 s46, s46, s57
s_cmp_eq_u32 s46, s82
s_cselect_b32 s46, s58, s46
mvva 148,204,152
v_add_u32 v238, s40, v234
s_add_u32 s40, s40, s42
s_cmp_eq_u32 s40, s43
s_cselect_b32 s40, 0, s40
s_waitcnt vmcnt(8) lgkmcnt(0)
s_barrier
mvva 160,208,128
s_add_u32 m0, s41, s50
s_add_u32 s41, s41, s42
tr 192,238,0
mvva 160,212,144
s_cmp_eq_u32 s41, s43
s_cselect_b32 s41, 0, s41
tr 194,238,256
mvva 168,212,148
tr 196,238,8448
mvva 168,208,132
buffer_load_dwordx4 v241, s[16:19], s46 offen lds
mvva 176,208,136
s_add_u32 s46, s46, s55
s_add_u32 m0, m0, s53
tr 198,238,8704
mvva 176,212,152
tr 200,238,8
tr 202,238,264
mvva 164,216,128
tr 204,238,8456
mvva 164,220,144
tr 206,238,8712
mvva 172,220,148
mvva 172,216,132
buffer_load_dwordx4 v241, s[16:19], s46 offen lds
mvva 180,216,136
s_add_u32 s46, s46, s56
s_add_u32 m0, m0, s54
mvva 180,220,152
s_waitcnt lgkmcnt(6)
L_bodyw:
mvva 64,192,160
s_waitcnt lgkmcnt(4)
tr 208,238,64
v_mul_f32 v231, v231, v252
v_mul_f32 v243, v243, v252
mvva 64,196,176
tr 210,238,320
v_mul_f32 v236, v236, v252
pk 56,248,249
mvva 72,196,180
tr 212,238,8512
pk 57,228,229
mvva 72,192,164
buffer_load_dwordx4 v241, s[16:19], s46 offen lds
pk 58,230,231
mvva 80,192,168
s_add_u32 s46, s46, s55
s_add_u32 m0, m0, s53
tr 214,238,8768
pk 59,243,236
mvva 80,196,184
tr 216,238,72
tr 218,238,328
v_add_u32 v239, s40, v235
s_waitcnt lgkmcnt(8)
s_add_u32 s40, s40, s42
mvva 68,200,160
s_waitcnt lgkmcnt(4)
tr 220,238,8520
mvva 68,204,176
s_cmp_eq_u32 s40, s43
s_cselect_b32 s40, 0, s40
tr 222,238,8776
mvva 76,204,180
ds_read_b128 a[192:195], v239 offset:0
mvva 76,200,164
buffer_load_dwordx4 v241, s[16:19], s46 offen lds
mvva 84,200,168
s_add_u32 s46, s46, s57
ds_read_b128 a[208:211], v239 offset:64
mvva 84,204,184
s_cmp_eq_u32 s46, s82
s_cselect_b32 s46, s58, s46
ds_read_b128 a[196:199], v239 offset:2112
s_add_u32 m0, s41, s50
s_add_u32 s41, s41, s42
ds_read_b128 a[212:215], v239 offset:2176
buffer_store_dwordx4 v[28:31], v240, s[24:27], s98 offen offset:3072 nt
mvva 96,208,160
s_waitcnt lgkmcnt(4)
s_add_u32 s48, s48, s72
tr 192,238,128
mvva 96,212,176
s_cmp_eq_u32 s41, s43
s_cselect_b32 s41, 0, s41
tr 194,238,384
mvva 104,212,180
tr 196,238,8576
mvva 104,208,164
buffer_load_dwordx4 v241, s[16:19], s46 offen lds
mvva 112,208,168
s_add_u32 s46, s46, s55
s_add_u32 m0, m0, s53
tr 198,238,8832
mvva 112,212,184
tr 200,238,136
tr 202,238,392
v_add_u32 v239, s40, v235
s_add_u32 s40, s40, s42
s_cmp_eq_u32 s40, s43
s_cselect_b32 s40, 0, s40
mvva 100,216,160
tr 204,238,8584
mvva 100,220,176
tr 206,238,8840
mvva 108,220,180
ds_read_b128 a[200:203], v239 offset:0
mvva 108,216,164
buffer_load_dwordx4 v241, s[16:19], s46 offen lds
mvva 116,216,168
s_add_u32 s46, s46, s56
s_add_u32 m0, m0, s54
ds_read_b128 a[216:219], v239 offset:64
mvva 116,220,184
ds_read_b128 a[204:207], v239 offset:2112
s_waitcnt lgkmcnt(4)
ds_read_b128 a[220:223], v239 offset:2176
buffer_store_dwordx4 v[32:35], v240, s[24:27], s48 offen nt
mvva 128,192,160
tr 208,238,192
mvva 128,196,176
tr 210,238,448
mvva 136,196,180
tr 212,238,8640
mvva 136,192,164
buffer_load_dwordx4 v241, s[16:19], s46 offen lds
mvva 144,192,168
s_add_u32 s46, s46, s55
s_add_u32 m0, m0, s53
tr 214,238,8896
mvva 144,196,184
tr 216,238,200
tr 218,238,456
mvva 132,200,160
s_waitcnt lgkmcnt(4)
tr 220,238,8648
mvva 132,204,176
tr 222,238,8904
mvva 140,204,180
mvva 140,200,164
buffer_load_dwordx4 v241, s[16:19], s46 offen lds
mvva 148,200,168
s_add_u32 s46, s46, s57
s_cmp_eq_u32 s46, s82
s_cselect_b32 s46, s58, s46
mvva 148,204,184
v_add_u32 v238, s40, v234
s_add_u32 s40, s40, s42
s_cmp_eq_u32 s40, s43
s_cselect_b32 s40, 0, s40
s_waitcnt vmcnt(14) lgkmcnt(0)
s_barrier
mvva 160,208,160
s_add_u32 m0, s41, s50
s_add_u32 s41, s41, s42
tr 192,238,0
mvva 160,212,176
s_cmp_eq_u32 s41, s43
s_cselect_b32 s41, 0, s41
tr 194,238,256
mvva 168,212,180
tr 196,238,8448
mvva 168,208,164
buffer_load_dwordx4 v241, s[16:19], s46 offen lds
mvva 176,208,168
s_add_u32 s46, s46, s55
s_add_u32 m0, m0, s53
tr 198,238,8704
mvva 176,212,184
tr 200,238,8
tr 202,238,264
buffer_store_dwordx4 v[36:39], v240, s[24:27], s48 offen offset:1024 nt
mvva 164,216,160
tr 204,238,8456
mvva 164,220,176
tr 206,238,8712
mvva 172,220,180
mvva 172,216,164
buffer_load_dwordx4 v241, s[16:19], s46 offen lds
mvva 180,216,168
s_add_u32 s46, s46, s56
s_add_u32 m0, m0, s54
mvva 180,220,184
s_waitcnt lgkmcnt(1)
mvva 64,192,192
tr 208,238,64
mvva 64,196,208
tr 210,238,320
mvva 72,196,212
tr 212,238,8512
mvva 72,192,196
buffer_load_dwordx4 v241, s[16:19], s46 offen lds
mvva 80,192,200
s_add_u32 s46, s46, s55
s_add_u32 m0, m0, s53
tr 214,238,8768
mvva 80,196,216
tr 216,238,72
tr 218,238,328
mvva 68,200,192
s_waitcnt lgkmcnt(4)
tr 220,238,8520
mvva 68,204,208
tr 222,238,8776
mvva 76,204,212
mvva 76,200,196
buffer_load_dwordx4 v241, s[16:19], s46 offen lds
mvva 84,200,200
s_add_u32 s46, s46, s57
s_cmp_eq_u32 s46, s82
s_cselect_b32 s46, s58, s46
mvva 84,204,216
s_add_u32 m0, s41, s50
s_add_u32 s41, s41, s42
pk 0,64,65
s_cmp_eq_u32 s41, s43
s_cselect_b32 s41, 0, s41
pk 1,66,67
buffer_store_dwordx4 v[40:43], v240, s[24:27], s48 offen offset:2048 sc1
mvva 96,208,192
s_waitcnt lgkmcnt(0)
s_or_b32 s98, s48, s93
tr 192,238,128
mvva 96,212,208
tr 194,238,384
pk 2,68,69
mvva 104,212,212
tr 196,238,8576
pk 3,70,71
mvva 104,208,196
buffer_load_dwordx4 v241, s[16:19], s46 offen lds
mvva 112,208,200
s_add_u32 s46, s46, s55
s_add_u32 m0, m0, s53
tr 198,238,8832
mvva 112,212,216
tr 200,238,136
pk 4,72,73
tr 202,238,392
pk 5,74,75
pk 6,76,77
pk 7,78,79
mvva 100,216,192
tr 204,238,8584
pk 8,80,81
mvva 100,220,208
tr 206,238,8840
pk 9,82,83
mvva 108,220,212
pk 10,84,85
pk 11,86,87
mvva 108,216,196
buffer_load_dwordx4 v241, s[16:19], s46 offen lds
mvva 116,216,200
s_add_u32 s46, s46, s56
s_add_u32 m0, m0, s54
mvva 116,220,216
s_waitcnt lgkmcnt(1)
pk 16,96,97
buffer_store_dwordx4 v[44:47], v240, s[24:27], s98 offen offset:3072 sc1
mvva 128,192,192
s_add_u32 s48, s48, s72
tr 208,238,192
pk 17,98,99
mvva 128,196,208
tr 210,238,448
pk 18,100,101
mvva 136,196,212
tr 212,238,8640
pk 19,102,103
mvva 136,192,196
buffer_load_dwordx4 v241, s[16:19], s46 offen lds
mvva 144,192,200
s_add_u32 s46, s46, s55
s_add_u32 m0, m0, s53
tr 214,238,8896
mvva 144,196,216
tr 216,238,200
pk 20,104,105
tr 218,238,456
pk 21,106,107
pk 22,108,109
pk 23,110,111
mvva 132,200,192
s_waitcnt lgkmcnt(4)
tr 220,238,8648
pk 24,112,113
mvva 132,204,208
tr 222,238,8904
pk 25,114,115
mvva 140,204,212
pk 26,116,117
pk 27,118,119
mvva 140,200,196
buffer_load_dwordx4 v241, s[16:19], s46 offen lds
mvva 148,200,200
s_add_u32 s46, s46, s57
s_cmp_eq_u32 s46, s82
s_cselect_b32 s46, s58, s46
mvva 148,204,216
v_add_u32 v238, s40, v234
s_add_u32 s40, s40, s42
s_cmp_eq_u32 s40, s43
s_cselect_b32 s40, 0, s40
s_waitcnt vmcnt(21) lgkmcnt(0)
s_barrier
mvva 160,208,192
s_add_u32 m0, s41, s50
s_add_u32 s41, s41, s42
tr 192,238,0
mvva 160,212,208
s_cmp_eq_u32 s41, s43
s_cselect_b32 s41, 0, s41
tr 194,238,256
mvva 168,212,212
tr 196,238,8448
mvva 168,208,196
buffer_load_dwordx4 v241, s[16:19], s46 offen lds
mvva 176,208,200
s_add_u32 s46, s46, s55
s_add_u32 m0, m0, s53
tr 198,238,8704
mvva 176,212,216
tr 200,238,8
tr 202,238,264
pk 32,128,129
buffer_store_dwordx4 v[48:51], v240, s[24:27], s48 offen sc1
mvva 164,216,192
tr 204,238,8456
pk 33,130,131
mvva 164,220,208
tr 206,238,8712
pk 34,132,133
mvva 172,220,212
pk 35,134,135
pk 36,136,137
mvva 172,216,196
buffer_load_dwordx4 v241, s[16:19], s46 offen lds
mvva 180,216,200
s_add_u32 s46, s46, s56
s_add_u32 m0, m0, s54
pk 37,138,139
mvva 180,220,216
pk 38,140,141
pk 39,142,143
pk 40,144,145
pk 41,146,147
s_waitcnt lgkmcnt(1)
pk 42,148,149
pk 43,150,151
mvvaz 64,192,0
tr 208,238,64
mvva 64,196,16
tr 210,238,320
mvvaz 72,196,20
tr 212,238,8512
mvva 72,192,4
buffer_load_dwordx4 v241, s[16:19], s46 offen lds
mvvaz 80,192,8
s_add_u32 s46, s46, s55
s_add_u32 m0, m0, s53
tr 214,238,8768
mvva 80,196,24
tr 216,238,72
tr 218,238,328
buffer_store_dwordx4 v[52:55], v240, s[24:27], s48 offen offset:1024 sc1
mvvaz 68,200,0
s_waitcnt lgkmcnt(4)
tr 220,238,8520
mvva 68,204,16
tr 222,238,8776
mvvaz 76,204,20
mvva 76,200,4
buffer_load_dwordx4 v241, s[16:19], s46 offen lds
mvvaz 84,200,8
s_add_u32 s46, s46, s57
s_cmp_eq_u32 s46, s82
s_cselect_b32 s46, s58, s46
mvva 84,204,24
s_add_u32 m0, s41, s50
s_add_u32 s41, s41, s42
s_cmp_eq_u32 s41, s43
s_cselect_b32 s41, 0, s41
buffer_store_dwordx4 v[56:59], v240, s[24:27], s48 offen offset:2048 sc1
mvvaz 96,208,0
s_waitcnt lgkmcnt(0)
s_or_b32 s98, s48, s93
tr 192,238,128
mvva 96,212,16
tr 194,238,384
mvvaz 104,212,20
tr 196,238,8576
mvva 104,208,4
buffer_load_dwordx4 v241, s[16:19], s46 offen lds
mvvaz 112,208,8
s_add_u32 s46, s46, s55
s_add_u32 m0, m0, s53
tr 198,238,8832
mvva 112,212,24
tr 200,238,136
tr 202,238,392
mvvaz 100,216,0
tr 204,238,8584
mvva 100,220,16
tr 206,238,8840
mvvaz 108,220,20
mvva 108,216,4
buffer_load_dwordx4 v241, s[16:19], s46 offen lds
buffer_store_dwordx4 v[60:63], v240, s[24:27], s98 offen offset:3072 sc1
mvvaz 116,216,8
s_add_u32 s46, s46, s56
s_add_u32 m0, m0, s54
s_add_u32 s48, s48, s72
mvva 116,220,24
pk 48,160,161
pk 49,162,163
pk 50,164,165
pk 51,166,167
s_waitcnt lgkmcnt(1)
pk 52,168,169
pk 53,170,171
mvvaz 128,192,0
tr 208,238,192
pk 54,172,173
mvva 128,196,16
tr 210,238,448
pk 55,174,175
mvvaz 136,196,20
tr 212,238,8640
pk 56,176,177
mvva 136,192,4
buffer_load_dwordx4 v241, s[16:19], s46 offen lds
mvvaz 144,192,8
s_add_u32 s46, s46, s55
s_add_u32 m0, m0, s53
tr 214,238,8896
mvva 144,196,24
tr 216,238,200
pk 57,178,179
tr 218,238,456
pk 58,180,181
pk 59,182,183
mvvaz 132,200,0
s_waitcnt lgkmcnt(4)
tr 220,238,8648
mvva 132,204,16
tr 222,238,8904
mvvaz 140,204,20
mvva 140,200,4
buffer_load_dwordx4 v241, s[16:19], s46 offen lds
mvvaz 148,200,8
s_add_u32 s46, s46, s57
s_cmp_eq_u32 s46, s82
s_cselect_b32 s46, s58, s46
mvva 148,204,24
v_add_u32 v238, s40, v234
s_add_u32 s40, s40, s42
s_cmp_eq_u32 s40, s43
s_cselect_b32 s40, 0, s40
s_waitcnt vmcnt(29) lgkmcnt(0)
s_barrier
mvvaz 160,208,0
s_add_u32 m0, s41, s49
s_add_u32 s41, s41, s42
tr 192,238,0
mvva 160,212,16
s_cmp_eq_u32 s41, s43
s_cselect_b32 s41, 0, s41
tr 194,238,256
mvvaz 168,212,20
tr 196,238,8448
mvva 168,208,4
buffer_load_dwordx4 v240, s[8:11], s44 offen nt lds
mvvaz 176,208,8
s_add_u32 m0, m0, 32
tr 198,238,8704
mvva 176,212,24
tr 200,238,8
tr 202,238,264
mvvaz 164,216,0
tr 204,238,8456
mvva 164,220,16
tr 206,238,8712
mvvaz 172,220,20
mvva 172,216,4
buffer_load_dwordx4 v240, s[8:11], s44 offen offset:1024 nt lds
mvvaz 180,216,8
s_add_u32 m0, m0, 32
mvva 180,220,24
s_waitcnt lgkmcnt(1)
mvva 64,192,32
tr 208,238,64
mvva 64,196,48
tr 210,238,320
mvva 72,196,52
tr 212,238,8512
mvva 72,192,36
buffer_load_dwordx4 v240, s[8:11], s44 offen offset:2048 nt lds
mvva 80,192,40
s_add_u32 m0, m0, 32
tr 214,238,8768
v_accvgpr_read_b32 v236, a224
mvva 80,196,56
tr 216,238,72
v_accvgpr_read_b32 v237, a225
tr 218,238,328
v_accvgpr_read_b32 v248, a226
v_accvgpr_read_b32 v249, a227
v_accvgpr_read_b32 v228, a240
mvva 68,200,32
s_waitcnt lgkmcnt(4)
tr 220,238,8520
v_accvgpr_read_b32 v229, a241
mvva 68,204,48
tr 222,238,8776
v_accvgpr_read_b32 v230, a242
mvva 76,204,52
v_accvgpr_read_b32 v231, a243
v_mul_f32 v236, v236, v250
mvva 76,200,36
buffer_load_dwordx4 v240, s[8:11], s44 offen offset:3072 nt lds
mvva 84,200,40
s_add_u32 s44, s44, s52
v_mul_f32 v237, v237, v250
v_mul_f32 v248, v248, v250
mvva 84,204,56
v_mul_f32 v249, v249, v250
v_mul_f32 v228, v228, v250
v_mul_f32 v229, v229, v250
v_mul_f32 v230, v230, v250
v_mul_f32 v231, v231, v250
pk 224,236,237
mvva 96,208,32
s_waitcnt lgkmcnt(0)
tr 192,238,128
pk 225,248,249
mvva 96,212,48
tr 194,238,384
pk 226,228,229
mvva 104,212,52
tr 196,238,8576
pk 227,230,231
mvva 104,208,36
mvva 112,208,40
tr 198,238,8832
mvva 112,212,56
tr 200,238,136
tr 202,238,392
buffer_store_dwordx4 v[224:227], v240, s[24:27], s48 offen sc1
mvva 100,216,32
tr 204,238,8584
mvva 100,220,48
tr 206,238,8840
v_accvgpr_read_b32 v243, a228
mvva 108,220,52
v_accvgpr_read_b32 v236, a229
v_accvgpr_read_b32 v237, a230
mvva 108,216,36
v_accvgpr_read_b32 v248, a231
v_accvgpr_read_b32 v249, a244
mvva 116,216,40
v_accvgpr_read_b32 v228, a245
v_accvgpr_read_b32 v229, a246
mvva 116,220,56
v_accvgpr_read_b32 v230, a247
v_mul_f32 v243, v243, v251
v_mul_f32 v236, v236, v251
v_mul_f32 v237, v237, v251
s_waitcnt lgkmcnt(1)
v_mul_f32 v248, v248, v251
v_mul_f32 v249, v249, v251
mvva 128,192,32
tr 208,238,192
v_mul_f32 v228, v228, v251
mvva 128,196,48
tr 210,238,448
v_mul_f32 v229, v229, v251
mvva 136,196,52
tr 212,238,8640
v_mul_f32 v230, v230, v251
mvva 136,192,36
pk 244,243,236
pk 245,237,248
mvva 144,192,40
tr 214,238,8896
pk 246,249,228
mvva 144,196,56
tr 216,238,200
pk 247,229,230
tr 218,238,456
mvva 132,200,32
s_waitcnt lgkmcnt(4)
tr 220,238,8648
mvva 132,204,48
tr 222,238,8904
mvva 140,204,52
mvva 140,200,36
v_add_u32 v238, s40, v234
mvva 148,200,40
s_add_u32 s40, s40, s42
s_cmp_eq_u32 s40, s43
s_cselect_b32 s40, 0, s40
mvva 148,204,56
buffer_store_dwordx4 v[244:247], v240, s[24:27], s48 offen offset:1024 sc1
s_waitcnt vmcnt(29) lgkmcnt(0)
s_barrier
mvva 160,208,32
s_add_u32 m0, s41, s49
s_add_u32 s41, s41, s42
tr 192,238,0
mvva 160,212,48
s_cmp_eq_u32 s41, s43
s_cselect_b32 s41, 0, s41
tr 194,238,256
mvva 168,212,52
tr 196,238,8448
mvva 168,208,36
buffer_load_dwordx4 v240, s[8:11], s44 offen nt lds
mvva 176,208,40
s_add_u32 m0, m0, 32
tr 198,238,8704
mvva 176,212,56
tr 200,238,8
tr 202,238,264
mvva 164,216,32
tr 204,238,8456
mvva 164,220,48
tr 206,238,8712
mvva 172,220,52
mvva 172,216,36
buffer_load_dwordx4 v240, s[8:11], s44 offen offset:1024 nt lds
mvva 180,216,40
s_add_u32 m0, m0, 32
mvva 180,220,56
s_waitcnt lgkmcnt(1)
mvva 64,192,64
tr 208,238,64
mvva 64,196,80
tr 210,238,320
mvva 72,196,84
tr 212,238,8512
mvva 72,192,68
buffer_load_dwordx4 v240, s[8:11], s44 offen offset:2048 nt lds
mvva 80,192,72
s_add_u32 m0, m0, 32
tr 214,238,8768
v_accvgpr_read_b32 v231, a232
mvva 80,196,88
tr 216,238,72
v_accvgpr_read_b32 v243, a233
tr 218,238,328
v_accvgpr_read_b32 v236, a234
v_accvgpr_read_b32 v237, a235
v_accvgpr_read_b32 v248, a248
mvva 68,200,64
s_waitcnt lgkmcnt(4)
tr 220,238,8520
v_accvgpr_read_b32 v249, a249
mvva 68,204,80
tr 222,238,8776
v_accvgpr_read_b32 v228, a250
mvva 76,204,84
v_accvgpr_read_b32 v229, a251
v_mul_f32 v231, v231, v252
mvva 76,200,68
buffer_load_dwordx4 v240, s[8:11], s44 offen offset:3072 nt lds
mvva 84,200,72
s_add_u32 s44, s44, s52
v_mul_f32 v243, v243, v252
v_mul_f32 v236, v236, v252
mvva 84,204,88
v_mul_f32 v237, v237, v252
v_mul_f32 v248, v248, v252
v_mul_f32 v249, v249, v252
v_mul_f32 v228, v228, v252
v_mul_f32 v229, v229, v252
pk 224,231,243
mvva 96,208,64
s_waitcnt lgkmcnt(0)
tr 192,238,128
pk 225,236,237
mvva 96,212,80
tr 194,238,384
pk 226,248,249
mvva 104,212,84
tr 196,238,8576
pk 227,228,229
mvva 104,208,68
mvva 112,208,72
tr 198,238,8832
mvva 112,212,88
tr 200,238,136
tr 202,238,392
buffer_store_dwordx4 v[224:227], v240, s[24:27], s48 offen offset:2048 sc1
mvva 100,216,64
s_or_b32 s98, s48, s93
tr 204,238,8584
mvva 100,220,80
tr 206,238,8840
mvva 108,220,84
mvva 108,216,68
mvva 116,216,72
mvva 116,220,88
s_waitcnt lgkmcnt(1)
mvva 128,192,64
tr 208,238,192
mvva 128,196,80
tr 210,238,448
mvva 136,196,84
tr 212,238,8640
mvva 136,192,68
mvva 144,192,72
tr 214,238,8896
mvva 144,196,88
tr 216,238,200
tr 218,238,456
mvva 132,200,64
s_waitcnt lgkmcnt(4)
tr 220,238,8648
mvva 132,204,80
tr 222,238,8904
mvva 140,204,84
mvva 140,200,68
v_add_u32 v238, s40, v234
mvva 148,200,72
s_add_u32 s40, s40, s42
s_cmp_eq_u32 s40, s43
s_cselect_b32 s40, 0, s40
mvva 148,204,88
buffer_store_dwordx4 v[244:247], v240, s[24:27], s98 offen offset:3072 sc1
s_add_u32 s48, s48, s72
s_waitcnt vmcnt(30) lgkmcnt(0)
s_barrier
mvva 160,208,64
s_add_u32 m0, s41, s49
s_add_u32 s41, s41, s42
tr 192,238,0
mvva 160,212,80
s_cmp_eq_u32 s41, s43
s_cselect_b32 s41, 0, s41
tr 194,238,256
mvva 168,212,84
tr 196,238,8448
mvva 168,208,68
buffer_load_dwordx4 v240, s[12:15], s45 offen nt lds
mvva 176,208,72
s_add_u32 m0, m0, 32
tr 198,238,8704
mvva 176,212,88
tr 200,238,8
tr 202,238,264
mvva 164,216,64
tr 204,238,8456
mvva 164,220,80
tr 206,238,8712
mvva 172,220,84
mvva 172,216,68
buffer_load_dwordx4 v240, s[12:15], s45 offen offset:1024 nt lds
mvva 180,216,72
s_add_u32 m0, m0, 32
mvva 180,220,88
s_waitcnt lgkmcnt(1)
mvva 64,192,96
tr 208,238,64
mvva 64,196,112
tr 210,238,320
mvva 72,196,116
tr 212,238,8512
mvva 72,192,100
buffer_load_dwordx4 v240, s[12:15], s45 offen offset:2048 nt lds
mvva 80,192,104
s_add_u32 m0, m0, 32
tr 214,238,8768
mvva 80,196,120
tr 216,238,72
tr 218,238,328
mvva 68,200,96
s_waitcnt lgkmcnt(4)
tr 220,238,8520
mvva 68,204,112
tr 222,238,8776
mvva 76,204,116
mvva 76,200,100
buffer_load_dwordx4 v240, s[12:15], s45 offen offset:3072 nt lds
mvva 84,200,104
s_add_u32 s45, s45, s52
mvva 84,204,120
mvva 96,208,96
s_waitcnt lgkmcnt(0)
tr 192,238,128
mvva 96,212,112
tr 194,238,384
mvva 104,212,116
tr 196,238,8576
mvva 104,208,100
mvva 112,208,104
tr 198,238,8832
mvva 112,212,120
tr 200,238,136
tr 202,238,392
mvva 100,216,96
tr 204,238,8584
mvva 100,220,112
tr 206,238,8840
mvva 108,220,116
mvva 108,216,100
mvva 116,216,104
mvva 116,220,120
s_waitcnt lgkmcnt(1)
mvva 128,192,96
tr 208,238,192
mvva 128,196,112
tr 210,238,448
mvva 136,196,116
tr 212,238,8640
mvva 136,192,100
mvva 144,192,104
tr 214,238,8896
mvva 144,196,120
tr 216,238,200
tr 218,238,456
mvva 132,200,96
s_waitcnt lgkmcnt(4)
tr 220,238,8648
mvva 132,204,112
tr 222,238,8904
mvva 140,204,116
mvva 140,200,100
v_add_u32 v238, s40, v234
mvva 148,200,104
s_add_u32 s40, s40, s42
s_cmp_eq_u32 s40, s43
s_cselect_b32 s40, 0, s40
mvva 148,204,120
s_waitcnt vmcnt(28) lgkmcnt(0)
s_barrier
mvva 160,208,96
s_add_u32 m0, s41, s49
s_add_u32 s41, s41, s42
tr 192,238,0
mvva 160,212,112
s_cmp_eq_u32 s41, s43
s_cselect_b32 s41, 0, s41
tr 194,238,256
mvva 168,212,116
tr 196,238,8448
mvva 168,208,100
buffer_load_dwordx4 v240, s[8:11], s44 offen nt lds
mvva 176,208,104
s_add_u32 m0, m0, 32
tr 198,238,8704
mvva 176,212,120
tr 200,238,8
tr 202,238,264
mvva 164,216,96
tr 204,238,8456
mvva 164,220,112
tr 206,238,8712
mvva 172,220,116
mvva 172,216,100
buffer_load_dwordx4 v240, s[8:11], s44 offen offset:1024 nt lds
mvva 180,216,104
s_add_u32 m0, m0, 32
mvva 180,220,120
s_waitcnt lgkmcnt(1)
mvva 64,192,128
tr 208,238,64
mvva 64,196,144
tr 210,238,320
mvva 72,196,148
tr 212,238,8512
mvva 72,192,132
buffer_load_dwordx4 v240, s[8:11], s44 offen offset:2048 nt lds
mvva 80,192,136
s_add_u32 m0, m0, 32
tr 214,238,8768
mvva 80,196,152
tr 216,238,72
tr 218,238,328
mvva 68,200,128
s_waitcnt lgkmcnt(4)
tr 220,238,8520
mvva 68,204,144
tr 222,238,8776
mvva 76,204,148
mvva 76,200,132
buffer_load_dwordx4 v240, s[8:11], s44 offen offset:3072 nt lds
mvva 84,200,136
s_add_u32 s44, s44, s52
mvva 84,204,152
mvva 96,208,128
s_waitcnt lgkmcnt(0)
tr 192,238,128
mvva 96,212,144
tr 194,238,384
mvva 104,212,148
tr 196,238,8576
mvva 104,208,132
mvva 112,208,136
tr 198,238,8832
mvva 112,212,152
tr 200,238,136
tr 202,238,392
mvva 100,216,128
tr 204,238,8584
mvva 100,220,144
tr 206,238,8840
mvva 108,220,148
mvva 108,216,132
mvva 116,216,136
mvva 116,220,152
s_waitcnt lgkmcnt(1)
mvva 128,192,128
tr 208,238,192
mvva 128,196,144
tr 210,238,448
mvva 136,196,148
tr 212,238,8640
mvva 136,192,132
mvva 144,192,136
tr 214,238,8896
mvva 144,196,152
tr 216,238,200
tr 218,238,456
mvva 132,200,128
s_waitcnt lgkmcnt(4)
tr 220,238,8648
mvva 132,204,144
tr 222,238,8904
mvva 140,204,148
mvva 140,200,132
v_add_u32 v238, s40, v234
mvva 148,200,136
s_add_u32 s40, s40, s42
s_cmp_eq_u32 s40, s43
s_cselect_b32 s40, 0, s40
mvva 148,204,152
s_waitcnt vmcnt(26) lgkmcnt(0)
s_barrier
mvva 160,208,128
s_add_u32 m0, s41, s49
s_add_u32 s41, s41, s42
tr 192,238,0
mvva 160,212,144
s_cmp_eq_u32 s41, s43
s_cselect_b32 s41, 0, s41
tr 194,238,256
mvva 168,212,148
tr 196,238,8448
mvva 168,208,132
buffer_load_dwordx4 v240, s[12:15], s45 offen nt lds
mvva 176,208,136
s_add_u32 m0, m0, 32
tr 198,238,8704
mvva 176,212,152
tr 200,238,8
tr 202,238,264
mvva 164,216,128
tr 204,238,8456
mvva 164,220,144
tr 206,238,8712
mvva 172,220,148
mvva 172,216,132
buffer_load_dwordx4 v240, s[12:15], s45 offen offset:1024 nt lds
mvva 180,216,136
s_add_u32 m0, m0, 32
mvva 180,220,152
s_waitcnt lgkmcnt(1)
mvva 64,192,160
tr 208,238,64
mvva 64,196,176
tr 210,238,320
mvva 72,196,180
tr 212,238,8512
mvva 72,192,164
buffer_load_dwordx4 v240, s[12:15], s45 offen offset:2048 nt lds
mvva 80,192,168
s_add_u32 m0, m0, 32
tr 214,238,8768
mvva 80,196,184
tr 216,238,72
tr 218,238,328
mvva 68,200,160
s_waitcnt lgkmcnt(4)
tr 220,238,8520
mvva 68,204,176
tr 222,238,8776
mvva 76,204,180
mvva 76,200,164
buffer_load_dwordx4 v240, s[12:15], s45 offen offset:3072 nt lds
mvva 84,200,168
s_add_u32 s45, s45, s52
mvva 84,204,184
mvva 96,208,160
s_waitcnt lgkmcnt(0)
tr 192,238,128
mvva 96,212,176
tr 194,238,384
mvva 104,212,180
tr 196,238,8576
mvva 104,208,164
mvva 112,208,168
tr 198,238,8832
mvva 112,212,184
tr 200,238,136
tr 202,238,392
mvva 100,216,160
tr 204,238,8584
mvva 100,220,176
tr 206,238,8840
mvva 108,220,180
mvva 108,216,164
mvva 116,216,168
mvva 116,220,184
s_waitcnt lgkmcnt(1)
mvva 128,192,160
s_mov_b32 m0, s73
tr 208,238,192
v_lshlrev_b32 v244, 2, v240
mvva 128,196,176
tr 210,238,448
mvva 136,196,180
tr 212,238,8640
mvva 136,192,164
buffer_load_dword v244, s[84:87], s88 offen lds
mvva 144,192,168
tr 214,238,8896
mvva 144,196,184
tr 216,238,200
tr 218,238,456
mvva 132,200,160
s_waitcnt lgkmcnt(4)
tr 220,238,8648
mvva 132,204,176
tr 222,238,8904
mvva 140,204,180
mvva 140,200,164
v_add_u32 v238, s40, v234
mvva 148,200,168
s_add_u32 s40, s40, s42
s_cmp_eq_u32 s40, s43
s_cselect_b32 s40, 0, s40
mvva 148,204,184
s_waitcnt vmcnt(25) lgkmcnt(0)
s_barrier
mvva 160,208,160
s_add_u32 m0, s41, s49
s_add_u32 s41, s41, s42
tr 192,238,0
mvva 160,212,176
s_cmp_eq_u32 s41, s43
s_cselect_b32 s41, 0, s41
tr 194,238,256
mvva 168,212,180
tr 196,238,8448
mvva 168,208,164
buffer_load_dwordx4 v240, s[8:11], s44 offen nt lds
mvva 176,208,168
s_add_u32 m0, m0, 32
tr 198,238,8704
mvva 176,212,184
tr 200,238,8
tr 202,238,264
mvva 164,216,160
tr 204,238,8456
mvva 164,220,176
tr 206,238,8712
mvva 172,220,180
mvva 172,216,164
buffer_load_dwordx4 v240, s[8:11], s44 offen offset:1024 nt lds
mvva 180,216,168
s_add_u32 m0, m0, 32
mvva 180,220,184
s_waitcnt lgkmcnt(1)
mvva 64,192,192
tr 208,238,64
mvva 64,196,208
tr 210,238,320
mvva 72,196,212
tr 212,238,8512
mvva 72,192,196
buffer_load_dwordx4 v240, s[8:11], s44 offen offset:2048 nt lds
mvva 80,192,200
s_add_u32 m0, m0, 32
tr 214,238,8768
mvva 80,196,216
tr 216,238,72
tr 218,238,328
mvva 68,200,192
s_waitcnt lgkmcnt(4)
tr 220,238,8520
mvva 68,204,208
tr 222,238,8776
mvva 76,204,212
mvva 76,200,196
buffer_load_dwordx4 v240, s[8:11], s44 offen offset:3072 nt lds
mvva 84,200,200
s_add_u32 s44, s44, s52
mvva 84,204,216
pk 64,64,65
pk 65,66,67
pk 66,68,69
pk 67,70,71
mvva 96,208,192
s_waitcnt lgkmcnt(0)
tr 192,238,128
pk 68,72,73
mvva 96,212,208
tr 194,238,384
pk 69,74,75
mvva 104,212,212
tr 196,238,8576
pk 70,76,77
mvva 104,208,196
pk 71,78,79
pk 72,80,81
mvva 112,208,200
tr 198,238,8832
pk 73,82,83
mvva 112,212,216
tr 200,238,136
pk 74,84,85
tr 202,238,392
pk 75,86,87
mvva 100,216,192
tr 204,238,8584
mvva 100,220,208
tr 206,238,8840
mvva 108,220,212
mvva 108,216,196
mvva 116,216,200
mvva 116,220,216
s_waitcnt lgkmcnt(1)
pk 80,96,97
pk 81,98,99
mvva 128,192,192
tr 208,238,192
pk 82,100,101
mvva 128,196,208
tr 210,238,448
pk 83,102,103
mvva 136,196,212
tr 212,238,8640
pk 84,104,105
mvva 136,192,196
pk 85,106,107
pk 86,108,109
mvva 144,192,200
tr 214,238,8896
pk 87,110,111
mvva 144,196,216
tr 216,238,200
pk 88,112,113
tr 218,238,456
pk 89,114,115
pk 90,116,117
pk 91,118,119
mvva 132,200,192
s_waitcnt lgkmcnt(4)
tr 220,238,8648
mvva 132,204,208
tr 222,238,8904
mvva 140,204,212
mvva 140,200,196
v_add_u32 v236, s40, v232
mvva 148,200,200
s_add_u32 s40, s40, s42
s_cmp_eq_u32 s40, s43
s_cselect_b32 s40, 0, s40
mvva 148,204,216
pk 96,128,129
pk 97,130,131
pk 98,132,133
pk 99,134,135
s_waitcnt vmcnt(25) lgkmcnt(0)
s_barrier
pk 100,136,137
mvva 160,208,192
s_add_u32 m0, s41, s49
s_add_u32 s41, s41, s42
ds_read_b128 v[192:195], v236 offset:0
mvva 160,212,208
s_cmp_eq_u32 s41, s43
s_cselect_b32 s41, 0, s41
pk 101,138,139
mvva 168,212,212
ds_read_b128 v[196:199], v236 offset:64
pk 102,140,141
mvva 168,208,196
buffer_load_dwordx4 v240, s[12:15], s45 offen nt lds
mvva 176,208,200
s_add_u32 m0, m0, 32
ds_read_b128 v[200:203], v236 offset:128
pk 103,142,143
mvva 176,212,216
pk 104,144,145
pk 105,146,147
ds_read_b128 v[204:207], v236 offset:192
pk 106,148,149
buffer_load_dwordx4 v240, s[12:15], s45 offen offset:1024 nt lds
mvva 164,216,192
s_add_u32 m0, m0, 32
pk 107,150,151
mvva 164,220,208
mvva 172,220,212
mvva 172,216,196
buffer_load_dwordx4 v240, s[12:15], s45 offen offset:2048 nt lds
mvva 180,216,200
s_add_u32 m0, m0, 32
pk 112,160,161
pk 113,162,163
mvva 180,220,216
pk 114,164,165
pk 115,166,167
s_waitcnt lgkmcnt(0)
pk 116,168,169
pk 117,170,171
buffer_load_dwordx4 v240, s[12:15], s45 offen offset:3072 nt lds
mvvvz 128,192,0
s_add_u32 s45, s45, s52
ds_read_b128 v[208:211], v236 offset:256
pk 118,172,173
mvvv 128,196,16
pk 119,174,175
pk 120,176,177
mvvv 128,200,32
s_add_u32 s16, s16, 0x200
s_addc_u32 s17, s17, 0
ds_read_b128 v[212:215], v236 offset:320
mvvv 128,204,48
s_sub_u32 s18, s18, 0x200
pk 121,178,179
pk 122,180,181
mvvvz 136,204,52
s_addk_i32 s46, -256
ds_read_b128 v[216:219], v236 offset:384
pk 123,182,183
mvvv 136,200,36
s_addk_i32 s82, -256
mvvv 136,196,20
s_addk_i32 s58, -256
ds_read_b128 v[220:223], v236 offset:448
mvvv 136,192,4
mvvvz 144,192,8
mvvv 144,196,24
v_mov_b32 v228, 0
v_mov_b32 v229, 0
mvvv 144,200,40
v_mov_b32 v230, 0
v_mov_b32 v231, 0
mvvv 144,204,56
s_waitcnt lgkmcnt(0)
mvvv 128,208,64
ds_read_b128 v[192:195], v236 offset:8448
mvvv 128,212,80
mvvv 128,216,96
ds_read_b128 v[196:199], v236 offset:8512
mvvv 128,220,112
mvvv 136,220,116
ds_read_b128 v[200:203], v236 offset:8576
mvvv 136,216,100
mvvv 136,212,84
ds_read_b128 v[204:207], v236 offset:8640
mvvv 136,208,68
mvvv 144,208,72
mvvv 144,212,88
v_max3_f32 v160, v128, v129, v130
v_max_f32 v160, v160, v131
mvvv 144,216,104
v_mov_b32 v164, v160
mvvv 144,220,120
s_nop 0
v_permlane32_swap_b32 v160, v164
v_max3_f32 v161, v136, v137, v138
v_max_f32 v160, v160, v164
v_mov_b32 v164, v160
v_max_f32 v161, v161, v139
v_mov_b32 v165, v161
s_waitcnt lgkmcnt(0)
v_permlane16_swap_b32 v160, v164
v_max3_f32 v162, v144, v145, v146
mvvvz 132,192,0
ds_read_b128 v[208:211], v236 offset:8704
v_max_f32 v160, v160, v164
mvvv 132,196,16
v_mul_f32 v224, s38, -v160
v_fma_f32 v128, v128, s38, v224
mvvv 132,200,32
ds_read_b128 v[212:215], v236 offset:8768
v_fma_f32 v129, v129, s38, v224
mvvv 132,204,48
v_fma_f32 v130, v130, s38, v224
v_fma_f32 v131, v131, s38, v224
mvvvz 140,204,52
ds_read_b128 v[216:219], v236 offset:8832
v_permlane32_swap_b32 v161, v165
mvvv 140,200,36
v_max_f32 v161, v161, v165
v_mov_b32 v165, v161
mvvv 140,196,20
ds_read_b128 v[220:223], v236 offset:8896
v_max_f32 v162, v162, v147
mvvv 140,192,4
v_permlane16_swap_b32 v161, v165
v_mov_b32 v166, v162
mvvvz 148,192,8
v_max_f32 v161, v161, v165
v_mul_f32 v225, s38, -v161
mvvv 148,196,24
v_fma_f32 v136, v136, s38, v225
v_fma_f32 v137, v137, s38, v225
mvvv 148,200,40
v_fma_f32 v138, v138, s38, v225
v_fma_f32 v139, v139, s38, v225
mvvv 148,204,56
v_add_u32 v236, s40, v232
v_permlane32_swap_b32 v162, v166
s_add_u32 s40, s40, s42
s_cmp_eq_u32 s40, s43
s_cselect_b32 s40, 0, s40
v_max_f32 v162, v162, v166
v_mov_b32 v166, v162
v_max3_f32 v163, v152, v153, v154
v_max_f32 v163, v163, v155
s_waitcnt vmcnt(17) lgkmcnt(0)
s_barrier
v_permlane16_swap_b32 v162, v166
mvvv 132,208,64
ds_read_b128 v[192:195], v236 offset:0
v_max_f32 v162, v162, v166
mvvv 132,212,80
v_mul_f32 v226, s38, -v162
v_fma_f32 v144, v144, s38, v226
mvvv 132,216,96
ds_read_b128 v[196:199], v236 offset:64
v_fma_f32 v145, v145, s38, v226
mvvv 132,220,112
v_fma_f32 v146, v146, s38, v226
v_fma_f32 v147, v147, s38, v226
mvvv 140,220,116
ds_read_b128 v[200:203], v236 offset:128
v_mov_b32 v167, v163
mvvv 140,216,100
mvvv 140,212,84
ds_read_b128 v[204:207], v236 offset:192
v_permlane32_swap_b32 v163, v167
mvvv 140,208,68
v_max_f32 v163, v163, v167
v_mov_b32 v167, v163
mvvv 148,208,72
mvvv 148,212,88
v_permlane16_swap_b32 v163, v167
mvvv 148,216,104
v_max_f32 v163, v163, v167
v_max_f32 v163, s77, v163
mvvv 148,220,120
v_mul_f32 v227, s38, -v163
s_add_u32 m0, s41, s49
s_add_u32 s41, s41, s42
s_cmp_eq_u32 s41, s43
s_cselect_b32 s41, 0, s41
v_fma_f32 v132, v132, s38, v224
s_waitcnt lgkmcnt(0)
v_fma_f32 v133, v133, s38, v224
v_max_f32 v243, v132, v133
mvvvz 160,192,0
ds_read_b128 v[208:211], v236 offset:256
v_fma_f32 v134, v134, s38, v224
mvvv 160,196,16
v_fma_f32 v135, v135, s38, v224
v_max3_f32 v243, v243, v134, v135
mvvv 160,200,32
ds_read_b128 v[212:215], v236 offset:320
v_fma_f32 v140, v140, s38, v225
mvvv 160,204,48
buffer_load_dwordx4 v240, s[8:11], s44 offen nt lds
mvvvz 168,204,52
s_add_u32 m0, m0, 32
ds_read_b128 v[216:219], v236 offset:384
v_fma_f32 v141, v141, s38, v225
mvvv 168,200,36
v_max3_f32 v243, v243, v140, v141
v_fma_f32 v142, v142, s38, v225
mvvv 168,196,20
s_mov_b32 s63, 0
ds_read_b128 v[220:223], v236 offset:448
v_fma_f32 v143, v143, s38, v225
mvvv 168,192,4
v_max3_f32 v243, v243, v142, v143
v_fma_f32 v148, v148, s38, v226
mvvvz 176,192,8
v_fma_f32 v149, v149, s38, v226
v_max3_f32 v243, v243, v148, v149
mvvv 176,196,24
v_fma_f32 v150, v150, s38, v226
v_fma_f32 v151, v151, s38, v226
mvvv 176,200,40
v_max3_f32 v243, v243, v150, v151
mvvv 176,204,56
buffer_load_dwordx4 v240, s[8:11], s44 offen offset:1024 nt lds
s_add_u32 m0, m0, 32
v_cmp_lt_f32 vcc, s39, v243
s_waitcnt lgkmcnt(0)
mvvv 160,208,64
s_cbranch_vccnz L_rare0w
L_ret0w:
ds_read_b128 v[192:195], v236 offset:8448
v_exp_f32 v128, v128
mvvv 160,212,80
v_exp_f32 v129, v129
v_add_f32 v228, v228, v128
mvvv 160,216,96
ds_read_b128 v[196:199], v236 offset:8512
v_exp_f32 v130, v130
v_add_f32 v228, v228, v129
mvvv 160,220,112
buffer_load_dwordx4 v240, s[8:11], s44 offen offset:2048 nt lds
pk 128,128,129
mvvv 168,220,116
s_add_u32 m0, m0, 32
ds_read_b128 v[200:203], v236 offset:8576
v_exp_f32 v131, v131
v_add_f32 v228, v228, v130
mvvv 168,216,100
v_exp_f32 v132, v132
v_add_f32 v228, v228, v131
pk 129,130,131
mvvv 168,212,84
ds_read_b128 v[204:207], v236 offset:8640
v_exp_f32 v133, v133
v_add_f32 v228, v228, v132
mvvv 168,208,68
v_fma_f32 v160, v160, s38, v224
v_fma_f32 v161, v161, s38, v224
v_exp_f32 v134, v134
mvvv 176,208,72
v_max_f32 v243, v160, v161
v_fma_f32 v162, v162, s38, v224
v_add_f32 v228, v228, v133
pk 130,132,133
mvvv 176,212,88
v_fma_f32 v163, v163, s38, v224
v_max3_f32 v243, v243, v162, v163
v_exp_f32 v135, v135
mvvv 176,216,104
v_fma_f32 v168, v168, s38, v225
v_fma_f32 v169, v169, s38, v225
v_add_f32 v228, v228, v134
mvvv 176,220,120
buffer_load_dwordx4 v240, s[8:11], s44 offen offset:3072 nt lds
v_exp_f32 v136, v136
s_add_u32 s44, s44, s52
v_max3_f32 v243, v243, v168, v169
v_fma_f32 v170, v170, s38, v225
v_add_f32 v228, v228, v135
pk 131,134,135
v_fma_f32 v171, v171, s38, v225
v_max3_f32 v243, v243, v170, v171
v_exp_f32 v137, v137
v_fma_f32 v176, v176, s38, v226
v_fma_f32 v177, v177, s38, v226
v_add_f32 v229, v229, v136
s_waitcnt lgkmcnt(0)
v_max3_f32 v243, v243, v176, v177
v_fma_f32 v178, v178, s38, v226
v_exp_f32 v138, v138
mvvvz 164,192,0
ds_read_b128 v[208:211], v236 offset:8704
v_fma_f32 v179, v179, s38, v226
v_add_f32 v229, v229, v137
pk 136,136,137
mvvv 164,196,16
v_max3_f32 v243, v243, v178, v179
v_exp_f32 v139, v139
v_add_f32 v229, v229, v138
mvvv 164,200,32
ds_read_b128 v[212:215], v236 offset:8768
v_exp_f32 v140, v140
mvvv 164,204,48
v_add_f32 v229, v229, v139
pk 137,138,139
mvvvz 172,204,52
ds_read_b128 v[216:219], v236 offset:8832
mvvv 172,200,36
v_exp_f32 v141, v141
mvvv 172,196,20
ds_read_b128 v[220:223], v236 offset:8896
v_add_f32 v229, v229, v140
v_exp_f32 v142, v142
mvvv 172,192,4
v_add_f32 v229, v229, v141
pk 138,140,141
v_exp_f32 v143, v143
mvvvz 180,192,8
v_add_f32 v229, v229, v142
v_exp_f32 v144, v144
v_add_f32 v229, v229, v143
mvvv 180,196,24
pk 139,142,143
v_exp_f32 v145, v145
v_add_f32 v230, v230, v144
mvvv 180,200,40
v_exp_f32 v146, v146
v_add_f32 v230, v230, v145
pk 144,144,145
mvvv 180,204,56
v_add_u32 v237, s40, v233
v_exp_f32 v147, v147
v_add_f32 v230, v230, v146
s_add_u32 s40, s40, s42
s_cmp_eq_u32 s40, s43
s_cselect_b32 s40, 0, s40
v_exp_f32 v148, v148
v_add_f32 v230, v230, v147
pk 145,146,147
v_exp_f32 v149, v149
v_add_f32 v230, v230, v148
v_exp_f32 v150, v150
s_waitcnt lgkmcnt(0)
v_add_f32 v230, v230, v149
pk 146,148,149
v_exp_f32 v151, v151
mvvv 164,208,64
tr 192,237,0
v_add_f32 v230, v230, v150
mvvv 164,212,80
tr 194,237,8448
v_add_f32 v230, v230, v151
pk 147,150,151
mvvv 164,216,96
tr 196,237,32
mvvv 164,220,112
mvvv 172,220,116
tr 198,237,8480
mvvv 172,216,100
tr 200,237,64
mvvv 172,212,84
tr 202,237,8512
mvvv 172,208,68
mvvv 180,208,72
tr 204,237,96
v_fma_f32 v164, v164, s38, v224
mvvv 180,212,88
tr 206,237,8544
v_fma_f32 v165, v165, s38, v224
mvvv 180,216,104
v_max3_f32 v243, v243, v164, v165
v_fma_f32 v166, v166, s38, v224
s_nop 0
mvvv 180,220,120
v_fma_f32 v167, v167, s38, v224
v_max3_f32 v243, v243, v166, v167
v_fma_f32 v172, v172, s38, v225
v_fma_f32 v173, v173, s38, v225
v_max3_f32 v243, v243, v172, v173
v_fma_f32 v174, v174, s38, v225
v_fma_f32 v175, v175, s38, v225
v_max3_f32 v243, v243, v174, v175
s_waitcnt lgkmcnt(1)
v_fma_f32 v180, v180, s38, v226
v_fma_f32 v181, v181, s38, v226
mavvz 0,192,128
s_mov_b32 s63, 1
tr 208,237,128
v_max3_f32 v243, v243, v180, v181
mavvz 4,192,136
tr 210,237,8576
v_fma_f32 v182, v182, s38, v226
mavvz 8,192,144
v_fma_f32 v183, v183, s38, v226
v_max3_f32 v243, v243, v182, v183
tr 212,237,160
tr 214,237,8608
mavvz 24,196,144
mavvz 20,196,136
tr 216,237,192
mavvz 16,196,128
tr 218,237,8640
mavvz 32,200,128
v_cmp_lt_f32 vcc, s39, v243
mavvz 36,200,136
tr 220,237,224
mavvz 40,200,144
s_cbranch_vccnz L_rare1w
L_ret1w:
tr 222,237,8672
s_waitcnt lgkmcnt(4)
v_exp_f32 v160, v160
tr 192,237,256
v_add_f32 v228, v228, v160
mavvz 56,204,144
tr 194,237,8704
mavvz 52,204,136
v_exp_f32 v161, v161
mavvz 48,204,128
tr 196,237,288
v_add_f32 v228, v228, v161
mavvz 64,208,128
tr 198,237,8736
pk 160,160,161
mavvz 68,208,136
v_exp_f32 v162, v162
mavvz 72,208,144
tr 200,237,320
v_add_f32 v228, v228, v162
tr 202,237,8768
v_exp_f32 v163, v163
mavvz 88,212,144
tr 204,237,352
v_add_f32 v228, v228, v163
mavvz 84,212,136
tr 206,237,8800
pk 161,162,163
mavvz 80,212,128
s_waitcnt lgkmcnt(4)
v_exp_f32 v164, v164
mavvz 96,216,128
tr 208,237,384
v_add_f32 v228, v228, v164
mavvz 100,216,136
tr 210,237,8832
mavvz 104,216,144
v_exp_f32 v165, v165
tr 212,237,416
v_add_f32 v228, v228, v165
tr 214,237,8864
pk 162,164,165
mavvz 120,220,144
v_exp_f32 v166, v166
mavvz 116,220,136
tr 216,237,448
v_add_f32 v228, v228, v166
mavvz 112,220,128
tr 218,237,8896
mavvz 128,192,128
v_exp_f32 v167, v167
mavvz 132,192,136
tr 220,237,480
v_add_f32 v228, v228, v167
mavvz 136,192,144
tr 222,237,8928
pk 163,166,167
v_exp_f32 v168, v168
v_exp_f32 v169, v169
mavvz 152,196,144
v_exp_f32 v170, v170
mavvz 148,196,136
v_exp_f32 v171, v171
mavvz 144,196,128
s_waitcnt lgkmcnt(2)
v_exp_f32 v172, v172
mavvz 160,200,128
v_exp_f32 v173, v173
mavvz 164,200,136
v_exp_f32 v174, v174
mavvz 168,200,144
v_exp_f32 v175, v175
v_add_u32 v236, s40, v232
v_add_f32 v229, v229, v168
s_add_u32 s40, s40, s42
s_cmp_eq_u32 s40, s43
s_cselect_b32 s40, 0, s40
mavvz 184,204,144
v_exp_f32 v176, v176
mavvz 180,204,136
v_exp_f32 v177, v177
mavvz 176,204,128
s_waitcnt vmcnt(13) lgkmcnt(0)
s_barrier
v_add_f32 v229, v229, v169
mavvz 192,208,128
s_add_u32 m0, s41, s49
s_add_u32 s41, s41, s42
ds_read_b128 v[192:195], v236 offset:0
mavvz 196,208,136
s_cmp_eq_u32 s41, s43
s_cselect_b32 s41, 0, s41
pk 168,168,169
mavvz 200,208,144
ds_read_b128 v[196:199], v236 offset:64
v_add_f32 v229, v229, v170
buffer_load_dwordx4 v240, s[12:15], s45 offen nt lds
s_add_u32 m0, m0, 32
ds_read_b128 v[200:203], v236 offset:128
v_add_f32 v229, v229, v171
mavvz 216,212,144
v_exp_f32 v178, v178
mavvz 212,212,136
ds_read_b128 v[204:207], v236 offset:192
pk 169,170,171
mavvz 208,212,128
buffer_load_dwordx4 v240, s[12:15], s45 offen offset:1024 nt lds
mavvz 224,216,128
s_add_u32 m0, m0, 32
v_exp_f32 v179, v179
mavvz 228,216,136
v_exp_f32 v180, v180
mavvz 232,216,144
v_exp_f32 v181, v181
buffer_load_dwordx4 v240, s[12:15], s45 offen offset:2048 nt lds
s_add_u32 m0, m0, 32
v_exp_f32 v182, v182
mavvz 248,220,144
v_exp_f32 v183, v183
mavvz 244,220,136
s_waitcnt lgkmcnt(0)
mavvz 240,220,128
buffer_load_dwordx4 v240, s[12:15], s45 offen offset:3072 nt lds
s_mov_b32 s64, 5
L_loopw:
mvvvz 128,192,0
s_add_u32 s45, s45, s52
s_add_u32 m0, s41, s49
ds_read_b128 v[208:211], v236 offset:256
mvvv 128,196,16
s_add_u32 s41, s41, s42
s_cmp_eq_u32 s41, s43
s_cselect_b32 s41, 0, s41
mvvv 128,200,32
ds_read_b128 v[212:215], v236 offset:320
v_add_f32 v229, v229, v172
mvvv 128,204,48
buffer_load_dwordx4 v240, s[8:11], s44 offen nt lds
mvvvz 136,204,52
s_add_u32 m0, m0, 32
ds_read_b128 v[216:219], v236 offset:384
v_add_f32 v229, v229, v173
mvvv 136,200,36
mvvv 136,196,20
ds_read_b128 v[220:223], v236 offset:448
pk 170,172,173
mvvv 136,192,4
mvvvz 144,192,8
mvvv 144,196,24
mvvv 144,200,40
mvvv 144,204,56
buffer_load_dwordx4 v240, s[8:11], s44 offen offset:1024 nt lds
s_add_u32 m0, m0, 32
v_add_f32 v229, v229, v174
v_add_f32 v229, v229, v175
s_waitcnt lgkmcnt(0)
pk 171,174,175
v_add_f32 v230, v230, v176
mvvv 128,208,64
ds_read_b128 v[192:195], v236 offset:8448
v_add_f32 v230, v230, v177
mvvv 128,212,80
pk 176,176,177
v_add_f32 v230, v230, v178
mvvv 128,216,96
ds_read_b128 v[196:199], v236 offset:8512
v_add_f32 v230, v230, v179
mvvv 128,220,112
buffer_load_dwordx4 v240, s[8:11], s44 offen offset:2048 nt lds
mvvv 136,220,116
s_add_u32 m0, m0, 32
ds_read_b128 v[200:203], v236 offset:8576
pk 177,178,179
mvvv 136,216,100
v_add_f32 v230, v230, v180
v_add_f32 v230, v230, v181
mvvv 136,212,84
ds_read_b128 v[204:207], v236 offset:8640
pk 178,180,181
mvvv 136,208,68
v_fma_f32 v128, v128, s38, v224
v_fma_f32 v129, v129, s38, v224
mvvv 144,208,72
v_max_f32 v243, v128, v129
v_fma_f32 v130, v130, s38, v224
mvvv 144,212,88
v_fma_f32 v131, v131, s38, v224
v_max3_f32 v243, v243, v130, v131
mvvv 144,216,104
v_fma_f32 v136, v136, s38, v225
v_fma_f32 v137, v137, s38, v225
mvvv 144,220,120
buffer_load_dwordx4 v240, s[8:11], s44 offen offset:3072 nt lds
s_add_u32 s44, s44, s52
v_max3_f32 v243, v243, v136, v137
v_fma_f32 v138, v138, s38, v225
v_fma_f32 v139, v139, s38, v225
v_max3_f32 v243, v243, v138, v139
s_nop 1
v_fma_f32 v144, v144, s38, v226
v_fma_f32 v145, v145, s38, v226
s_waitcnt lgkmcnt(0)
v_max3_f32 v243, v243, v144, v145
v_fma_f32 v146, v146, s38, v226
mvvvz 132,192,0
ds_read_b128 v[208:211], v236 offset:8704
v_fma_f32 v147, v147, s38, v226
mvvv 132,196,16
v_max3_f32 v243, v243, v146, v147
v_add_f32 v230, v230, v182
mvvv 132,200,32
ds_read_b128 v[212:215], v236 offset:8768
mvvv 132,204,48
mvvvz 140,204,52
ds_read_b128 v[216:219], v236 offset:8832
mvvv 140,200,36
mvvv 140,196,20
ds_read_b128 v[220:223], v236 offset:8896
v_add_f32 v230, v230, v183
mvvv 140,192,4
pk 179,182,183
mvvvz 148,192,8
mvvv 148,196,24
mvvv 148,200,40
mvvv 148,204,56
v_add_u32 v237, s40, v233
s_add_u32 s40, s40, s42
s_cmp_eq_u32 s40, s43
s_cselect_b32 s40, 0, s40
s_waitcnt lgkmcnt(0)
mvvv 132,208,64
tr 192,237,0
mvvv 132,212,80
tr 194,237,8448
mvvv 132,216,96
tr 196,237,32
mvvv 132,220,112
mvvv 140,220,116
tr 198,237,8480
mvvv 140,216,100
tr 200,237,64
mvvv 140,212,84
tr 202,237,8512
mvvv 140,208,68
mvvv 148,208,72
tr 204,237,96
v_fma_f32 v132, v132, s38, v224
mvvv 148,212,88
tr 206,237,8544
v_fma_f32 v133, v133, s38, v224
mvvv 148,216,104
v_max3_f32 v243, v243, v132, v133
v_fma_f32 v134, v134, s38, v224
mvvv 148,220,120
v_fma_f32 v135, v135, s38, v224
v_max3_f32 v243, v243, v134, v135
v_fma_f32 v140, v140, s38, v225
v_fma_f32 v141, v141, s38, v225
v_max3_f32 v243, v243, v140, v141
v_fma_f32 v142, v142, s38, v225
v_fma_f32 v143, v143, s38, v225
v_max3_f32 v243, v243, v142, v143
s_waitcnt lgkmcnt(1)
v_fma_f32 v148, v148, s38, v226
v_fma_f32 v149, v149, s38, v226
mavv 0,192,160
s_mov_b32 s63, 2
tr 208,237,128
v_max3_f32 v243, v243, v148, v149
mavv 4,192,168
tr 210,237,8576
v_fma_f32 v150, v150, s38, v226
mavv 8,192,176
v_fma_f32 v151, v151, s38, v226
v_max3_f32 v243, v243, v150, v151
tr 212,237,160
tr 214,237,8608
mavv 24,196,176
mavv 20,196,168
tr 216,237,192
mavv 16,196,160
tr 218,237,8640
mavv 32,200,160
v_cmp_lt_f32 vcc, s39, v243
mavv 36,200,168
tr 220,237,224
mavv 40,200,176
s_cbranch_vccnz L_rare0w
L_ret2w:
tr 222,237,8672
s_waitcnt lgkmcnt(4)
v_exp_f32 v128, v128
tr 192,237,256
v_add_f32 v228, v228, v128
mavv 56,204,176
tr 194,237,8704
mavv 52,204,168
v_exp_f32 v129, v129
mavv 48,204,160
tr 196,237,288
v_add_f32 v228, v228, v129
mavv 64,208,160
tr 198,237,8736
pk 128,128,129
mavv 68,208,168
v_exp_f32 v130, v130
mavv 72,208,176
tr 200,237,320
v_add_f32 v228, v228, v130
tr 202,237,8768
v_exp_f32 v131, v131
mavv 88,212,176
tr 204,237,352
v_add_f32 v228, v228, v131
mavv 84,212,168
tr 206,237,8800
pk 129,130,131
mavv 80,212,160
s_waitcnt lgkmcnt(4)
v_exp_f32 v132, v132
mavv 96,216,160
tr 208,237,384
v_add_f32 v228, v228, v132
mavv 100,216,168
tr 210,237,8832
mavv 104,216,176
v_exp_f32 v133, v133
tr 212,237,416
v_add_f32 v228, v228, v133
tr 214,237,8864
pk 130,132,133
mavv 120,220,176
v_exp_f32 v134, v134
mavv 116,220,168
tr 216,237,448
v_add_f32 v228, v228, v134
mavv 112,220,160
tr 218,237,8896
mavv 128,192,160
v_exp_f32 v135, v135
mavv 132,192,168
tr 220,237,480
v_add_f32 v228, v228, v135
mavv 136,192,176
tr 222,237,8928
pk 131,134,135
v_exp_f32 v136, v136
v_exp_f32 v137, v137
mavv 152,196,176
v_exp_f32 v138, v138
mavv 148,196,168
v_exp_f32 v139, v139
mavv 144,196,160
s_waitcnt lgkmcnt(2)
v_exp_f32 v140, v140
mavv 160,200,160
v_exp_f32 v141, v141
mavv 164,200,168
v_exp_f32 v142, v142
mavv 168,200,176
v_exp_f32 v143, v143
v_add_u32 v236, s40, v232
v_add_f32 v229, v229, v136
s_add_u32 s40, s40, s42
s_cmp_eq_u32 s40, s43
s_cselect_b32 s40, 0, s40
mavv 184,204,176
v_exp_f32 v144, v144
mavv 180,204,168
v_exp_f32 v145, v145
mavv 176,204,160
s_waitcnt vmcnt(12) lgkmcnt(0)
s_barrier
v_add_f32 v229, v229, v137
mavv 192,208,160
s_add_u32 m0, s41, s49
s_add_u32 s41, s41, s42
ds_read_b128 v[192:195], v236 offset:0
mavv 196,208,168
s_cmp_eq_u32 s41, s43
s_cselect_b32 s41, 0, s41
pk 136,136,137
mavv 200,208,176
ds_read_b128 v[196:199], v236 offset:64
v_add_f32 v229, v229, v138
buffer_load_dwordx4 v240, s[12:15], s45 offen nt lds
s_add_u32 m0, m0, 32
ds_read_b128 v[200:203], v236 offset:128
v_add_f32 v229, v229, v139
mavv 216,212,176
v_exp_f32 v146, v146
mavv 212,212,168
ds_read_b128 v[204:207], v236 offset:192
pk 137,138,139
mavv 208,212,160
buffer_load_dwordx4 v240, s[12:15], s45 offen offset:1024 nt lds
mavv 224,216,160
s_add_u32 m0, m0, 32
v_exp_f32 v147, v147
mavv 228,216,168
v_exp_f32 v148, v148
mavv 232,216,176
v_exp_f32 v149, v149
buffer_load_dwordx4 v240, s[12:15], s45 offen offset:2048 nt lds
s_add_u32 m0, m0, 32
v_exp_f32 v150, v150
mavv 248,220,176
v_exp_f32 v151, v151
mavv 244,220,168
s_waitcnt lgkmcnt(0)
mavv 240,220,160
buffer_load_dwordx4 v240, s[12:15], s45 offen offset:3072 nt lds
mvvvz 160,192,0
s_add_u32 s45, s45, s52
s_add_u32 m0, s41, s49
ds_read_b128 v[208:211], v236 offset:256
mvvv 160,196,16
s_add_u32 s41, s41, s42
s_cmp_eq_u32 s41, s43
s_cselect_b32 s41, 0, s41
mvvv 160,200,32
ds_read_b128 v[212:215], v236 offset:320
v_add_f32 v229, v229, v140
mvvv 160,204,48
buffer_load_dwordx4 v240, s[8:11], s44 offen nt lds
mvvvz 168,204,52
s_add_u32 m0, m0, 32
ds_read_b128 v[216:219], v236 offset:384
v_add_f32 v229, v229, v141
mvvv 168,200,36
mvvv 168,196,20
ds_read_b128 v[220:223], v236 offset:448
pk 138,140,141
mvvv 168,192,4
mvvvz 176,192,8
mvvv 176,196,24
mvvv 176,200,40
mvvv 176,204,56
buffer_load_dwordx4 v240, s[8:11], s44 offen offset:1024 nt lds
s_add_u32 m0, m0, 32
v_add_f32 v229, v229, v142
v_add_f32 v229, v229, v143
s_waitcnt lgkmcnt(0)
pk 139,142,143
v_add_f32 v230, v230, v144
mvvv 160,208,64
ds_read_b128 v[192:195], v236 offset:8448
v_add_f32 v230, v230, v145
mvvv 160,212,80
pk 144,144,145
v_add_f32 v230, v230, v146
mvvv 160,216,96
ds_read_b128 v[196:199], v236 offset:8512
v_add_f32 v230, v230, v147
mvvv 160,220,112
buffer_load_dwordx4 v240, s[8:11], s44 offen offset:2048 nt lds
mvvv 168,220,116
s_add_u32 m0, m0, 32
ds_read_b128 v[200:203], v236 offset:8576
pk 145,146,147
mvvv 168,216,100
v_add_f32 v230, v230, v148
v_add_f32 v230, v230, v149
mvvv 168,212,84
ds_read_b128 v[204:207], v236 offset:8640
pk 146,148,149
mvvv 168,208,68
v_fma_f32 v160, v160, s38, v224
v_fma_f32 v161, v161, s38, v224
mvvv 176,208,72
v_max_f32 v243, v160, v161
v_fma_f32 v162, v162, s38, v224
mvvv 176,212,88
v_fma_f32 v163, v163, s38, v224
v_max3_f32 v243, v243, v162, v163
mvvv 176,216,104
v_fma_f32 v168, v168, s38, v225
v_fma_f32 v169, v169, s38, v225
mvvv 176,220,120
buffer_load_dwordx4 v240, s[8:11], s44 offen offset:3072 nt lds
s_add_u32 s44, s44, s52
v_max3_f32 v243, v243, v168, v169
v_fma_f32 v170, v170, s38, v225
v_fma_f32 v171, v171, s38, v225
v_max3_f32 v243, v243, v170, v171
s_nop 1
v_fma_f32 v176, v176, s38, v226
v_fma_f32 v177, v177, s38, v226
s_waitcnt lgkmcnt(0)
v_max3_f32 v243, v243, v176, v177
v_fma_f32 v178, v178, s38, v226
mvvvz 164,192,0
ds_read_b128 v[208:211], v236 offset:8704
v_fma_f32 v179, v179, s38, v226
mvvv 164,196,16
v_max3_f32 v243, v243, v178, v179
v_add_f32 v230, v230, v150
mvvv 164,200,32
ds_read_b128 v[212:215], v236 offset:8768
mvvv 164,204,48
mvvvz 172,204,52
ds_read_b128 v[216:219], v236 offset:8832
mvvv 172,200,36
mvvv 172,196,20
ds_read_b128 v[220:223], v236 offset:8896
v_add_f32 v230, v230, v151
mvvv 172,192,4
pk 147,150,151
mvvvz 180,192,8
mvvv 180,196,24
mvvv 180,200,40
mvvv 180,204,56
v_add_u32 v237, s40, v233
s_add_u32 s40, s40, s42
s_cmp_eq_u32 s40, s43
s_cselect_b32 s40, 0, s40
s_waitcnt lgkmcnt(0)
mvvv 164,208,64
tr 192,237,0
mvvv 164,212,80
tr 194,237,8448
mvvv 164,216,96
tr 196,237,32
mvvv 164,220,112
mvvv 172,220,116
tr 198,237,8480
mvvv 172,216,100
tr 200,237,64
mvvv 172,212,84
tr 202,237,8512
mvvv 172,208,68
mvvv 180,208,72
tr 204,237,96
v_fma_f32 v164, v164, s38, v224
mvvv 180,212,88
tr 206,237,8544
v_fma_f32 v165, v165, s38, v224
mvvv 180,216,104
v_max3_f32 v243, v243, v164, v165
v_fma_f32 v166, v166, s38, v224
mvvv 180,220,120
v_fma_f32 v167, v167, s38, v224
v_max3_f32 v243, v243, v166, v167
v_fma_f32 v172, v172, s38, v225
v_fma_f32 v173, v173, s38, v225
v_max3_f32 v243, v243, v172, v173
v_fma_f32 v174, v174, s38, v225
v_fma_f32 v175, v175, s38, v225
v_max3_f32 v243, v243, v174, v175
s_waitcnt lgkmcnt(1)
v_fma_f32 v180, v180, s38, v226
v_fma_f32 v181, v181, s38, v226
mavv 0,192,128
s_mov_b32 s63, 3
tr 208,237,128
v_max3_f32 v243, v243, v180, v181
mavv 4,192,136
tr 210,237,8576
v_fma_f32 v182, v182, s38, v226
mavv 8,192,144
v_fma_f32 v183, v183, s38, v226
v_max3_f32 v243, v243, v182, v183
tr 212,237,160
tr 214,237,8608
mavv 24,196,144
mavv 20,196,136
tr 216,237,192
mavv 16,196,128
tr 218,237,8640
mavv 32,200,128
v_cmp_lt_f32 vcc, s39, v243
mavv 36,200,136
tr 220,237,224
mavv 40,200,144
s_cbranch_vccnz L_rare1w
L_ret3w:
tr 222,237,8672
s_waitcnt lgkmcnt(4)
v_exp_f32 v160, v160
tr 192,237,256
v_add_f32 v228, v228, v160
mavv 56,204,144
tr 194,237,8704
mavv 52,204,136
v_exp_f32 v161, v161
mavv 48,204,128
tr 196,237,288
v_add_f32 v228, v228, v161
mavv 64,208,128
tr 198,237,8736
pk 160,160,161
mavv 68,208,136
v_exp_f32 v162, v162
mavv 72,208,144
tr 200,237,320
v_add_f32 v228, v228, v162
tr 202,237,8768
v_exp_f32 v163, v163
mavv 88,212,144
tr 204,237,352
v_add_f32 v228, v228, v163
mavv 84,212,136
tr 206,237,8800
pk 161,162,163
mavv 80,212,128
s_waitcnt lgkmcnt(4)
v_exp_f32 v164, v164
mavv 96,216,128
tr 208,237,384
v_add_f32 v228, v228, v164
mavv 100,216,136
tr 210,237,8832
mavv 104,216,144
v_exp_f32 v165, v165
tr 212,237,416
v_add_f32 v228, v228, v165
tr 214,237,8864
pk 162,164,165
mavv 120,220,144
v_exp_f32 v166, v166
mavv 116,220,136
tr 216,237,448
v_add_f32 v228, v228, v166
mavv 112,220,128
tr 218,237,8896
mavv 128,192,128
v_exp_f32 v167, v167
mavv 132,192,136
tr 220,237,480
v_add_f32 v228, v228, v167
mavv 136,192,144
tr 222,237,8928
pk 163,166,167
v_exp_f32 v168, v168
v_exp_f32 v169, v169
mavv 152,196,144
v_exp_f32 v170, v170
mavv 148,196,136
v_exp_f32 v171, v171
mavv 144,196,128
s_waitcnt lgkmcnt(2)
v_exp_f32 v172, v172
mavv 160,200,128
v_exp_f32 v173, v173
mavv 164,200,136
v_exp_f32 v174, v174
mavv 168,200,144
v_exp_f32 v175, v175
v_add_u32 v236, s40, v232
v_add_f32 v229, v229, v168
s_add_u32 s40, s40, s42
s_cmp_eq_u32 s40, s43
s_cselect_b32 s40, 0, s40
mavv 184,204,144
v_exp_f32 v176, v176
mavv 180,204,136
v_exp_f32 v177, v177
mavv 176,204,128
s_waitcnt vmcnt(12) lgkmcnt(0)
s_barrier
v_add_f32 v229, v229, v169
mavv 192,208,128
s_add_u32 m0, s41, s49
s_add_u32 s41, s41, s42
ds_read_b128 v[192:195], v236 offset:0
mavv 196,208,136
s_cmp_eq_u32 s41, s43
s_cselect_b32 s41, 0, s41
pk 168,168,169
mavv 200,208,144
ds_read_b128 v[196:199], v236 offset:64
v_add_f32 v229, v229, v170
buffer_load_dwordx4 v240, s[12:15], s45 offen nt lds
s_add_u32 m0, m0, 32
ds_read_b128 v[200:203], v236 offset:128
v_add_f32 v229, v229, v171
mavv 216,212,144
v_exp_f32 v178, v178
mavv 212,212,136
ds_read_b128 v[204:207], v236 offset:192
pk 169,170,171
mavv 208,212,128
buffer_load_dwordx4 v240, s[12:15], s45 offen offset:1024 nt lds
mavv 224,216,128
s_add_u32 m0, m0, 32
v_exp_f32 v179, v179
mavv 228,216,136
v_exp_f32 v180, v180
mavv 232,216,144
v_exp_f32 v181, v181
buffer_load_dwordx4 v240, s[12:15], s45 offen offset:2048 nt lds
s_add_u32 m0, m0, 32
v_exp_f32 v182, v182
mavv 248,220,144
v_exp_f32 v183, v183
mavv 244,220,136
s_waitcnt lgkmcnt(0)
mavv 240,220,128
buffer_load_dwordx4 v240, s[12:15], s45 offen offset:3072 nt lds
s_sub_u32 s64, s64, 1
s_cmp_lg_u32 s64, 0
s_cbranch_scc1 L_loopw
s_cmp_lg_u32 s5, 0
s_cbranch_scc1 L_pre_bw
s_mov_b64 vcc, -1
s_branch L_padC3
L_hop_aw:
s_cmp_eq_u32 s4, 3
s_cbranch_scc1 L_ret_aw
L_ret_aw:
s_mov_b64 vcc, 0
L_tail_aw:
mvvvz 128,192,0
s_add_u32 s45, s45, s52
s_add_u32 m0, s41, s49
ds_read_b128 v[208:211], v236 offset:256
mvvv 128,196,16
s_add_u32 s41, s41, s42
s_cmp_eq_u32 s41, s43
s_cselect_b32 s41, 0, s41
mvvv 128,200,32
s_mov_b32 s26, 0x20000
s_mov_b32 s48, s70
ds_read_b128 v[212:215], v236 offset:320
mvvv 128,204,48
buffer_load_dwordx4 v240, s[8:11], s44 offen nt lds
mvvvz 136,204,52
s_add_u32 m0, m0, 32
s_mov_b32 s84, s36
ds_read_b128 v[216:219], v236 offset:384
mvvv 136,200,36
s_mov_b32 s85, s37
s_bitcmp1_b32 s4, 0
s_cselect_b32 s86, 0x3800, 0x3800
s_bitcmp1_b32 s4, 0
s_cselect_b32 s94, 0, 0x200
mvvv 136,196,20
s_movk_i32 s95, 0x400
s_bitcmp1_b32 s4, 0
s_cselect_b32 s95, 0x200, s95
ds_read_b128 v[220:223], v236 offset:448
mvvv 136,192,4
s_movk_i32 s64, 0x4000
s_bitcmp1_b32 s4, 0
s_cselect_b32 s64, 0x2000, s64
v_add_f32 v229, v229, v172
mvvvz 144,192,8
mvvv 144,196,24
mvvv 144,200,40
mvvv 144,204,56
buffer_load_dwordx4 v240, s[8:11], s44 offen offset:1024 nt lds
s_add_u32 m0, m0, 32
s_waitcnt lgkmcnt(0)
mvvv 128,208,64
ds_read_b128 v[192:195], v236 offset:8448
v_add_f32 v229, v229, v173
mvvv 128,212,80
pk 170,172,173
v_add_f32 v229, v229, v174
mvvv 128,216,96
ds_read_b128 v[196:199], v236 offset:8512
v_add_f32 v229, v229, v175
mvvv 128,220,112
buffer_load_dwordx4 v240, s[8:11], s44 offen offset:2048 nt lds
mvvv 136,220,116
s_add_u32 m0, m0, 32
ds_read_b128 v[200:203], v236 offset:8576
pk 171,174,175
mvvv 136,216,100
v_add_f32 v230, v230, v176
v_add_f32 v230, v230, v177
mvvv 136,212,84
ds_read_b128 v[204:207], v236 offset:8640
pk 176,176,177
mvvv 136,208,68
v_fma_f32 v128, v128, s38, v224
v_fma_f32 v129, v129, s38, v224
mvvv 144,208,72
v_max_f32 v243, v128, v129
v_fma_f32 v130, v130, s38, v224
mvvv 144,212,88
v_fma_f32 v131, v131, s38, v224
v_max3_f32 v243, v243, v130, v131
mvvv 144,216,104
v_fma_f32 v136, v136, s38, v225
v_fma_f32 v137, v137, s38, v225
mvvv 144,220,120
buffer_load_dwordx4 v240, s[8:11], s44 offen offset:3072 nt lds
s_add_u32 s44, s44, s52
v_max3_f32 v243, v243, v136, v137
v_fma_f32 v138, v138, s38, v225
v_fma_f32 v139, v139, s38, v225
v_max3_f32 v243, v243, v138, v139
s_nop 1
v_fma_f32 v144, v144, s38, v226
v_fma_f32 v145, v145, s38, v226
s_waitcnt lgkmcnt(0)
v_max3_f32 v243, v243, v144, v145
v_fma_f32 v146, v146, s38, v226
mvvvz 132,192,0
ds_read_b128 v[208:211], v236 offset:8704
v_fma_f32 v147, v147, s38, v226
mvvv 132,196,16
v_max3_f32 v243, v243, v146, v147
v_add_f32 v230, v230, v178
mvvv 132,200,32
ds_read_b128 v[212:215], v236 offset:8768
mvvv 132,204,48
mvvvz 140,204,52
ds_read_b128 v[216:219], v236 offset:8832
mvvv 140,200,36
mvvv 140,196,20
ds_read_b128 v[220:223], v236 offset:8896
v_add_f32 v230, v230, v179
mvvv 140,192,4
pk 177,178,179
v_add_f32 v230, v230, v180
mvvvz 148,192,8
v_add_f32 v230, v230, v181
pk 178,180,181
mvvv 148,196,24
v_add_f32 v230, v230, v182
v_add_f32 v230, v230, v183
mvvv 148,200,40
pk 179,182,183
mvvv 148,204,56
v_add_u32 v237, s40, v233
s_add_u32 s40, s40, s42
s_cmp_eq_u32 s40, s43
s_cselect_b32 s40, 0, s40
s_waitcnt lgkmcnt(0)
mvvv 132,208,64
tr 192,237,0
mvvv 132,212,80
tr 194,237,8448
mvvv 132,216,96
tr 196,237,32
mvvv 132,220,112
mvvv 140,220,116
tr 198,237,8480
mvvv 140,216,100
tr 200,237,64
mvvv 140,212,84
tr 202,237,8512
mvvv 140,208,68
mvvv 148,208,72
tr 204,237,96
v_fma_f32 v132, v132, s38, v224
mvvv 148,212,88
tr 206,237,8544
v_fma_f32 v133, v133, s38, v224
mvvv 148,216,104
v_max3_f32 v243, v243, v132, v133
v_fma_f32 v134, v134, s38, v224
mvvv 148,220,120
v_fma_f32 v135, v135, s38, v224
v_max3_f32 v243, v243, v134, v135
v_fma_f32 v140, v140, s38, v225
v_fma_f32 v141, v141, s38, v225
v_max3_f32 v243, v243, v140, v141
v_fma_f32 v142, v142, s38, v225
v_fma_f32 v143, v143, s38, v225
v_max3_f32 v243, v243, v142, v143
s_waitcnt lgkmcnt(1)
v_fma_f32 v148, v148, s38, v226
v_fma_f32 v149, v149, s38, v226
mavv 0,192,160
s_mov_b32 s63, 12
tr 208,237,128
v_max3_f32 v243, v243, v148, v149
mavv 4,192,168
tr 210,237,8576
v_fma_f32 v150, v150, s38, v226
mavv 8,192,176
v_fma_f32 v151, v151, s38, v226
v_max3_f32 v243, v243, v150, v151
tr 212,237,160
tr 214,237,8608
mavv 24,196,176
mavv 20,196,168
tr 216,237,192
mavv 16,196,160
tr 218,237,8640
mavv 32,200,160
v_cmp_lt_f32 vcc, s39, v243
mavv 36,200,168
tr 220,237,224
mavv 40,200,176
s_cbranch_vccnz L_rare0w
L_ret12w:
tr 222,237,8672
s_waitcnt lgkmcnt(4)
v_exp_f32 v128, v128
tr 192,237,256
v_add_f32 v228, v228, v128
mavv 56,204,176
tr 194,237,8704
mavv 52,204,168
v_exp_f32 v129, v129
mavv 48,204,160
tr 196,237,288
v_add_f32 v228, v228, v129
mavv 64,208,160
tr 198,237,8736
pk 128,128,129
mavv 68,208,168
v_exp_f32 v130, v130
mavv 72,208,176
tr 200,237,320
v_add_f32 v228, v228, v130
tr 202,237,8768
v_exp_f32 v131, v131
mavv 88,212,176
tr 204,237,352
v_add_f32 v228, v228, v131
mavv 84,212,168
tr 206,237,8800
pk 129,130,131
mavv 80,212,160
s_waitcnt lgkmcnt(4)
v_exp_f32 v132, v132
mavv 96,216,160
tr 208,237,384
v_add_f32 v228, v228, v132
mavv 100,216,168
tr 210,237,8832
mavv 104,216,176
v_exp_f32 v133, v133
tr 212,237,416
v_add_f32 v228, v228, v133
tr 214,237,8864
pk 130,132,133
mavv 120,220,176
v_exp_f32 v134, v134
mavv 116,220,168
tr 216,237,448
v_add_f32 v228, v228, v134
mavv 112,220,160
tr 218,237,8896
mavv 128,192,160
v_exp_f32 v135, v135
mavv 132,192,168
tr 220,237,480
v_add_f32 v228, v228, v135
mavv 136,192,176
tr 222,237,8928
pk 131,134,135
v_exp_f32 v136, v136
v_exp_f32 v137, v137
mavv 152,196,176
v_exp_f32 v138, v138
mavv 148,196,168
v_exp_f32 v139, v139
mavv 144,196,160
s_waitcnt lgkmcnt(2)
v_exp_f32 v140, v140
mavv 160,200,160
v_exp_f32 v141, v141
mavv 164,200,168
v_exp_f32 v142, v142
mavv 168,200,176
v_exp_f32 v143, v143
v_add_u32 v236, s40, v232
v_add_f32 v229, v229, v136
s_add_u32 s40, s40, s42
s_cmp_eq_u32 s40, s43
s_cselect_b32 s40, 0, s40
mavv 184,204,176
v_exp_f32 v144, v144
mavv 180,204,168
v_exp_f32 v145, v145
mavv 176,204,160
s_waitcnt vmcnt(12) lgkmcnt(0)
s_barrier
v_add_f32 v229, v229, v137
mavv 192,208,160
s_add_u32 m0, s41, s49
s_add_u32 s41, s41, s42
ds_read_b128 v[192:195], v236 offset:0
mavv 196,208,168
s_cmp_eq_u32 s41, s43
s_cselect_b32 s41, 0, s41
pk 136,136,137
mavv 200,208,176
ds_read_b128 v[196:199], v236 offset:64
v_add_f32 v229, v229, v138
buffer_load_dwordx4 v240, s[12:15], s45 offen nt lds
s_add_u32 m0, m0, 32
ds_read_b128 v[200:203], v236 offset:128
v_add_f32 v229, v229, v139
mavv 216,212,176
v_exp_f32 v146, v146
mavv 212,212,168
ds_read_b128 v[204:207], v236 offset:192
pk 137,138,139
mavv 208,212,160
buffer_load_dwordx4 v240, s[12:15], s45 offen offset:1024 nt lds
mavv 224,216,160
s_add_u32 m0, m0, 32
v_exp_f32 v147, v147
mavv 228,216,168
v_exp_f32 v148, v148
mavv 232,216,176
v_exp_f32 v149, v149
buffer_load_dwordx4 v240, s[12:15], s45 offen offset:2048 nt lds
s_add_u32 m0, m0, 32
v_exp_f32 v150, v150
mavv 248,220,176
v_exp_f32 v151, v151
mavv 244,220,168
s_waitcnt lgkmcnt(0)
mavv 240,220,160
buffer_load_dwordx4 v240, s[12:15], s45 offen offset:3072 nt lds
mvvvz 160,192,0
s_add_u32 s45, s45, s52
s_add_u32 m0, s41, s49
ds_read_b128 v[208:211], v236 offset:256
mvvv 160,196,16
s_add_u32 s41, s41, s42
s_cmp_eq_u32 s41, s43
s_cselect_b32 s41, 0, s41
mvvv 160,200,32
ds_read_b128 v[212:215], v236 offset:320
v_add_f32 v229, v229, v140
mvvv 160,204,48
buffer_load_dwordx4 v240, s[12:15], s45 offen nt lds
mvvvz 168,204,52
s_add_u32 m0, m0, 32
ds_read_b128 v[216:219], v236 offset:384
v_add_f32 v229, v229, v141
mvvv 168,200,36
mvvv 168,196,20
ds_read_b128 v[220:223], v236 offset:448
pk 138,140,141
mvvv 168,192,4
mvvvz 176,192,8
mvvv 176,196,24
mvvv 176,200,40
mvvv 176,204,56
buffer_load_dwordx4 v240, s[12:15], s45 offen offset:1024 nt lds
s_add_u32 m0, m0, 32
v_add_f32 v229, v229, v142
v_add_f32 v229, v229, v143
s_waitcnt lgkmcnt(0)
pk 139,142,143
v_add_f32 v230, v230, v144
mvvv 160,208,64
ds_read_b128 v[192:195], v236 offset:8448
v_add_f32 v230, v230, v145
mvvv 160,212,80
pk 144,144,145
v_add_f32 v230, v230, v146
mvvv 160,216,96
ds_read_b128 v[196:199], v236 offset:8512
v_add_f32 v230, v230, v147
mvvv 160,220,112
buffer_load_dwordx4 v240, s[12:15], s45 offen offset:2048 nt lds
mvvv 168,220,116
s_add_u32 m0, m0, 32
ds_read_b128 v[200:203], v236 offset:8576
pk 145,146,147
mvvv 168,216,100
v_add_f32 v230, v230, v148
v_add_f32 v230, v230, v149
mvvv 168,212,84
ds_read_b128 v[204:207], v236 offset:8640
pk 146,148,149
mvvv 168,208,68
v_fma_f32 v160, v160, s38, v224
v_fma_f32 v161, v161, s38, v224
mvvv 176,208,72
v_max_f32 v243, v160, v161
v_fma_f32 v162, v162, s38, v224
mvvv 176,212,88
v_fma_f32 v163, v163, s38, v224
v_max3_f32 v243, v243, v162, v163
mvvv 176,216,104
v_fma_f32 v168, v168, s38, v225
v_fma_f32 v169, v169, s38, v225
mvvv 176,220,120
buffer_load_dwordx4 v240, s[12:15], s45 offen offset:3072 nt lds
s_add_u32 s45, s45, s52
s_add_u32 m0, s41, s49
s_add_u32 s41, s41, s42
s_cmp_eq_u32 s41, s43
s_cselect_b32 s41, 0, s41
v_max3_f32 v243, v243, v168, v169
s_waitcnt lgkmcnt(0)
v_fma_f32 v170, v170, s38, v225
v_fma_f32 v171, v171, s38, v225
buffer_load_dwordx4 v242, s[20:23], s47 offen lds
mvvvz 164,192,0
s_add_u32 s47, s47, s59
s_add_u32 m0, m0, s61
ds_read_b128 v[208:211], v236 offset:8704
mvvv 164,196,16
v_max3_f32 v243, v243, v170, v171
v_fma_f32 v176, v176, s38, v226
mvvv 164,200,32
ds_read_b128 v[212:215], v236 offset:8768
v_fma_f32 v177, v177, s38, v226
mvvv 164,204,48
buffer_load_dwordx4 v242, s[20:23], s47 offen lds
mvvvz 172,204,52
s_add_u32 s47, s47, s59
s_add_u32 m0, m0, s62
ds_read_b128 v[216:219], v236 offset:8832
mvvv 172,200,36
v_max3_f32 v243, v243, v176, v177
v_fma_f32 v178, v178, s38, v226
mvvv 172,196,20
ds_read_b128 v[220:223], v236 offset:8896
v_fma_f32 v179, v179, s38, v226
mvvv 172,192,4
buffer_load_dwordx4 v242, s[20:23], s47 offen lds
mvvvz 180,192,8
s_add_u32 s47, s47, s59
s_add_u32 m0, m0, s61
v_max3_f32 v243, v243, v178, v179
mvvv 180,196,24
mvvv 180,200,40
mvvv 180,204,56
v_add_u32 v237, s40, v233
s_add_u32 s40, s40, s42
s_cmp_eq_u32 s40, s43
s_cselect_b32 s40, 0, s40
buffer_load_dwordx4 v242, s[20:23], s47 offen lds
s_add_u32 s47, s47, s59
v_add_f32 v230, v230, v150
s_waitcnt lgkmcnt(0)
v_add_f32 v230, v230, v151
pk 147,150,151
mvvv 164,208,64
tr 192,237,0
mvvv 164,212,80
tr 194,237,8448
mvvv 164,216,96
tr 196,237,32
mvvv 164,220,112
mvvv 172,220,116
tr 198,237,8480
mvvv 172,216,100
tr 200,237,64
mvvv 172,212,84
tr 202,237,8512
mvvv 172,208,68
mvvv 180,208,72
tr 204,237,96
v_fma_f32 v164, v164, s38, v224
mvvv 180,212,88
tr 206,237,8544
v_fma_f32 v165, v165, s38, v224
mvvv 180,216,104
v_max3_f32 v243, v243, v164, v165
v_fma_f32 v166, v166, s38, v224
mvvv 180,220,120
v_fma_f32 v167, v167, s38, v224
v_max3_f32 v243, v243, v166, v167
v_fma_f32 v172, v172, s38, v225
v_fma_f32 v173, v173, s38, v225
v_max3_f32 v243, v243, v172, v173
v_fma_f32 v174, v174, s38, v225
v_fma_f32 v175, v175, s38, v225
v_max3_f32 v243, v243, v174, v175
s_waitcnt lgkmcnt(1)
v_fma_f32 v180, v180, s38, v226
v_fma_f32 v181, v181, s38, v226
mavv 0,192,128
s_mov_b32 s63, 13
tr 208,237,128
v_max3_f32 v243, v243, v180, v181
mavv 4,192,136
tr 210,237,8576
v_fma_f32 v182, v182, s38, v226
mavv 8,192,144
v_fma_f32 v183, v183, s38, v226
v_max3_f32 v243, v243, v182, v183
tr 212,237,160
tr 214,237,8608
mavv 24,196,144
mavv 20,196,136
tr 216,237,192
mavv 16,196,128
tr 218,237,8640
mavv 32,200,128
v_cmp_lt_f32 vcc, s39, v243
mavv 36,200,136
tr 220,237,224
mavv 40,200,144
s_cbranch_vccnz L_rare1w
L_ret13w:
tr 222,237,8672
s_waitcnt lgkmcnt(4)
v_exp_f32 v160, v160
tr 192,237,256
v_add_f32 v228, v228, v160
mavv 56,204,144
tr 194,237,8704
mavv 52,204,136
v_exp_f32 v161, v161
mavv 48,204,128
tr 196,237,288
v_add_f32 v228, v228, v161
mavv 64,208,128
tr 198,237,8736
pk 160,160,161
mavv 68,208,136
v_exp_f32 v162, v162
mavv 72,208,144
tr 200,237,320
v_add_f32 v228, v228, v162
tr 202,237,8768
v_exp_f32 v163, v163
mavv 88,212,144
tr 204,237,352
v_add_f32 v228, v228, v163
mavv 84,212,136
tr 206,237,8800
pk 161,162,163
mavv 80,212,128
s_waitcnt lgkmcnt(4)
v_exp_f32 v164, v164
mavv 96,216,128
tr 208,237,384
v_add_f32 v228, v228, v164
mavv 100,216,136
tr 210,237,8832
mavv 104,216,144
v_exp_f32 v165, v165
tr 212,237,416
v_add_f32 v228, v228, v165
tr 214,237,8864
pk 162,164,165
mavv 120,220,144
v_exp_f32 v166, v166
mavv 116,220,136
tr 216,237,448
v_add_f32 v228, v228, v166
mavv 112,220,128
tr 218,237,8896
mavv 128,192,128
v_exp_f32 v167, v167
mavv 132,192,136
tr 220,237,480
v_add_f32 v228, v228, v167
mavv 136,192,144
tr 222,237,8928
pk 163,166,167
v_exp_f32 v168, v168
v_exp_f32 v169, v169
mavv 152,196,144
v_exp_f32 v170, v170
mavv 148,196,136
v_exp_f32 v171, v171
mavv 144,196,128
s_waitcnt lgkmcnt(2)
v_exp_f32 v172, v172
mavv 160,200,128
v_exp_f32 v173, v173
mavv 164,200,136
v_exp_f32 v174, v174
mavv 168,200,144
v_exp_f32 v175, v175
v_add_u32 v236, s40, v232
v_add_f32 v229, v229, v168
s_add_u32 s40, s40, s42
s_cmp_eq_u32 s40, s43
s_cselect_b32 s40, 0, s40
mavv 184,204,144
v_exp_f32 v176, v176
mavv 180,204,136
v_exp_f32 v177, v177
mavv 176,204,128
s_waitcnt vmcnt(16) lgkmcnt(0)
s_barrier
v_add_f32 v229, v229, v169
mavv 192,208,128
s_add_u32 m0, s41, s49
s_add_u32 s41, s41, s42
ds_read_b128 v[192:195], v236 offset:0
mavv 196,208,136
s_cmp_eq_u32 s41, s43
s_cselect_b32 s41, 0, s41
pk 168,168,169
mavv 200,208,144
ds_read_b128 v[196:199], v236 offset:64
v_add_f32 v229, v229, v170
buffer_load_dwordx4 v242, s[20:23], s47 offen lds
s_add_u32 s47, s47, s59
s_add_u32 m0, m0, s61
ds_read_b128 v[200:203], v236 offset:128
mavv 216,212,144
v_exp_f32 v178, v178
mavv 212,212,136
ds_read_b128 v[204:207], v236 offset:192
v_add_f32 v229, v229, v171
mavv 208,212,128
buffer_load_dwordx4 v242, s[20:23], s47 offen lds
mavv 224,216,128
s_add_u32 s47, s47, s59
s_add_u32 m0, m0, s62
pk 169,170,171
mavv 228,216,136
v_exp_f32 v179, v179
mavv 232,216,144
v_exp_f32 v180, v180
buffer_load_dwordx4 v242, s[20:23], s47 offen lds
s_add_u32 s47, s47, s59
s_add_u32 m0, m0, s61
v_add_f32 v229, v229, v172
mavv 248,220,144
v_exp_f32 v181, v181
mavv 244,220,136
s_waitcnt lgkmcnt(0)
v_exp_f32 v182, v182
mavv 240,220,128
buffer_load_dwordx4 v242, s[20:23], s47 offen lds
mvvvz 128,192,0
s_add_u32 s47, s47, s60
s_add_u32 m0, s41, s50
ds_read_b128 v[208:211], v236 offset:256
mvvv 128,196,16
s_cmp_eq_u32 s47, s83
s_cselect_b32 s47, s76, s47
s_add_u32 s41, s41, s42
mvvv 128,200,32
s_cmp_eq_u32 s41, s43
s_cselect_b32 s41, 0, s41
ds_read_b128 v[212:215], v236 offset:320
mvvv 128,204,48
buffer_load_dwordx4 v241, s[16:19], s46 offen lds
mvvvz 136,204,52
s_add_u32 s46, s46, s55
s_add_u32 m0, m0, s53
ds_read_b128 v[216:219], v236 offset:384
mvvv 136,200,36
v_exp_f32 v183, v183
mvvv 136,196,20
ds_read_b128 v[220:223], v236 offset:448
v_add_f32 v229, v229, v173
mvvv 136,192,4
mvvvz 144,192,8
mvvv 144,196,24
mvvv 144,200,40
mvvv 144,204,56
buffer_load_dwordx4 v241, s[16:19], s46 offen lds
s_add_u32 s46, s46, s56
s_add_u32 m0, m0, s54
pk 170,172,173
s_waitcnt lgkmcnt(0)
mvvv 128,208,64
ds_read_b128 v[192:195], v236 offset:8448
v_add_f32 v229, v229, v174
mvvv 128,212,80
mvvv 128,216,96
ds_read_b128 v[196:199], v236 offset:8512
v_add_f32 v229, v229, v175
mvvv 128,220,112
buffer_load_dwordx4 v241, s[16:19], s46 offen lds
mvvv 136,220,116
s_add_u32 s46, s46, s55
s_add_u32 m0, m0, s53
ds_read_b128 v[200:203], v236 offset:8576
mvvv 136,216,100
pk 171,174,175
v_add_f32 v230, v230, v176
mvvv 136,212,84
ds_read_b128 v[204:207], v236 offset:8640
v_fma_f32 v128, v128, s38, v224
mvvv 136,208,68
v_fma_f32 v129, v129, s38, v224
v_max_f32 v243, v128, v129
mvvv 144,208,72
v_fma_f32 v130, v130, s38, v224
v_fma_f32 v131, v131, s38, v224
mvvv 144,212,88
v_max3_f32 v243, v243, v130, v131
v_add_f32 v230, v230, v177
mvvv 144,216,104
v_fma_f32 v136, v136, s38, v225
v_fma_f32 v137, v137, s38, v225
mvvv 144,220,120
buffer_load_dwordx4 v241, s[16:19], s46 offen lds
s_add_u32 s46, s46, s57
s_cmp_eq_u32 s46, s82
s_cselect_b32 s46, s58, s46
s_add_u32 m0, s41, s49
s_add_u32 s41, s41, s42
v_max3_f32 v243, v243, v136, v137
s_waitcnt lgkmcnt(0)
s_cmp_eq_u32 s41, s43
s_cselect_b32 s41, 0, s41
buffer_load_dwordx4 v242, s[20:23], s47 offen lds
mvvvz 132,192,0
s_add_u32 s47, s47, s59
s_add_u32 m0, m0, s61
ds_read_b128 v[208:211], v236 offset:8704
mvvv 132,196,16
v_fma_f32 v138, v138, s38, v225
v_fma_f32 v139, v139, s38, v225
mvvv 132,200,32
ds_read_b128 v[212:215], v236 offset:8768
v_max3_f32 v243, v243, v138, v139
mvvv 132,204,48
buffer_load_dwordx4 v242, s[20:23], s47 offen lds
mvvvz 140,204,52
s_add_u32 s47, s47, s59
s_add_u32 m0, m0, s62
ds_read_b128 v[216:219], v236 offset:8832
mvvv 140,200,36
v_fma_f32 v144, v144, s38, v226
v_fma_f32 v145, v145, s38, v226
mvvv 140,196,20
ds_read_b128 v[220:223], v236 offset:8896
v_max3_f32 v243, v243, v144, v145
mvvv 140,192,4
buffer_load_dwordx4 v242, s[20:23], s47 offen lds
mvvvz 148,192,8
s_add_u32 s47, s47, s59
s_add_u32 m0, m0, s61
v_fma_f32 v146, v146, s38, v226
mvvv 148,196,24
v_fma_f32 v147, v147, s38, v226
v_max3_f32 v243, v243, v146, v147
mvvv 148,200,40
mvvv 148,204,56
v_add_u32 v237, s40, v233
s_add_u32 s40, s40, s42
s_cmp_eq_u32 s40, s43
s_cselect_b32 s40, 0, s40
buffer_load_dwordx4 v242, s[20:23], s47 offen lds
s_add_u32 s47, s47, s59
s_waitcnt lgkmcnt(0)
pk 176,176,177
mvvv 132,208,64
tr 192,237,0
v_add_f32 v230, v230, v178
mvvv 132,212,80
tr 194,237,8448
v_add_f32 v230, v230, v179
mvvv 132,216,96
tr 196,237,32
pk 177,178,179
mvvv 132,220,112
v_add_f32 v230, v230, v180
v_add_f32 v230, v230, v181
mvvv 140,220,116
tr 198,237,8480
pk 178,180,181
mvvv 140,216,100
tr 200,237,64
v_add_f32 v230, v230, v182
mvvv 140,212,84
tr 202,237,8512
v_add_f32 v230, v230, v183
mvvv 140,208,68
pk 179,182,183
mvvv 148,208,72
tr 204,237,96
v_fma_f32 v132, v132, s38, v224
mvvv 148,212,88
tr 206,237,8544
v_fma_f32 v133, v133, s38, v224
mvvv 148,216,104
v_max3_f32 v243, v243, v132, v133
v_fma_f32 v134, v134, s38, v224
mvvv 148,220,120
v_fma_f32 v135, v135, s38, v224
v_max3_f32 v243, v243, v134, v135
v_fma_f32 v140, v140, s38, v225
v_fma_f32 v141, v141, s38, v225
v_max3_f32 v243, v243, v140, v141
v_fma_f32 v142, v142, s38, v225
v_fma_f32 v143, v143, s38, v225
v_max3_f32 v243, v243, v142, v143
s_waitcnt lgkmcnt(1)
v_fma_f32 v148, v148, s38, v226
v_fma_f32 v149, v149, s38, v226
mavv 0,192,160
s_mov_b32 s63, 14
tr 208,237,128
v_max3_f32 v243, v243, v148, v149
mavv 4,192,168
tr 210,237,8576
v_fma_f32 v150, v150, s38, v226
mavv 8,192,176
v_fma_f32 v151, v151, s38, v226
v_max3_f32 v243, v243, v150, v151
tr 212,237,160
tr 214,237,8608
mavv 24,196,176
mavv 20,196,168
tr 216,237,192
mavv 16,196,160
tr 218,237,8640
mavv 32,200,160
v_cmp_lt_f32 vcc, s39, v243
mavv 36,200,168
tr 220,237,224
mavv 40,200,176
s_cbranch_vccnz L_rare0w
L_ret14w:
tr 222,237,8672
s_waitcnt lgkmcnt(4)
v_exp_f32 v128, v128
tr 192,237,256
v_add_f32 v228, v228, v128
mavv 56,204,176
tr 194,237,8704
mavv 52,204,168
v_exp_f32 v129, v129
mavv 48,204,160
tr 196,237,288
v_add_f32 v228, v228, v129
mavv 64,208,160
tr 198,237,8736
pk 128,128,129
mavv 68,208,168
v_exp_f32 v130, v130
mavv 72,208,176
tr 200,237,320
v_add_f32 v228, v228, v130
tr 202,237,8768
v_exp_f32 v131, v131
mavv 88,212,176
tr 204,237,352
v_lshrrev_b32 v239, 6, v240
mavv 84,212,168
tr 206,237,8800
v_mul_u32_u24 v239, s95, v239
mavv 80,212,160
s_waitcnt lgkmcnt(4)
v_bfe_u32 v238, v240, 4, 2
v_lshl_add_u32 v238, v238, 7, v239
mavv 96,216,160
tr 208,237,384
v_add_f32 v228, v228, v131
mavv 100,216,168
tr 210,237,8832
pk 129,130,131
mavv 104,216,176
s_mov_b32 m0, s73
v_exp_f32 v132, v132
tr 212,237,416
v_add_f32 v228, v228, v132
tr 214,237,8864
mavv 120,220,176
buffer_load_dword v238, s[84:87], s94 offen lds
mavv 116,220,168
tr 216,237,448
mavv 112,220,160
tr 218,237,8896
mavv 128,192,160
v_exp_f32 v133, v133
mavv 132,192,168
tr 220,237,480
v_add_f32 v228, v228, v133
mavv 136,192,176
tr 222,237,8928
pk 130,132,133
v_exp_f32 v134, v134
v_exp_f32 v135, v135
mavv 152,196,176
v_exp_f32 v136, v136
mavv 148,196,168
v_exp_f32 v137, v137
mavv 144,196,160
s_waitcnt lgkmcnt(2)
v_exp_f32 v138, v138
mavv 160,200,160
v_exp_f32 v139, v139
mavv 164,200,168
v_exp_f32 v140, v140
mavv 168,200,176
v_exp_f32 v141, v141
v_add_u32 v236, s40, v232
v_add_f32 v228, v228, v134
s_add_u32 s40, s40, s42
s_cmp_eq_u32 s40, s43
s_cselect_b32 s40, 0, s40
mavv 184,204,176
v_exp_f32 v142, v142
mavv 180,204,168
v_exp_f32 v143, v143
mavv 176,204,160
s_waitcnt vmcnt(21) lgkmcnt(0)
s_barrier
v_add_f32 v228, v228, v135
mavv 192,208,160
s_add_u32 m0, s41, s49
s_add_u32 s41, s41, s42
ds_read_b128 v[192:195], v236 offset:0
mavv 196,208,168
s_cmp_eq_u32 s41, s43
s_cselect_b32 s41, 0, s41
pk 131,134,135
mavv 200,208,176
ds_read_b128 v[196:199], v236 offset:64
v_add_f32 v229, v229, v136
buffer_load_dwordx4 v242, s[20:23], s47 offen lds
s_add_u32 s47, s47, s59
s_add_u32 m0, m0, s61
ds_read_b128 v[200:203], v236 offset:128
mavv 216,212,176
v_exp_f32 v144, v144
mavv 212,212,168
ds_read_b128 v[204:207], v236 offset:192
v_add_f32 v229, v229, v137
mavv 208,212,160
buffer_load_dwordx4 v242, s[20:23], s47 offen lds
mavv 224,216,160
s_add_u32 s47, s47, s59
s_add_u32 m0, m0, s62
pk 136,136,137
mavv 228,216,168
v_exp_f32 v145, v145
mavv 232,216,176
v_exp_f32 v146, v146
buffer_load_dwordx4 v242, s[20:23], s47 offen lds
s_add_u32 s47, s47, s59
s_add_u32 m0, m0, s61
v_add_f32 v229, v229, v138
mavv 248,220,176
v_exp_f32 v147, v147
mavv 244,220,168
s_waitcnt lgkmcnt(0)
v_exp_f32 v148, v148
mavv 240,220,160
buffer_load_dwordx4 v242, s[20:23], s47 offen lds
mvvvz 160,192,0
s_add_u32 s47, s47, s60
s_add_u32 m0, s41, s50
ds_read_b128 v[208:211], v236 offset:256
mvvv 160,196,16
s_cmp_eq_u32 s47, s83
s_cselect_b32 s47, s76, s47
s_add_u32 s41, s41, s42
mvvv 160,200,32
s_cmp_eq_u32 s41, s43
s_cselect_b32 s41, 0, s41
ds_read_b128 v[212:215], v236 offset:320
mvvv 160,204,48
buffer_load_dwordx4 v241, s[16:19], s46 offen lds
mvvvz 168,204,52
s_add_u32 s46, s46, s55
s_add_u32 m0, m0, s53
ds_read_b128 v[216:219], v236 offset:384
mvvv 168,200,36
v_exp_f32 v149, v149
mvvv 168,196,20
ds_read_b128 v[220:223], v236 offset:448
v_add_f32 v229, v229, v139
mvvv 168,192,4
v_exp_f32 v150, v150
mvvvz 176,192,8
v_exp_f32 v151, v151
mvvv 176,196,24
mvvv 176,200,40
mvvv 176,204,56
buffer_load_dwordx4 v241, s[16:19], s46 offen lds
s_add_u32 s46, s46, s56
s_add_u32 m0, m0, s54
pk 137,138,139
s_waitcnt lgkmcnt(0)
mvvv 160,208,64
ds_read_b128 v[192:195], v236 offset:8448
v_add_f32 v229, v229, v140
mvvv 160,212,80
mvvv 160,216,96
ds_read_b128 v[196:199], v236 offset:8512
v_add_f32 v229, v229, v141
mvvv 160,220,112
buffer_load_dwordx4 v241, s[16:19], s46 offen lds
mvvv 168,220,116
s_add_u32 s46, s46, s55
s_add_u32 m0, m0, s53
ds_read_b128 v[200:203], v236 offset:8576
mvvv 168,216,100
mvvv 168,212,84
ds_read_b128 v[204:207], v236 offset:8640
v_fma_f32 v160, v160, s38, v224
mvvv 168,208,68
v_fma_f32 v161, v161, s38, v224
v_max_f32 v243, v160, v161
mvvv 176,208,72
v_fma_f32 v162, v162, s38, v224
v_fma_f32 v163, v163, s38, v224
mvvv 176,212,88
v_max3_f32 v243, v243, v162, v163
pk 138,140,141
mvvv 176,216,104
v_fma_f32 v168, v168, s38, v225
v_fma_f32 v169, v169, s38, v225
mvvv 176,220,120
buffer_load_dwordx4 v241, s[16:19], s46 offen lds
s_add_u32 s46, s46, s57
s_cmp_eq_u32 s46, s82
s_cselect_b32 s46, s58, s46
v_lshrrev_b32 v239, 6, v240
v_mul_u32_u24 v239, s95, v239
v_bfe_u32 v238, v240, 4, 2
v_lshl_add_u32 v238, v238, 7, v239
s_waitcnt lgkmcnt(0)
v_max3_f32 v243, v243, v168, v169
v_fma_f32 v170, v170, s38, v225
mvvvz 164,192,0
s_mov_b32 m0, s73
ds_read_b128 v[208:211], v236 offset:8704
v_fma_f32 v171, v171, s38, v225
mvvv 164,196,16
v_max3_f32 v243, v243, v170, v171
v_fma_f32 v176, v176, s38, v226
mvvv 164,200,32
ds_read_b128 v[212:215], v236 offset:8768
v_fma_f32 v177, v177, s38, v226
mvvv 164,204,48
buffer_load_dword v238, s[84:87], s64 offen lds
mvvvz 172,204,52
s_mov_b32 s84, s34
s_mov_b32 s85, s35
ds_read_b128 v[216:219], v236 offset:8832
mvvv 172,200,36
s_cmp_eq_u32 s4, 0
s_cselect_b32 s86, 4, 0
v_mov_b32 v239, s51
mvvv 172,196,20
ds_read_b128 v[220:223], v236 offset:8896
v_max3_f32 v243, v243, v176, v177
mvvv 172,192,4
v_fma_f32 v178, v178, s38, v226
v_fma_f32 v179, v179, s38, v226
mvvvz 180,192,8
v_max3_f32 v243, v243, v178, v179
mvvv 180,196,24
mvvv 180,200,40
mvvv 180,204,56
v_add_u32 v237, s40, v233
s_add_u32 s40, s40, s42
s_cmp_eq_u32 s40, s43
s_cselect_b32 s40, 0, s40
buffer_atomic_add v239, v240, s[84:87], 0 offen
s_waitcnt lgkmcnt(0)
s_mov_b32 s84, s78
s_mov_b32 s85, s79
mvvv 164,208,64
s_mov_b32 s86, L_code_end-L_code_pf
tr 192,237,0
v_add_f32 v229, v229, v142
mvvv 164,212,80
tr 194,237,8448
v_add_f32 v229, v229, v143
mvvv 164,216,96
tr 196,237,32
pk 139,142,143
mvvv 164,220,112
v_add_f32 v230, v230, v144
v_add_f32 v230, v230, v145
mvvv 172,220,116
tr 198,237,8480
pk 144,144,145
mvvv 172,216,100
tr 200,237,64
v_add_f32 v230, v230, v146
mvvv 172,212,84
tr 202,237,8512
v_add_f32 v230, v230, v147
mvvv 172,208,68
pk 145,146,147
v_add_f32 v230, v230, v148
v_add_f32 v230, v230, v149
mvvv 180,208,72
tr 204,237,96
v_fma_f32 v164, v164, s38, v224
pk 146,148,149
mvvv 180,212,88
tr 206,237,8544
v_fma_f32 v165, v165, s38, v224
v_add_f32 v230, v230, v150
mvvv 180,216,104
v_max3_f32 v243, v243, v164, v165
v_fma_f32 v166, v166, s38, v224
v_add_f32 v230, v230, v151
mvvv 180,220,120
v_fma_f32 v167, v167, s38, v224
v_max3_f32 v243, v243, v166, v167
pk 147,150,151
v_fma_f32 v172, v172, s38, v225
v_fma_f32 v173, v173, s38, v225
v_max3_f32 v243, v243, v172, v173
v_fma_f32 v174, v174, s38, v225
v_fma_f32 v175, v175, s38, v225
v_max3_f32 v243, v243, v174, v175
s_waitcnt lgkmcnt(1)
v_fma_f32 v180, v180, s38, v226
v_fma_f32 v181, v181, s38, v226
mavv 0,192,128
s_mov_b32 s63, 15
tr 208,237,128
v_max3_f32 v243, v243, v180, v181
mavv 4,192,136
tr 210,237,8576
v_fma_f32 v182, v182, s38, v226
mavv 8,192,144
v_fma_f32 v183, v183, s38, v226
v_max3_f32 v243, v243, v182, v183
tr 212,237,160
tr 214,237,8608
mavv 24,196,144
mavv 20,196,136
tr 216,237,192
mavv 16,196,128
tr 218,237,8640
mavv 32,200,128
v_cmp_lt_f32 vcc, s39, v243
mavv 36,200,136
tr 220,237,224
mavv 40,200,144
s_cbranch_vccnz L_rare1w
L_ret15w:
tr 222,237,8672
s_waitcnt lgkmcnt(4)
v_exp_f32 v160, v160
tr 192,237,256
mavv 56,204,144
tr 194,237,8704
mavv 52,204,136
v_exp_f32 v161, v161
mavv 48,204,128
tr 196,237,288
v_add_f32 v228, v228, v160
mavv 64,208,128
tr 198,237,8736
mavv 68,208,136
v_exp_f32 v162, v162
mavv 72,208,144
tr 200,237,320
v_add_f32 v228, v228, v161
tr 202,237,8768
pk 160,160,161
v_exp_f32 v163, v163
mavv 88,212,144
tr 204,237,352
v_add_f32 v228, v228, v162
mavv 84,212,136
tr 206,237,8800
mavv 80,212,128
s_waitcnt lgkmcnt(4)
v_exp_f32 v164, v164
mavv 96,216,128
tr 208,237,384
v_add_f32 v228, v228, v163
mavv 100,216,136
tr 210,237,8832
pk 161,162,163
mavv 104,216,144
v_exp_f32 v165, v165
tr 212,237,416
v_add_f32 v228, v228, v164
tr 214,237,8864
mavv 120,220,144
v_exp_f32 v166, v166
mavv 116,220,136
tr 216,237,448
v_add_f32 v228, v228, v165
mavv 112,220,128
tr 218,237,8896
pk 162,164,165
mavv 128,192,128
v_exp_f32 v167, v167
mavv 132,192,136
tr 220,237,480
v_add_f32 v228, v228, v166
mavv 136,192,144
tr 222,237,8928
v_exp_f32 v168, v168
v_add_f32 v228, v228, v167
pk 163,166,167
mavv 152,196,144
v_exp_f32 v169, v169
mavv 148,196,136
v_add_f32 v229, v229, v168
mavv 144,196,128
s_waitcnt lgkmcnt(2)
v_exp_f32 v170, v170
mavv 160,200,128
v_add_f32 v229, v229, v169
pk 168,168,169
mavv 164,200,136
v_exp_f32 v171, v171
mavv 168,200,144
v_add_f32 v229, v229, v170
v_add_u32 v237, s40, v233
s_add_u32 s40, s40, s42
s_cmp_eq_u32 s40, s43
s_cselect_b32 s40, 0, s40
mavv 184,204,144
v_exp_f32 v172, v172
mavv 180,204,136
v_add_f32 v229, v229, v171
pk 169,170,171
mavv 176,204,128
s_waitcnt vmcnt(27) lgkmcnt(0)
s_barrier
mavv 192,208,128
s_add_u32 m0, s41, s49
s_add_u32 s41, s41, s42
tr 192,237,0
mavv 196,208,136
s_cmp_eq_u32 s41, s43
s_cselect_b32 s41, 0, s41
tr 194,237,8448
mavv 200,208,144
tr 196,237,32
buffer_load_dwordx4 v242, s[20:23], s47 offen lds
s_add_u32 s47, s47, s59
s_add_u32 m0, m0, s61
tr 198,237,8480
mavv 216,212,144
tr 200,237,64
mavv 212,212,136
tr 202,237,8512
mavv 208,212,128
buffer_load_dwordx4 v242, s[20:23], s47 offen lds
mavv 224,216,128
s_add_u32 s47, s47, s59
s_add_u32 m0, m0, s62
tr 204,237,96
mavv 228,216,136
tr 206,237,8544
mavv 232,216,144
v_exp_f32 v173, v173
buffer_load_dwordx4 v242, s[20:23], s47 offen lds
s_add_u32 s47, s47, s59
s_add_u32 m0, m0, s61
v_add_f32 v229, v229, v172
mavv 248,220,144
v_exp_f32 v174, v174
mavv 244,220,136
v_add_f32 v229, v229, v173
pk 170,172,173
mavv 240,220,128
buffer_load_dwordx4 v242, s[20:23], s47 offen lds
s_waitcnt lgkmcnt(6)
s_add_u32 s47, s47, s59
s_add_u32 m0, s41, s49
s_add_u32 s41, s41, s42
s_cmp_eq_u32 s41, s43
s_cselect_b32 s41, 0, s41
v_exp_f32 v175, v175
v_add_f32 v229, v229, v174
v_exp_f32 v176, v176
v_add_f32 v229, v229, v175
pk 171,174,175
v_exp_f32 v177, v177
v_add_f32 v230, v230, v176
v_exp_f32 v178, v178
v_add_f32 v230, v230, v177
pk 176,176,177
v_exp_f32 v179, v179
v_add_f32 v230, v230, v178
v_exp_f32 v180, v180
v_add_f32 v230, v230, v179
pk 177,178,179
v_exp_f32 v181, v181
v_add_f32 v230, v230, v180
v_exp_f32 v182, v182
v_add_f32 v230, v230, v181
pk 178,180,181
v_exp_f32 v183, v183
v_add_f32 v230, v230, v182
v_add_f32 v230, v230, v183
pk 179,182,183
s_nop 0
s_nop 1
mavv 0,192,160
tr 208,237,128
v_mov_b32 v244, v228
v_mov_b32 v245, v229
mavv 4,192,168
tr 210,237,8576
v_mov_b32 v246, v230
v_mov_b32 v247, v231
mavv 8,192,176
buffer_load_dwordx4 v242, s[20:23], s47 offen lds
v_permlane32_swap_b32 v228, v244
v_permlane32_swap_b32 v229, v245
s_waitcnt lgkmcnt(2)
s_add_u32 s47, s47, s59
tr 212,237,160
v_permlane32_swap_b32 v230, v246
s_add_u32 m0, m0, s61
tr 214,237,8608
v_permlane32_swap_b32 v231, v247
v_add_f32 v228, v228, v244
v_add_f32 v229, v229, v245
mavv 24,196,176
v_add_f32 v230, v230, v246
v_add_f32 v231, v231, v247
v_mov_b32 v244, v228
mavv 20,196,168
tr 216,237,192
v_mov_b32 v245, v229
v_mov_b32 v246, v230
mavv 16,196,160
tr 218,237,8640
v_mov_b32 v247, v231
v_permlane16_swap_b32 v228, v244
v_permlane16_swap_b32 v229, v245
mavv 32,200,160
buffer_load_dwordx4 v242, s[20:23], s47 offen lds
v_permlane16_swap_b32 v230, v246
mavv 36,200,168
s_add_u32 s47, s47, s59
s_add_u32 m0, m0, s62
tr 220,237,224
v_permlane16_swap_b32 v231, v247
v_add_f32 v228, v228, v244
mavv 40,200,176
tr 222,237,8672
v_add_f32 v229, v229, v245
v_add_f32 v230, v230, v246
v_add_f32 v231, v231, v247
v_rcp_f32 v250, v228
tr 192,237,256
v_rcp_f32 v251, v229
mavv 56,204,176
tr 194,237,8704
v_rcp_f32 v252, v230
mavv 52,204,168
buffer_load_dwordx4 v242, s[20:23], s47 offen lds
v_rcp_f32 v253, v231
mavv 48,204,160
s_waitcnt lgkmcnt(4)
s_add_u32 s47, s47, s59
tr 196,237,288
mavv 64,208,160
s_add_u32 m0, m0, s61
tr 198,237,8736
v_accvgpr_read_b32 v64, a0
v_accvgpr_read_b32 v65, a1
mavv 68,208,168
v_accvgpr_read_b32 v66, a2
v_accvgpr_read_b32 v67, a3
v_accvgpr_read_b32 v68, a16
mavv 72,208,176
tr 200,237,320
v_accvgpr_read_b32 v69, a17
tr 202,237,8768
v_accvgpr_read_b32 v70, a18
v_accvgpr_read_b32 v71, a19
buffer_load_dwordx4 v242, s[20:23], s47 offen lds
v_mul_f32 v64, v64, v250
mavv 88,212,176
s_add_u32 s47, s47, s60
tr 204,237,352
v_mul_f32 v65, v65, v250
mavv 84,212,168
s_cmp_eq_u32 s47, s83
s_cselect_b32 s47, s76, s47
tr 206,237,8800
v_mul_f32 v66, v66, v250
mavv 80,212,160
v_mul_f32 v67, v67, v250
v_mul_f32 v68, v68, v250
v_mul_f32 v69, v69, v250
mavv 96,216,160
tr 208,237,384
v_mul_f32 v70, v70, v250
v_mul_f32 v71, v71, v250
mavv 100,216,168
tr 210,237,8832
pk 16,64,65
mavv 104,216,176
pk 17,66,67
pk 18,68,69
pk 19,70,71
s_waitcnt lgkmcnt(4)
tr 212,237,416
v_accvgpr_read_b32 v72, a4
v_accvgpr_read_b32 v73, a5
tr 214,237,8864
v_accvgpr_read_b32 v74, a6
mavv 120,220,176
v_accvgpr_read_b32 v75, a7
v_accvgpr_read_b32 v76, a20
v_accvgpr_read_b32 v77, a21
mavv 116,220,168
tr 216,237,448
v_accvgpr_read_b32 v78, a22
v_accvgpr_read_b32 v79, a23
v_accvgpr_read_b32 v80, a8
mavv 112,220,160
tr 218,237,8896
v_mul_f32 v72, v72, v251
v_accvgpr_read_b32 v81, a9
v_accvgpr_read_b32 v82, a10
v_accvgpr_read_b32 v83, a11
mavv 128,192,160
buffer_store_dwordx4 v[16:19], v240, s[24:27], s48 offen nt
v_mul_f32 v73, v73, v251
v_accvgpr_read_b32 v84, a24
mavv 132,192,168
tr 220,237,480
v_mul_f32 v74, v74, v251
v_mul_f32 v75, v75, v251
v_accvgpr_read_b32 v85, a25
v_accvgpr_read_b32 v86, a26
mavv 136,192,176
tr 222,237,8928
v_mul_f32 v76, v76, v251
v_mul_f32 v77, v77, v251
v_accvgpr_read_b32 v87, a27
v_mul_f32 v80, v80, v252
v_mul_f32 v78, v78, v251
v_mul_f32 v79, v79, v251
v_mul_f32 v81, v81, v252
v_mul_f32 v82, v82, v252
v_add_u32 v239, s40, v235
pk 20,72,73
pk 21,74,75
v_mul_f32 v83, v83, v252
v_mul_f32 v84, v84, v252
mavv 152,196,176
s_add_u32 s40, s40, s42
s_cmp_eq_u32 s40, s43
s_cselect_b32 s40, 0, s40
pk 22,76,77
v_mul_f32 v85, v85, v252
mavv 148,196,168
pk 23,78,79
v_mul_f32 v86, v86, v252
v_mul_f32 v87, v87, v252
pk 24,80,81
pk 25,82,83
mavv 144,196,160
s_waitcnt vmcnt(15) lgkmcnt(0)
s_barrier
pk 26,84,85
pk 27,86,87
mavv 160,200,160
s_add_u32 m0, s41, s50
s_add_u32 s41, s41, s42
ds_read_b128 a[0:3], v239 offset:0
mavv 164,200,168
s_cmp_eq_u32 s41, s43
s_cselect_b32 s41, 0, s41
ds_read_b128 a[16:19], v239 offset:64
mavv 168,200,176
buffer_load_dwordx4 v241, s[16:19], s46 offen lds
s_add_u32 s46, s46, s55
s_add_u32 m0, m0, s53
ds_read_b128 a[4:7], v239 offset:2112
ds_read_b128 a[20:23], v239 offset:2176
v_add_u32 v239, s40, v235
mavv 184,204,176
buffer_store_dwordx4 v[20:23], v240, s[24:27], s48 offen offset:1024 nt
mavv 180,204,168
buffer_load_dwordx4 v241, s[16:19], s46 offen lds
mavv 176,204,160
s_add_u32 s46, s46, s56
s_add_u32 m0, m0, s54
ds_read_b128 a[8:11], v239 offset:0
v_accvgpr_read_b32 v96, a32
v_accvgpr_read_b32 v97, a33
mavv 192,208,160
s_add_u32 s40, s40, s42
ds_read_b128 a[24:27], v239 offset:64
v_accvgpr_read_b32 v98, a34
v_accvgpr_read_b32 v99, a35
v_accvgpr_read_b32 v100, a48
mavv 196,208,168
s_cmp_eq_u32 s40, s43
s_cselect_b32 s40, 0, s40
ds_read_b128 a[12:15], v239 offset:2112
v_accvgpr_read_b32 v101, a49
mavv 200,208,176
ds_read_b128 a[28:31], v239 offset:2176
v_add_u32 v238, s40, v234
v_accvgpr_read_b32 v102, a50
v_accvgpr_read_b32 v103, a51
buffer_load_dwordx4 v241, s[16:19], s46 offen lds
v_mul_f32 v96, v96, v250
v_mul_f32 v97, v97, v250
s_add_u32 s46, s46, s55
s_add_u32 m0, m0, s53
tr 192,238,0
v_mul_f32 v98, v98, v250
v_mul_f32 v99, v99, v250
mavv 216,212,176
s_add_u32 s40, s40, s42
tr 194,238,256
v_mul_f32 v100, v100, v250
v_mul_f32 v101, v101, v250
v_mul_f32 v102, v102, v250
mavv 212,212,168
s_cmp_eq_u32 s40, s43
s_cselect_b32 s40, 0, s40
tr 196,238,8448
v_mul_f32 v103, v103, v250
mavv 208,212,160
buffer_load_dwordx4 v241, s[16:19], s46 offen lds
pk 32,96,97
pk 33,98,99
mavv 224,216,160
s_add_u32 s46, s46, s57
tr 198,238,8704
pk 34,100,101
pk 35,102,103
v_accvgpr_read_b32 v104, a36
mavv 228,216,168
s_cmp_eq_u32 s46, s82
s_cselect_b32 s46, s58, s46
tr 200,238,8
v_accvgpr_read_b32 v105, a37
v_accvgpr_read_b32 v106, a38
mavv 232,216,176
tr 202,238,264
v_accvgpr_read_b32 v107, a39
v_accvgpr_read_b32 v108, a52
v_accvgpr_read_b32 v109, a53
tr 204,238,8456
v_accvgpr_read_b32 v110, a54
v_accvgpr_read_b32 v111, a55
tr 206,238,8712
v_mul_f32 v104, v104, v251
v_mul_f32 v105, v105, v251
v_mul_f32 v106, v106, v251
mavv 248,220,176
v_mul_f32 v107, v107, v251
v_mul_f32 v108, v108, v251
v_mul_f32 v109, v109, v251
v_mul_f32 v110, v110, v251
mavv 244,220,168
buffer_store_dwordx4 v[24:27], v240, s[24:27], s48 offen offset:2048 nt
v_mul_f32 v111, v111, v251
pk 36,104,105
mavv 240,220,160
s_waitcnt lgkmcnt(4)
s_or_b32 s98, s48, s93
pk 37,106,107
pk 38,108,109
pk 39,110,111
mvvaz 64,192,0
tr 208,238,64
v_accvgpr_read_b32 v228, a40
v_accvgpr_read_b32 v229, a41
mvva 64,196,16
tr 210,238,320
v_accvgpr_read_b32 v230, a42
v_accvgpr_read_b32 v231, a43
mvvaz 72,196,20
tr 212,238,8512
v_accvgpr_read_b32 v243, a56
v_accvgpr_read_b32 v236, a57
mvva 72,192,4
v_accvgpr_read_b32 v237, a58
v_accvgpr_read_b32 v248, a59
v_mul_f32 v228, v228, v252
mvvaz 80,192,8
tr 214,238,8768
v_mul_f32 v229, v229, v252
v_mul_f32 v230, v230, v252
mvva 80,196,24
tr 216,238,72
v_mul_f32 v231, v231, v252
v_mul_f32 v243, v243, v252
tr 218,238,328
v_add_u32 v239, s40, v235
v_mul_f32 v236, v236, v252
s_waitcnt lgkmcnt(0)
s_barrier
s_add_u32 s40, s40, s42
v_mul_f32 v237, v237, v252
mvvaz 68,200,0
s_add_u32 m0, s41, s49
s_add_u32 s41, s41, s42
tr 220,238,8520
v_mul_f32 v248, v248, v252
mvva 68,204,16
s_cmp_eq_u32 s41, s43
s_cselect_b32 s41, 0, s41
tr 222,238,8776
pk 40,228,229
pk 41,230,231
mvvaz 76,204,20
s_cmp_eq_u32 s40, s43
s_cselect_b32 s40, 0, s40
ds_read_b128 a[32:35], v239 offset:0
pk 42,243,236
mvva 76,200,4
buffer_load_dwordx4 v242, s[20:23], s47 offen lds
pk 43,237,248
mvvaz 84,200,8
s_add_u32 s47, s47, s59
s_add_u32 m0, m0, s61
ds_read_b128 a[48:51], v239 offset:64
mvva 84,204,24
ds_read_b128 a[36:39], v239 offset:2112
ds_read_b128 a[52:55], v239 offset:2176
buffer_load_dwordx4 v242, s[20:23], s47 offen lds
mvvaz 96,208,0
s_add_u32 s47, s47, s59
s_add_u32 m0, m0, s62
tr 192,238,128
mvva 96,212,16
tr 194,238,384
mvvaz 104,212,20
tr 196,238,8576
mvva 104,208,4
buffer_load_dwordx4 v242, s[20:23], s47 offen lds
mvvaz 112,208,8
s_add_u32 s47, s47, s59
s_add_u32 m0, m0, s61
tr 198,238,8832
mvva 112,212,24
tr 200,238,136
tr 202,238,392
v_add_u32 v239, s40, v235
buffer_load_dwordx4 v242, s[20:23], s47 offen lds
mvvaz 100,216,0
s_waitcnt lgkmcnt(4)
s_add_u32 s47, s47, s59
tr 204,238,8584
mvva 100,220,16
s_add_u32 m0, s41, s49
s_add_u32 s41, s41, s42
tr 206,238,8840
mvvaz 108,220,20
s_cmp_eq_u32 s41, s43
s_cselect_b32 s41, 0, s41
ds_read_b128 a[40:43], v239 offset:0
mvva 108,216,4
buffer_load_dwordx4 v242, s[20:23], s47 offen lds
v_accvgpr_read_b32 v248, a64
mvvaz 116,216,8
s_add_u32 s47, s47, s59
s_add_u32 m0, m0, s61
ds_read_b128 a[56:59], v239 offset:64
v_accvgpr_read_b32 v249, a65
mvva 116,220,24
s_add_u32 s40, s40, s42
ds_read_b128 a[44:47], v239 offset:2112
v_accvgpr_read_b32 v228, a66
v_accvgpr_read_b32 v229, a67
s_cmp_eq_u32 s40, s43
s_cselect_b32 s40, 0, s40
ds_read_b128 a[60:63], v239 offset:2176
v_accvgpr_read_b32 v230, a80
buffer_load_dwordx4 v242, s[20:23], s47 offen lds
v_accvgpr_read_b32 v231, a81
mvvaz 128,192,0
s_waitcnt lgkmcnt(4)
s_add_u32 s47, s47, s59
tr 208,238,192
v_accvgpr_read_b32 v243, a82
mvva 128,196,16
s_add_u32 m0, m0, s62
tr 210,238,448
v_accvgpr_read_b32 v236, a83
v_mul_f32 v248, v248, v250
mvvaz 136,196,20
tr 212,238,8640
v_mul_f32 v249, v249, v250
v_mul_f32 v228, v228, v250
mvva 136,192,4
buffer_load_dwordx4 v242, s[20:23], s47 offen lds
v_mul_f32 v229, v229, v250
mvvaz 144,192,8
s_add_u32 s47, s47, s59
s_add_u32 m0, m0, s61
tr 214,238,8896
mvva 144,196,24
tr 216,238,200
v_mul_f32 v230, v230, v250
v_mul_f32 v231, v231, v250
tr 218,238,456
v_mul_f32 v243, v243, v250
v_mul_f32 v236, v236, v250
buffer_load_dwordx4 v242, s[20:23], s47 offen lds
pk 48,248,249
mvvaz 132,200,0
s_add_u32 s47, s47, s60
tr 220,238,8648
pk 49,228,229
pk 50,230,231
mvva 132,204,16
s_cmp_eq_u32 s47, s83
s_cselect_b32 s47, s76, s47
tr 222,238,8904
pk 51,243,236
mvvaz 140,204,20
buffer_store_dwordx4 v[28:31], v240, s[24:27], s98 offen offset:3072 nt
v_accvgpr_read_b32 v237, a68
mvva 140,200,4
s_add_u32 s48, s48, s72
v_add_u32 v238, s40, v234
v_accvgpr_read_b32 v248, a69
v_accvgpr_read_b32 v249, a70
mvvaz 148,200,8
s_add_u32 s40, s40, s42
s_cmp_eq_u32 s40, s43
s_cselect_b32 s40, 0, s40
v_accvgpr_read_b32 v228, a71
mvva 148,204,24
buffer_store_dwordx4 v[32:35], v240, s[24:27], s48 offen nt
v_accvgpr_read_b32 v229, a84
v_accvgpr_read_b32 v230, a85
v_accvgpr_read_b32 v231, a86
s_waitcnt vmcnt(17) lgkmcnt(0)
s_barrier
v_accvgpr_read_b32 v243, a87
v_mul_f32 v237, v237, v251
mvvaz 160,208,0
s_add_u32 m0, s41, s50
s_add_u32 s41, s41, s42
tr 192,238,0
v_mul_f32 v248, v248, v251
mvva 160,212,16
s_cmp_eq_u32 s41, s43
s_cselect_b32 s41, 0, s41
tr 194,238,256
v_mul_f32 v249, v249, v251
mvvaz 168,212,20
tr 196,238,8448
v_mul_f32 v228, v228, v251
v_mul_f32 v229, v229, v251
mvva 168,208,4
buffer_load_dwordx4 v241, s[16:19], s46 offen lds
v_mul_f32 v230, v230, v251
mvvaz 176,208,8
s_add_u32 s46, s46, s55
s_add_u32 m0, m0, s53
tr 198,238,8704
v_mul_f32 v231, v231, v251
mvva 176,212,24
tr 200,238,8
v_mul_f32 v243, v243, v251
pk 52,237,248
tr 202,238,264
pk 53,249,228
pk 54,229,230
buffer_load_dwordx4 v241, s[16:19], s46 offen lds
pk 55,231,243
mvvaz 164,216,0
s_add_u32 s46, s46, s56
s_add_u32 m0, m0, s54
tr 204,238,8456
mvva 164,220,16
tr 206,238,8712
v_accvgpr_read_b32 v236, a72
v_accvgpr_read_b32 v237, a73
mvvaz 172,220,20
v_accvgpr_read_b32 v248, a74
v_accvgpr_read_b32 v249, a75
v_accvgpr_read_b32 v228, a88
mvva 172,216,4
buffer_load_dwordx4 v241, s[16:19], s46 offen lds
v_accvgpr_read_b32 v229, a89
mvvaz 180,216,8
s_add_u32 s46, s46, s55
s_add_u32 m0, m0, s53
v_accvgpr_read_b32 v230, a90
v_accvgpr_read_b32 v231, a91
mvva 180,220,24
buffer_store_dwordx4 v[36:39], v240, s[24:27], s48 offen offset:1024 nt
v_mul_f32 v236, v236, v252
s_waitcnt lgkmcnt(1)
v_mul_f32 v237, v237, v252
v_mul_f32 v248, v248, v252
v_mul_f32 v249, v249, v252
buffer_load_dwordx4 v241, s[16:19], s46 offen lds
v_mul_f32 v228, v228, v252
mvva 64,192,32
s_add_u32 s46, s46, s57
s_add_u32 m0, s41, s49
tr 208,238,64
v_mul_f32 v229, v229, v252
mvva 64,196,48
s_cmp_eq_u32 s46, s82
s_cselect_b32 s46, s58, s46
tr 210,238,320
v_mul_f32 v230, v230, v252
mvva 72,196,52
s_add_u32 s41, s41, s42
tr 212,238,8512
v_mul_f32 v231, v231, v252
mvva 72,192,36
buffer_load_dwordx4 v242, s[20:23], s47 offen lds
pk 56,236,237
mvva 80,192,40
s_add_u32 s47, s47, s59
s_add_u32 m0, m0, s61
tr 214,238,8768
pk 57,248,249
mvva 80,196,56
s_cmp_eq_u32 s41, s43
s_cselect_b32 s41, 0, s41
tr 216,238,72
pk 58,228,229
tr 218,238,328
v_add_u32 v239, s40, v235
pk 59,230,231
buffer_load_dwordx4 v242, s[20:23], s47 offen lds
mvva 68,200,32
s_waitcnt lgkmcnt(4)
s_add_u32 s47, s47, s59
tr 220,238,8520
mvva 68,204,48
s_add_u32 m0, m0, s62
s_add_u32 s40, s40, s42
tr 222,238,8776
mvva 76,204,52
s_cmp_eq_u32 s40, s43
s_cselect_b32 s40, 0, s40
ds_read_b128 a[64:67], v239 offset:0
mvva 76,200,36
buffer_load_dwordx4 v242, s[20:23], s47 offen lds
mvva 84,200,40
s_add_u32 s47, s47, s59
s_add_u32 m0, m0, s61
ds_read_b128 a[80:83], v239 offset:64
mvva 84,204,56
ds_read_b128 a[68:71], v239 offset:2112
ds_read_b128 a[84:87], v239 offset:2176
buffer_load_dwordx4 v242, s[20:23], s47 offen lds
mvva 96,208,32
s_waitcnt lgkmcnt(4)
s_add_u32 s47, s47, s59
tr 192,238,128
mvva 96,212,48
s_add_u32 m0, s41, s49
s_add_u32 s41, s41, s42
tr 194,238,384
mvva 104,212,52
s_cmp_eq_u32 s41, s43
s_cselect_b32 s41, 0, s41
tr 196,238,8576
mvva 104,208,36
buffer_load_dwordx4 v242, s[20:23], s47 offen lds
mvva 112,208,40
s_add_u32 s47, s47, s59
s_add_u32 m0, m0, s61
tr 198,238,8832
mvva 112,212,56
tr 200,238,136
tr 202,238,392
v_add_u32 v239, s40, v235
buffer_load_dwordx4 v242, s[20:23], s47 offen lds
mvva 100,216,32
s_add_u32 s47, s47, s59
s_add_u32 m0, m0, s62
tr 204,238,8584
mvva 100,220,48
s_add_u32 s40, s40, s42
tr 206,238,8840
mvva 108,220,52
s_cmp_eq_u32 s40, s43
s_cselect_b32 s40, 0, s40
ds_read_b128 a[72:75], v239 offset:0
mvva 108,216,36
buffer_load_dwordx4 v242, s[20:23], s47 offen lds
v_accvgpr_read_b32 v231, a96
mvva 116,216,40
s_add_u32 s47, s47, s59
s_add_u32 m0, m0, s61
ds_read_b128 a[88:91], v239 offset:64
v_accvgpr_read_b32 v243, a97
mvva 116,220,56
ds_read_b128 a[76:79], v239 offset:2112
v_accvgpr_read_b32 v236, a98
v_accvgpr_read_b32 v237, a99
s_waitcnt lgkmcnt(4)
ds_read_b128 a[92:95], v239 offset:2176
v_accvgpr_read_b32 v248, a112
v_accvgpr_read_b32 v249, a113
buffer_load_dwordx4 v242, s[20:23], s47 offen lds
mvva 128,192,32
s_add_u32 s47, s47, s60
tr 208,238,192
v_accvgpr_read_b32 v228, a114
v_accvgpr_read_b32 v229, a115
mvva 128,196,48
s_cmp_eq_u32 s47, s83
s_cselect_b32 s47, s76, s47
tr 210,238,448
v_mul_f32 v231, v231, v250
mvva 136,196,52
tr 212,238,8640
v_mul_f32 v243, v243, v250
v_mul_f32 v236, v236, v250
mvva 136,192,36
buffer_store_dwordx4 v[40:43], v240, s[24:27], s48 offen offset:2048 nt
v_mul_f32 v237, v237, v250
mvva 144,192,40
s_or_b32 s98, s48, s93
tr 214,238,8896
v_mul_f32 v248, v248, v250
mvva 144,196,56
tr 216,238,200
v_mul_f32 v249, v249, v250
v_mul_f32 v228, v228, v250
tr 218,238,456
v_mul_f32 v229, v229, v250
pk 0,231,243
pk 1,236,237
pk 2,248,249
pk 3,228,229
mvva 132,200,32
s_waitcnt lgkmcnt(4)
tr 220,238,8648
v_accvgpr_read_b32 v230, a100
v_accvgpr_read_b32 v231, a101
mvva 132,204,48
tr 222,238,8904
v_accvgpr_read_b32 v243, a102
mvva 140,204,52
v_accvgpr_read_b32 v236, a103
v_accvgpr_read_b32 v237, a116
v_accvgpr_read_b32 v248, a117
mvva 140,200,36
v_add_u32 v238, s40, v234
v_accvgpr_read_b32 v249, a118
v_accvgpr_read_b32 v228, a119
mvva 148,200,40
buffer_store_dwordx4 v[44:47], v240, s[24:27], s98 offen offset:3072 nt
v_mul_f32 v230, v230, v251
mvva 148,204,56
s_add_u32 s40, s40, s42
s_cmp_eq_u32 s40, s43
s_cselect_b32 s40, 0, s40
s_add_u32 s48, s48, s72
v_mul_f32 v231, v231, v251
v_mul_f32 v243, v243, v251
s_waitcnt vmcnt(17) lgkmcnt(0)
s_barrier
v_mul_f32 v236, v236, v251
v_mul_f32 v237, v237, v251
mvva 160,208,32
s_add_u32 m0, s41, s50
s_add_u32 s41, s41, s42
tr 192,238,0
v_mul_f32 v248, v248, v251
mvva 160,212,48
s_cmp_eq_u32 s41, s43
s_cselect_b32 s41, 0, s41
tr 194,238,256
v_mul_f32 v249, v249, v251
mvva 168,212,52
tr 196,238,8448
v_mul_f32 v228, v228, v251
pk 4,230,231
mvva 168,208,36
buffer_load_dwordx4 v241, s[16:19], s46 offen lds
mvva 176,208,40
s_add_u32 s46, s46, s55
s_add_u32 m0, m0, s53
tr 198,238,8704
pk 5,243,236
mvva 176,212,56
tr 200,238,8
pk 6,237,248
pk 7,249,228
tr 202,238,264
v_accvgpr_read_b32 v229, a104
v_accvgpr_read_b32 v230, a105
buffer_load_dwordx4 v241, s[16:19], s46 offen lds
v_accvgpr_read_b32 v231, a106
mvva 164,216,32
s_add_u32 s46, s46, s56
s_add_u32 m0, m0, s54
tr 204,238,8456
mvva 164,220,48
tr 206,238,8712
v_accvgpr_read_b32 v243, a107
v_accvgpr_read_b32 v236, a120
mvva 172,220,52
v_accvgpr_read_b32 v237, a121
v_accvgpr_read_b32 v248, a122
v_accvgpr_read_b32 v249, a123
mvva 172,216,36
buffer_load_dwordx4 v241, s[16:19], s46 offen lds
v_mul_f32 v229, v229, v252
mvva 180,216,40
s_add_u32 s46, s46, s55
s_add_u32 m0, m0, s53
v_mul_f32 v230, v230, v252
v_mul_f32 v231, v231, v252
mvva 180,220,56
buffer_store_dwordx4 v[48:51], v240, s[24:27], s48 offen nt
s_waitcnt lgkmcnt(1)
v_mul_f32 v243, v243, v252
v_mul_f32 v236, v236, v252
v_mul_f32 v237, v237, v252
buffer_load_dwordx4 v241, s[16:19], s46 offen lds
v_mul_f32 v248, v248, v252
mvva 64,192,64
s_add_u32 s46, s46, s57
s_add_u32 m0, s41, s49
tr 208,238,64
v_mul_f32 v249, v249, v252
mvva 64,196,80
s_cmp_eq_u32 s46, s82
s_cselect_b32 s46, s58, s46
tr 210,238,320
pk 8,229,230
mvva 72,196,84
s_add_u32 s41, s41, s42
tr 212,238,8512
pk 9,231,243
mvva 72,192,68
buffer_load_dwordx4 v242, s[20:23], s47 offen lds
pk 10,236,237
mvva 80,192,72
s_add_u32 s47, s47, s59
s_add_u32 m0, m0, s61
tr 214,238,8768
pk 11,248,249
mvva 80,196,88
s_cmp_eq_u32 s41, s43
s_cselect_b32 s41, 0, s41
tr 216,238,72
tr 218,238,328
v_add_u32 v239, s40, v235
buffer_load_dwordx4 v242, s[20:23], s47 offen lds
mvva 68,200,64
s_waitcnt lgkmcnt(4)
s_add_u32 s47, s47, s59
tr 220,238,8520
mvva 68,204,80
s_add_u32 m0, m0, s62
s_add_u32 s40, s40, s42
tr 222,238,8776
mvva 76,204,84
s_cmp_eq_u32 s40, s43
s_cselect_b32 s40, 0, s40
ds_read_b128 a[96:99], v239 offset:0
mvva 76,200,68
buffer_load_dwordx4 v242, s[20:23], s47 offen lds
mvva 84,200,72
s_add_u32 s47, s47, s59
s_add_u32 m0, m0, s61
ds_read_b128 a[112:115], v239 offset:64
mvva 84,204,88
ds_read_b128 a[100:103], v239 offset:2112
ds_read_b128 a[116:119], v239 offset:2176
buffer_load_dwordx4 v242, s[20:23], s47 offen lds
mvva 96,208,64
s_waitcnt lgkmcnt(4)
s_add_u32 s47, s47, s59
tr 192,238,128
mvva 96,212,80
s_add_u32 m0, s41, s49
s_add_u32 s41, s41, s42
tr 194,238,384
mvva 104,212,84
s_cmp_eq_u32 s41, s43
s_cselect_b32 s41, 0, s41
tr 196,238,8576
mvva 104,208,68
buffer_load_dwordx4 v242, s[20:23], s47 offen lds
mvva 112,208,72
s_add_u32 s47, s47, s59
s_add_u32 m0, m0, s61
tr 198,238,8832
mvva 112,212,88
tr 200,238,136
tr 202,238,392
v_add_u32 v239, s40, v235
buffer_load_dwordx4 v242, s[20:23], s47 offen lds
mvva 100,216,64
s_add_u32 s47, s47, s59
s_add_u32 m0, m0, s62
tr 204,238,8584
mvva 100,220,80
s_add_u32 s40, s40, s42
tr 206,238,8840
mvva 108,220,84
s_cmp_eq_u32 s40, s43
s_cselect_b32 s40, 0, s40
ds_read_b128 a[104:107], v239 offset:0
mvva 108,216,68
buffer_load_dwordx4 v242, s[20:23], s47 offen lds
v_accvgpr_read_b32 v249, a128
mvva 116,216,72
s_add_u32 s47, s47, s59
s_add_u32 m0, m0, s61
ds_read_b128 a[120:123], v239 offset:64
v_accvgpr_read_b32 v228, a129
mvva 116,220,88
ds_read_b128 a[108:111], v239 offset:2112
v_accvgpr_read_b32 v229, a130
v_accvgpr_read_b32 v230, a131
s_waitcnt lgkmcnt(4)
ds_read_b128 a[124:127], v239 offset:2176
v_accvgpr_read_b32 v231, a144
v_accvgpr_read_b32 v243, a145
buffer_load_dwordx4 v242, s[20:23], s47 offen lds
mvva 128,192,64
s_add_u32 s47, s47, s60
tr 208,238,192
v_accvgpr_read_b32 v236, a146
v_accvgpr_read_b32 v237, a147
mvva 128,196,80
s_cmp_eq_u32 s47, s83
s_cselect_b32 s47, s76, s47
tr 210,238,448
v_mul_f32 v249, v249, v250
mvva 136,196,84
tr 212,238,8640
v_mul_f32 v228, v228, v250
v_mul_f32 v229, v229, v250
mvva 136,192,68
buffer_store_dwordx4 v[52:55], v240, s[24:27], s48 offen offset:1024 nt
v_mul_f32 v230, v230, v250
mvva 144,192,72
tr 214,238,8896
v_mul_f32 v231, v231, v250
mvva 144,196,88
tr 216,238,200
v_mul_f32 v243, v243, v250
v_mul_f32 v236, v236, v250
tr 218,238,456
v_mul_f32 v237, v237, v250
pk 16,249,228
pk 17,229,230
pk 18,231,243
pk 19,236,237
mvva 132,200,64
s_waitcnt lgkmcnt(4)
tr 220,238,8648
v_accvgpr_read_b32 v248, a132
v_accvgpr_read_b32 v249, a133
mvva 132,204,80
tr 222,238,8904
v_accvgpr_read_b32 v228, a134
mvva 140,204,84
v_accvgpr_read_b32 v229, a135
v_accvgpr_read_b32 v230, a148
v_accvgpr_read_b32 v231, a149
mvva 140,200,68
v_add_u32 v238, s40, v234
v_accvgpr_read_b32 v243, a150
v_accvgpr_read_b32 v236, a151
mvva 148,200,72
buffer_store_dwordx4 v[56:59], v240, s[24:27], s48 offen offset:2048 nt
v_mul_f32 v248, v248, v251
mvva 148,204,88
s_add_u32 s40, s40, s42
s_cmp_eq_u32 s40, s43
s_cselect_b32 s40, 0, s40
v_mul_f32 v249, v249, v251
s_or_b32 s98, s48, s93
v_mul_f32 v228, v228, v251
v_mul_f32 v229, v229, v251
s_waitcnt vmcnt(17) lgkmcnt(0)
s_barrier
v_mul_f32 v230, v230, v251
v_mul_f32 v231, v231, v251
mvva 160,208,64
s_add_u32 m0, s41, s50
s_add_u32 s41, s41, s42
tr 192,238,0
v_mul_f32 v243, v243, v251
mvva 160,212,80
s_cmp_eq_u32 s41, s43
s_cselect_b32 s41, 0, s41
tr 194,238,256
v_mul_f32 v236, v236, v251
mvva 168,212,84
tr 196,238,8448
pk 20,248,249
pk 21,228,229
mvva 168,208,68
buffer_load_dwordx4 v241, s[16:19], s46 offen lds
mvva 176,208,72
s_add_u32 s46, s46, s55
s_add_u32 m0, m0, s53
tr 198,238,8704
pk 22,230,231
mvva 176,212,88
tr 200,238,8
pk 23,243,236
v_accvgpr_read_b32 v237, a136
tr 202,238,264
v_accvgpr_read_b32 v248, a137
v_accvgpr_read_b32 v249, a138
buffer_load_dwordx4 v241, s[16:19], s46 offen lds
v_accvgpr_read_b32 v228, a139
mvva 164,216,64
s_add_u32 s46, s46, s56
s_add_u32 m0, m0, s54
tr 204,238,8456
mvva 164,220,80
tr 206,238,8712
v_accvgpr_read_b32 v229, a152
v_accvgpr_read_b32 v230, a153
mvva 172,220,84
v_accvgpr_read_b32 v231, a154
v_accvgpr_read_b32 v243, a155
v_mul_f32 v237, v237, v252
mvva 172,216,68
buffer_load_dwordx4 v241, s[16:19], s46 offen lds
v_mul_f32 v248, v248, v252
mvva 180,216,72
s_add_u32 s46, s46, s55
s_add_u32 m0, m0, s53
v_mul_f32 v249, v249, v252
v_mul_f32 v228, v228, v252
mvva 180,220,88
buffer_store_dwordx4 v[60:63], v240, s[24:27], s98 offen offset:3072 nt
s_waitcnt lgkmcnt(1)
s_add_u32 s48, s48, s72
v_mul_f32 v229, v229, v252
v_mul_f32 v230, v230, v252
buffer_load_dwordx4 v241, s[16:19], s46 offen lds
v_mul_f32 v231, v231, v252
mvva 64,192,96
s_add_u32 s46, s46, s57
s_add_u32 m0, s41, s49
tr 208,238,64
v_mul_f32 v243, v243, v252
mvva 64,196,112
s_cmp_eq_u32 s46, s82
s_cselect_b32 s46, s58, s46
tr 210,238,320
pk 24,237,248
mvva 72,196,116
s_add_u32 s41, s41, s42
tr 212,238,8512
pk 25,249,228
mvva 72,192,100
buffer_load_dwordx4 v242, s[20:23], s47 offen lds
pk 26,229,230
mvva 80,192,104
s_add_u32 s47, s47, s59
s_add_u32 m0, m0, s61
tr 214,238,8768
pk 27,231,243
mvva 80,196,120
s_cmp_eq_u32 s41, s43
s_cselect_b32 s41, 0, s41
tr 216,238,72
tr 218,238,328
v_add_u32 v239, s40, v235
buffer_load_dwordx4 v242, s[20:23], s47 offen lds
mvva 68,200,96
s_waitcnt lgkmcnt(4)
s_add_u32 s47, s47, s59
tr 220,238,8520
mvva 68,204,112
s_add_u32 m0, m0, s62
s_add_u32 s40, s40, s42
tr 222,238,8776
mvva 76,204,116
s_cmp_eq_u32 s40, s43
s_cselect_b32 s40, 0, s40
ds_read_b128 a[128:131], v239 offset:0
mvva 76,200,100
buffer_load_dwordx4 v242, s[20:23], s47 offen lds
mvva 84,200,104
s_add_u32 s47, s47, s59
s_add_u32 m0, m0, s61
ds_read_b128 a[144:147], v239 offset:64
mvva 84,204,120
ds_read_b128 a[132:135], v239 offset:2112
ds_read_b128 a[148:151], v239 offset:2176
buffer_load_dwordx4 v242, s[20:23], s47 offen lds
mvva 96,208,96
s_waitcnt lgkmcnt(4)
s_add_u32 s47, s47, s59
tr 192,238,128
mvva 96,212,112
s_add_u32 m0, s41, s49
s_add_u32 s41, s41, s42
tr 194,238,384
mvva 104,212,116
s_cmp_eq_u32 s41, s43
s_cselect_b32 s41, 0, s41
tr 196,238,8576
mvva 104,208,100
buffer_load_dwordx4 v242, s[20:23], s47 offen lds
mvva 112,208,104
s_add_u32 s47, s47, s59
s_add_u32 m0, m0, s61
tr 198,238,8832
mvva 112,212,120
tr 200,238,136
tr 202,238,392
v_add_u32 v239, s40, v235
buffer_load_dwordx4 v242, s[20:23], s47 offen lds
mvva 100,216,96
s_add_u32 s47, s47, s59
s_add_u32 m0, m0, s62
tr 204,238,8584
mvva 100,220,112
s_add_u32 s40, s40, s42
tr 206,238,8840
mvva 108,220,116
s_cmp_eq_u32 s40, s43
s_cselect_b32 s40, 0, s40
ds_read_b128 a[136:139], v239 offset:0
mvva 108,216,100
buffer_load_dwordx4 v242, s[20:23], s47 offen lds
v_accvgpr_read_b32 v243, a160
mvva 116,216,104
s_add_u32 s47, s47, s59
s_add_u32 m0, m0, s61
ds_read_b128 a[152:155], v239 offset:64
mvva 116,220,120
ds_read_b128 a[140:143], v239 offset:2112
v_accvgpr_read_b32 v236, a161
v_accvgpr_read_b32 v237, a162
s_waitcnt lgkmcnt(4)
ds_read_b128 a[156:159], v239 offset:2176
v_accvgpr_read_b32 v248, a163
v_accvgpr_read_b32 v249, a176
buffer_load_dwordx4 v242, s[20:23], s47 offen lds
mvva 128,192,96
s_add_u32 s47, s47, s60
tr 208,238,192
v_accvgpr_read_b32 v228, a177
v_accvgpr_read_b32 v229, a178
mvva 128,196,112
s_cmp_eq_u32 s47, s83
s_cselect_b32 s47, s76, s47
tr 210,238,448
mvva 136,196,116
tr 212,238,8640
v_accvgpr_read_b32 v230, a179
v_mul_f32 v243, v243, v250
mvva 136,192,100
buffer_store_dwordx4 v[0:3], v240, s[24:27], s48 offen nt
v_mul_f32 v236, v236, v250
mvva 144,192,104
tr 214,238,8896
v_mul_f32 v237, v237, v250
mvva 144,196,120
tr 216,238,200
v_mul_f32 v248, v248, v250
v_mul_f32 v249, v249, v250
tr 218,238,456
v_mul_f32 v228, v228, v250
v_mul_f32 v229, v229, v250
v_mul_f32 v230, v230, v250
pk 32,243,236
mvva 132,200,96
s_waitcnt lgkmcnt(4)
tr 220,238,8648
pk 33,237,248
pk 34,249,228
mvva 132,204,112
tr 222,238,8904
pk 35,229,230
mvva 140,204,116
v_accvgpr_read_b32 v231, a164
v_accvgpr_read_b32 v243, a165
v_accvgpr_read_b32 v236, a166
mvva 140,200,100
v_add_u32 v238, s40, v234
v_accvgpr_read_b32 v237, a167
mvva 148,200,104
buffer_store_dwordx4 v[4:7], v240, s[24:27], s48 offen offset:1024 nt
v_accvgpr_read_b32 v248, a180
mvva 148,204,120
s_add_u32 s40, s40, s42
s_cmp_eq_u32 s40, s43
s_cselect_b32 s40, 0, s40
v_accvgpr_read_b32 v249, a181
v_accvgpr_read_b32 v228, a182
v_accvgpr_read_b32 v229, a183
s_waitcnt vmcnt(17) lgkmcnt(0)
s_barrier
v_mul_f32 v231, v231, v251
v_mul_f32 v243, v243, v251
mvva 160,208,96
s_add_u32 m0, s41, s50
s_add_u32 s41, s41, s42
tr 192,238,0
mvva 160,212,112
s_cmp_eq_u32 s41, s43
s_cselect_b32 s41, 0, s41
tr 194,238,256
v_mul_f32 v236, v236, v251
mvva 168,212,116
tr 196,238,8448
v_mul_f32 v237, v237, v251
v_mul_f32 v248, v248, v251
mvva 168,208,100
buffer_load_dwordx4 v241, s[16:19], s46 offen lds
mvva 176,208,104
s_add_u32 s46, s46, s55
s_add_u32 m0, m0, s53
tr 198,238,8704
v_mul_f32 v249, v249, v251
mvva 176,212,120
tr 200,238,8
v_mul_f32 v228, v228, v251
tr 202,238,264
v_mul_f32 v229, v229, v251
pk 36,231,243
pk 37,236,237
pk 38,248,249
pk 39,228,229
mvva 164,216,96
tr 204,238,8456
v_accvgpr_read_b32 v230, a168
mvva 164,220,112
tr 206,238,8712
v_accvgpr_read_b32 v231, a169
v_accvgpr_read_b32 v243, a170
mvva 172,220,116
v_accvgpr_read_b32 v236, a171
v_accvgpr_read_b32 v237, a184
mvva 172,216,100
buffer_load_dwordx4 v241, s[16:19], s46 offen lds
v_accvgpr_read_b32 v248, a185
mvva 180,216,104
s_add_u32 s46, s46, s56
s_add_u32 m0, m0, s54
v_accvgpr_read_b32 v249, a186
v_accvgpr_read_b32 v228, a187
mvva 180,220,120
buffer_store_dwordx4 v[8:11], v240, s[24:27], s48 offen offset:2048 nt
s_or_b32 s98, s48, s93
v_mul_f32 v230, v230, v252
v_mul_f32 v231, v231, v252
v_mul_f32 v243, v243, v252
s_waitcnt lgkmcnt(1)
v_mul_f32 v236, v236, v252
v_mul_f32 v237, v237, v252
mvva 64,192,128
tr 208,238,64
v_mul_f32 v248, v248, v252
v_mul_f32 v249, v249, v252
mvva 64,196,144
tr 210,238,320
v_mul_f32 v228, v228, v252
pk 40,230,231
mvva 72,196,148
tr 212,238,8512
pk 41,243,236
mvva 72,192,132
buffer_load_dwordx4 v241, s[16:19], s46 offen lds
pk 42,237,248
mvva 80,192,136
s_add_u32 s46, s46, s55
s_add_u32 m0, m0, s53
tr 214,238,8768
mvva 80,196,152
tr 216,238,72
pk 43,249,228
tr 218,238,328
v_add_u32 v239, s40, v235
s_add_u32 s40, s40, s42
s_cmp_eq_u32 s40, s43
s_cselect_b32 s40, 0, s40
mvva 68,200,128
s_waitcnt lgkmcnt(4)
tr 220,238,8520
mvva 68,204,144
tr 222,238,8776
mvva 76,204,148
ds_read_b128 a[160:163], v239 offset:0
mvva 76,200,132
buffer_load_dwordx4 v241, s[16:19], s46 offen lds
mvva 84,200,136
s_add_u32 s46, s46, s57
ds_read_b128 a[176:179], v239 offset:64
mvva 84,204,152
s_cmp_eq_u32 s46, s82
s_cselect_b32 s46, s58, s46
ds_read_b128 a[164:167], v239 offset:2112
s_addk_i32 s46, 256
s_addk_i32 s82, 256
s_addk_i32 s58, 256
ds_read_b128 a[180:183], v239 offset:2176
buffer_store_dwordx4 v[12:15], v240, s[24:27], s98 offen offset:3072 nt
mvva 96,208,128
s_waitcnt lgkmcnt(4)
s_add_u32 m0, s41, s50
s_add_u32 s48, s48, s72
tr 192,238,128
mvva 96,212,144
s_add_u32 s41, s41, s42
tr 194,238,384
mvva 104,212,148
s_cmp_eq_u32 s41, s43
s_cselect_b32 s41, 0, s41
tr 196,238,8576
mvva 104,208,132
buffer_load_dwordx4 v241, s[16:19], s46 offen lds
mvva 112,208,136
s_add_u32 s46, s46, s55
s_add_u32 m0, m0, s53
tr 198,238,8832
mvva 112,212,152
tr 200,238,136
tr 202,238,392
v_add_u32 v239, s40, v235
s_add_u32 s40, s40, s42
s_cmp_eq_u32 s40, s43
s_cselect_b32 s40, 0, s40
mvva 100,216,128
tr 204,238,8584
mvva 100,220,144
tr 206,238,8840
mvva 108,220,148
ds_read_b128 a[168:171], v239 offset:0
v_accvgpr_read_b32 v228, a192
mvva 108,216,132
buffer_load_dwordx4 v241, s[16:19], s46 offen lds
v_accvgpr_read_b32 v229, a193
mvva 116,216,136
s_add_u32 s46, s46, s56
s_add_u32 m0, m0, s54
ds_read_b128 a[184:187], v239 offset:64
v_accvgpr_read_b32 v230, a194
mvva 116,220,152
ds_read_b128 a[172:175], v239 offset:2112
v_accvgpr_read_b32 v231, a195
s_waitcnt lgkmcnt(4)
ds_read_b128 a[188:191], v239 offset:2176
v_accvgpr_read_b32 v243, a208
v_accvgpr_read_b32 v236, a209
buffer_store_dwordx4 v[16:19], v240, s[24:27], s48 offen nt
v_accvgpr_read_b32 v237, a210
mvva 128,192,128
tr 208,238,192
v_accvgpr_read_b32 v248, a211
mvva 128,196,144
tr 210,238,448
v_mul_f32 v228, v228, v250
v_mul_f32 v229, v229, v250
mvva 136,196,148
tr 212,238,8640
v_mul_f32 v230, v230, v250
v_mul_f32 v231, v231, v250
mvva 136,192,132
buffer_load_dwordx4 v241, s[16:19], s46 offen lds
v_mul_f32 v243, v243, v250
mvva 144,192,136
s_add_u32 s46, s46, s55
s_add_u32 m0, m0, s53
tr 214,238,8896
mvva 144,196,152
tr 216,238,200
v_mul_f32 v236, v236, v250
v_mul_f32 v237, v237, v250
tr 218,238,456
v_mul_f32 v248, v248, v250
pk 48,228,229
pk 49,230,231
pk 50,243,236
mvva 132,200,128
s_waitcnt lgkmcnt(4)
tr 220,238,8648
pk 51,237,248
v_accvgpr_read_b32 v249, a196
mvva 132,204,144
tr 222,238,8904
v_accvgpr_read_b32 v228, a197
v_accvgpr_read_b32 v229, a198
mvva 140,204,148
v_accvgpr_read_b32 v230, a199
v_accvgpr_read_b32 v231, a212
mvva 140,200,132
buffer_load_dwordx4 v241, s[16:19], s46 offen lds
v_add_u32 v238, s40, v234
mvva 148,200,136
s_add_u32 s46, s46, s57
s_cmp_eq_u32 s46, s82
s_cselect_b32 s46, s58, s46
v_accvgpr_read_b32 v243, a213
mvva 148,204,152
buffer_store_dwordx4 v[20:23], v240, s[24:27], s48 offen offset:1024 nt
v_accvgpr_read_b32 v236, a214
s_add_u32 s40, s40, s42
s_cmp_eq_u32 s40, s43
s_cselect_b32 s40, 0, s40
s_waitcnt vmcnt(14) lgkmcnt(0)
s_barrier
v_accvgpr_read_b32 v237, a215
v_mul_f32 v249, v249, v251
mvva 160,208,128
s_add_u32 m0, s41, s50
s_add_u32 s41, s41, s42
tr 192,238,0
v_mul_f32 v228, v228, v251
mvva 160,212,144
s_cmp_eq_u32 s41, s43
s_cselect_b32 s41, 0, s41
tr 194,238,256
mvva 168,212,148
tr 196,238,8448
v_mul_f32 v229, v229, v251
v_mul_f32 v230, v230, v251
mvva 168,208,132
buffer_load_dwordx4 v241, s[16:19], s46 offen lds
v_mul_f32 v231, v231, v251
mvva 176,208,136
s_add_u32 s46, s46, s55
s_add_u32 m0, m0, s53
tr 198,238,8704
mvva 176,212,152
tr 200,238,8
v_mul_f32 v243, v243, v251
v_mul_f32 v236, v236, v251
tr 202,238,264
v_mul_f32 v237, v237, v251
pk 52,249,228
pk 53,229,230
pk 54,231,243
pk 55,236,237
mvva 164,216,128
tr 204,238,8456
v_accvgpr_read_b32 v248, a200
mvva 164,220,144
tr 206,238,8712
v_accvgpr_read_b32 v249, a201
v_accvgpr_read_b32 v228, a202
mvva 172,220,148
v_accvgpr_read_b32 v229, a203
v_accvgpr_read_b32 v230, a216
v_accvgpr_read_b32 v231, a217
mvva 172,216,132
buffer_load_dwordx4 v241, s[16:19], s46 offen lds
mvva 180,216,136
s_add_u32 s46, s46, s56
s_add_u32 m0, m0, s54
v_accvgpr_read_b32 v243, a218
v_accvgpr_read_b32 v236, a219
mvva 180,220,152
v_mul_f32 v248, v248, v252
v_mul_f32 v249, v249, v252
v_mul_f32 v228, v228, v252
buffer_store_dwordx4 v[24:27], v240, s[24:27], s48 offen offset:2048 nt
s_waitcnt lgkmcnt(6)
s_or_b32 s98, s48, s93
v_mul_f32 v229, v229, v252
v_mul_f32 v230, v230, v252
s_mov_b32 s5, 1
s_mov_b64 vcc, -1
s_branch L_padB3
L_hop_bodyw:
s_cmp_eq_u32 s5, 0
s_nop 0
L_hop_body2w:
s_cmp_eq_u32 s4, 3
s_cbranch_scc1 L_ret_bodyw
L_ret_bodyw:
s_mov_b64 vcc, 0
s_branch L_bodyw
.fill 929, 4, 0xbf800000
L_tail_bw:
L_pre_bw:
s_mov_b64 vcc, -1
s_branch L_padD3
L_hop_bw:
s_cmp_eq_u32 s4, 3
s_cbranch_scc1 L_ret_bw
L_ret_bw:
s_mov_b64 vcc, 0
mvvvz 128,192,0
s_add_u32 s45, s45, s52
s_add_u32 m0, s41, s49
ds_read_b128 v[208:211], v236 offset:256
mvvv 128,196,16
s_add_u32 s41, s41, s42
s_cmp_eq_u32 s41, s43
s_cselect_b32 s41, 0, s41
mvvv 128,200,32
ds_read_b128 v[212:215], v236 offset:320
v_add_f32 v229, v229, v172
mvvv 128,204,48
buffer_load_dwordx4 v240, s[8:11], s44 offen nt lds
mvvvz 136,204,52
s_add_u32 m0, m0, 32
ds_read_b128 v[216:219], v236 offset:384
v_add_f32 v229, v229, v173
mvvv 136,200,36
mvvv 136,196,20
ds_read_b128 v[220:223], v236 offset:448
pk 170,172,173
mvvv 136,192,4
mvvvz 144,192,8
mvvv 144,196,24
mvvv 144,200,40
mvvv 144,204,56
buffer_load_dwordx4 v240, s[8:11], s44 offen offset:1024 nt lds
s_add_u32 m0, m0, 32
v_add_f32 v229, v229, v174
v_add_f32 v229, v229, v175
s_waitcnt lgkmcnt(0)
pk 171,174,175
v_add_f32 v230, v230, v176
mvvv 128,208,64
ds_read_b128 v[192:195], v236 offset:8448
v_add_f32 v230, v230, v177
mvvv 128,212,80
pk 176,176,177
v_add_f32 v230, v230, v178
mvvv 128,216,96
ds_read_b128 v[196:199], v236 offset:8512
v_add_f32 v230, v230, v179
mvvv 128,220,112
buffer_load_dwordx4 v240, s[8:11], s44 offen offset:2048 nt lds
mvvv 136,220,116
s_add_u32 m0, m0, 32
ds_read_b128 v[200:203], v236 offset:8576
pk 177,178,179
mvvv 136,216,100
v_add_f32 v230, v230, v180
v_add_f32 v230, v230, v181
mvvv 136,212,84
ds_read_b128 v[204:207], v236 offset:8640
pk 178,180,181
mvvv 136,208,68
v_fma_f32 v128, v128, s38, v224
v_fma_f32 v129, v129, s38, v224
mvvv 144,208,72
v_max_f32 v243, v128, v129
v_fma_f32 v130, v130, s38, v224
mvvv 144,212,88
v_fma_f32 v131, v131, s38, v224
v_max3_f32 v243, v243, v130, v131
mvvv 144,216,104
v_fma_f32 v136, v136, s38, v225
v_fma_f32 v137, v137, s38, v225
mvvv 144,220,120
buffer_load_dwordx4 v240, s[8:11], s44 offen offset:3072 nt lds
s_add_u32 s44, s44, s52
v_max3_f32 v243, v243, v136, v137
v_fma_f32 v138, v138, s38, v225
s_mov_b32 s16, s30
v_fma_f32 v139, v139, s38, v225
v_max3_f32 v243, v243, v138, v139
s_mov_b32 s17, s31
v_lshrrev_b32 v239, 7, v240
v_mul_u32_u24 v239, s59, v239
s_waitcnt lgkmcnt(0)
s_mov_b32 s18, 0x70000
v_and_b32 v242, 0x70, v240
mvvvz 132,192,0
s_mov_b32 m0, s73
ds_read_b128 v[208:211], v236 offset:8704
v_lshlrev_b32 v238, 2, v240
mvvv 132,196,16
s_add_u32 s46, s71, s74
v_add_u32 v242, v242, v239
v_lshrrev_b32 v239, 9, v240
mvvv 132,200,32
s_add_u32 s77, s71, 0x380
ds_read_b128 v[212:215], v236 offset:8768
v_mul_u32_u24 v239, 0x180, v239
mvvv 132,204,48
buffer_load_dword v238, s[84:87], s88 offen lds
mvvvz 140,204,52
s_movk_i32 s53, 160
ds_read_b128 v[216:219], v236 offset:8832
v_sub_u32 v235, v233, v239
mvvv 140,200,36
s_mov_b32 s55, 114688
v_add_u32 v234, s49, v240
v_fma_f32 v144, v144, s38, v226
mvvv 140,196,20
s_mov_b32 s56, 0xfffac000
ds_read_b128 v[220:223], v236 offset:8896
v_fma_f32 v145, v145, s38, v226
mvvv 140,192,4
s_mov_b32 s57, 114816
v_max3_f32 v243, v243, v144, v145
v_fma_f32 v146, v146, s38, v226
mvvvz 148,192,8
s_mov_b32 s48, s70
v_fma_f32 v147, v147, s38, v226
v_max3_f32 v243, v243, v146, v147
mvvv 148,196,24
mvvv 148,200,40
mvvv 148,204,56
v_add_u32 v237, s40, v233
s_add_u32 s40, s40, s42
s_cmp_eq_u32 s40, s43
s_cselect_b32 s40, 0, s40
v_add_f32 v230, v230, v182
v_add_f32 v230, v230, v183
pk 179,182,183
s_waitcnt lgkmcnt(0)
mvvv 132,208,64
tr 192,237,0
mvvv 132,212,80
tr 194,237,8448
mvvv 132,216,96
tr 196,237,32
mvvv 132,220,112
mvvv 140,220,116
tr 198,237,8480
mvvv 140,216,100
tr 200,237,64
mvvv 140,212,84
tr 202,237,8512
mvvv 140,208,68
mvvv 148,208,72
tr 204,237,96
v_fma_f32 v132, v132, s38, v224
mvvv 148,212,88
tr 206,237,8544
v_fma_f32 v133, v133, s38, v224
mvvv 148,216,104
v_max3_f32 v243, v243, v132, v133
v_fma_f32 v134, v134, s38, v224
mvvv 148,220,120
v_fma_f32 v135, v135, s38, v224
v_max3_f32 v243, v243, v134, v135
v_fma_f32 v140, v140, s38, v225
v_fma_f32 v141, v141, s38, v225
v_max3_f32 v243, v243, v140, v141
v_fma_f32 v142, v142, s38, v225
v_fma_f32 v143, v143, s38, v225
v_max3_f32 v243, v243, v142, v143
s_waitcnt lgkmcnt(1)
v_fma_f32 v148, v148, s38, v226
v_fma_f32 v149, v149, s38, v226
mavv 0,192,160
s_mov_b32 s63, 28
tr 208,237,128
v_max3_f32 v243, v243, v148, v149
mavv 4,192,168
tr 210,237,8576
v_fma_f32 v150, v150, s38, v226
mavv 8,192,176
v_fma_f32 v151, v151, s38, v226
v_max3_f32 v243, v243, v150, v151
tr 212,237,160
tr 214,237,8608
mavv 24,196,176
mavv 20,196,168
tr 216,237,192
mavv 16,196,160
tr 218,237,8640
mavv 32,200,160
v_cmp_lt_f32 vcc, s39, v243
mavv 36,200,168
tr 220,237,224
mavv 40,200,176
s_cbranch_vccnz L_rare0w
L_ret28w:
tr 222,237,8672
s_waitcnt lgkmcnt(4)
v_exp_f32 v128, v128
tr 192,237,256
v_add_f32 v228, v228, v128
mavv 56,204,176
tr 194,237,8704
mavv 52,204,168
v_exp_f32 v129, v129
mavv 48,204,160
tr 196,237,288
v_add_f32 v228, v228, v129
mavv 64,208,160
tr 198,237,8736
pk 128,128,129
mavv 68,208,168
v_exp_f32 v130, v130
mavv 72,208,176
tr 200,237,320
v_add_f32 v228, v228, v130
tr 202,237,8768
v_exp_f32 v131, v131
mavv 88,212,176
tr 204,237,352
v_add_f32 v228, v228, v131
mavv 84,212,168
tr 206,237,8800
pk 129,130,131
mavv 80,212,160
s_waitcnt lgkmcnt(4)
v_exp_f32 v132, v132
mavv 96,216,160
tr 208,237,384
v_add_f32 v228, v228, v132
mavv 100,216,168
tr 210,237,8832
mavv 104,216,176
v_exp_f32 v133, v133
tr 212,237,416
v_add_f32 v228, v228, v133
tr 214,237,8864
pk 130,132,133
mavv 120,220,176
v_exp_f32 v134, v134
mavv 116,220,168
tr 216,237,448
v_add_f32 v228, v228, v134
mavv 112,220,160
tr 218,237,8896
mavv 128,192,160
v_exp_f32 v135, v135
mavv 132,192,168
tr 220,237,480
v_add_f32 v228, v228, v135
mavv 136,192,176
tr 222,237,8928
pk 131,134,135
v_exp_f32 v136, v136
v_exp_f32 v137, v137
mavv 152,196,176
v_exp_f32 v138, v138
mavv 148,196,168
v_exp_f32 v139, v139
mavv 144,196,160
s_waitcnt lgkmcnt(2)
v_exp_f32 v140, v140
mavv 160,200,160
v_exp_f32 v141, v141
mavv 164,200,168
v_exp_f32 v142, v142
mavv 168,200,176
v_exp_f32 v143, v143
v_add_u32 v236, s40, v232
v_add_f32 v229, v229, v136
s_add_u32 s40, s40, s42
s_cmp_eq_u32 s40, s43
s_cselect_b32 s40, 0, s40
mavv 184,204,176
v_exp_f32 v144, v144
mavv 180,204,168
v_exp_f32 v145, v145
mavv 176,204,160
s_waitcnt vmcnt(13) lgkmcnt(0)
s_barrier
v_add_f32 v229, v229, v137
mavv 192,208,160
s_add_u32 m0, s41, s49
s_add_u32 s41, s41, s42
ds_read_b128 v[192:195], v236 offset:0
mavv 196,208,168
s_cmp_eq_u32 s41, s43
s_cselect_b32 s41, 0, s41
pk 136,136,137
mavv 200,208,176
ds_read_b128 v[196:199], v236 offset:64
v_add_f32 v229, v229, v138
buffer_load_dwordx4 v240, s[12:15], s45 offen nt lds
s_add_u32 m0, m0, 32
ds_read_b128 v[200:203], v236 offset:128
v_add_f32 v229, v229, v139
mavv 216,212,176
v_exp_f32 v146, v146
mavv 212,212,168
ds_read_b128 v[204:207], v236 offset:192
pk 137,138,139
mavv 208,212,160
buffer_load_dwordx4 v240, s[12:15], s45 offen offset:1024 nt lds
mavv 224,216,160
s_add_u32 m0, m0, 32
v_exp_f32 v147, v147
mavv 228,216,168
v_exp_f32 v148, v148
mavv 232,216,176
v_exp_f32 v149, v149
buffer_load_dwordx4 v240, s[12:15], s45 offen offset:2048 nt lds
s_add_u32 m0, m0, 32
v_exp_f32 v150, v150
mavv 248,220,176
v_exp_f32 v151, v151
mavv 244,220,168
s_waitcnt lgkmcnt(0)
mavv 240,220,160
buffer_load_dwordx4 v240, s[12:15], s45 offen offset:3072 nt lds
mvvvz 160,192,0
s_add_u32 s45, s45, s52
s_add_u32 m0, s41, s49
ds_read_b128 v[208:211], v236 offset:256
mvvv 160,196,16
s_add_u32 s41, s41, s42
s_cmp_eq_u32 s41, s43
s_cselect_b32 s41, 0, s41
mvvv 160,200,32
ds_read_b128 v[212:215], v236 offset:320
v_add_f32 v229, v229, v140
mvvv 160,204,48
buffer_load_dwordx4 v240, s[12:15], s45 offen nt lds
mvvvz 168,204,52
s_add_u32 m0, m0, 32
ds_read_b128 v[216:219], v236 offset:384
v_add_f32 v229, v229, v141
mvvv 168,200,36
mvvv 168,196,20
ds_read_b128 v[220:223], v236 offset:448
pk 138,140,141
mvvv 168,192,4
mvvvz 176,192,8
mvvv 176,196,24
mvvv 176,200,40
mvvv 176,204,56
buffer_load_dwordx4 v240, s[12:15], s45 offen offset:1024 nt lds
s_add_u32 m0, m0, 32
v_add_f32 v229, v229, v142
v_add_f32 v229, v229, v143
s_waitcnt lgkmcnt(0)
pk 139,142,143
v_add_f32 v230, v230, v144
mvvv 160,208,64
ds_read_b128 v[192:195], v236 offset:8448
v_add_f32 v230, v230, v145
mvvv 160,212,80
pk 144,144,145
v_add_f32 v230, v230, v146
mvvv 160,216,96
ds_read_b128 v[196:199], v236 offset:8512
v_add_f32 v230, v230, v147
mvvv 160,220,112
buffer_load_dwordx4 v240, s[12:15], s45 offen offset:2048 nt lds
mvvv 168,220,116
s_add_u32 m0, m0, 32
ds_read_b128 v[200:203], v236 offset:8576
pk 145,146,147
mvvv 168,216,100
v_add_f32 v230, v230, v148
v_add_f32 v230, v230, v149
mvvv 168,212,84
ds_read_b128 v[204:207], v236 offset:8640
pk 146,148,149
mvvv 168,208,68
v_fma_f32 v160, v160, s38, v224
v_fma_f32 v161, v161, s38, v224
mvvv 176,208,72
v_max_f32 v243, v160, v161
v_fma_f32 v162, v162, s38, v224
mvvv 176,212,88
v_fma_f32 v163, v163, s38, v224
v_max3_f32 v243, v243, v162, v163
mvvv 176,216,104
v_fma_f32 v168, v168, s38, v225
v_fma_f32 v169, v169, s38, v225
mvvv 176,220,120
buffer_load_dwordx4 v240, s[12:15], s45 offen offset:3072 nt lds
s_add_u32 s45, s45, s52
s_add_u32 m0, s41, s49
s_add_u32 s41, s41, s42
s_cmp_eq_u32 s41, s43
s_cselect_b32 s41, 0, s41
v_max3_f32 v243, v243, v168, v169
s_waitcnt lgkmcnt(0)
v_fma_f32 v170, v170, s38, v225
v_fma_f32 v171, v171, s38, v225
buffer_load_dwordx4 v242, s[16:19], s46 offen lds
mvvvz 164,192,0
s_add_u32 m0, m0, s53
ds_read_b128 v[208:211], v236 offset:8704
v_max3_f32 v243, v243, v170, v171
mvvv 164,196,16
v_fma_f32 v176, v176, s38, v226
v_fma_f32 v177, v177, s38, v226
mvvv 164,200,32
ds_read_b128 v[212:215], v236 offset:8768
v_max3_f32 v243, v243, v176, v177
mvvv 164,204,48
buffer_load_dwordx4 v242, s[16:19], s46 offen offset:896 lds
mvvvz 172,204,52
s_add_u32 m0, m0, s53
ds_read_b128 v[216:219], v236 offset:8832
v_fma_f32 v178, v178, s38, v226
mvvv 172,200,36
v_fma_f32 v179, v179, s38, v226
v_max3_f32 v243, v243, v178, v179
mvvv 172,196,20
ds_read_b128 v[220:223], v236 offset:8896
mvvv 172,192,4
buffer_load_dwordx4 v242, s[16:19], s46 offen offset:1792 lds
mvvvz 180,192,8
s_add_u32 m0, m0, s53
mvvv 180,196,24
mvvv 180,200,40
v_add_f32 v230, v230, v150
mvvv 180,204,56
v_add_u32 v237, s40, v233
v_add_f32 v230, v230, v151
s_add_u32 s40, s40, s42
s_cmp_eq_u32 s40, s43
s_cselect_b32 s40, 0, s40
buffer_load_dwordx4 v242, s[16:19], s46 offen offset:2688 lds
s_add_u32 s46, s46, s55
pk 147,150,151
s_waitcnt lgkmcnt(0)
mvvv 164,208,64
tr 192,237,0
mvvv 164,212,80
tr 194,237,8448
mvvv 164,216,96
tr 196,237,32
mvvv 164,220,112
mvvv 172,220,116
tr 198,237,8480
mvvv 172,216,100
tr 200,237,64
mvvv 172,212,84
tr 202,237,8512
mvvv 172,208,68
mvvv 180,208,72
tr 204,237,96
v_fma_f32 v164, v164, s38, v224
mvvv 180,212,88
tr 206,237,8544
v_fma_f32 v165, v165, s38, v224
mvvv 180,216,104
v_max3_f32 v243, v243, v164, v165
v_fma_f32 v166, v166, s38, v224
mvvv 180,220,120
v_fma_f32 v167, v167, s38, v224
v_max3_f32 v243, v243, v166, v167
v_fma_f32 v172, v172, s38, v225
v_fma_f32 v173, v173, s38, v225
v_max3_f32 v243, v243, v172, v173
v_fma_f32 v174, v174, s38, v225
v_fma_f32 v175, v175, s38, v225
v_max3_f32 v243, v243, v174, v175
s_waitcnt lgkmcnt(1)
v_fma_f32 v180, v180, s38, v226
v_fma_f32 v181, v181, s38, v226
mavv 0,192,128
s_mov_b32 s63, 29
tr 208,237,128
v_max3_f32 v243, v243, v180, v181
mavv 4,192,136
tr 210,237,8576
v_fma_f32 v182, v182, s38, v226
mavv 8,192,144
v_fma_f32 v183, v183, s38, v226
v_max3_f32 v243, v243, v182, v183
tr 212,237,160
tr 214,237,8608
mavv 24,196,144
mavv 20,196,136
tr 216,237,192
mavv 16,196,128
tr 218,237,8640
mavv 32,200,128
v_cmp_lt_f32 vcc, s39, v243
mavv 36,200,136
tr 220,237,224
mavv 40,200,144
s_cbranch_vccnz L_rare1w
L_ret29w:
tr 222,237,8672
s_waitcnt lgkmcnt(4)
v_exp_f32 v160, v160
tr 192,237,256
v_add_f32 v228, v228, v160
mavv 56,204,144
tr 194,237,8704
mavv 52,204,136
v_exp_f32 v161, v161
mavv 48,204,128
tr 196,237,288
v_add_f32 v228, v228, v161
mavv 64,208,128
tr 198,237,8736
pk 160,160,161
mavv 68,208,136
v_exp_f32 v162, v162
mavv 72,208,144
tr 200,237,320
v_add_f32 v228, v228, v162
tr 202,237,8768
v_exp_f32 v163, v163
mavv 88,212,144
tr 204,237,352
v_add_f32 v228, v228, v163
mavv 84,212,136
tr 206,237,8800
pk 161,162,163
mavv 80,212,128
s_waitcnt lgkmcnt(4)
v_exp_f32 v164, v164
mavv 96,216,128
tr 208,237,384
v_add_f32 v228, v228, v164
mavv 100,216,136
tr 210,237,8832
mavv 104,216,144
v_exp_f32 v165, v165
tr 212,237,416
v_add_f32 v228, v228, v165
tr 214,237,8864
pk 162,164,165
mavv 120,220,144
v_exp_f32 v166, v166
mavv 116,220,136
tr 216,237,448
v_add_f32 v228, v228, v166
mavv 112,220,128
tr 218,237,8896
mavv 128,192,128
v_exp_f32 v167, v167
mavv 132,192,136
tr 220,237,480
v_add_f32 v228, v228, v167
mavv 136,192,144
tr 222,237,8928
pk 163,166,167
v_exp_f32 v168, v168
v_exp_f32 v169, v169
mavv 152,196,144
v_exp_f32 v170, v170
mavv 148,196,136
v_exp_f32 v171, v171
mavv 144,196,128
s_waitcnt lgkmcnt(2)
v_exp_f32 v172, v172
mavv 160,200,128
v_exp_f32 v173, v173
mavv 164,200,136
v_exp_f32 v174, v174
mavv 168,200,144
v_exp_f32 v175, v175
v_add_u32 v236, s40, v232
v_add_f32 v229, v229, v168
s_add_u32 s40, s40, s42
s_cmp_eq_u32 s40, s43
s_cselect_b32 s40, 0, s40
mavv 184,204,144
v_exp_f32 v176, v176
mavv 180,204,136
v_exp_f32 v177, v177
mavv 176,204,128
s_waitcnt vmcnt(17) lgkmcnt(0)
s_barrier
v_add_f32 v229, v229, v169
mavv 192,208,128
s_add_u32 m0, s41, s49
s_add_u32 s41, s41, s42
ds_read_b128 v[192:195], v236 offset:0
mavv 196,208,136
s_cmp_eq_u32 s41, s43
s_cselect_b32 s41, 0, s41
pk 168,168,169
mavv 200,208,144
ds_read_b128 v[196:199], v236 offset:64
v_add_f32 v229, v229, v170
buffer_load_dwordx4 v240, s[24:27], s48 offen lds
s_add_u32 m0, m0, 32
ds_read_b128 v[200:203], v236 offset:128
v_add_f32 v229, v229, v171
mavv 216,212,144
v_exp_f32 v178, v178
mavv 212,212,136
ds_read_b128 v[204:207], v236 offset:192
pk 169,170,171
mavv 208,212,128
buffer_load_dwordx4 v240, s[24:27], s48 offen offset:1024 lds
mavv 224,216,128
s_add_u32 m0, m0, 32
v_exp_f32 v179, v179
mavv 228,216,136
v_exp_f32 v180, v180
mavv 232,216,144
v_exp_f32 v181, v181
buffer_load_dwordx4 v240, s[24:27], s48 offen offset:2048 lds
s_or_b32 s48, s48, s93
s_add_u32 m0, m0, 32
v_add_f32 v229, v229, v172
mavv 248,220,144
v_exp_f32 v182, v182
mavv 244,220,136
s_waitcnt lgkmcnt(0)
v_exp_f32 v183, v183
mavv 240,220,128
buffer_load_dwordx4 v240, s[24:27], s48 offen offset:3072 lds
mvvvz 128,192,0
s_bitset0_b32 s48, 30
s_add_u32 s48, s48, s72
ds_read_b128 v[208:211], v236 offset:256
mvvv 128,196,16
s_add_u32 m0, s41, s49
s_add_u32 s41, s41, s42
s_mov_b32 s10, 0x200000
mvvv 128,200,32
s_cmp_eq_u32 s41, s43
s_cselect_b32 s41, 0, s41
ds_read_b128 v[212:215], v236 offset:320
mvvv 128,204,48
buffer_load_dwordx4 v240, s[24:27], s48 offen lds
mvvvz 136,204,52
s_add_u32 m0, m0, 32
s_lshl_b32 s36, s65, 15
ds_read_b128 v[216:219], v236 offset:384
mvvv 136,200,36
s_sub_u32 s36, s24, s36
s_subb_u32 s37, s25, 0
mvvv 136,196,20
s_add_u32 s5, s3, 0x380
ds_read_b128 v[220:223], v236 offset:448
v_add_f32 v229, v229, v173
mvvv 136,192,4
s_add_u32 s3, s3, s74
mvvvz 144,192,8
s_sub_u32 s74, s5, 0x380
mvvv 144,196,24
s_lshl_b32 s76, s51, 3
mvvv 144,200,40
s_mov_b32 s12, s32
mvvv 144,204,56
buffer_load_dwordx4 v240, s[24:27], s48 offen offset:1024 lds
s_add_u32 m0, m0, 32
s_mov_b32 s13, s33
pk 170,172,173
s_mov_b32 s14, 429184
s_mov_b32 s20, s96
s_waitcnt lgkmcnt(0)
s_mov_b32 s21, s97
v_add_f32 v229, v229, v174
mvvv 128,208,64
s_movk_i32 s22, 160
ds_read_b128 v[192:195], v236 offset:8448
v_add_f32 v229, v229, v175
mvvv 128,212,80
s_movk_i32 s95, 255
mvvv 128,216,96
s_mov_b32 s98, 0x40000
ds_read_b128 v[196:199], v236 offset:8512
pk 171,174,175
mvvv 128,220,112
buffer_load_dwordx4 v240, s[24:27], s48 offen offset:2048 lds
mvvv 136,220,116
s_or_b32 s48, s48, s93
s_add_u32 m0, m0, 32
ds_read_b128 v[200:203], v236 offset:8576
mvvv 136,216,100
s_mov_b32 s84, s34
v_add_f32 v230, v230, v176
v_add_f32 v230, v230, v177
mvvv 136,212,84
s_mov_b32 s85, s35
ds_read_b128 v[204:207], v236 offset:8640
v_fma_f32 v128, v128, s38, v224
mvvv 136,208,68
s_mov_b32 s86, 4
v_fma_f32 v129, v129, s38, v224
v_max_f32 v243, v128, v129
mvvv 144,208,72
v_fma_f32 v130, v130, s38, v224
v_fma_f32 v131, v131, s38, v224
mvvv 144,212,88
v_max3_f32 v243, v243, v130, v131
pk 176,176,177
mvvv 144,216,104
v_fma_f32 v136, v136, s38, v225
v_fma_f32 v137, v137, s38, v225
mvvv 144,220,120
buffer_load_dwordx4 v240, s[24:27], s48 offen offset:3072 lds
s_bitset0_b32 s48, 30
s_add_u32 s48, s48, s72
s_add_u32 m0, s41, s49
s_add_u32 s41, s41, s42
s_cmp_eq_u32 s41, s43
s_cselect_b32 s41, 0, s41
s_waitcnt lgkmcnt(0)
v_max3_f32 v243, v243, v136, v137
v_fma_f32 v138, v138, s38, v225
buffer_load_dwordx4 v240, s[24:27], s48 offen lds
mvvvz 132,192,0
s_add_u32 m0, m0, 32
ds_read_b128 v[208:211], v236 offset:8704
v_fma_f32 v139, v139, s38, v225
mvvv 132,196,16
v_max3_f32 v243, v243, v138, v139
v_fma_f32 v144, v144, s38, v226
mvvv 132,200,32
ds_read_b128 v[212:215], v236 offset:8768
v_fma_f32 v145, v145, s38, v226
mvvv 132,204,48
buffer_load_dwordx4 v240, s[24:27], s48 offen offset:1024 lds
mvvvz 140,204,52
s_add_u32 m0, m0, 32
ds_read_b128 v[216:219], v236 offset:8832
v_max3_f32 v243, v243, v144, v145
mvvv 140,200,36
v_fma_f32 v146, v146, s38, v226
v_fma_f32 v147, v147, s38, v226
mvvv 140,196,20
ds_read_b128 v[220:223], v236 offset:8896
v_max3_f32 v243, v243, v146, v147
mvvv 140,192,4
buffer_load_dwordx4 v240, s[24:27], s48 offen offset:2048 lds
mvvvz 148,192,8
s_or_b32 s48, s48, s93
s_add_u32 m0, m0, 32
mvvv 148,196,24
mvvv 148,200,40
mvvv 148,204,56
v_add_u32 v237, s40, v233
s_add_u32 s40, s40, s42
s_cmp_eq_u32 s40, s43
s_cselect_b32 s40, 0, s40
buffer_load_dwordx4 v240, s[24:27], s48 offen offset:3072 lds
s_bitset0_b32 s48, 30
s_add_u32 s48, s48, s72
v_add_f32 v230, v230, v178
s_waitcnt lgkmcnt(0)
v_add_f32 v230, v230, v179
pk 177,178,179
mvvv 132,208,64
tr 192,237,0
v_add_f32 v230, v230, v180
mvvv 132,212,80
tr 194,237,8448
v_add_f32 v230, v230, v181
mvvv 132,216,96
tr 196,237,32
pk 178,180,181
mvvv 132,220,112
v_add_f32 v230, v230, v182
v_add_f32 v230, v230, v183
mvvv 140,220,116
tr 198,237,8480
pk 179,182,183
mvvv 140,216,100
tr 200,237,64
mvvv 140,212,84
tr 202,237,8512
mvvv 140,208,68
mvvv 148,208,72
tr 204,237,96
v_fma_f32 v132, v132, s38, v224
mvvv 148,212,88
tr 206,237,8544
v_fma_f32 v133, v133, s38, v224
mvvv 148,216,104
v_max3_f32 v243, v243, v132, v133
v_fma_f32 v134, v134, s38, v224
mvvv 148,220,120
v_fma_f32 v135, v135, s38, v224
v_max3_f32 v243, v243, v134, v135
v_fma_f32 v140, v140, s38, v225
v_fma_f32 v141, v141, s38, v225
v_max3_f32 v243, v243, v140, v141
v_fma_f32 v142, v142, s38, v225
v_fma_f32 v143, v143, s38, v225
v_max3_f32 v243, v243, v142, v143
s_waitcnt lgkmcnt(1)
v_fma_f32 v148, v148, s38, v226
v_fma_f32 v149, v149, s38, v226
mavv 0,192,160
s_mov_b32 s63, 30
tr 208,237,128
v_max3_f32 v243, v243, v148, v149
mavv 4,192,168
tr 210,237,8576
v_fma_f32 v150, v150, s38, v226
mavv 8,192,176
v_fma_f32 v151, v151, s38, v226
v_max3_f32 v243, v243, v150, v151
tr 212,237,160
tr 214,237,8608
mavv 24,196,176
mavv 20,196,168
tr 216,237,192
mavv 16,196,160
tr 218,237,8640
mavv 32,200,160
v_cmp_lt_f32 vcc, s39, v243
mavv 36,200,168
tr 220,237,224
mavv 40,200,176
s_cbranch_vccnz L_rare0w
L_ret30w:
tr 222,237,8672
s_waitcnt lgkmcnt(4)
v_exp_f32 v128, v128
tr 192,237,256
v_add_f32 v228, v228, v128
mavv 56,204,176
tr 194,237,8704
mavv 52,204,168
v_exp_f32 v129, v129
mavv 48,204,160
tr 196,237,288
v_add_f32 v228, v228, v129
mavv 64,208,160
tr 198,237,8736
pk 128,128,129
mavv 68,208,168
v_exp_f32 v130, v130
mavv 72,208,176
tr 200,237,320
v_add_f32 v228, v228, v130
tr 202,237,8768
v_exp_f32 v131, v131
mavv 88,212,176
tr 204,237,352
v_add_f32 v228, v228, v131
mavv 84,212,168
tr 206,237,8800
pk 129,130,131
mavv 80,212,160
s_waitcnt lgkmcnt(4)
v_exp_f32 v132, v132
mavv 96,216,160
tr 208,237,384
v_add_f32 v228, v228, v132
mavv 100,216,168
tr 210,237,8832
mavv 104,216,176
v_exp_f32 v133, v133
tr 212,237,416
v_add_f32 v228, v228, v133
tr 214,237,8864
pk 130,132,133
mavv 120,220,176
v_exp_f32 v134, v134
mavv 116,220,168
tr 216,237,448
v_add_f32 v228, v228, v134
mavv 112,220,160
tr 218,237,8896
mavv 128,192,160
v_exp_f32 v135, v135
mavv 132,192,168
tr 220,237,480
v_add_f32 v228, v228, v135
mavv 136,192,176
tr 222,237,8928
pk 131,134,135
v_exp_f32 v136, v136
v_exp_f32 v137, v137
mavv 152,196,176
v_exp_f32 v138, v138
mavv 148,196,168
buffer_load_dword v241, v240, s[84:87], 0 offen sc1
mavv 144,196,160
s_waitcnt lgkmcnt(2)
v_exp_f32 v139, v139
mavv 160,200,160
v_exp_f32 v140, v140
mavv 164,200,168
v_exp_f32 v141, v141
mavv 168,200,176
v_exp_f32 v142, v142
v_add_u32 v236, s40, v232
v_add_f32 v229, v229, v136
s_add_u32 s40, s40, s42
s_cmp_eq_u32 s40, s43
s_cselect_b32 s40, 0, s40
mavv 184,204,176
v_exp_f32 v143, v143
mavv 180,204,168
v_exp_f32 v144, v144
mavv 176,204,160
s_waitcnt vmcnt(21) lgkmcnt(0)
s_barrier
v_add_f32 v229, v229, v137
mavv 192,208,160
s_add_u32 m0, s41, s49
s_add_u32 s41, s41, s42
ds_read_b128 v[192:195], v236 offset:0
mavv 196,208,168
s_cmp_eq_u32 s41, s43
s_cselect_b32 s41, 0, s41
pk 136,136,137
mavv 200,208,176
ds_read_b128 v[196:199], v236 offset:64
v_add_f32 v229, v229, v138
buffer_load_dwordx4 v240, s[24:27], s48 offen lds
s_add_u32 m0, m0, 32
ds_read_b128 v[200:203], v236 offset:128
v_add_f32 v229, v229, v139
mavv 216,212,176
v_exp_f32 v145, v145
mavv 212,212,168
ds_read_b128 v[204:207], v236 offset:192
pk 137,138,139
mavv 208,212,160
buffer_load_dwordx4 v240, s[24:27], s48 offen offset:1024 lds
mavv 224,216,160
s_add_u32 m0, m0, 32
v_exp_f32 v146, v146
mavv 228,216,168
v_exp_f32 v147, v147
mavv 232,216,176
v_exp_f32 v148, v148
buffer_load_dwordx4 v240, s[24:27], s48 offen offset:2048 lds
s_or_b32 s48, s48, s93
s_add_u32 m0, m0, 32
v_add_f32 v229, v229, v140
mavv 248,220,176
v_exp_f32 v149, v149
mavv 244,220,168
s_waitcnt lgkmcnt(0)
v_exp_f32 v150, v150
mavv 240,220,160
buffer_load_dwordx4 v240, s[24:27], s48 offen offset:3072 lds
mvvvz 160,192,0
s_bitset0_b32 s48, 30
s_add_u32 s48, s48, s72
ds_read_b128 v[208:211], v236 offset:256
mvvv 160,196,16
s_add_u32 m0, s41, s49
s_add_u32 s41, s41, s42
v_add_f32 v229, v229, v141
mvvv 160,200,32
s_cmp_eq_u32 s41, s43
s_cselect_b32 s41, 0, s41
ds_read_b128 v[212:215], v236 offset:320
mvvv 160,204,48
buffer_load_dwordx4 v242, s[16:19], s46 offen lds
mvvvz 168,204,52
s_add_u32 m0, m0, s53
ds_read_b128 v[216:219], v236 offset:384
pk 138,140,141
mvvv 168,200,36
v_exp_f32 v151, v151
mvvv 168,196,20
ds_read_b128 v[220:223], v236 offset:448
v_add_f32 v229, v229, v142
mvvv 168,192,4
mvvvz 176,192,8
mvvv 176,196,24
mvvv 176,200,40
mvvv 176,204,56
buffer_load_dwordx4 v242, s[16:19], s46 offen offset:896 lds
s_add_u32 m0, m0, s53
s_waitcnt lgkmcnt(0)
mvvv 160,208,64
ds_read_b128 v[192:195], v236 offset:8448
v_add_f32 v229, v229, v143
mvvv 160,212,80
pk 139,142,143
v_add_f32 v230, v230, v144
mvvv 160,216,96
ds_read_b128 v[196:199], v236 offset:8512
v_add_f32 v230, v230, v145
mvvv 160,220,112
buffer_load_dwordx4 v242, s[16:19], s46 offen offset:1792 lds
mvvv 168,220,116
s_add_u32 m0, m0, s53
ds_read_b128 v[200:203], v236 offset:8576
pk 144,144,145
mvvv 168,216,100
v_add_f32 v230, v230, v146
v_add_f32 v230, v230, v147
mvvv 168,212,84
ds_read_b128 v[204:207], v236 offset:8640
pk 145,146,147
mvvv 168,208,68
v_fma_f32 v160, v160, s38, v224
v_fma_f32 v161, v161, s38, v224
mvvv 176,208,72
v_max_f32 v243, v160, v161
v_fma_f32 v162, v162, s38, v224
mvvv 176,212,88
v_fma_f32 v163, v163, s38, v224
v_max3_f32 v243, v243, v162, v163
mvvv 176,216,104
v_fma_f32 v168, v168, s38, v225
v_fma_f32 v169, v169, s38, v225
mvvv 176,220,120
buffer_load_dwordx4 v242, s[16:19], s46 offen offset:2688 lds
s_add_u32 s46, s46, s56
v_max3_f32 v243, v243, v168, v169
v_fma_f32 v170, v170, s38, v225
v_fma_f32 v171, v171, s38, v225
v_max3_f32 v243, v243, v170, v171
s_nop 1
v_fma_f32 v176, v176, s38, v226
v_fma_f32 v177, v177, s38, v226
s_waitcnt lgkmcnt(0)
s_waitcnt vmcnt(8)
v_max3_f32 v243, v243, v176, v177
mvvvz 164,192,0
ds_read_b128 v[208:211], v236 offset:8704
v_readfirstlane_b32 s94, v241
mvvv 164,196,16
v_fma_f32 v178, v178, s38, v226
v_fma_f32 v179, v179, s38, v226
mvvv 164,200,32
ds_read_b128 v[212:215], v236 offset:8768
v_max3_f32 v243, v243, v178, v179
mvvv 164,204,48
mvvvz 172,204,52
ds_read_b128 v[216:219], v236 offset:8832
mvvv 172,200,36
mvvv 172,196,20
ds_read_b128 v[220:223], v236 offset:8896
mvvv 172,192,4
v_add_f32 v230, v230, v148
v_add_f32 v230, v230, v149
mvvvz 180,192,8
pk 146,148,149
v_add_f32 v230, v230, v150
mvvv 180,196,24
s_bitcmp0_b32 s94, 3
s_cbranch_scc1 L_spin_clearw
L_clearedw:
v_add_f32 v230, v230, v151
mvvv 180,200,40
pk 147,150,151
mvvv 180,204,56
s_mov_b32 s61, 0x70000000
v_add_u32 v237, s40, v233
s_add_u32 s54, s65, 0
s_add_u32 s40, s40, s42
s_add_u32 s62, s65, 0x80
s_cmp_eq_u32 s40, s43
s_cselect_b32 s40, 0, s40
s_mov_b32 s44, 0xfff20000
s_waitcnt lgkmcnt(0)
s_mov_b32 s58, 0x20000
mvvv 164,208,64
s_cmp_eq_u32 s94, s76
s_cselect_b32 s75, 0, 1
tr 192,237,0
mvvv 164,212,80
s_cmp_eq_u32 s94, s76
s_cselect_b32 s60, 0xfffff000, s72
tr 194,237,8448
mvvv 164,216,96
s_cmp_eq_u32 s94, s76
s_cselect_b32 s44, s44, 0xffe42000
tr 196,237,32
mvvv 164,220,112
s_cmp_eq_u32 s94, s76
s_cselect_b32 s58, s58, 0x40000
mvvv 172,220,116
s_cmp_eq_u32 s94, s76
s_cselect_b32 s64, s61, s62
tr 198,237,8480
mvvv 172,216,100
s_cmp_eq_u32 s94, s76
s_cselect_b32 s54, s54, s61
tr 200,237,64
mvvv 172,212,84
s_cmp_eq_u32 s94, s76
s_cselect_b32 s62, 0, 0x80
tr 202,237,8512
mvvv 172,208,68
s_cmp_eq_u32 s94, s76
s_cselect_b32 s8, s36, s28
v_fma_f32 v164, v164, s38, v224
mvvv 180,208,72
s_cmp_eq_u32 s94, s76
s_cselect_b32 s9, s37, s29
tr 204,237,96
mvvv 180,212,88
s_cmp_eq_u32 s94, s76
s_cselect_b32 s6, s6, s7
tr 206,237,8544
mvvv 180,216,104
s_cmp_eq_u32 s94, s76
s_cselect_b32 s66, s66, s68
v_fma_f32 v165, v165, s38, v224
mvvv 180,220,120
s_cmp_eq_u32 s94, s76
s_cselect_b32 s67, s67, s69
v_max3_f32 v243, v243, v164, v165
s_cmp_eq_u32 s4, 0
s_cselect_b32 s61, s64, s61
v_fma_f32 v166, v166, s38, v224
s_mov_b32 s94, 1
v_fma_f32 v167, v167, s38, v224
v_max3_f32 v243, v243, v166, v167
s_addk_i32 s3, -128
v_fma_f32 v172, v172, s38, v225
v_fma_f32 v173, v173, s38, v225
s_waitcnt lgkmcnt(1)
s_bitset1_b32 s3, 31
v_max3_f32 v243, v243, v172, v173
mavv 0,192,128
tr 208,237,128
v_fma_f32 v174, v174, s38, v225
mavv 4,192,136
tr 210,237,8576
v_fma_f32 v175, v175, s38, v225
mavv 8,192,144
v_max3_f32 v243, v243, v174, v175
v_fma_f32 v180, v180, s38, v226
s_mov_b32 s63, 31
tr 212,237,160
v_fma_f32 v181, v181, s38, v226
tr 214,237,8608
v_max3_f32 v243, v243, v180, v181
mavv 24,196,144
v_fma_f32 v182, v182, s38, v226
v_fma_f32 v183, v183, s38, v226
mavv 20,196,136
tr 216,237,192
v_max3_f32 v243, v243, v182, v183
mavv 16,196,128
tr 218,237,8640
mavv 32,200,128
mavv 36,200,136
tr 220,237,224
mavv 40,200,144
tr 222,237,8672
s_waitcnt lgkmcnt(4)
v_cmp_lt_f32 vcc, s39, v243
tr 192,237,256
mavv 56,204,144
s_cbranch_vccnz L_rare1w
L_ret31w:
tr 194,237,8704
mavv 52,204,136
v_exp_f32 v160, v160
mavv 48,204,128
tr 196,237,288
mavv 64,208,128
tr 198,237,8736
mavv 68,208,136
v_exp_f32 v161, v161
mavv 72,208,144
tr 200,237,320
v_add_f32 v228, v228, v160
tr 202,237,8768
v_exp_f32 v162, v162
mavv 88,212,144
tr 204,237,352
v_add_f32 v228, v228, v161
mavv 84,212,136
tr 206,237,8800
pk 160,160,161
mavv 80,212,128
s_waitcnt lgkmcnt(4)
v_exp_f32 v163, v163
mavv 96,216,128
tr 208,237,384
v_add_f32 v228, v228, v162
mavv 100,216,136
tr 210,237,8832
mavv 104,216,144
v_exp_f32 v164, v164
tr 212,237,416
v_add_f32 v228, v228, v163
tr 214,237,8864
pk 161,162,163
mavv 120,220,144
v_exp_f32 v165, v165
mavv 116,220,136
tr 216,237,448
v_add_f32 v228, v228, v164
mavv 112,220,128
tr 218,237,8896
mavv 128,192,128
v_exp_f32 v166, v166
mavv 132,192,136
tr 220,237,480
v_add_f32 v228, v228, v165
mavv 136,192,144
tr 222,237,8928
pk 162,164,165
v_exp_f32 v167, v167
v_add_f32 v228, v228, v166
mavv 152,196,144
v_exp_f32 v168, v168
mavv 148,196,136
v_add_f32 v228, v228, v167
pk 163,166,167
mavv 144,196,128
s_waitcnt lgkmcnt(2)
v_exp_f32 v169, v169
mavv 160,200,128
v_add_f32 v229, v229, v168
mavv 164,200,136
v_exp_f32 v170, v170
mavv 168,200,144
v_add_f32 v229, v229, v169
pk 168,168,169
v_add_u32 v237, s40, v233
s_add_u32 s40, s40, s42
s_cmp_eq_u32 s40, s43
s_cselect_b32 s40, 0, s40
mavv 184,204,144
v_exp_f32 v171, v171
mavv 180,204,136
v_add_f32 v229, v229, v170
mavv 176,204,128
s_waitcnt vmcnt(25) lgkmcnt(0)
s_barrier
mavv 192,208,128
s_add_u32 m0, s41, s49
s_add_u32 s41, s41, s42
tr 192,237,0
mavv 196,208,136
s_cmp_eq_u32 s41, s43
s_cselect_b32 s41, 0, s41
tr 194,237,8448
mavv 200,208,144
tr 196,237,32
buffer_load_dwordx4 v240, s[24:27], s48 offen lds
s_add_u32 m0, m0, 32
tr 198,237,8480
mavv 216,212,144
tr 200,237,64
mavv 212,212,136
tr 202,237,8512
mavv 208,212,128
buffer_load_dwordx4 v240, s[24:27], s48 offen offset:1024 lds
mavv 224,216,128
s_add_u32 m0, m0, 32
tr 204,237,96
mavv 228,216,136
tr 206,237,8544
mavv 232,216,144
v_exp_f32 v172, v172
buffer_load_dwordx4 v240, s[24:27], s48 offen offset:2048 lds
s_or_b32 s48, s48, s93
s_add_u32 m0, m0, 32
v_add_f32 v229, v229, v171
mavv 248,220,144
pk 169,170,171
mavv 244,220,136
v_exp_f32 v173, v173
mavv 240,220,128
buffer_load_dwordx4 v240, s[24:27], s48 offen offset:3072 lds
s_waitcnt lgkmcnt(6)
s_bitset0_b32 s48, 30
s_add_u32 s48, s48, s72
s_add_u32 m0, s41, s49
s_add_u32 s41, s41, s42
s_cmp_eq_u32 s41, s43
s_cselect_b32 s41, 0, s41
v_add_f32 v229, v229, v172
v_exp_f32 v174, v174
v_add_f32 v229, v229, v173
pk 170,172,173
v_exp_f32 v175, v175
v_add_f32 v229, v229, v174
v_exp_f32 v176, v176
v_add_f32 v229, v229, v175
pk 171,174,175
v_exp_f32 v177, v177
v_add_f32 v230, v230, v176
v_exp_f32 v178, v178
v_add_f32 v230, v230, v177
pk 176,176,177
v_exp_f32 v179, v179
v_add_f32 v230, v230, v178
v_exp_f32 v180, v180
v_add_f32 v230, v230, v179
pk 177,178,179
v_exp_f32 v181, v181
v_add_f32 v230, v230, v180
v_exp_f32 v182, v182
v_add_f32 v230, v230, v181
pk 178,180,181
v_exp_f32 v183, v183
v_add_f32 v230, v230, v182
v_add_f32 v230, v230, v183
pk 179,182,183
s_nop 0
s_nop 1
mavv 0,192,160
tr 208,237,128
mavv 4,192,168
tr 210,237,8576
mavv 8,192,176
buffer_load_dwordx4 v240, s[24:27], s48 offen lds
s_waitcnt lgkmcnt(2)
s_add_u32 m0, m0, 32
tr 212,237,160
tr 214,237,8608
mavv 24,196,176
mavv 20,196,168
tr 216,237,192
mavv 16,196,160
tr 218,237,8640
mavv 32,200,160
buffer_load_dwordx4 v240, s[24:27], s48 offen offset:1024 lds
mavv 36,200,168
s_add_u32 m0, m0, 32
tr 220,237,224
mavv 40,200,176
tr 222,237,8672
v_accvgpr_read_b32 v128, a0
v_accvgpr_read_b32 v129, a1
v_accvgpr_read_b32 v130, a2
tr 192,237,256
v_accvgpr_read_b32 v131, a3
mavv 56,204,176
tr 194,237,8704
v_accvgpr_read_b32 v132, a16
mavv 52,204,168
buffer_load_dwordx4 v240, s[24:27], s48 offen offset:2048 lds
mavv 48,204,160
s_waitcnt lgkmcnt(4)
s_or_b32 s48, s48, s93
tr 196,237,288
mavv 64,208,160
s_add_u32 m0, m0, 32
tr 198,237,8736
v_accvgpr_read_b32 v133, a17
mavv 68,208,168
v_accvgpr_read_b32 v134, a18
v_accvgpr_read_b32 v135, a19
mavv 72,208,176
tr 200,237,320
pk 0,128,129
tr 202,237,8768
pk 1,130,131
buffer_load_dwordx4 v240, s[24:27], s48 offen offset:3072 lds
mavv 88,212,176
s_bitset0_b32 s48, 30
s_add_u32 s48, s48, s72
tr 204,237,352
mavv 84,212,168
tr 206,237,8800
pk 2,132,133
mavv 80,212,160
pk 3,134,135
v_accvgpr_read_b32 v136, a4
mavv 96,216,160
tr 208,237,384
v_accvgpr_read_b32 v137, a5
mavv 100,216,168
tr 210,237,8832
v_accvgpr_read_b32 v138, a6
mavv 104,216,176
v_accvgpr_read_b32 v139, a7
v_accvgpr_read_b32 v140, a20
s_waitcnt lgkmcnt(4)
tr 212,237,416
v_accvgpr_read_b32 v141, a21
tr 214,237,8864
v_accvgpr_read_b32 v142, a22
mavv 120,220,176
v_accvgpr_read_b32 v143, a23
pk 4,136,137
mavv 116,220,168
tr 216,237,448
pk 5,138,139
mavv 112,220,160
tr 218,237,8896
pk 6,140,141
mavv 128,192,160
pk 7,142,143
v_accvgpr_read_b32 v144, a8
mavv 132,192,168
tr 220,237,480
v_accvgpr_read_b32 v145, a9
mavv 136,192,176
tr 222,237,8928
v_accvgpr_read_b32 v146, a10
v_accvgpr_read_b32 v147, a11
v_accvgpr_read_b32 v148, a24
v_accvgpr_read_b32 v149, a25
v_accvgpr_read_b32 v150, a26
mavv 152,196,176
v_accvgpr_read_b32 v151, a27
pk 8,144,145
mavv 148,196,168
pk 9,146,147
pk 10,148,149
mavv 144,196,160
s_waitcnt vmcnt(12) lgkmcnt(0)
s_barrier
pk 11,150,151
mavv 160,200,160
s_add_u32 m0, s41, s49
s_add_u32 s41, s41, s42
mavv 164,200,168
s_cmp_eq_u32 s41, s43
s_cselect_b32 s41, 0, s41
mavv 168,200,176
buffer_load_dwordx4 v240, s[24:27], s48 offen lds
s_add_u32 m0, m0, 32
v_add_u32 v239, s40, v235
s_add_u32 s40, s40, s42
s_cmp_eq_u32 s40, s43
s_cselect_b32 s40, 0, s40
mavv 184,204,176
mavv 180,204,168
buffer_load_dwordx4 v240, s[24:27], s48 offen offset:1024 lds
mavv 176,204,160
s_add_u32 m0, m0, 32
mavv 192,208,160
tr 192,239,0
mavv 196,208,168
tr 194,239,256
mavv 200,208,176
tr 196,239,512
buffer_load_dwordx4 v240, s[24:27], s48 offen offset:2048 lds
s_or_b32 s48, s48, s93
s_add_u32 m0, m0, 32
tr 198,239,768
mavv 216,212,176
tr 200,239,8448
mavv 212,212,168
tr 202,239,8704
mavv 208,212,160
buffer_load_dwordx4 v240, s[24:27], s48 offen offset:3072 lds
mavv 224,216,160
s_bitset0_b32 s48, 30
s_add_u32 s48, s48, s72
tr 204,239,8960
mavv 228,216,168
tr 206,239,9216
v_accvgpr_read_b32 v128, a32
mavv 232,216,176
v_accvgpr_read_b32 v129, a33
v_accvgpr_read_b32 v130, a34
v_accvgpr_read_b32 v131, a35
v_accvgpr_read_b32 v132, a48
v_accvgpr_read_b32 v133, a49
v_accvgpr_read_b32 v134, a50
mavv 248,220,176
v_accvgpr_read_b32 v135, a51
pk 16,128,129
mavv 244,220,168
pk 17,130,131
pk 18,132,133
mavv 240,220,160
pk 19,134,135
v_accvgpr_read_b32 v136, a36
s_waitcnt lgkmcnt(6)
v_accvgpr_read_b32 v137, a37
v_accvgpr_read_b32 v138, a38
v_accvgpr_read_b32 v139, a39
v_accvgpr_read_b32 v140, a52
v_accvgpr_read_b32 v141, a53
v_accvgpr_read_b32 v142, a54
v_accvgpr_read_b32 v143, a55
pk 20,136,137
pk 21,138,139
pk 22,140,141
pk 23,142,143
v_accvgpr_read_b32 v144, a40
v_accvgpr_read_b32 v145, a41
v_accvgpr_read_b32 v146, a42
v_accvgpr_read_b32 v147, a43
v_accvgpr_read_b32 v148, a56
v_accvgpr_read_b32 v149, a57
v_accvgpr_read_b32 v150, a58
v_accvgpr_read_b32 v151, a59
pk 24,144,145
pk 25,146,147
pk 26,148,149
pk 27,150,151
v_accvgpr_read_b32 v128, a64
v_accvgpr_read_b32 v129, a65
v_accvgpr_read_b32 v130, a66
v_accvgpr_read_b32 v131, a67
v_accvgpr_read_b32 v132, a80
v_accvgpr_read_b32 v133, a81
v_accvgpr_read_b32 v134, a82
v_accvgpr_read_b32 v135, a83
pk 32,128,129
pk 33,130,131
pk 34,132,133
pk 35,134,135
v_accvgpr_read_b32 v136, a68
v_accvgpr_read_b32 v137, a69
v_accvgpr_read_b32 v138, a70
v_accvgpr_read_b32 v139, a71
v_accvgpr_read_b32 v140, a84
v_accvgpr_read_b32 v141, a85
v_accvgpr_read_b32 v142, a86
v_accvgpr_read_b32 v143, a87
pk 36,136,137
pk 37,138,139
pk 38,140,141
pk 39,142,143
v_accvgpr_read_b32 v144, a72
v_accvgpr_read_b32 v145, a73
v_accvgpr_read_b32 v146, a74
v_accvgpr_read_b32 v147, a75
v_accvgpr_read_b32 v148, a88
v_accvgpr_read_b32 v149, a89
v_accvgpr_read_b32 v150, a90
v_accvgpr_read_b32 v151, a91
pk 40,144,145
pk 41,146,147
pk 42,148,149
pk 43,150,151
v_accvgpr_read_b32 v128, a96
v_accvgpr_read_b32 v129, a97
v_accvgpr_read_b32 v130, a98
v_accvgpr_read_b32 v131, a99
v_accvgpr_read_b32 v132, a112
v_accvgpr_read_b32 v133, a113
v_accvgpr_read_b32 v134, a114
v_accvgpr_read_b32 v135, a115
pk 48,128,129
pk 49,130,131
pk 50,132,133
pk 51,134,135
v_accvgpr_read_b32 v136, a100
v_accvgpr_read_b32 v137, a101
v_accvgpr_read_b32 v138, a102
v_accvgpr_read_b32 v139, a103
v_accvgpr_read_b32 v140, a116
v_accvgpr_read_b32 v141, a117
v_accvgpr_read_b32 v142, a118
v_accvgpr_read_b32 v143, a119
pk 52,136,137
pk 53,138,139
pk 54,140,141
pk 55,142,143
v_accvgpr_read_b32 v144, a104
v_accvgpr_read_b32 v145, a105
v_accvgpr_read_b32 v146, a106
v_accvgpr_read_b32 v147, a107
v_accvgpr_read_b32 v148, a120
v_accvgpr_read_b32 v149, a121
v_accvgpr_read_b32 v150, a122
v_accvgpr_read_b32 v151, a123
pk 56,144,145
pk 57,146,147
pk 58,148,149
pk 59,150,151
s_nop 1
mvvvz 128,192,0
s_waitcnt lgkmcnt(0)
tr 208,239,32
v_accvgpr_read_b32 v232, a128
v_accvgpr_read_b32 v236, a129
v_accvgpr_read_b32 v241, a130
mvvv 128,196,16
tr 210,239,288
v_accvgpr_read_b32 v243, a131
v_accvgpr_read_b32 v237, a144
v_accvgpr_read_b32 v233, a145
mvvv 128,200,32
tr 212,239,544
v_accvgpr_read_b32 v244, a146
v_accvgpr_read_b32 v245, a147
pk 64,232,236
mvvv 128,204,48
buffer_load_dwordx4 a[112:115], v240, s[24:27], s48 offen offset:0
pk 65,241,243
pk 66,237,233
pk 67,244,245
mvvvz 136,204,52
tr 214,239,800
v_accvgpr_read_b32 v246, a132
v_accvgpr_read_b32 v247, a133
v_accvgpr_read_b32 v248, a134
mvvv 136,200,36
tr 216,239,8480
v_accvgpr_read_b32 v249, a135
v_accvgpr_read_b32 v232, a148
v_accvgpr_read_b32 v236, a149
mvvv 136,196,20
tr 218,239,8736
v_accvgpr_read_b32 v241, a150
v_accvgpr_read_b32 v243, a151
pk 68,246,247
pk 69,248,249
mvvv 136,192,4
v_add_u32 v238, s40, v234
pk 70,232,236
pk 71,241,243
v_accvgpr_read_b32 v237, a136
mvvvz 144,192,8
s_add_u32 s40, s40, s42
tr 220,239,8992
v_accvgpr_read_b32 v233, a137
v_accvgpr_read_b32 v244, a138
v_accvgpr_read_b32 v245, a139
mvvv 144,196,24
s_cmp_eq_u32 s40, s43
s_cselect_b32 s40, 0, s40
tr 222,239,9248
v_accvgpr_read_b32 v246, a152
v_accvgpr_read_b32 v247, a153
v_accvgpr_read_b32 v248, a154
mvvv 144,200,40
ds_read_b128 a[0:3], v238 offset:0
v_accvgpr_read_b32 v249, a155
pk 72,237,233
pk 73,244,245
mvvv 144,204,56
buffer_load_dwordx4 a[116:119], v240, s[24:27], s48 offen offset:1024
pk 74,246,247
pk 75,248,249
ds_read_b128 a[4:7], v238 offset:1056
ds_read_b128 a[8:11], v238 offset:2112
ds_read_b128 a[12:15], v238 offset:3168
s_waitcnt lgkmcnt(5)
v_add_u32 v238, s40, v234
v_accvgpr_read_b32 v246, a160
mvvvz 132,208,0
s_add_u32 s40, s40, s42
tr 192,239,64
v_accvgpr_read_b32 v247, a161
v_accvgpr_read_b32 v248, a162
v_accvgpr_read_b32 v249, a163
v_accvgpr_read_b32 v232, a176
mvvv 132,212,16
s_cmp_eq_u32 s40, s43
s_cselect_b32 s40, 0, s40
tr 194,239,320
v_accvgpr_read_b32 v236, a177
v_accvgpr_read_b32 v241, a178
mvvv 132,216,32
s_waitcnt lgkmcnt(5)
tr 196,239,576
v_accvgpr_read_b32 v243, a179
pk 80,246,247
pk 81,248,249
mvvv 132,220,48
ds_read_b128 a[16:19], v238 offset:0
pk 82,232,236
pk 83,241,243
v_accvgpr_read_b32 v237, a164
v_accvgpr_read_b32 v233, a165
mvvvz 140,220,52
tr 198,239,832
v_accvgpr_read_b32 v244, a166
v_accvgpr_read_b32 v245, a167
v_accvgpr_read_b32 v246, a180
mvvv 140,216,36
tr 200,239,8512
v_accvgpr_read_b32 v247, a181
v_accvgpr_read_b32 v248, a182
v_accvgpr_read_b32 v249, a183
mvvv 140,212,20
tr 202,239,8768
pk 84,237,233
pk 85,244,245
pk 86,246,247
mvvv 140,208,4
ds_read_b128 a[20:23], v238 offset:1056
pk 87,248,249
v_accvgpr_read_b32 v232, a168
v_accvgpr_read_b32 v236, a169
v_accvgpr_read_b32 v241, a170
mvvvz 148,208,8
tr 204,239,9024
v_accvgpr_read_b32 v243, a171
v_accvgpr_read_b32 v237, a184
v_accvgpr_read_b32 v233, a185
mvvv 148,212,24
tr 206,239,9280
v_accvgpr_read_b32 v244, a186
v_accvgpr_read_b32 v245, a187
pk 88,232,236
mvvv 148,216,40
ds_read_b128 a[24:27], v238 offset:2112
pk 89,241,243
pk 90,237,233
pk 91,244,245
mvvv 148,220,56
ds_read_b128 a[28:31], v238 offset:3168
v_add_u32 v238, s40, v234
s_add_u32 s40, s40, s42
ds_read_b128 a[32:35], v238 offset:0
s_cmp_eq_u32 s40, s43
s_cselect_b32 s40, 0, s40
ds_read_b128 a[36:39], v238 offset:1056
ds_read_b128 a[40:43], v238 offset:2112
s_waitcnt lgkmcnt(6)
ds_read_b128 a[44:47], v238 offset:3168
v_accvgpr_read_b32 v237, a192
v_accvgpr_read_b32 v233, a193
v_accvgpr_read_b32 v244, a194
mvvvz 160,192,0
tr 208,239,96
v_accvgpr_read_b32 v245, a195
v_accvgpr_read_b32 v246, a208
v_accvgpr_read_b32 v247, a209
mvvv 160,196,16
tr 210,239,352
v_add_u32 v238, s40, v234
v_accvgpr_read_b32 v248, a210
v_accvgpr_read_b32 v249, a211
pk 96,237,233
mvvv 160,200,32
s_waitcnt lgkmcnt(6)
s_add_u32 s40, s40, s42
tr 212,239,608
pk 97,244,245
pk 98,246,247
mvvv 160,204,48
s_cmp_eq_u32 s40, s43
s_cselect_b32 s40, 0, s40
ds_read_b128 a[48:51], v238 offset:0
pk 99,248,249
v_accvgpr_read_b32 v232, a196
mvvvz 168,204,52
tr 214,239,864
v_accvgpr_read_b32 v236, a197
v_accvgpr_read_b32 v241, a198
v_accvgpr_read_b32 v243, a199
v_accvgpr_read_b32 v237, a212
mvvv 168,200,36
tr 216,239,8544
v_accvgpr_read_b32 v233, a213
v_accvgpr_read_b32 v244, a214
v_accvgpr_read_b32 v245, a215
mvvv 168,196,20
tr 218,239,8800
pk 100,232,236
pk 101,241,243
pk 102,237,233
mvvv 168,192,4
ds_read_b128 a[52:55], v238 offset:1056
pk 103,244,245
v_accvgpr_read_b32 v246, a200
v_accvgpr_read_b32 v247, a201
v_accvgpr_read_b32 v248, a202
mvvvz 176,192,8
tr 220,239,9056
v_accvgpr_read_b32 v249, a203
v_accvgpr_read_b32 v232, a216
v_accvgpr_read_b32 v236, a217
mvvv 176,196,24
tr 222,239,9312
v_accvgpr_read_b32 v241, a218
v_accvgpr_read_b32 v243, a219
pk 104,246,247
mvvv 176,200,40
ds_read_b128 a[56:59], v238 offset:2112
pk 105,248,249
pk 106,232,236
pk 107,241,243
mvvv 176,204,56
ds_read_b128 a[60:63], v238 offset:3168
v_add_u32 v239, s40, v235
buffer_load_dwordx4 a[120:123], v240, s[24:27], s48 offen offset:2048
s_add_u32 s40, s40, s42
s_cmp_eq_u32 s40, s43
s_cselect_b32 s40, 0, s40
s_or_b32 s48, s48, s93
buffer_load_dwordx4 a[124:127], v240, s[24:27], s48 offen offset:3072
s_waitcnt vmcnt(4) lgkmcnt(0)
s_barrier
mvvvz 164,208,0
s_add_u32 m0, s41, s49
s_add_u32 s41, s41, s42
tr 192,239,0
v_accvgpr_read_b32 v232, a224
v_accvgpr_read_b32 v236, a225
mvvv 164,212,16
s_cmp_eq_u32 s41, s43
s_cselect_b32 s41, 0, s41
tr 194,239,256
v_accvgpr_read_b32 v241, a226
v_accvgpr_read_b32 v243, a227
v_accvgpr_read_b32 v237, a240
mvvv 164,216,32
tr 196,239,512
v_accvgpr_read_b32 v233, a241
v_accvgpr_read_b32 v244, a242
v_accvgpr_read_b32 v245, a243
mvvv 164,220,48
buffer_load_dwordx4 v242, s[16:19], s46 offen lds
pk 112,232,236
pk 113,241,243
mvvvz 172,220,52
s_add_u32 m0, m0, s53
tr 198,239,768
pk 114,237,233
pk 115,244,245
v_accvgpr_read_b32 v246, a228
mvvv 172,216,36
tr 200,239,8448
v_accvgpr_read_b32 v247, a229
v_accvgpr_read_b32 v248, a230
v_accvgpr_read_b32 v249, a231
v_accvgpr_read_b32 v232, a244
mvvv 172,212,20
tr 202,239,8704
v_accvgpr_read_b32 v236, a245
v_accvgpr_read_b32 v241, a246
v_accvgpr_read_b32 v243, a247
mvvv 172,208,4
buffer_load_dwordx4 v242, s[16:19], s46 offen offset:896 lds
pk 116,246,247
pk 117,248,249
mvvvz 180,208,8
s_add_u32 m0, m0, s53
tr 204,239,8960
pk 118,232,236
pk 119,241,243
v_accvgpr_read_b32 v237, a232
v_accvgpr_read_b32 v233, a233
mvvv 180,212,24
tr 206,239,9216
v_accvgpr_read_b32 v244, a234
v_accvgpr_read_b32 v245, a235
v_accvgpr_read_b32 v246, a248
mvvv 180,216,40
v_accvgpr_read_b32 v247, a249
v_accvgpr_read_b32 v248, a250
v_accvgpr_read_b32 v249, a251
pk 120,237,233
mvvv 180,220,56
buffer_load_dwordx4 v242, s[16:19], s46 offen offset:1792 lds
pk 121,244,245
pk 122,246,247
pk 123,248,249
s_add_u32 m0, m0, s53
s_waitcnt lgkmcnt(1)
buffer_load_dwordx4 v242, s[16:19], s46 offen offset:2688 lds
mvvv 128,192,64
s_add_u32 s46, s46, s55
s_add_u32 m0, s41, s49
tr 208,239,32
mvvv 128,196,80
s_add_u32 s41, s41, s42
tr 210,239,288
v_mov_b32 v244, v228
v_mov_b32 v245, v229
mvvv 128,200,96
s_waitcnt lgkmcnt(2)
tr 212,239,544
v_mov_b32 v246, v230
mvvv 128,204,112
buffer_load_dwordx4 v242, s[16:19], s46 offen lds
v_mov_b32 v247, v231
mvvv 136,204,116
s_cmp_eq_u32 s41, s43
s_cselect_b32 s41, 0, s41
tr 214,239,800
mvvv 136,200,100
s_add_u32 m0, m0, s53
tr 216,239,8480
v_permlane32_swap_b32 v228, v244
v_permlane32_swap_b32 v229, v245
mvvv 136,196,84
tr 218,239,8736
v_permlane32_swap_b32 v230, v246
mvvv 136,192,68
buffer_load_dwordx4 v242, s[16:19], s46 offen offset:896 lds
v_permlane32_swap_b32 v231, v247
mvvv 144,192,72
s_add_u32 m0, m0, s53
tr 220,239,8992
v_add_u32 v238, s40, v234
mvvv 144,196,88
s_add_u32 s40, s40, s42
tr 222,239,9248
v_add_f32 v228, v228, v244
v_add_f32 v229, v229, v245
mvvv 144,200,104
s_cmp_eq_u32 s40, s43
s_cselect_b32 s40, 0, s40
ds_read_b128 a[64:67], v238 offset:0
mvvv 144,204,120
buffer_load_dwordx4 v242, s[16:19], s46 offen offset:1792 lds
v_add_f32 v230, v230, v246
s_add_u32 m0, m0, s53
ds_read_b128 a[68:71], v238 offset:1056
v_add_f32 v231, v231, v247
ds_read_b128 a[72:75], v238 offset:2112
v_mov_b32 v244, v228
v_mov_b32 v245, v229
s_waitcnt lgkmcnt(4)
ds_read_b128 a[76:79], v238 offset:3168
v_mov_b32 v246, v230
buffer_load_dwordx4 v242, s[16:19], s46 offen offset:2688 lds
v_mov_b32 v247, v231
mvvv 132,208,64
s_add_u32 s46, s46, s57
tr 192,239,64
v_add_u32 v238, s40, v234
mvvv 132,212,80
s_cmp_eq_u32 s46, s77
s_cselect_b32 s46, s71, s46
tr 194,239,320
v_permlane16_swap_b32 v228, v244
mvvv 132,216,96
s_waitcnt lgkmcnt(5)
s_add_u32 s40, s40, s42
tr 196,239,576
mvvv 132,220,112
s_cmp_eq_u32 s40, s43
s_cselect_b32 s40, 0, s40
ds_read_b128 a[80:83], v238 offset:0
v_permlane16_swap_b32 v229, v245
mvvv 140,220,116
tr 198,239,832
v_permlane16_swap_b32 v230, v246
mvvv 140,216,100
tr 200,239,8512
v_permlane16_swap_b32 v231, v247
v_add_f32 v228, v228, v244
mvvv 140,212,84
tr 202,239,8768
v_add_f32 v229, v229, v245
mvvv 140,208,68
ds_read_b128 a[84:87], v238 offset:1056
v_add_f32 v230, v230, v246
v_add_f32 v231, v231, v247
mvvv 148,208,72
tr 204,239,9024
mvvv 148,212,88
tr 206,239,9280
v_rcp_f32 v224, v228
mvvv 148,216,104
ds_read_b128 a[88:91], v238 offset:2112
mvvv 148,220,120
ds_read_b128 a[92:95], v238 offset:3168
v_add_u32 v238, s40, v234
s_add_u32 s40, s40, s42
ds_read_b128 a[96:99], v238 offset:0
s_cmp_eq_u32 s40, s43
s_cselect_b32 s40, 0, s40
ds_read_b128 a[100:103], v238 offset:1056
ds_read_b128 a[104:107], v238 offset:2112
s_waitcnt lgkmcnt(6)
ds_read_b128 a[108:111], v238 offset:3168
v_rcp_f32 v225, v229
mvvv 160,192,64
tr 208,239,96
mvvv 160,196,80
tr 210,239,352
v_rcp_f32 v226, v230
mvvv 160,200,96
s_waitcnt lgkmcnt(6)
tr 212,239,608
mvvv 160,204,112
v_rcp_f32 v227, v231
mvvv 168,204,116
tr 214,239,864
v_mul_f32 v128, v128, v224
mvvv 168,200,100
tr 216,239,8544
v_mul_f32 v129, v129, v224
mvvv 168,196,84
tr 218,239,8800
v_mul_f32 v130, v130, v224
mvvv 168,192,68
v_mul_f32 v131, v131, v224
v_mul_f32 v136, v136, v225
mvvv 176,192,72
tr 220,239,9056
v_mul_f32 v137, v137, v225
mvvv 176,196,88
tr 222,239,9312
v_mul_f32 v138, v138, v225
mvvv 176,200,104
v_mul_f32 v139, v139, v225
v_mul_f32 v144, v144, v226
mvvv 176,204,120
v_add_u32 v239, s40, v235
v_mul_f32 v145, v145, v226
s_add_u32 s40, s40, s42
s_cmp_eq_u32 s40, s43
s_cselect_b32 s40, 0, s40
v_mul_f32 v146, v146, v226
v_mul_f32 v147, v147, v226
s_waitcnt vmcnt(4) lgkmcnt(0)
s_barrier
mvvv 164,208,64
s_add_u32 m0, s41, s49
s_add_u32 s41, s41, s42
tr 192,239,0
mvvv 164,212,80
s_cmp_eq_u32 s41, s43
s_cselect_b32 s41, 0, s41
tr 194,239,256
mvvv 164,216,96
tr 196,239,512
mvvv 164,220,112
buffer_load_dwordx4 v242, s[16:19], s46 offen lds
mvvv 172,220,116
s_add_u32 m0, m0, s53
tr 198,239,768
v_mul_f32 v132, v132, v224
mvvv 172,216,100
tr 200,239,8448
v_mul_f32 v133, v133, v224
mvvv 172,212,84
tr 202,239,8704
v_mul_f32 v134, v134, v224
mvvv 172,208,68
buffer_load_dwordx4 v242, s[16:19], s46 offen offset:896 lds
mvvv 180,208,72
s_add_u32 m0, m0, s53
tr 204,239,8960
v_mul_f32 v135, v135, v224
mvvv 180,212,88
tr 206,239,9216
v_mul_f32 v140, v140, v225
mvvv 180,216,104
v_mul_f32 v141, v141, v225
v_mul_f32 v142, v142, v225
mvvv 180,220,120
buffer_load_dwordx4 v242, s[16:19], s46 offen offset:1792 lds
s_add_u32 m0, m0, s53
v_mul_f32 v143, v143, v225
v_mul_f32 v148, v148, v226
v_mul_f32 v149, v149, v226
v_mul_f32 v150, v150, v226
s_waitcnt lgkmcnt(1)
v_mul_f32 v151, v151, v226
buffer_load_dwordx4 v242, s[16:19], s46 offen offset:2688 lds
mvva 128,192,0
s_add_u32 s46, s46, s55
s_add_u32 m0, s41, s49
tr 208,239,32
mvva 128,196,16
s_add_u32 s41, s41, s42
tr 210,239,288
mvva 128,200,32
s_waitcnt lgkmcnt(2)
tr 212,239,544
mvva 128,204,48
buffer_load_dwordx4 v242, s[16:19], s46 offen lds
mvva 136,204,52
s_cmp_eq_u32 s41, s43
s_cselect_b32 s41, 0, s41
tr 214,239,800
mvva 136,200,36
s_add_u32 m0, m0, s53
tr 216,239,8480
mvva 136,196,20
tr 218,239,8736
v_mul_f32 v160, v160, v224
mvva 136,192,4
buffer_load_dwordx4 v242, s[16:19], s46 offen offset:896 lds
mvva 144,192,8
s_add_u32 m0, m0, s53
tr 220,239,8992
v_mul_f32 v161, v161, v224
mvva 144,196,24
tr 222,239,9248
v_mul_f32 v162, v162, v224
mvva 144,200,40
v_mul_f32 v163, v163, v224
v_mul_f32 v168, v168, v225
mvva 144,204,56
buffer_load_dwordx4 v242, s[16:19], s46 offen offset:1792 lds
s_add_u32 m0, m0, s53
v_mul_f32 v169, v169, v225
v_mul_f32 v170, v170, v225
v_mul_f32 v171, v171, v225
v_mul_f32 v176, v176, v226
s_waitcnt lgkmcnt(1)
v_mul_f32 v177, v177, v226
v_mul_f32 v178, v178, v226
buffer_load_dwordx4 v242, s[16:19], s46 offen offset:2688 lds
mvva 132,208,0
s_add_u32 s46, s46, s56
s_add_u32 m0, s41, s49
tr 192,239,64
mvva 132,212,16
s_add_u32 s41, s41, s42
tr 194,239,320
v_mul_f32 v179, v179, v226
mvva 132,216,32
s_waitcnt lgkmcnt(2)
tr 196,239,576
mvva 132,220,48
buffer_load_dwordx4 v242, s[16:19], s46 offen lds
mvva 140,220,52
s_cmp_eq_u32 s41, s43
s_cselect_b32 s41, 0, s41
tr 198,239,832
mvva 140,216,36
s_add_u32 m0, m0, s53
tr 200,239,8512
mvva 140,212,20
tr 202,239,8768
mvva 140,208,4
buffer_load_dwordx4 v242, s[16:19], s46 offen offset:896 lds
mvva 148,208,8
s_add_u32 m0, m0, s53
tr 204,239,9024
mvva 148,212,24
tr 206,239,9280
v_mul_f32 v164, v164, v224
mvva 148,216,40
v_mul_f32 v165, v165, v224
v_mul_f32 v166, v166, v224
mvva 148,220,56
buffer_load_dwordx4 v242, s[16:19], s46 offen offset:1792 lds
s_add_u32 m0, m0, s53
v_mul_f32 v167, v167, v224
v_mul_f32 v172, v172, v225
v_mul_f32 v173, v173, v225
v_mul_f32 v174, v174, v225
s_waitcnt lgkmcnt(1)
v_mul_f32 v175, v175, v225
v_mul_f32 v180, v180, v226
buffer_load_dwordx4 v242, s[16:19], s46 offen offset:2688 lds
mvva 160,192,0
s_add_u32 s46, s46, s55
tr 208,239,96
v_mul_f32 v181, v181, v226
mvva 160,196,16
tr 210,239,352
v_mul_f32 v182, v182, v226
mvva 160,200,32
s_waitcnt lgkmcnt(2)
tr 212,239,608
v_mul_f32 v183, v183, v226
mvva 160,204,48
mvva 168,204,52
tr 214,239,864
mvva 168,200,36
tr 216,239,8544
mvva 168,196,20
tr 218,239,8800
mvva 168,192,4
mvva 176,192,8
tr 220,239,9056
v_lshrrev_b32 v232, 2, v240
mvva 176,196,24
tr 222,239,9312
v_lshlrev_b32 v237, 4, v240
mvva 176,200,40
v_lshrrev_b32 v244, 4, v240
v_and_b32 v245, 15, v244
mvva 176,204,56
v_add_u32 v239, s40, v235
v_mul_u32_u24 v245, 0x700, v245
s_add_u32 s40, s40, s42
s_cmp_eq_u32 s40, s43
s_cselect_b32 s40, 0, s40
v_and_b32 v246, 48, v244
v_add_u32 v249, v245, v246
v_lshrrev_b32 v245, 4, v244
v_bfe_u32 v246, v244, 2, 1
s_waitcnt vmcnt(12) lgkmcnt(0)
s_barrier
v_lshlrev_b32 v246, 1, v246
mvva 164,208,0
s_add_u32 m0, s41, s49
s_add_u32 s41, s41, s42
tr 192,239,0
mvva 164,212,16
s_cmp_eq_u32 s41, s43
s_cselect_b32 s41, 0, s41
tr 194,239,256
mvva 164,216,32
tr 196,239,512
v_sub_u32 v245, v245, v246
mvva 164,220,48
buffer_load_dwordx4 v242, s[16:19], s46 offen lds
mvva 172,220,52
s_add_u32 m0, m0, s53
tr 198,239,768
v_bfe_u32 v246, v244, 3, 1
mvva 172,216,36
tr 200,239,8448
v_lshl_add_u32 v245, v245, 1, v246
mvva 172,212,20
tr 202,239,8704
v_bfe_u32 v246, v244, 1, 1
mvva 172,208,4
buffer_load_dwordx4 v242, s[16:19], s46 offen offset:896 lds
mvva 180,208,8
s_add_u32 m0, m0, s53
tr 204,239,8960
v_lshl_add_u32 v245, v245, 1, v246
mvva 180,212,24
tr 206,239,9216
v_lshlrev_b32 v245, v245, 1
mvva 180,216,40
v_and_b32 v246, 1, v244
v_lshlrev_b32 v246, 4, v246
mvva 180,220,56
buffer_load_dwordx4 v242, s[16:19], s46 offen offset:1792 lds
s_add_u32 m0, m0, s53
v_mov_b32 v247, 0x3f80
v_lshlrev_b32 v246, v246, v247
v_bfe_i32 v247, v245, 0, 1
v_and_b32 v247, v247, v246
s_waitcnt lgkmcnt(1)
v_accvgpr_write_b32 a160, v247
v_bfe_i32 v247, v245, 1, 1
buffer_load_dwordx4 v242, s[16:19], s46 offen offset:2688 lds
mvva 128,192,64
s_add_u32 s46, s46, s57
s_add_u32 m0, s41, s49
tr 208,239,32
mvva 128,196,80
s_cmp_eq_u32 s46, s77
s_cselect_b32 s46, s71, s46
tr 210,239,288
mvva 128,200,96
s_waitcnt lgkmcnt(2)
s_add_u32 s41, s41, s42
tr 212,239,544
mvva 128,204,112
buffer_load_dwordx4 v242, s[16:19], s46 offen lds
mvva 136,204,116
s_cmp_eq_u32 s41, s43
s_cselect_b32 s41, 0, s41
tr 214,239,800
mvva 136,200,100
s_add_u32 m0, m0, s53
tr 216,239,8480
v_and_b32 v247, v247, v246
mvva 136,196,84
tr 218,239,8736
v_accvgpr_write_b32 a161, v247
mvva 136,192,68
buffer_load_dwordx4 v242, s[16:19], s46 offen offset:896 lds
mvva 144,192,72
s_add_u32 m0, m0, s53
tr 220,239,8992
v_bfe_i32 v247, v245, 2, 1
mvva 144,196,88
tr 222,239,9248
v_and_b32 v247, v247, v246
mvva 144,200,104
v_accvgpr_write_b32 a162, v247
v_bfe_i32 v247, v245, 3, 1
mvva 144,204,120
buffer_load_dwordx4 v242, s[16:19], s46 offen offset:1792 lds
s_add_u32 m0, m0, s53
v_and_b32 v247, v247, v246
v_accvgpr_write_b32 a163, v247
v_bfe_i32 v247, v245, 4, 1
v_and_b32 v247, v247, v246
s_waitcnt lgkmcnt(1)
v_accvgpr_write_b32 a164, v247
v_bfe_i32 v247, v245, 5, 1
buffer_load_dwordx4 v242, s[16:19], s46 offen offset:2688 lds
mvva 132,208,64
s_add_u32 s46, s46, s55
tr 192,239,64
v_and_b32 v247, v247, v246
mvva 132,212,80
tr 194,239,320
v_accvgpr_write_b32 a165, v247
mvva 132,216,96
s_waitcnt lgkmcnt(2)
tr 196,239,576
v_bfe_i32 v247, v245, 6, 1
mvva 132,220,112
v_and_b32 v247, v247, v246
v_accvgpr_write_b32 a166, v247
mvva 140,220,116
tr 198,239,832
v_bfe_i32 v247, v245, 7, 1
mvva 140,216,100
tr 200,239,8512
v_and_b32 v247, v247, v246
mvva 140,212,84
tr 202,239,8768
v_accvgpr_write_b32 a167, v247
mvva 140,208,68
pk 128,128,129
pk 129,130,131
mvva 148,208,72
tr 204,239,9024
pk 130,132,133
mvva 148,212,88
tr 206,239,9280
pk 131,134,135
mvva 148,216,104
buffer_store_dwordx4 v[128:131], v240, s[8:11], s66 offen offset:0
mvva 148,220,120
pk 136,136,137
pk 137,138,139
pk 138,140,141
pk 139,142,143
s_waitcnt lgkmcnt(1)
mvva 160,192,64
tr 208,239,96
mvva 160,196,80
tr 210,239,352
mvva 160,200,96
s_waitcnt lgkmcnt(2)
tr 212,239,608
mvva 160,204,112
buffer_store_dwordx4 v[136:139], v240, s[8:11], s66 offen offset:1024
mvva 168,204,116
tr 214,239,864
pk 144,144,145
pk 145,146,147
mvva 168,200,100
tr 216,239,8544
pk 146,148,149
mvva 168,196,84
tr 218,239,8800
pk 147,150,151
mvva 168,192,68
buffer_store_dwordx4 v[144:147], v240, s[8:11], s66 offen offset:2048
mvva 176,192,72
s_add_u32 s66, s66, s72
tr 220,239,9056
mvva 176,196,88
tr 222,239,9312
mvva 176,200,104
mvva 176,204,120
v_add_u32 v239, s40, v235
s_add_u32 s40, s40, s42
s_cmp_eq_u32 s40, s43
s_cselect_b32 s40, 0, s40
buffer_store_dwordx4 v[152:155], v240, s[8:11], s67 offen offset:3072
s_add_u32 s67, s67, s72
s_waitcnt vmcnt(20) lgkmcnt(0)
s_barrier
mvva 164,208,64
tr 192,239,0
mvva 164,212,80
tr 194,239,256
mvva 164,216,96
tr 196,239,512
mvva 164,220,112
mvva 172,220,116
tr 198,239,768
mvva 172,216,100
tr 200,239,8448
mvva 172,212,84
tr 202,239,8704
mvva 172,208,68
mvva 180,208,72
tr 204,239,8960
pk 160,160,161
mvva 180,212,88
tr 206,239,9216
pk 161,162,163
mvva 180,216,104
pk 162,164,165
pk 163,166,167
mvva 180,220,120
buffer_store_dwordx4 v[160:163], v240, s[8:11], s66 offen offset:0
pk 168,168,169
pk 169,170,171
pk 170,172,173
pk 171,174,175
s_waitcnt lgkmcnt(6)
s_nop 7
buffer_store_dwordx4 v[168:171], v240, s[8:11], s66 offen offset:1024
pk 176,176,177
pk 177,178,179
pk 178,180,181
pk 179,182,183
buffer_store_dwordx4 v[176:179], v240, s[8:11], s66 offen offset:2048
buffer_store_dwordx4 v[184:187], v240, s[8:11], s67 offen offset:3072
s_add_u32 s66, s66, s60
s_add_u32 s67, s67, s60
s_mov_b32 s64, 6
L_oploopw:
mvvvz 128,192,0
s_waitcnt lgkmcnt(4)
tr 208,239,32
mvvv 128,196,16
s_waitcnt lgkmcnt(3)
s_add_u32 m0, s41, s49
tr 210,239,288
mvvv 128,200,32
s_waitcnt lgkmcnt(2)
s_add_u32 s41, s41, s42
tr 212,239,544
mvvv 128,204,48
s_cmp_eq_u32 s41, s43
s_cselect_b32 s41, 0, s41
mvvvz 136,204,52
tr 214,239,800
mvvv 136,200,36
tr 216,239,8480
mvvv 136,196,20
tr 218,239,8736
mvvv 136,192,4
buffer_load_dwordx4 v242, s[16:19], s46 offen lds
mvvvz 144,192,8
s_add_u32 m0, m0, s53
tr 220,239,8992
mvvv 144,196,24
tr 222,239,9248
mvvv 144,200,40
buffer_load_dwordx4 v242, s[16:19], s46 offen offset:896 lds
mvvv 144,204,56
s_add_u32 m0, m0, s53
s_nop 0
buffer_load_dwordx4 v242, s[16:19], s46 offen offset:1792 lds
s_add_u32 m0, m0, s53
s_nop 0
buffer_load_dwordx4 v242, s[16:19], s46 offen offset:2688 lds
s_waitcnt lgkmcnt(1)
s_add_u32 s46, s46, s56
s_add_u32 m0, s41, s49
mvvvz 132,208,0
s_add_u32 s41, s41, s42
tr 192,239,64
mvvv 132,212,16
s_cmp_eq_u32 s41, s43
s_cselect_b32 s41, 0, s41
tr 194,239,320
mvvv 132,216,32
s_waitcnt lgkmcnt(2)
tr 196,239,576
mvvv 132,220,48
buffer_load_dwordx4 v242, s[16:19], s46 offen lds
mvvvz 140,220,52
s_add_u32 m0, m0, s53
tr 198,239,832
mvvv 140,216,36
tr 200,239,8512
mvvv 140,212,20
tr 202,239,8768
mvvv 140,208,4
buffer_load_dwordx4 v242, s[16:19], s46 offen offset:896 lds
mvvvz 148,208,8
s_add_u32 m0, m0, s53
tr 204,239,9024
mvvv 148,212,24
tr 206,239,9280
mvvv 148,216,40
buffer_load_dwordx4 v242, s[16:19], s46 offen offset:1792 lds
mvvv 148,220,56
s_add_u32 m0, m0, s53
s_nop 0
buffer_load_dwordx4 v242, s[16:19], s46 offen offset:2688 lds
s_add_u32 s46, s46, s55
pk 244,244,245
pk 245,246,247
pk 246,228,229
pk 247,230,231
s_waitcnt lgkmcnt(1)
mvvvz 160,192,0
tr 208,239,96
mvvv 160,196,16
tr 210,239,352
mvvv 160,200,32
s_waitcnt lgkmcnt(2)
tr 212,239,608
mvvv 160,204,48
mvvvz 168,204,52
tr 214,239,864
mvvv 168,200,36
tr 216,239,8544
mvvv 168,196,20
tr 218,239,8800
mvvv 168,192,4
mvvvz 176,192,8
tr 220,239,9056
v_mov_b32 v233, s94
mvvv 176,196,24
tr 222,239,9312
mvvv 176,200,40
mvvv 176,204,56
v_add_u32 v239, s40, v235
s_add_u32 s40, s40, s42
s_cmp_eq_u32 s40, s43
s_cselect_b32 s40, 0, s40
s_waitcnt vmcnt(8)
s_barrier
s_waitcnt lgkmcnt(1)
s_cmp_lt_u32 s61, s95
s_cbranch_scc1 L_releasew
L_rel0w:
mvvvz 164,208,0
tr 192,239,0
mvvv 164,212,16
tr 194,239,256
mvvv 164,216,32
s_waitcnt lgkmcnt(2)
tr 196,239,512
mvvv 164,220,48
buffer_store_dword v233, v237, s[20:23], s54 offen
mvvvz 172,220,52
tr 198,239,768
mvvv 172,216,36
tr 200,239,8448
mvvv 172,212,20
tr 202,239,8704
mvvv 172,208,4
buffer_store_dword v233, v237, s[20:23], s61 offen sc1
mvvvz 180,208,8
tr 204,239,8960
mvvv 180,212,24
tr 206,239,9216
mvvv 180,216,40
mvvv 180,220,56
s_waitcnt lgkmcnt(1)
mvvv 128,192,64
tr 208,239,32
mvvv 128,196,80
tr 210,239,288
mvvv 128,200,96
s_waitcnt lgkmcnt(2)
tr 212,239,544
mvvv 128,204,112
mvvv 136,204,116
tr 214,239,800
mvvv 136,200,100
tr 216,239,8480
mvvv 136,196,84
tr 218,239,8736
mvvv 136,192,68
mvvv 144,192,72
tr 220,239,8992
v_mul_f32 v128, v128, v224
mvvv 144,196,88
tr 222,239,9248
v_mul_f32 v129, v129, v224
mvvv 144,200,104
v_mul_f32 v130, v130, v224
v_mul_f32 v131, v131, v224
mvvv 144,204,120
v_mul_f32 v136, v136, v225
v_mul_f32 v137, v137, v225
v_mul_f32 v138, v138, v225
v_mul_f32 v139, v139, v225
buffer_load_dword v248, v232, s[20:23], s62 offen sc1
s_waitcnt lgkmcnt(1)
s_nop 1
v_mul_f32 v144, v144, v226
v_mul_f32 v145, v145, v226
mvvv 132,208,64
tr 192,239,64
v_mul_f32 v146, v146, v226
mvvv 132,212,80
tr 194,239,320
v_mul_f32 v147, v147, v226
mvvv 132,216,96
s_waitcnt lgkmcnt(2)
tr 196,239,576
mvvv 132,220,112
mvvv 140,220,116
tr 198,239,832
mvvv 140,216,100
tr 200,239,8512
mvvv 140,212,84
tr 202,239,8768
s_nop 1
v_mul_f32 v132, v132, v224
mvvv 140,208,68
v_mul_f32 v133, v133, v224
v_mul_f32 v134, v134, v224
mvvv 148,208,72
tr 204,239,9024
v_mul_f32 v135, v135, v224
mvvv 148,212,88
tr 206,239,9280
mvvv 148,216,104
s_waitcnt vmcnt(0)
v_cmp_gt_u32 vcc, s94, v248
v_mul_f32 v140, v140, v225
mvvv 148,220,120
v_mul_f32 v141, v141, v225
v_mul_f32 v142, v142, v225
s_and_b32 vcc_lo, vcc_lo, s95
s_or_b32 vcc_lo, vcc_lo, s75
s_cbranch_scc1 L_spinw
L_back0w:
s_mov_b64 vcc, 0
s_add_u32 s94, s94, 1
v_mul_f32 v143, v143, v225
s_nop 0
v_mul_f32 v148, v148, v226
s_waitcnt lgkmcnt(1)
v_mul_f32 v149, v149, v226
v_mul_f32 v150, v150, v226
buffer_load_dwordx4 a[128:131], v240, s[8:11], s6 offen sc1
mvvv 160,192,64
s_add_u32 s6, s6, s58
tr 208,239,96
v_mul_f32 v151, v151, v226
mvvv 160,196,80
tr 210,239,352
mvvv 160,200,96
s_waitcnt lgkmcnt(2)
tr 212,239,608
mvvv 160,204,112
buffer_load_dwordx4 a[132:135], v240, s[8:11], s6 offen sc1
mvvv 168,204,116
s_add_u32 s6, s6, s58
tr 214,239,864
mvvv 168,200,100
tr 216,239,8544
mvvv 168,196,84
tr 218,239,8800
mvvv 168,192,68
buffer_load_dwordx4 a[136:139], v240, s[8:11], s6 offen sc1
mvvv 176,192,72
s_add_u32 s6, s6, s58
tr 220,239,9056
v_mul_f32 v160, v160, v224
mvvv 176,196,88
tr 222,239,9312
v_mul_f32 v161, v161, v224
mvvv 176,200,104
buffer_load_dwordx4 a[140:143], v240, s[8:11], s6 offen sc1
mvvv 176,204,120
s_add_u32 s6, s6, s58
v_add_u32 v239, s40, v235
v_mul_f32 v162, v162, v224
s_add_u32 s40, s40, s42
s_cmp_eq_u32 s40, s43
s_cselect_b32 s40, 0, s40
buffer_load_dwordx4 a[144:147], v240, s[8:11], s6 offen sc1
s_add_u32 s6, s6, s58
v_mul_f32 v163, v163, v224
v_mul_f32 v168, v168, v225
s_waitcnt lgkmcnt(1)
v_mul_f32 v169, v169, v225
v_mul_f32 v170, v170, v225
mvvv 164,208,64
tr 192,239,0
v_mul_f32 v171, v171, v225
mvvv 164,212,80
tr 194,239,256
v_mul_f32 v176, v176, v226
mvvv 164,216,96
s_waitcnt lgkmcnt(2)
tr 196,239,512
v_mul_f32 v177, v177, v226
mvvv 164,220,112
buffer_load_dwordx4 a[148:151], v240, s[8:11], s6 offen sc1
mvvv 172,220,116
s_add_u32 s6, s6, s58
tr 198,239,768
v_mul_f32 v178, v178, v226
mvvv 172,216,100
tr 200,239,8448
v_mul_f32 v179, v179, v226
mvvv 172,212,84
tr 202,239,8704
mvvv 172,208,68
buffer_load_dwordx4 a[152:155], v240, s[8:11], s6 offen sc1
mvvv 180,208,72
s_add_u32 s6, s6, s58
tr 204,239,8960
mvvv 180,212,88
tr 206,239,9216
mvvv 180,216,104
v_mul_f32 v164, v164, v224
mvvv 180,220,120
buffer_load_dwordx4 a[156:159], v240, s[8:11], s6 offen sc1
s_add_u32 s6, s6, s44
v_mul_f32 v165, v165, v224
v_mul_f32 v166, v166, v224
v_mul_f32 v167, v167, v224
v_mul_f32 v172, v172, v225
v_mul_f32 v173, v173, v225
v_mul_f32 v174, v174, v225
s_waitcnt lgkmcnt(1)
v_mul_f32 v175, v175, v225
v_mul_f32 v180, v180, v226
mvva 128,192,0
tr 208,239,32
v_mul_f32 v181, v181, v226
mvva 128,196,16
tr 210,239,288
v_mul_f32 v182, v182, v226
mvva 128,200,32
s_waitcnt lgkmcnt(2)
tr 212,239,544
v_mul_f32 v183, v183, v226
mvva 128,204,48
mvva 136,204,52
tr 214,239,800
mvva 136,200,36
tr 216,239,8480
mvva 136,196,20
tr 218,239,8736
mvva 136,192,4
buffer_store_dwordx4 v[244:247], v249, s[12:15], s3 offen nt
mvva 144,192,8
s_addk_i32 s3, 128
tr 220,239,8992
mvva 144,196,24
s_cmp_eq_u32 s3, s5
s_cselect_b32 s3, s74, s3
tr 222,239,9248
mvva 144,200,40
s_bitset0_b32 s3, 31
mvva 144,204,56
s_waitcnt lgkmcnt(1)
mvva 132,208,0
tr 192,239,64
mvva 132,212,16
tr 194,239,320
mvva 132,216,32
s_waitcnt lgkmcnt(2)
tr 196,239,576
mvva 132,220,48
mvva 140,220,52
tr 198,239,832
mvva 140,216,36
tr 200,239,8512
mvva 140,212,20
tr 202,239,8768
mvva 140,208,4
mvva 148,208,8
tr 204,239,9024
v_mov_b32 v233, s94
mvva 148,212,24
tr 206,239,9280
mvva 148,216,40
mvva 148,220,56
s_waitcnt vmcnt(1)
s_barrier
s_waitcnt lgkmcnt(1)
mvva 160,192,0
tr 208,239,96
mvva 160,196,16
tr 210,239,352
mvva 160,200,32
s_waitcnt lgkmcnt(2)
tr 212,239,608
mvva 160,204,48
buffer_store_dword v233, v237, s[20:23], s54 offen
mvva 168,204,52
tr 214,239,864
mvva 168,200,36
tr 216,239,8544
mvva 168,196,20
tr 218,239,8800
mvva 168,192,4
buffer_store_dword v233, v237, s[20:23], s61 offen sc1
mvva 176,192,8
tr 220,239,9056
mvva 176,196,24
tr 222,239,9312
mvva 176,200,40
mvva 176,204,56
v_add_u32 v239, s40, v235
s_add_u32 s40, s40, s42
s_cmp_eq_u32 s40, s43
s_cselect_b32 s40, 0, s40
s_waitcnt lgkmcnt(1)
mvva 164,208,0
tr 192,239,0
mvva 164,212,16
tr 194,239,256
mvva 164,216,32
s_waitcnt lgkmcnt(2)
tr 196,239,512
mvva 164,220,48
mvva 172,220,52
tr 198,239,768
mvva 172,216,36
tr 200,239,8448
mvva 172,212,20
tr 202,239,8704
mvva 172,208,4
mvva 180,208,8
tr 204,239,8960
mvva 180,212,24
tr 206,239,9216
mvva 180,216,40
mvva 180,220,56
buffer_load_dword v248, v232, s[20:23], s62 offen sc1
s_waitcnt lgkmcnt(1)
mvva 128,192,64
tr 208,239,32
mvva 128,196,80
tr 210,239,288
mvva 128,200,96
s_waitcnt lgkmcnt(2)
tr 212,239,544
mvva 128,204,112
mvva 136,204,116
tr 214,239,800
mvva 136,200,100
tr 216,239,8480
mvva 136,196,84
tr 218,239,8736
mvva 136,192,68
mvva 144,192,72
s_add_u32 m0, s41, s49
s_add_u32 s41, s41, s42
tr 220,239,8992
mvva 144,196,88
s_cmp_eq_u32 s41, s43
s_cselect_b32 s41, 0, s41
tr 222,239,9248
mvva 144,200,104
s_waitcnt vmcnt(0)
v_cmp_gt_u32 vcc, s94, v248
mvva 144,204,120
s_and_b32 vcc_lo, vcc_lo, s95
s_or_b32 vcc_lo, vcc_lo, s75
s_cbranch_scc1 L_spinw
L_back1w:
s_mov_b64 vcc, 0
s_add_u32 s94, s94, 1
buffer_load_dwordx4 v242, s[16:19], s46 offen lds
s_waitcnt lgkmcnt(1)
s_add_u32 m0, m0, s53
mvva 132,208,64
tr 192,239,64
mvva 132,212,80
tr 194,239,320
mvva 132,216,96
s_waitcnt lgkmcnt(2)
tr 196,239,576
mvva 132,220,112
buffer_load_dwordx4 v242, s[16:19], s46 offen offset:896 lds
mvva 140,220,116
s_add_u32 m0, m0, s53
tr 198,239,832
mvva 140,216,100
tr 200,239,8512
mvva 140,212,84
tr 202,239,8768
pk 128,128,129
mvva 140,208,68
buffer_load_dwordx4 v242, s[16:19], s46 offen offset:1792 lds
mvva 148,208,72
s_add_u32 m0, m0, s53
tr 204,239,9024
pk 129,130,131
mvva 148,212,88
tr 206,239,9280
pk 130,132,133
mvva 148,216,104
buffer_load_dwordx4 v242, s[16:19], s46 offen offset:2688 lds
mvva 148,220,120
s_add_u32 s46, s46, s57
s_cmp_eq_u32 s46, s77
s_cselect_b32 s46, s71, s46
s_add_u32 m0, s41, s49
s_add_u32 s41, s41, s42
pk 131,134,135
s_cmp_eq_u32 s41, s43
s_cselect_b32 s41, 0, s41
s_waitcnt lgkmcnt(1)
s_cmp_ge_u32 s94, 11
s_cselect_b32 s18, 0, s18
buffer_load_dwordx4 v242, s[16:19], s46 offen lds
mvva 160,192,64
s_add_u32 m0, m0, s53
tr 208,239,96
mvva 160,196,80
tr 210,239,352
mvva 160,200,96
s_waitcnt lgkmcnt(2)
tr 212,239,608
mvva 160,204,112
buffer_load_dwordx4 v242, s[16:19], s46 offen offset:896 lds
mvva 168,204,116
s_add_u32 m0, m0, s53
tr 214,239,864
mvva 168,200,100
tr 216,239,8544
mvva 168,196,84
tr 218,239,8800
mvva 168,192,68
buffer_store_dwordx4 v[128:131], v240, s[8:11], s66 offen offset:0
mvva 176,192,72
tr 220,239,9056
pk 136,136,137
mvva 176,196,88
tr 222,239,9312
pk 137,138,139
mvva 176,200,104
buffer_load_dwordx4 v242, s[16:19], s46 offen offset:1792 lds
mvva 176,204,120
s_add_u32 m0, m0, s53
v_add_u32 v239, s40, v235
pk 138,140,141
s_add_u32 s40, s40, s42
s_cmp_eq_u32 s40, s43
s_cselect_b32 s40, 0, s40
buffer_load_dwordx4 v242, s[16:19], s46 offen offset:2688 lds
s_add_u32 s46, s46, s55
pk 139,142,143
s_waitcnt lgkmcnt(1)
mvva 164,208,64
tr 192,239,0
mvva 164,212,80
tr 194,239,256
mvva 164,216,96
s_waitcnt lgkmcnt(2)
tr 196,239,512
mvva 164,220,112
buffer_store_dwordx4 v[136:139], v240, s[8:11], s66 offen offset:1024
mvva 172,220,116
tr 198,239,768
pk 144,144,145
mvva 172,216,100
tr 200,239,8448
pk 145,146,147
mvva 172,212,84
tr 202,239,8704
pk 146,148,149
mvva 172,208,68
pk 147,150,151
pk 160,160,161
mvva 180,208,72
tr 204,239,8960
pk 161,162,163
mvva 180,212,88
tr 206,239,9216
pk 162,164,165
mvva 180,216,104
buffer_store_dwordx4 v[144:147], v240, s[8:11], s66 offen offset:2048
mvva 180,220,120
s_add_u32 s66, s66, s72
buffer_store_dwordx4 v[152:155], v240, s[8:11], s67 offen offset:3072
s_add_u32 s67, s67, s72
pk 163,166,167
buffer_store_dwordx4 v[160:163], v240, s[8:11], s66 offen offset:0
mvaaz 244,160,128
pk 168,168,169
pk 169,170,171
mvaaz 228,164,128
pk 170,172,173
pk 171,174,175
mvaa 244,160,132
buffer_store_dwordx4 v[168:171], v240, s[8:11], s66 offen offset:1024
mvaa 228,164,132
pk 176,176,177
pk 177,178,179
mvaa 244,160,136
pk 178,180,181
pk 179,182,183
mvaa 228,164,136
buffer_store_dwordx4 v[176:179], v240, s[8:11], s66 offen offset:2048
mvaa 244,160,140
s_add_u32 s66, s66, s60
mvaa 228,164,140
mvaa 244,160,144
mvaa 228,164,144
buffer_store_dwordx4 v[184:187], v240, s[8:11], s67 offen offset:3072
mvaa 244,160,148
s_add_u32 s67, s67, s60
mvaa 228,164,148
mvaa 244,160,152
mvaa 228,164,152
mvaa 244,160,156
mvaa 228,164,156
s_waitcnt lgkmcnt(6)
s_sub_u32 s64, s64, 1
s_cmp_lg_u32 s64, 0
s_cbranch_scc1 L_oploopw
s_nop 3
s_waitcnt vmcnt(0)
s_barrier
v_mov_b32 v233, s94
s_cmp_lt_u32 s61, s95
s_cbranch_scc1 L_releasew
L_rel1w:
buffer_store_dword v233, v237, s[20:23], s54 offen
buffer_store_dword v233, v237, s[20:23], s61 offen sc1
buffer_load_dword v248, v232, s[20:23], s62 offen sc1
pk 244,244,245
pk 245,246,247
pk 246,228,229
pk 247,230,231
s_waitcnt vmcnt(0)
v_cmp_gt_u32 vcc, s94, v248
s_nop 1
s_and_b32 vcc_lo, vcc_lo, s95
s_or_b32 vcc_lo, vcc_lo, s75
s_cbranch_scc1 L_spinw
L_back2w:
buffer_load_dwordx4 a[128:131], v240, s[8:11], s6 offen sc1
s_add_u32 s6, s6, s58
buffer_load_dwordx4 a[132:135], v240, s[8:11], s6 offen sc1
s_add_u32 s6, s6, s58
buffer_load_dwordx4 a[136:139], v240, s[8:11], s6 offen sc1
s_add_u32 s6, s6, s58
buffer_load_dwordx4 a[140:143], v240, s[8:11], s6 offen sc1
s_add_u32 s6, s6, s58
buffer_load_dwordx4 a[144:147], v240, s[8:11], s6 offen sc1
s_add_u32 s6, s6, s58
buffer_load_dwordx4 a[148:151], v240, s[8:11], s6 offen sc1
s_add_u32 s6, s6, s58
buffer_load_dwordx4 a[152:155], v240, s[8:11], s6 offen sc1
s_add_u32 s6, s6, s58
buffer_load_dwordx4 a[156:159], v240, s[8:11], s6 offen sc1
s_add_u32 s6, s6, s44
buffer_store_dwordx4 v[244:247], v249, s[12:15], s3 offen nt
s_addk_i32 s3, 128
s_cmp_eq_u32 s3, s5
s_cselect_b32 s3, s74, s3
s_bitset0_b32 s3, 31
s_waitcnt vmcnt(7)
mvaaz 244,160,128
mvaaz 228,164,128
mvaa 244,160,132
mvaa 228,164,132
s_waitcnt vmcnt(5)
mvaa 244,160,136
mvaa 228,164,136
mvaa 244,160,140
mvaa 228,164,140
s_waitcnt vmcnt(3)
mvaa 244,160,144
mvaa 228,164,144
mvaa 244,160,148
mvaa 228,164,148
s_waitcnt vmcnt(1)
mvaa 244,160,152
mvaa 228,164,152
mvaa 244,160,156
mvaa 228,164,156
s_nop 7
pk 244,244,245
pk 245,246,247
pk 246,228,229
pk 247,230,231
buffer_store_dwordx4 v[244:247], v249, s[12:15], s3 offen nt
L_endw:
s_endpgm
L_spinw:
buffer_load_dword v248, v232, s[20:23], s62 offen sc1
s_waitcnt vmcnt(0)
v_cmp_gt_u32 vcc, s94, v248
s_cmp_eq_u32 s98, 0
s_cbranch_scc1 L_spin_outw
s_sub_u32 s98, s98, 1
s_and_b32 vcc_lo, vcc_lo, s95
s_cbranch_scc0 L_spin_outw
s_sleep 1
s_branch L_spinw
L_spin_outw:
s_cmp_eq_u32 s75, 0
s_cbranch_scc1 L_acquiredw
buffer_inv sc1
s_waitcnt vmcnt(0)
L_acquiredw:
s_cmp_eq_u32 s94, 13
s_cbranch_scc1 L_back2w
s_bitcmp1_b32 s94, 0
s_cbranch_scc1 L_back0w
s_branch L_back1w
L_releasew:
buffer_wbl2 sc1
s_waitcnt vmcnt(0)
s_cmp_eq_u32 s94, 13
s_cbranch_scc1 L_rel1w
s_branch L_rel0w
L_spin_clearw:
s_sleep 1
buffer_load_dword v241, v240, s[84:87], 0 offen sc1
s_waitcnt vmcnt(0)
v_readfirstlane_b32 s94, v241
s_cmp_eq_u32 s98, 0
s_cbranch_scc1 L_clearedw
s_sub_u32 s98, s98, 1
s_bitcmp0_b32 s94, 3
s_cbranch_scc1 L_spin_clearw
s_branch L_clearedw
L_rare0w:
s_nop 7
v_max3_f32 v243, v128, v129, v130
v_max3_f32 v243, v243, v131, v132
v_max3_f32 v243, v243, v133, v134
v_max_f32 v243, v243, v135
v_mov_b32 v238, v243
s_nop 1
v_permlane32_swap_b32 v243, v238
s_nop 1
v_max_f32 v243, v243, v238
v_mov_b32 v238, v243
s_nop 1
v_permlane16_swap_b32 v243, v238
s_nop 1
v_max_f32 v243, v243, v238
v_ceil_f32 v243, v243
v_max_f32 v243, 0, v243
v_sub_f32 v128, v128, v243
v_sub_f32 v129, v129, v243
v_sub_f32 v130, v130, v243
v_sub_f32 v131, v131, v243
v_sub_f32 v132, v132, v243
v_sub_f32 v133, v133, v243
v_sub_f32 v134, v134, v243
v_sub_f32 v135, v135, v243
v_sub_f32 v224, v224, v243
v_cvt_i32_f32 v239, -v243
v_ldexp_f32 v228, v228, v239
s_cmp_eq_u32 s63, 0
s_cbranch_scc1 L_rare0_q0w
v_lshlrev_b32 v243, 16, v160
v_and_b32 v238, s81, v160
v_ldexp_f32 v243, v243, v239
v_ldexp_f32 v238, v238, v239
pk 160,243,238
v_lshlrev_b32 v243, 16, v161
v_and_b32 v238, s81, v161
v_ldexp_f32 v243, v243, v239
v_ldexp_f32 v238, v238, v239
pk 161,243,238
v_lshlrev_b32 v243, 16, v162
v_and_b32 v238, s81, v162
v_ldexp_f32 v243, v243, v239
v_ldexp_f32 v238, v238, v239
pk 162,243,238
v_lshlrev_b32 v243, 16, v163
v_and_b32 v238, s81, v163
v_ldexp_f32 v243, v243, v239
v_ldexp_f32 v238, v238, v239
pk 163,243,238
v_accvgpr_read_b32 v243, a0
v_ldexp_f32 v243, v243, v239
v_accvgpr_write_b32 a0, v243
v_accvgpr_read_b32 v238, a1
v_ldexp_f32 v238, v238, v239
v_accvgpr_write_b32 a1, v238
v_accvgpr_read_b32 v243, a2
v_ldexp_f32 v243, v243, v239
v_accvgpr_write_b32 a2, v243
v_accvgpr_read_b32 v238, a3
v_ldexp_f32 v238, v238, v239
v_accvgpr_write_b32 a3, v238
v_accvgpr_read_b32 v243, a16
v_ldexp_f32 v243, v243, v239
v_accvgpr_write_b32 a16, v243
v_accvgpr_read_b32 v238, a17
v_ldexp_f32 v238, v238, v239
v_accvgpr_write_b32 a17, v238
v_accvgpr_read_b32 v243, a18
v_ldexp_f32 v243, v243, v239
v_accvgpr_write_b32 a18, v243
v_accvgpr_read_b32 v238, a19
v_ldexp_f32 v238, v238, v239
v_accvgpr_write_b32 a19, v238
v_accvgpr_read_b32 v243, a32
v_ldexp_f32 v243, v243, v239
v_accvgpr_write_b32 a32, v243
v_accvgpr_read_b32 v238, a33
v_ldexp_f32 v238, v238, v239
v_accvgpr_write_b32 a33, v238
v_accvgpr_read_b32 v243, a34
v_ldexp_f32 v243, v243, v239
v_accvgpr_write_b32 a34, v243
v_accvgpr_read_b32 v238, a35
v_ldexp_f32 v238, v238, v239
v_accvgpr_write_b32 a35, v238
v_accvgpr_read_b32 v243, a48
v_ldexp_f32 v243, v243, v239
v_accvgpr_write_b32 a48, v243
v_accvgpr_read_b32 v238, a49
v_ldexp_f32 v238, v238, v239
v_accvgpr_write_b32 a49, v238
v_accvgpr_read_b32 v243, a50
v_ldexp_f32 v243, v243, v239
v_accvgpr_write_b32 a50, v243
v_accvgpr_read_b32 v238, a51
v_ldexp_f32 v238, v238, v239
v_accvgpr_write_b32 a51, v238
v_accvgpr_read_b32 v243, a64
v_ldexp_f32 v243, v243, v239
v_accvgpr_write_b32 a64, v243
v_accvgpr_read_b32 v238, a65
v_ldexp_f32 v238, v238, v239
v_accvgpr_write_b32 a65, v238
v_accvgpr_read_b32 v243, a66
v_ldexp_f32 v243, v243, v239
v_accvgpr_write_b32 a66, v243
v_accvgpr_read_b32 v238, a67
v_ldexp_f32 v238, v238, v239
v_accvgpr_write_b32 a67, v238
v_accvgpr_read_b32 v243, a80
v_ldexp_f32 v243, v243, v239
v_accvgpr_write_b32 a80, v243
v_accvgpr_read_b32 v238, a81
v_ldexp_f32 v238, v238, v239
v_accvgpr_write_b32 a81, v238
v_accvgpr_read_b32 v243, a82
v_ldexp_f32 v243, v243, v239
v_accvgpr_write_b32 a82, v243
v_accvgpr_read_b32 v238, a83
v_ldexp_f32 v238, v238, v239
v_accvgpr_write_b32 a83, v238
v_accvgpr_read_b32 v243, a96
v_ldexp_f32 v243, v243, v239
v_accvgpr_write_b32 a96, v243
v_accvgpr_read_b32 v238, a97
v_ldexp_f32 v238, v238, v239
v_accvgpr_write_b32 a97, v238
v_accvgpr_read_b32 v243, a98
v_ldexp_f32 v243, v243, v239
v_accvgpr_write_b32 a98, v243
v_accvgpr_read_b32 v238, a99
v_ldexp_f32 v238, v238, v239
v_accvgpr_write_b32 a99, v238
v_accvgpr_read_b32 v243, a112
v_ldexp_f32 v243, v243, v239
v_accvgpr_write_b32 a112, v243
v_accvgpr_read_b32 v238, a113
v_ldexp_f32 v238, v238, v239
v_accvgpr_write_b32 a113, v238
v_accvgpr_read_b32 v243, a114
v_ldexp_f32 v243, v243, v239
v_accvgpr_write_b32 a114, v243
v_accvgpr_read_b32 v238, a115
v_ldexp_f32 v238, v238, v239
v_accvgpr_write_b32 a115, v238
v_accvgpr_read_b32 v243, a128
v_ldexp_f32 v243, v243, v239
v_accvgpr_write_b32 a128, v243
v_accvgpr_read_b32 v238, a129
v_ldexp_f32 v238, v238, v239
v_accvgpr_write_b32 a129, v238
v_accvgpr_read_b32 v243, a130
v_ldexp_f32 v243, v243, v239
v_accvgpr_write_b32 a130, v243
v_accvgpr_read_b32 v238, a131
v_ldexp_f32 v238, v238, v239
v_accvgpr_write_b32 a131, v238
v_accvgpr_read_b32 v243, a144
v_ldexp_f32 v243, v243, v239
v_accvgpr_write_b32 a144, v243
v_accvgpr_read_b32 v238, a145
v_ldexp_f32 v238, v238, v239
v_accvgpr_write_b32 a145, v238
v_accvgpr_read_b32 v243, a146
v_ldexp_f32 v243, v243, v239
v_accvgpr_write_b32 a146, v243
v_accvgpr_read_b32 v238, a147
v_ldexp_f32 v238, v238, v239
v_accvgpr_write_b32 a147, v238
v_accvgpr_read_b32 v243, a160
v_ldexp_f32 v243, v243, v239
v_accvgpr_write_b32 a160, v243
v_accvgpr_read_b32 v238, a161
v_ldexp_f32 v238, v238, v239
v_accvgpr_write_b32 a161, v238
v_accvgpr_read_b32 v243, a162
v_ldexp_f32 v243, v243, v239
v_accvgpr_write_b32 a162, v243
v_accvgpr_read_b32 v238, a163
v_ldexp_f32 v238, v238, v239
v_accvgpr_write_b32 a163, v238
v_accvgpr_read_b32 v243, a176
v_ldexp_f32 v243, v243, v239
v_accvgpr_write_b32 a176, v243
v_accvgpr_read_b32 v238, a177
v_ldexp_f32 v238, v238, v239
v_accvgpr_write_b32 a177, v238
v_accvgpr_read_b32 v243, a178
v_ldexp_f32 v243, v243, v239
v_accvgpr_write_b32 a178, v243
v_accvgpr_read_b32 v238, a179
v_ldexp_f32 v238, v238, v239
v_accvgpr_write_b32 a179, v238
v_accvgpr_read_b32 v243, a192
v_ldexp_f32 v243, v243, v239
v_accvgpr_write_b32 a192, v243
v_accvgpr_read_b32 v238, a193
v_ldexp_f32 v238, v238, v239
v_accvgpr_write_b32 a193, v238
v_accvgpr_read_b32 v243, a194
v_ldexp_f32 v243, v243, v239
v_accvgpr_write_b32 a194, v243
v_accvgpr_read_b32 v238, a195
v_ldexp_f32 v238, v238, v239
v_accvgpr_write_b32 a195, v238
v_accvgpr_read_b32 v243, a208
v_ldexp_f32 v243, v243, v239
v_accvgpr_write_b32 a208, v243
v_accvgpr_read_b32 v238, a209
v_ldexp_f32 v238, v238, v239
v_accvgpr_write_b32 a209, v238
v_accvgpr_read_b32 v243, a210
v_ldexp_f32 v243, v243, v239
v_accvgpr_write_b32 a210, v243
v_accvgpr_read_b32 v238, a211
v_ldexp_f32 v238, v238, v239
v_accvgpr_write_b32 a211, v238
v_accvgpr_read_b32 v243, a224
v_ldexp_f32 v243, v243, v239
v_accvgpr_write_b32 a224, v243
v_accvgpr_read_b32 v238, a225
v_ldexp_f32 v238, v238, v239
v_accvgpr_write_b32 a225, v238
v_accvgpr_read_b32 v243, a226
v_ldexp_f32 v243, v243, v239
v_accvgpr_write_b32 a226, v243
v_accvgpr_read_b32 v238, a227
v_ldexp_f32 v238, v238, v239
v_accvgpr_write_b32 a227, v238
v_accvgpr_read_b32 v243, a240
v_ldexp_f32 v243, v243, v239
v_accvgpr_write_b32 a240, v243
v_accvgpr_read_b32 v238, a241
v_ldexp_f32 v238, v238, v239
v_accvgpr_write_b32 a241, v238
v_accvgpr_read_b32 v243, a242
v_ldexp_f32 v243, v243, v239
v_accvgpr_write_b32 a242, v243
v_accvgpr_read_b32 v238, a243
v_ldexp_f32 v238, v238, v239
v_accvgpr_write_b32 a243, v238
L_rare0_q0w:
v_max3_f32 v243, v136, v137, v138
v_max3_f32 v243, v243, v139, v140
v_max3_f32 v243, v243, v141, v142
v_max_f32 v243, v243, v143
v_mov_b32 v238, v243
s_nop 1
v_permlane32_swap_b32 v243, v238
s_nop 1
v_max_f32 v243, v243, v238
v_mov_b32 v238, v243
s_nop 1
v_permlane16_swap_b32 v243, v238
s_nop 1
v_max_f32 v243, v243, v238
v_ceil_f32 v243, v243
v_max_f32 v243, 0, v243
v_sub_f32 v136, v136, v243
v_sub_f32 v137, v137, v243
v_sub_f32 v138, v138, v243
v_sub_f32 v139, v139, v243
v_sub_f32 v140, v140, v243
v_sub_f32 v141, v141, v243
v_sub_f32 v142, v142, v243
v_sub_f32 v143, v143, v243
v_sub_f32 v225, v225, v243
v_cvt_i32_f32 v239, -v243
v_ldexp_f32 v229, v229, v239
s_cmp_eq_u32 s63, 0
s_cbranch_scc1 L_rare0_q1w
v_lshlrev_b32 v243, 16, v168
v_and_b32 v238, s81, v168
v_ldexp_f32 v243, v243, v239
v_ldexp_f32 v238, v238, v239
pk 168,243,238
v_lshlrev_b32 v243, 16, v169
v_and_b32 v238, s81, v169
v_ldexp_f32 v243, v243, v239
v_ldexp_f32 v238, v238, v239
pk 169,243,238
v_lshlrev_b32 v243, 16, v170
v_and_b32 v238, s81, v170
v_ldexp_f32 v243, v243, v239
v_ldexp_f32 v238, v238, v239
pk 170,243,238
v_lshlrev_b32 v243, 16, v171
v_and_b32 v238, s81, v171
v_ldexp_f32 v243, v243, v239
v_ldexp_f32 v238, v238, v239
pk 171,243,238
v_accvgpr_read_b32 v243, a4
v_ldexp_f32 v243, v243, v239
v_accvgpr_write_b32 a4, v243
v_accvgpr_read_b32 v238, a5
v_ldexp_f32 v238, v238, v239
v_accvgpr_write_b32 a5, v238
v_accvgpr_read_b32 v243, a6
v_ldexp_f32 v243, v243, v239
v_accvgpr_write_b32 a6, v243
v_accvgpr_read_b32 v238, a7
v_ldexp_f32 v238, v238, v239
v_accvgpr_write_b32 a7, v238
v_accvgpr_read_b32 v243, a20
v_ldexp_f32 v243, v243, v239
v_accvgpr_write_b32 a20, v243
v_accvgpr_read_b32 v238, a21
v_ldexp_f32 v238, v238, v239
v_accvgpr_write_b32 a21, v238
v_accvgpr_read_b32 v243, a22
v_ldexp_f32 v243, v243, v239
v_accvgpr_write_b32 a22, v243
v_accvgpr_read_b32 v238, a23
v_ldexp_f32 v238, v238, v239
v_accvgpr_write_b32 a23, v238
v_accvgpr_read_b32 v243, a36
v_ldexp_f32 v243, v243, v239
v_accvgpr_write_b32 a36, v243
v_accvgpr_read_b32 v238, a37
v_ldexp_f32 v238, v238, v239
v_accvgpr_write_b32 a37, v238
v_accvgpr_read_b32 v243, a38
v_ldexp_f32 v243, v243, v239
v_accvgpr_write_b32 a38, v243
v_accvgpr_read_b32 v238, a39
v_ldexp_f32 v238, v238, v239
v_accvgpr_write_b32 a39, v238
v_accvgpr_read_b32 v243, a52
v_ldexp_f32 v243, v243, v239
v_accvgpr_write_b32 a52, v243
v_accvgpr_read_b32 v238, a53
v_ldexp_f32 v238, v238, v239
v_accvgpr_write_b32 a53, v238
v_accvgpr_read_b32 v243, a54
v_ldexp_f32 v243, v243, v239
v_accvgpr_write_b32 a54, v243
v_accvgpr_read_b32 v238, a55
v_ldexp_f32 v238, v238, v239
v_accvgpr_write_b32 a55, v238
v_accvgpr_read_b32 v243, a68
v_ldexp_f32 v243, v243, v239
v_accvgpr_write_b32 a68, v243
v_accvgpr_read_b32 v238, a69
v_ldexp_f32 v238, v238, v239
v_accvgpr_write_b32 a69, v238
v_accvgpr_read_b32 v243, a70
v_ldexp_f32 v243, v243, v239
v_accvgpr_write_b32 a70, v243
v_accvgpr_read_b32 v238, a71
v_ldexp_f32 v238, v238, v239
v_accvgpr_write_b32 a71, v238
v_accvgpr_read_b32 v243, a84
v_ldexp_f32 v243, v243, v239
v_accvgpr_write_b32 a84, v243
v_accvgpr_read_b32 v238, a85
v_ldexp_f32 v238, v238, v239
v_accvgpr_write_b32 a85, v238
v_accvgpr_read_b32 v243, a86
v_ldexp_f32 v243, v243, v239
v_accvgpr_write_b32 a86, v243
v_accvgpr_read_b32 v238, a87
v_ldexp_f32 v238, v238, v239
v_accvgpr_write_b32 a87, v238
v_accvgpr_read_b32 v243, a100
v_ldexp_f32 v243, v243, v239
v_accvgpr_write_b32 a100, v243
v_accvgpr_read_b32 v238, a101
v_ldexp_f32 v238, v238, v239
v_accvgpr_write_b32 a101, v238
v_accvgpr_read_b32 v243, a102
v_ldexp_f32 v243, v243, v239
v_accvgpr_write_b32 a102, v243
v_accvgpr_read_b32 v238, a103
v_ldexp_f32 v238, v238, v239
v_accvgpr_write_b32 a103, v238
v_accvgpr_read_b32 v243, a116
v_ldexp_f32 v243, v243, v239
v_accvgpr_write_b32 a116, v243
v_accvgpr_read_b32 v238, a117
v_ldexp_f32 v238, v238, v239
v_accvgpr_write_b32 a117, v238
v_accvgpr_read_b32 v243, a118
v_ldexp_f32 v243, v243, v239
v_accvgpr_write_b32 a118, v243
v_accvgpr_read_b32 v238, a119
v_ldexp_f32 v238, v238, v239
v_accvgpr_write_b32 a119, v238
v_accvgpr_read_b32 v243, a132
v_ldexp_f32 v243, v243, v239
v_accvgpr_write_b32 a132, v243
v_accvgpr_read_b32 v238, a133
v_ldexp_f32 v238, v238, v239
v_accvgpr_write_b32 a133, v238
v_accvgpr_read_b32 v243, a134
v_ldexp_f32 v243, v243, v239
v_accvgpr_write_b32 a134, v243
v_accvgpr_read_b32 v238, a135
v_ldexp_f32 v238, v238, v239
v_accvgpr_write_b32 a135, v238
v_accvgpr_read_b32 v243, a148
v_ldexp_f32 v243, v243, v239
v_accvgpr_write_b32 a148, v243
v_accvgpr_read_b32 v238, a149
v_ldexp_f32 v238, v238, v239
v_accvgpr_write_b32 a149, v238
v_accvgpr_read_b32 v243, a150
v_ldexp_f32 v243, v243, v239
v_accvgpr_write_b32 a150, v243
v_accvgpr_read_b32 v238, a151
v_ldexp_f32 v238, v238, v239
v_accvgpr_write_b32 a151, v238
v_accvgpr_read_b32 v243, a164
v_ldexp_f32 v243, v243, v239
v_accvgpr_write_b32 a164, v243
v_accvgpr_read_b32 v238, a165
v_ldexp_f32 v238, v238, v239
v_accvgpr_write_b32 a165, v238
v_accvgpr_read_b32 v243, a166
v_ldexp_f32 v243, v243, v239
v_accvgpr_write_b32 a166, v243
v_accvgpr_read_b32 v238, a167
v_ldexp_f32 v238, v238, v239
v_accvgpr_write_b32 a167, v238
v_accvgpr_read_b32 v243, a180
v_ldexp_f32 v243, v243, v239
v_accvgpr_write_b32 a180, v243
v_accvgpr_read_b32 v238, a181
v_ldexp_f32 v238, v238, v239
v_accvgpr_write_b32 a181, v238
v_accvgpr_read_b32 v243, a182
v_ldexp_f32 v243, v243, v239
v_accvgpr_write_b32 a182, v243
v_accvgpr_read_b32 v238, a183
v_ldexp_f32 v238, v238, v239
v_accvgpr_write_b32 a183, v238
v_accvgpr_read_b32 v243, a196
v_ldexp_f32 v243, v243, v239
v_accvgpr_write_b32 a196, v243
v_accvgpr_read_b32 v238, a197
v_ldexp_f32 v238, v238, v239
v_accvgpr_write_b32 a197, v238
v_accvgpr_read_b32 v243, a198
v_ldexp_f32 v243, v243, v239
v_accvgpr_write_b32 a198, v243
v_accvgpr_read_b32 v238, a199
v_ldexp_f32 v238, v238, v239
v_accvgpr_write_b32 a199, v238
v_accvgpr_read_b32 v243, a212
v_ldexp_f32 v243, v243, v239
v_accvgpr_write_b32 a212, v243
v_accvgpr_read_b32 v238, a213
v_ldexp_f32 v238, v238, v239
v_accvgpr_write_b32 a213, v238
v_accvgpr_read_b32 v243, a214
v_ldexp_f32 v243, v243, v239
v_accvgpr_write_b32 a214, v243
v_accvgpr_read_b32 v238, a215
v_ldexp_f32 v238, v238, v239
v_accvgpr_write_b32 a215, v238
v_accvgpr_read_b32 v243, a228
v_ldexp_f32 v243, v243, v239
v_accvgpr_write_b32 a228, v243
v_accvgpr_read_b32 v238, a229
v_ldexp_f32 v238, v238, v239
v_accvgpr_write_b32 a229, v238
v_accvgpr_read_b32 v243, a230
v_ldexp_f32 v243, v243, v239
v_accvgpr_write_b32 a230, v243
v_accvgpr_read_b32 v238, a231
v_ldexp_f32 v238, v238, v239
v_accvgpr_write_b32 a231, v238
v_accvgpr_read_b32 v243, a244
v_ldexp_f32 v243, v243, v239
v_accvgpr_write_b32 a244, v243
v_accvgpr_read_b32 v238, a245
v_ldexp_f32 v238, v238, v239
v_accvgpr_write_b32 a245, v238
v_accvgpr_read_b32 v243, a246
v_ldexp_f32 v243, v243, v239
v_accvgpr_write_b32 a246, v243
v_accvgpr_read_b32 v238, a247
v_ldexp_f32 v238, v238, v239
v_accvgpr_write_b32 a247, v238
L_rare0_q1w:
v_max3_f32 v243, v144, v145, v146
v_max3_f32 v243, v243, v147, v148
v_max3_f32 v243, v243, v149, v150
v_max_f32 v243, v243, v151
v_mov_b32 v238, v243
s_nop 1
v_permlane32_swap_b32 v243, v238
s_nop 1
v_max_f32 v243, v243, v238
v_mov_b32 v238, v243
s_nop 1
v_permlane16_swap_b32 v243, v238
s_nop 1
v_max_f32 v243, v243, v238
v_ceil_f32 v243, v243
v_max_f32 v243, 0, v243
v_sub_f32 v144, v144, v243
v_sub_f32 v145, v145, v243
v_sub_f32 v146, v146, v243
v_sub_f32 v147, v147, v243
v_sub_f32 v148, v148, v243
v_sub_f32 v149, v149, v243
v_sub_f32 v150, v150, v243
v_sub_f32 v151, v151, v243
v_sub_f32 v226, v226, v243
v_cvt_i32_f32 v239, -v243
v_ldexp_f32 v230, v230, v239
s_cmp_eq_u32 s63, 0
s_cbranch_scc1 L_rare0_q2w
v_lshlrev_b32 v243, 16, v176
v_and_b32 v238, s81, v176
v_ldexp_f32 v243, v243, v239
v_ldexp_f32 v238, v238, v239
pk 176,243,238
v_lshlrev_b32 v243, 16, v177
v_and_b32 v238, s81, v177
v_ldexp_f32 v243, v243, v239
v_ldexp_f32 v238, v238, v239
pk 177,243,238
v_lshlrev_b32 v243, 16, v178
v_and_b32 v238, s81, v178
v_ldexp_f32 v243, v243, v239
v_ldexp_f32 v238, v238, v239
pk 178,243,238
v_lshlrev_b32 v243, 16, v179
v_and_b32 v238, s81, v179
v_ldexp_f32 v243, v243, v239
v_ldexp_f32 v238, v238, v239
pk 179,243,238
v_accvgpr_read_b32 v243, a8
v_ldexp_f32 v243, v243, v239
v_accvgpr_write_b32 a8, v243
v_accvgpr_read_b32 v238, a9
v_ldexp_f32 v238, v238, v239
v_accvgpr_write_b32 a9, v238
v_accvgpr_read_b32 v243, a10
v_ldexp_f32 v243, v243, v239
v_accvgpr_write_b32 a10, v243
v_accvgpr_read_b32 v238, a11
v_ldexp_f32 v238, v238, v239
v_accvgpr_write_b32 a11, v238
v_accvgpr_read_b32 v243, a24
v_ldexp_f32 v243, v243, v239
v_accvgpr_write_b32 a24, v243
v_accvgpr_read_b32 v238, a25
v_ldexp_f32 v238, v238, v239
v_accvgpr_write_b32 a25, v238
v_accvgpr_read_b32 v243, a26
v_ldexp_f32 v243, v243, v239
v_accvgpr_write_b32 a26, v243
v_accvgpr_read_b32 v238, a27
v_ldexp_f32 v238, v238, v239
v_accvgpr_write_b32 a27, v238
v_accvgpr_read_b32 v243, a40
v_ldexp_f32 v243, v243, v239
v_accvgpr_write_b32 a40, v243
v_accvgpr_read_b32 v238, a41
v_ldexp_f32 v238, v238, v239
v_accvgpr_write_b32 a41, v238
v_accvgpr_read_b32 v243, a42
v_ldexp_f32 v243, v243, v239
v_accvgpr_write_b32 a42, v243
v_accvgpr_read_b32 v238, a43
v_ldexp_f32 v238, v238, v239
v_accvgpr_write_b32 a43, v238
v_accvgpr_read_b32 v243, a56
v_ldexp_f32 v243, v243, v239
v_accvgpr_write_b32 a56, v243
v_accvgpr_read_b32 v238, a57
v_ldexp_f32 v238, v238, v239
v_accvgpr_write_b32 a57, v238
v_accvgpr_read_b32 v243, a58
v_ldexp_f32 v243, v243, v239
v_accvgpr_write_b32 a58, v243
v_accvgpr_read_b32 v238, a59
v_ldexp_f32 v238, v238, v239
v_accvgpr_write_b32 a59, v238
v_accvgpr_read_b32 v243, a72
v_ldexp_f32 v243, v243, v239
v_accvgpr_write_b32 a72, v243
v_accvgpr_read_b32 v238, a73
v_ldexp_f32 v238, v238, v239
v_accvgpr_write_b32 a73, v238
v_accvgpr_read_b32 v243, a74
v_ldexp_f32 v243, v243, v239
v_accvgpr_write_b32 a74, v243
v_accvgpr_read_b32 v238, a75
v_ldexp_f32 v238, v238, v239
v_accvgpr_write_b32 a75, v238
v_accvgpr_read_b32 v243, a88
v_ldexp_f32 v243, v243, v239
v_accvgpr_write_b32 a88, v243
v_accvgpr_read_b32 v238, a89
v_ldexp_f32 v238, v238, v239
v_accvgpr_write_b32 a89, v238
v_accvgpr_read_b32 v243, a90
v_ldexp_f32 v243, v243, v239
v_accvgpr_write_b32 a90, v243
v_accvgpr_read_b32 v238, a91
v_ldexp_f32 v238, v238, v239
v_accvgpr_write_b32 a91, v238
v_accvgpr_read_b32 v243, a104
v_ldexp_f32 v243, v243, v239
v_accvgpr_write_b32 a104, v243
v_accvgpr_read_b32 v238, a105
v_ldexp_f32 v238, v238, v239
v_accvgpr_write_b32 a105, v238
v_accvgpr_read_b32 v243, a106
v_ldexp_f32 v243, v243, v239
v_accvgpr_write_b32 a106, v243
v_accvgpr_read_b32 v238, a107
v_ldexp_f32 v238, v238, v239
v_accvgpr_write_b32 a107, v238
v_accvgpr_read_b32 v243, a120
v_ldexp_f32 v243, v243, v239
v_accvgpr_write_b32 a120, v243
v_accvgpr_read_b32 v238, a121
v_ldexp_f32 v238, v238, v239
v_accvgpr_write_b32 a121, v238
v_accvgpr_read_b32 v243, a122
v_ldexp_f32 v243, v243, v239
v_accvgpr_write_b32 a122, v243
v_accvgpr_read_b32 v238, a123
v_ldexp_f32 v238, v238, v239
v_accvgpr_write_b32 a123, v238
v_accvgpr_read_b32 v243, a136
v_ldexp_f32 v243, v243, v239
v_accvgpr_write_b32 a136, v243
v_accvgpr_read_b32 v238, a137
v_ldexp_f32 v238, v238, v239
v_accvgpr_write_b32 a137, v238
v_accvgpr_read_b32 v243, a138
v_ldexp_f32 v243, v243, v239
v_accvgpr_write_b32 a138, v243
v_accvgpr_read_b32 v238, a139
v_ldexp_f32 v238, v238, v239
v_accvgpr_write_b32 a139, v238
v_accvgpr_read_b32 v243, a152
v_ldexp_f32 v243, v243, v239
v_accvgpr_write_b32 a152, v243
v_accvgpr_read_b32 v238, a153
v_ldexp_f32 v238, v238, v239
v_accvgpr_write_b32 a153, v238
v_accvgpr_read_b32 v243, a154
v_ldexp_f32 v243, v243, v239
v_accvgpr_write_b32 a154, v243
v_accvgpr_read_b32 v238, a155
v_ldexp_f32 v238, v238, v239
v_accvgpr_write_b32 a155, v238
v_accvgpr_read_b32 v243, a168
v_ldexp_f32 v243, v243, v239
v_accvgpr_write_b32 a168, v243
v_accvgpr_read_b32 v238, a169
v_ldexp_f32 v238, v238, v239
v_accvgpr_write_b32 a169, v238
v_accvgpr_read_b32 v243, a170
v_ldexp_f32 v243, v243, v239
v_accvgpr_write_b32 a170, v243
v_accvgpr_read_b32 v238, a171
v_ldexp_f32 v238, v238, v239
v_accvgpr_write_b32 a171, v238
v_accvgpr_read_b32 v243, a184
v_ldexp_f32 v243, v243, v239
v_accvgpr_write_b32 a184, v243
v_accvgpr_read_b32 v238, a185
v_ldexp_f32 v238, v238, v239
v_accvgpr_write_b32 a185, v238
v_accvgpr_read_b32 v243, a186
v_ldexp_f32 v243, v243, v239
v_accvgpr_write_b32 a186, v243
v_accvgpr_read_b32 v238, a187
v_ldexp_f32 v238, v238, v239
v_accvgpr_write_b32 a187, v238
v_accvgpr_read_b32 v243, a200
v_ldexp_f32 v243, v243, v239
v_accvgpr_write_b32 a200, v243
v_accvgpr_read_b32 v238, a201
v_ldexp_f32 v238, v238, v239
v_accvgpr_write_b32 a201, v238
v_accvgpr_read_b32 v243, a202
v_ldexp_f32 v243, v243, v239
v_accvgpr_write_b32 a202, v243
v_accvgpr_read_b32 v238, a203
v_ldexp_f32 v238, v238, v239
v_accvgpr_write_b32 a203, v238
v_accvgpr_read_b32 v243, a216
v_ldexp_f32 v243, v243, v239
v_accvgpr_write_b32 a216, v243
v_accvgpr_read_b32 v238, a217
v_ldexp_f32 v238, v238, v239
v_accvgpr_write_b32 a217, v238
v_accvgpr_read_b32 v243, a218
v_ldexp_f32 v243, v243, v239
v_accvgpr_write_b32 a218, v243
v_accvgpr_read_b32 v238, a219
v_ldexp_f32 v238, v238, v239
v_accvgpr_write_b32 a219, v238
v_accvgpr_read_b32 v243, a232
v_ldexp_f32 v243, v243, v239
v_accvgpr_write_b32 a232, v243
v_accvgpr_read_b32 v238, a233
v_ldexp_f32 v238, v238, v239
v_accvgpr_write_b32 a233, v238
v_accvgpr_read_b32 v243, a234
v_ldexp_f32 v243, v243, v239
v_accvgpr_write_b32 a234, v243
v_accvgpr_read_b32 v238, a235
v_ldexp_f32 v238, v238, v239
v_accvgpr_write_b32 a235, v238
v_accvgpr_read_b32 v243, a248
v_ldexp_f32 v243, v243, v239
v_accvgpr_write_b32 a248, v243
v_accvgpr_read_b32 v238, a249
v_ldexp_f32 v238, v238, v239
v_accvgpr_write_b32 a249, v238
v_accvgpr_read_b32 v243, a250
v_ldexp_f32 v243, v243, v239
v_accvgpr_write_b32 a250, v243
v_accvgpr_read_b32 v238, a251
v_ldexp_f32 v238, v238, v239
v_accvgpr_write_b32 a251, v238
L_rare0_q2w:
v_max3_f32 v243, v152, v153, v154
v_max3_f32 v243, v243, v155, v156
v_max3_f32 v243, v243, v157, v158
v_max_f32 v243, v243, v159
v_mov_b32 v238, v243
s_nop 1
v_permlane32_swap_b32 v243, v238
s_nop 1
v_max_f32 v243, v243, v238
v_mov_b32 v238, v243
s_nop 1
v_permlane16_swap_b32 v243, v238
s_nop 1
v_max_f32 v243, v243, v238
v_ceil_f32 v243, v243
v_max_f32 v243, 0, v243
v_sub_f32 v152, v152, v243
v_sub_f32 v153, v153, v243
v_sub_f32 v154, v154, v243
v_sub_f32 v155, v155, v243
v_sub_f32 v156, v156, v243
v_sub_f32 v157, v157, v243
v_sub_f32 v158, v158, v243
v_sub_f32 v159, v159, v243
v_sub_f32 v227, v227, v243
v_cvt_i32_f32 v239, -v243
v_ldexp_f32 v231, v231, v239
s_cmp_eq_u32 s63, 0
s_cbranch_scc1 L_rare0_q3w
v_lshlrev_b32 v243, 16, v184
v_and_b32 v238, s81, v184
v_ldexp_f32 v243, v243, v239
v_ldexp_f32 v238, v238, v239
pk 184,243,238
v_lshlrev_b32 v243, 16, v185
v_and_b32 v238, s81, v185
v_ldexp_f32 v243, v243, v239
v_ldexp_f32 v238, v238, v239
pk 185,243,238
v_lshlrev_b32 v243, 16, v186
v_and_b32 v238, s81, v186
v_ldexp_f32 v243, v243, v239
v_ldexp_f32 v238, v238, v239
pk 186,243,238
v_lshlrev_b32 v243, 16, v187
v_and_b32 v238, s81, v187
v_ldexp_f32 v243, v243, v239
v_ldexp_f32 v238, v238, v239
pk 187,243,238
v_accvgpr_read_b32 v243, a12
v_ldexp_f32 v243, v243, v239
v_accvgpr_write_b32 a12, v243
v_accvgpr_read_b32 v238, a13
v_ldexp_f32 v238, v238, v239
v_accvgpr_write_b32 a13, v238
v_accvgpr_read_b32 v243, a14
v_ldexp_f32 v243, v243, v239
v_accvgpr_write_b32 a14, v243
v_accvgpr_read_b32 v238, a15
v_ldexp_f32 v238, v238, v239
v_accvgpr_write_b32 a15, v238
v_accvgpr_read_b32 v243, a28
v_ldexp_f32 v243, v243, v239
v_accvgpr_write_b32 a28, v243
v_accvgpr_read_b32 v238, a29
v_ldexp_f32 v238, v238, v239
v_accvgpr_write_b32 a29, v238
v_accvgpr_read_b32 v243, a30
v_ldexp_f32 v243, v243, v239
v_accvgpr_write_b32 a30, v243
v_accvgpr_read_b32 v238, a31
v_ldexp_f32 v238, v238, v239
v_accvgpr_write_b32 a31, v238
v_accvgpr_read_b32 v243, a44
v_ldexp_f32 v243, v243, v239
v_accvgpr_write_b32 a44, v243
v_accvgpr_read_b32 v238, a45
v_ldexp_f32 v238, v238, v239
v_accvgpr_write_b32 a45, v238
v_accvgpr_read_b32 v243, a46
v_ldexp_f32 v243, v243, v239
v_accvgpr_write_b32 a46, v243
v_accvgpr_read_b32 v238, a47
v_ldexp_f32 v238, v238, v239
v_accvgpr_write_b32 a47, v238
v_accvgpr_read_b32 v243, a60
v_ldexp_f32 v243, v243, v239
v_accvgpr_write_b32 a60, v243
v_accvgpr_read_b32 v238, a61
v_ldexp_f32 v238, v238, v239
v_accvgpr_write_b32 a61, v238
v_accvgpr_read_b32 v243, a62
v_ldexp_f32 v243, v243, v239
v_accvgpr_write_b32 a62, v243
v_accvgpr_read_b32 v238, a63
v_ldexp_f32 v238, v238, v239
v_accvgpr_write_b32 a63, v238
v_accvgpr_read_b32 v243, a76
v_ldexp_f32 v243, v243, v239
v_accvgpr_write_b32 a76, v243
v_accvgpr_read_b32 v238, a77
v_ldexp_f32 v238, v238, v239
v_accvgpr_write_b32 a77, v238
v_accvgpr_read_b32 v243, a78
v_ldexp_f32 v243, v243, v239
v_accvgpr_write_b32 a78, v243
v_accvgpr_read_b32 v238, a79
v_ldexp_f32 v238, v238, v239
v_accvgpr_write_b32 a79, v238
v_accvgpr_read_b32 v243, a92
v_ldexp_f32 v243, v243, v239
v_accvgpr_write_b32 a92, v243
v_accvgpr_read_b32 v238, a93
v_ldexp_f32 v238, v238, v239
v_accvgpr_write_b32 a93, v238
v_accvgpr_read_b32 v243, a94
v_ldexp_f32 v243, v243, v239
v_accvgpr_write_b32 a94, v243
v_accvgpr_read_b32 v238, a95
v_ldexp_f32 v238, v238, v239
v_accvgpr_write_b32 a95, v238
v_accvgpr_read_b32 v243, a108
v_ldexp_f32 v243, v243, v239
v_accvgpr_write_b32 a108, v243
v_accvgpr_read_b32 v238, a109
v_ldexp_f32 v238, v238, v239
v_accvgpr_write_b32 a109, v238
v_accvgpr_read_b32 v243, a110
v_ldexp_f32 v243, v243, v239
v_accvgpr_write_b32 a110, v243
v_accvgpr_read_b32 v238, a111
v_ldexp_f32 v238, v238, v239
v_accvgpr_write_b32 a111, v238
v_accvgpr_read_b32 v243, a124
v_ldexp_f32 v243, v243, v239
v_accvgpr_write_b32 a124, v243
v_accvgpr_read_b32 v238, a125
v_ldexp_f32 v238, v238, v239
v_accvgpr_write_b32 a125, v238
v_accvgpr_read_b32 v243, a126
v_ldexp_f32 v243, v243, v239
v_accvgpr_write_b32 a126, v243
v_accvgpr_read_b32 v238, a127
v_ldexp_f32 v238, v238, v239
v_accvgpr_write_b32 a127, v238
v_accvgpr_read_b32 v243, a140
v_ldexp_f32 v243, v243, v239
v_accvgpr_write_b32 a140, v243
v_accvgpr_read_b32 v238, a141
v_ldexp_f32 v238, v238, v239
v_accvgpr_write_b32 a141, v238
v_accvgpr_read_b32 v243, a142
v_ldexp_f32 v243, v243, v239
v_accvgpr_write_b32 a142, v243
v_accvgpr_read_b32 v238, a143
v_ldexp_f32 v238, v238, v239
v_accvgpr_write_b32 a143, v238
v_accvgpr_read_b32 v243, a156
v_ldexp_f32 v243, v243, v239
v_accvgpr_write_b32 a156, v243
v_accvgpr_read_b32 v238, a157
v_ldexp_f32 v238, v238, v239
v_accvgpr_write_b32 a157, v238
v_accvgpr_read_b32 v243, a158
v_ldexp_f32 v243, v243, v239
v_accvgpr_write_b32 a158, v243
v_accvgpr_read_b32 v238, a159
v_ldexp_f32 v238, v238, v239
v_accvgpr_write_b32 a159, v238
v_accvgpr_read_b32 v243, a172
v_ldexp_f32 v243, v243, v239
v_accvgpr_write_b32 a172, v243
v_accvgpr_read_b32 v238, a173
v_ldexp_f32 v238, v238, v239
v_accvgpr_write_b32 a173, v238
v_accvgpr_read_b32 v243, a174
v_ldexp_f32 v243, v243, v239
v_accvgpr_write_b32 a174, v243
v_accvgpr_read_b32 v238, a175
v_ldexp_f32 v238, v238, v239
v_accvgpr_write_b32 a175, v238
v_accvgpr_read_b32 v243, a188
v_ldexp_f32 v243, v243, v239
v_accvgpr_write_b32 a188, v243
v_accvgpr_read_b32 v238, a189
v_ldexp_f32 v238, v238, v239
v_accvgpr_write_b32 a189, v238
v_accvgpr_read_b32 v243, a190
v_ldexp_f32 v243, v243, v239
v_accvgpr_write_b32 a190, v243
v_accvgpr_read_b32 v238, a191
v_ldexp_f32 v238, v238, v239
v_accvgpr_write_b32 a191, v238
v_accvgpr_read_b32 v243, a204
v_ldexp_f32 v243, v243, v239
v_accvgpr_write_b32 a204, v243
v_accvgpr_read_b32 v238, a205
v_ldexp_f32 v238, v238, v239
v_accvgpr_write_b32 a205, v238
v_accvgpr_read_b32 v243, a206
v_ldexp_f32 v243, v243, v239
v_accvgpr_write_b32 a206, v243
v_accvgpr_read_b32 v238, a207
v_ldexp_f32 v238, v238, v239
v_accvgpr_write_b32 a207, v238
v_accvgpr_read_b32 v243, a220
v_ldexp_f32 v243, v243, v239
v_accvgpr_write_b32 a220, v243
v_accvgpr_read_b32 v238, a221
v_ldexp_f32 v238, v238, v239
v_accvgpr_write_b32 a221, v238
v_accvgpr_read_b32 v243, a222
v_ldexp_f32 v243, v243, v239
v_accvgpr_write_b32 a222, v243
v_accvgpr_read_b32 v238, a223
v_ldexp_f32 v238, v238, v239
v_accvgpr_write_b32 a223, v238
v_accvgpr_read_b32 v243, a236
v_ldexp_f32 v243, v243, v239
v_accvgpr_write_b32 a236, v243
v_accvgpr_read_b32 v238, a237
v_ldexp_f32 v238, v238, v239
v_accvgpr_write_b32 a237, v238
v_accvgpr_read_b32 v243, a238
v_ldexp_f32 v243, v243, v239
v_accvgpr_write_b32 a238, v243
v_accvgpr_read_b32 v238, a239
v_ldexp_f32 v238, v238, v239
v_accvgpr_write_b32 a239, v238
v_accvgpr_read_b32 v243, a252
v_ldexp_f32 v243, v243, v239
v_accvgpr_write_b32 a252, v243
v_accvgpr_read_b32 v238, a253
v_ldexp_f32 v238, v238, v239
v_accvgpr_write_b32 a253, v238
v_accvgpr_read_b32 v243, a254
v_ldexp_f32 v243, v243, v239
v_accvgpr_write_b32 a254, v243
v_accvgpr_read_b32 v238, a255
v_ldexp_f32 v238, v238, v239
v_accvgpr_write_b32 a255, v238
L_rare0_q3w:
s_mov_b64 vcc, 0
s_nop 0
s_cmp_eq_u32 s63, 0
s_cbranch_scc1 L_ret0w
s_cmp_eq_u32 s63, 2
s_cbranch_scc1 L_ret2w
s_cmp_eq_u32 s63, 12
s_cbranch_scc1 L_ret12w
s_cmp_eq_u32 s63, 14
s_cbranch_scc1 L_ret14w
s_cmp_eq_u32 s63, 28
s_cbranch_scc1 L_ret28w
s_branch L_ret30w
L_rare1w:
s_nop 7
v_max3_f32 v243, v160, v161, v162
v_max3_f32 v243, v243, v163, v164
v_max3_f32 v243, v243, v165, v166
v_max_f32 v243, v243, v167
v_mov_b32 v238, v243
s_nop 1
v_permlane32_swap_b32 v243, v238
s_nop 1
v_max_f32 v243, v243, v238
v_mov_b32 v238, v243
s_nop 1
v_permlane16_swap_b32 v243, v238
s_nop 1
v_max_f32 v243, v243, v238
v_ceil_f32 v243, v243
v_max_f32 v243, 0, v243
v_sub_f32 v160, v160, v243
v_sub_f32 v161, v161, v243
v_sub_f32 v162, v162, v243
v_sub_f32 v163, v163, v243
v_sub_f32 v164, v164, v243
v_sub_f32 v165, v165, v243
v_sub_f32 v166, v166, v243
v_sub_f32 v167, v167, v243
v_sub_f32 v224, v224, v243
v_cvt_i32_f32 v239, -v243
v_ldexp_f32 v228, v228, v239
v_lshlrev_b32 v243, 16, v128
v_and_b32 v238, s81, v128
v_ldexp_f32 v243, v243, v239
v_ldexp_f32 v238, v238, v239
pk 128,243,238
v_lshlrev_b32 v243, 16, v129
v_and_b32 v238, s81, v129
v_ldexp_f32 v243, v243, v239
v_ldexp_f32 v238, v238, v239
pk 129,243,238
v_lshlrev_b32 v243, 16, v130
v_and_b32 v238, s81, v130
v_ldexp_f32 v243, v243, v239
v_ldexp_f32 v238, v238, v239
pk 130,243,238
v_lshlrev_b32 v243, 16, v131
v_and_b32 v238, s81, v131
v_ldexp_f32 v243, v243, v239
v_ldexp_f32 v238, v238, v239
pk 131,243,238
v_accvgpr_read_b32 v243, a0
v_ldexp_f32 v243, v243, v239
v_accvgpr_write_b32 a0, v243
v_accvgpr_read_b32 v238, a1
v_ldexp_f32 v238, v238, v239
v_accvgpr_write_b32 a1, v238
v_accvgpr_read_b32 v243, a2
v_ldexp_f32 v243, v243, v239
v_accvgpr_write_b32 a2, v243
v_accvgpr_read_b32 v238, a3
v_ldexp_f32 v238, v238, v239
v_accvgpr_write_b32 a3, v238
v_accvgpr_read_b32 v243, a16
v_ldexp_f32 v243, v243, v239
v_accvgpr_write_b32 a16, v243
v_accvgpr_read_b32 v238, a17
v_ldexp_f32 v238, v238, v239
v_accvgpr_write_b32 a17, v238
v_accvgpr_read_b32 v243, a18
v_ldexp_f32 v243, v243, v239
v_accvgpr_write_b32 a18, v243
v_accvgpr_read_b32 v238, a19
v_ldexp_f32 v238, v238, v239
v_accvgpr_write_b32 a19, v238
v_accvgpr_read_b32 v243, a32
v_ldexp_f32 v243, v243, v239
v_accvgpr_write_b32 a32, v243
v_accvgpr_read_b32 v238, a33
v_ldexp_f32 v238, v238, v239
v_accvgpr_write_b32 a33, v238
v_accvgpr_read_b32 v243, a34
v_ldexp_f32 v243, v243, v239
v_accvgpr_write_b32 a34, v243
v_accvgpr_read_b32 v238, a35
v_ldexp_f32 v238, v238, v239
v_accvgpr_write_b32 a35, v238
v_accvgpr_read_b32 v243, a48
v_ldexp_f32 v243, v243, v239
v_accvgpr_write_b32 a48, v243
v_accvgpr_read_b32 v238, a49
v_ldexp_f32 v238, v238, v239
v_accvgpr_write_b32 a49, v238
v_accvgpr_read_b32 v243, a50
v_ldexp_f32 v243, v243, v239
v_accvgpr_write_b32 a50, v243
v_accvgpr_read_b32 v238, a51
v_ldexp_f32 v238, v238, v239
v_accvgpr_write_b32 a51, v238
v_accvgpr_read_b32 v243, a64
v_ldexp_f32 v243, v243, v239
v_accvgpr_write_b32 a64, v243
v_accvgpr_read_b32 v238, a65
v_ldexp_f32 v238, v238, v239
v_accvgpr_write_b32 a65, v238
v_accvgpr_read_b32 v243, a66
v_ldexp_f32 v243, v243, v239
v_accvgpr_write_b32 a66, v243
v_accvgpr_read_b32 v238, a67
v_ldexp_f32 v238, v238, v239
v_accvgpr_write_b32 a67, v238
v_accvgpr_read_b32 v243, a80
v_ldexp_f32 v243, v243, v239
v_accvgpr_write_b32 a80, v243
v_accvgpr_read_b32 v238, a81
v_ldexp_f32 v238, v238, v239
v_accvgpr_write_b32 a81, v238
v_accvgpr_read_b32 v243, a82
v_ldexp_f32 v243, v243, v239
v_accvgpr_write_b32 a82, v243
v_accvgpr_read_b32 v238, a83
v_ldexp_f32 v238, v238, v239
v_accvgpr_write_b32 a83, v238
v_accvgpr_read_b32 v243, a96
v_ldexp_f32 v243, v243, v239
v_accvgpr_write_b32 a96, v243
v_accvgpr_read_b32 v238, a97
v_ldexp_f32 v238, v238, v239
v_accvgpr_write_b32 a97, v238
v_accvgpr_read_b32 v243, a98
v_ldexp_f32 v243, v243, v239
v_accvgpr_write_b32 a98, v243
v_accvgpr_read_b32 v238, a99
v_ldexp_f32 v238, v238, v239
v_accvgpr_write_b32 a99, v238
v_accvgpr_read_b32 v243, a112
v_ldexp_f32 v243, v243, v239
v_accvgpr_write_b32 a112, v243
v_accvgpr_read_b32 v238, a113
v_ldexp_f32 v238, v238, v239
v_accvgpr_write_b32 a113, v238
v_accvgpr_read_b32 v243, a114
v_ldexp_f32 v243, v243, v239
v_accvgpr_write_b32 a114, v243
v_accvgpr_read_b32 v238, a115
v_ldexp_f32 v238, v238, v239
v_accvgpr_write_b32 a115, v238
v_accvgpr_read_b32 v243, a128
v_ldexp_f32 v243, v243, v239
v_accvgpr_write_b32 a128, v243
v_accvgpr_read_b32 v238, a129
v_ldexp_f32 v238, v238, v239
v_accvgpr_write_b32 a129, v238
v_accvgpr_read_b32 v243, a130
v_ldexp_f32 v243, v243, v239
v_accvgpr_write_b32 a130, v243
v_accvgpr_read_b32 v238, a131
v_ldexp_f32 v238, v238, v239
v_accvgpr_write_b32 a131, v238
v_accvgpr_read_b32 v243, a144
v_ldexp_f32 v243, v243, v239
v_accvgpr_write_b32 a144, v243
v_accvgpr_read_b32 v238, a145
v_ldexp_f32 v238, v238, v239
v_accvgpr_write_b32 a145, v238
v_accvgpr_read_b32 v243, a146
v_ldexp_f32 v243, v243, v239
v_accvgpr_write_b32 a146, v243
v_accvgpr_read_b32 v238, a147
v_ldexp_f32 v238, v238, v239
v_accvgpr_write_b32 a147, v238
v_accvgpr_read_b32 v243, a160
v_ldexp_f32 v243, v243, v239
v_accvgpr_write_b32 a160, v243
v_accvgpr_read_b32 v238, a161
v_ldexp_f32 v238, v238, v239
v_accvgpr_write_b32 a161, v238
v_accvgpr_read_b32 v243, a162
v_ldexp_f32 v243, v243, v239
v_accvgpr_write_b32 a162, v243
v_accvgpr_read_b32 v238, a163
v_ldexp_f32 v238, v238, v239
v_accvgpr_write_b32 a163, v238
v_accvgpr_read_b32 v243, a176
v_ldexp_f32 v243, v243, v239
v_accvgpr_write_b32 a176, v243
v_accvgpr_read_b32 v238, a177
v_ldexp_f32 v238, v238, v239
v_accvgpr_write_b32 a177, v238
v_accvgpr_read_b32 v243, a178
v_ldexp_f32 v243, v243, v239
v_accvgpr_write_b32 a178, v243
v_accvgpr_read_b32 v238, a179
v_ldexp_f32 v238, v238, v239
v_accvgpr_write_b32 a179, v238
v_accvgpr_read_b32 v243, a192
v_ldexp_f32 v243, v243, v239
v_accvgpr_write_b32 a192, v243
v_accvgpr_read_b32 v238, a193
v_ldexp_f32 v238, v238, v239
v_accvgpr_write_b32 a193, v238
v_accvgpr_read_b32 v243, a194
v_ldexp_f32 v243, v243, v239
v_accvgpr_write_b32 a194, v243
v_accvgpr_read_b32 v238, a195
v_ldexp_f32 v238, v238, v239
v_accvgpr_write_b32 a195, v238
v_accvgpr_read_b32 v243, a208
v_ldexp_f32 v243, v243, v239
v_accvgpr_write_b32 a208, v243
v_accvgpr_read_b32 v238, a209
v_ldexp_f32 v238, v238, v239
v_accvgpr_write_b32 a209, v238
v_accvgpr_read_b32 v243, a210
v_ldexp_f32 v243, v243, v239
v_accvgpr_write_b32 a210, v243
v_accvgpr_read_b32 v238, a211
v_ldexp_f32 v238, v238, v239
v_accvgpr_write_b32 a211, v238
v_accvgpr_read_b32 v243, a224
v_ldexp_f32 v243, v243, v239
v_accvgpr_write_b32 a224, v243
v_accvgpr_read_b32 v238, a225
v_ldexp_f32 v238, v238, v239
v_accvgpr_write_b32 a225, v238
v_accvgpr_read_b32 v243, a226
v_ldexp_f32 v243, v243, v239
v_accvgpr_write_b32 a226, v243
v_accvgpr_read_b32 v238, a227
v_ldexp_f32 v238, v238, v239
v_accvgpr_write_b32 a227, v238
v_accvgpr_read_b32 v243, a240
v_ldexp_f32 v243, v243, v239
v_accvgpr_write_b32 a240, v243
v_accvgpr_read_b32 v238, a241
v_ldexp_f32 v238, v238, v239
v_accvgpr_write_b32 a241, v238
v_accvgpr_read_b32 v243, a242
v_ldexp_f32 v243, v243, v239
v_accvgpr_write_b32 a242, v243
v_accvgpr_read_b32 v238, a243
v_ldexp_f32 v238, v238, v239
v_accvgpr_write_b32 a243, v238
v_max3_f32 v243, v168, v169, v170
v_max3_f32 v243, v243, v171, v172
v_max3_f32 v243, v243, v173, v174
v_max_f32 v243, v243, v175
v_mov_b32 v238, v243
s_nop 1
v_permlane32_swap_b32 v243, v238
s_nop 1
v_max_f32 v243, v243, v238
v_mov_b32 v238, v243
s_nop 1
v_permlane16_swap_b32 v243, v238
s_nop 1
v_max_f32 v243, v243, v238
v_ceil_f32 v243, v243
v_max_f32 v243, 0, v243
v_sub_f32 v168, v168, v243
v_sub_f32 v169, v169, v243
v_sub_f32 v170, v170, v243
v_sub_f32 v171, v171, v243
v_sub_f32 v172, v172, v243
v_sub_f32 v173, v173, v243
v_sub_f32 v174, v174, v243
v_sub_f32 v175, v175, v243
v_sub_f32 v225, v225, v243
v_cvt_i32_f32 v239, -v243
v_ldexp_f32 v229, v229, v239
v_lshlrev_b32 v243, 16, v136
v_and_b32 v238, s81, v136
v_ldexp_f32 v243, v243, v239
v_ldexp_f32 v238, v238, v239
pk 136,243,238
v_lshlrev_b32 v243, 16, v137
v_and_b32 v238, s81, v137
v_ldexp_f32 v243, v243, v239
v_ldexp_f32 v238, v238, v239
pk 137,243,238
v_lshlrev_b32 v243, 16, v138
v_and_b32 v238, s81, v138
v_ldexp_f32 v243, v243, v239
v_ldexp_f32 v238, v238, v239
pk 138,243,238
v_lshlrev_b32 v243, 16, v139
v_and_b32 v238, s81, v139
v_ldexp_f32 v243, v243, v239
v_ldexp_f32 v238, v238, v239
pk 139,243,238
v_accvgpr_read_b32 v243, a4
v_ldexp_f32 v243, v243, v239
v_accvgpr_write_b32 a4, v243
v_accvgpr_read_b32 v238, a5
v_ldexp_f32 v238, v238, v239
v_accvgpr_write_b32 a5, v238
v_accvgpr_read_b32 v243, a6
v_ldexp_f32 v243, v243, v239
v_accvgpr_write_b32 a6, v243
v_accvgpr_read_b32 v238, a7
v_ldexp_f32 v238, v238, v239
v_accvgpr_write_b32 a7, v238
v_accvgpr_read_b32 v243, a20
v_ldexp_f32 v243, v243, v239
v_accvgpr_write_b32 a20, v243
v_accvgpr_read_b32 v238, a21
v_ldexp_f32 v238, v238, v239
v_accvgpr_write_b32 a21, v238
v_accvgpr_read_b32 v243, a22
v_ldexp_f32 v243, v243, v239
v_accvgpr_write_b32 a22, v243
v_accvgpr_read_b32 v238, a23
v_ldexp_f32 v238, v238, v239
v_accvgpr_write_b32 a23, v238
v_accvgpr_read_b32 v243, a36
v_ldexp_f32 v243, v243, v239
v_accvgpr_write_b32 a36, v243
v_accvgpr_read_b32 v238, a37
v_ldexp_f32 v238, v238, v239
v_accvgpr_write_b32 a37, v238
v_accvgpr_read_b32 v243, a38
v_ldexp_f32 v243, v243, v239
v_accvgpr_write_b32 a38, v243
v_accvgpr_read_b32 v238, a39
v_ldexp_f32 v238, v238, v239
v_accvgpr_write_b32 a39, v238
v_accvgpr_read_b32 v243, a52
v_ldexp_f32 v243, v243, v239
v_accvgpr_write_b32 a52, v243
v_accvgpr_read_b32 v238, a53
v_ldexp_f32 v238, v238, v239
v_accvgpr_write_b32 a53, v238
v_accvgpr_read_b32 v243, a54
v_ldexp_f32 v243, v243, v239
v_accvgpr_write_b32 a54, v243
v_accvgpr_read_b32 v238, a55
v_ldexp_f32 v238, v238, v239
v_accvgpr_write_b32 a55, v238
v_accvgpr_read_b32 v243, a68
v_ldexp_f32 v243, v243, v239
v_accvgpr_write_b32 a68, v243
v_accvgpr_read_b32 v238, a69
v_ldexp_f32 v238, v238, v239
v_accvgpr_write_b32 a69, v238
v_accvgpr_read_b32 v243, a70
v_ldexp_f32 v243, v243, v239
v_accvgpr_write_b32 a70, v243
v_accvgpr_read_b32 v238, a71
v_ldexp_f32 v238, v238, v239
v_accvgpr_write_b32 a71, v238
v_accvgpr_read_b32 v243, a84
v_ldexp_f32 v243, v243, v239
v_accvgpr_write_b32 a84, v243
v_accvgpr_read_b32 v238, a85
v_ldexp_f32 v238, v238, v239
v_accvgpr_write_b32 a85, v238
v_accvgpr_read_b32 v243, a86
v_ldexp_f32 v243, v243, v239
v_accvgpr_write_b32 a86, v243
v_accvgpr_read_b32 v238, a87
v_ldexp_f32 v238, v238, v239
v_accvgpr_write_b32 a87, v238
v_accvgpr_read_b32 v243, a100
v_ldexp_f32 v243, v243, v239
v_accvgpr_write_b32 a100, v243
v_accvgpr_read_b32 v238, a101
v_ldexp_f32 v238, v238, v239
v_accvgpr_write_b32 a101, v238
v_accvgpr_read_b32 v243, a102
v_ldexp_f32 v243, v243, v239
v_accvgpr_write_b32 a102, v243
v_accvgpr_read_b32 v238, a103
v_ldexp_f32 v238, v238, v239
v_accvgpr_write_b32 a103, v238
v_accvgpr_read_b32 v243, a116
v_ldexp_f32 v243, v243, v239
v_accvgpr_write_b32 a116, v243
v_accvgpr_read_b32 v238, a117
v_ldexp_f32 v238, v238, v239
v_accvgpr_write_b32 a117, v238
v_accvgpr_read_b32 v243, a118
v_ldexp_f32 v243, v243, v239
v_accvgpr_write_b32 a118, v243
v_accvgpr_read_b32 v238, a119
v_ldexp_f32 v238, v238, v239
v_accvgpr_write_b32 a119, v238
v_accvgpr_read_b32 v243, a132
v_ldexp_f32 v243, v243, v239
v_accvgpr_write_b32 a132, v243
v_accvgpr_read_b32 v238, a133
v_ldexp_f32 v238, v238, v239
v_accvgpr_write_b32 a133, v238
v_accvgpr_read_b32 v243, a134
v_ldexp_f32 v243, v243, v239
v_accvgpr_write_b32 a134, v243
v_accvgpr_read_b32 v238, a135
v_ldexp_f32 v238, v238, v239
v_accvgpr_write_b32 a135, v238
v_accvgpr_read_b32 v243, a148
v_ldexp_f32 v243, v243, v239
v_accvgpr_write_b32 a148, v243
v_accvgpr_read_b32 v238, a149
v_ldexp_f32 v238, v238, v239
v_accvgpr_write_b32 a149, v238
v_accvgpr_read_b32 v243, a150
v_ldexp_f32 v243, v243, v239
v_accvgpr_write_b32 a150, v243
v_accvgpr_read_b32 v238, a151
v_ldexp_f32 v238, v238, v239
v_accvgpr_write_b32 a151, v238
v_accvgpr_read_b32 v243, a164
v_ldexp_f32 v243, v243, v239
v_accvgpr_write_b32 a164, v243
v_accvgpr_read_b32 v238, a165
v_ldexp_f32 v238, v238, v239
v_accvgpr_write_b32 a165, v238
v_accvgpr_read_b32 v243, a166
v_ldexp_f32 v243, v243, v239
v_accvgpr_write_b32 a166, v243
v_accvgpr_read_b32 v238, a167
v_ldexp_f32 v238, v238, v239
v_accvgpr_write_b32 a167, v238
v_accvgpr_read_b32 v243, a180
v_ldexp_f32 v243, v243, v239
v_accvgpr_write_b32 a180, v243
v_accvgpr_read_b32 v238, a181
v_ldexp_f32 v238, v238, v239
v_accvgpr_write_b32 a181, v238
v_accvgpr_read_b32 v243, a182
v_ldexp_f32 v243, v243, v239
v_accvgpr_write_b32 a182, v243
v_accvgpr_read_b32 v238, a183
v_ldexp_f32 v238, v238, v239
v_accvgpr_write_b32 a183, v238
v_accvgpr_read_b32 v243, a196
v_ldexp_f32 v243, v243, v239
v_accvgpr_write_b32 a196, v243
v_accvgpr_read_b32 v238, a197
v_ldexp_f32 v238, v238, v239
v_accvgpr_write_b32 a197, v238
v_accvgpr_read_b32 v243, a198
v_ldexp_f32 v243, v243, v239
v_accvgpr_write_b32 a198, v243
v_accvgpr_read_b32 v238, a199
v_ldexp_f32 v238, v238, v239
v_accvgpr_write_b32 a199, v238
v_accvgpr_read_b32 v243, a212
v_ldexp_f32 v243, v243, v239
v_accvgpr_write_b32 a212, v243
v_accvgpr_read_b32 v238, a213
v_ldexp_f32 v238, v238, v239
v_accvgpr_write_b32 a213, v238
v_accvgpr_read_b32 v243, a214
v_ldexp_f32 v243, v243, v239
v_accvgpr_write_b32 a214, v243
v_accvgpr_read_b32 v238, a215
v_ldexp_f32 v238, v238, v239
v_accvgpr_write_b32 a215, v238
v_accvgpr_read_b32 v243, a228
v_ldexp_f32 v243, v243, v239
v_accvgpr_write_b32 a228, v243
v_accvgpr_read_b32 v238, a229
v_ldexp_f32 v238, v238, v239
v_accvgpr_write_b32 a229, v238
v_accvgpr_read_b32 v243, a230
v_ldexp_f32 v243, v243, v239
v_accvgpr_write_b32 a230, v243
v_accvgpr_read_b32 v238, a231
v_ldexp_f32 v238, v238, v239
v_accvgpr_write_b32 a231, v238
v_accvgpr_read_b32 v243, a244
v_ldexp_f32 v243, v243, v239
v_accvgpr_write_b32 a244, v243
v_accvgpr_read_b32 v238, a245
v_ldexp_f32 v238, v238, v239
v_accvgpr_write_b32 a245, v238
v_accvgpr_read_b32 v243, a246
v_ldexp_f32 v243, v243, v239
v_accvgpr_write_b32 a246, v243
v_accvgpr_read_b32 v238, a247
v_ldexp_f32 v238, v238, v239
v_accvgpr_write_b32 a247, v238
v_max3_f32 v243, v176, v177, v178
v_max3_f32 v243, v243, v179, v180
v_max3_f32 v243, v243, v181, v182
v_max_f32 v243, v243, v183
v_mov_b32 v238, v243
s_nop 1
v_permlane32_swap_b32 v243, v238
s_nop 1
v_max_f32 v243, v243, v238
v_mov_b32 v238, v243
s_nop 1
v_permlane16_swap_b32 v243, v238
s_nop 1
v_max_f32 v243, v243, v238
v_ceil_f32 v243, v243
v_max_f32 v243, 0, v243
v_sub_f32 v176, v176, v243
v_sub_f32 v177, v177, v243
v_sub_f32 v178, v178, v243
v_sub_f32 v179, v179, v243
v_sub_f32 v180, v180, v243
v_sub_f32 v181, v181, v243
v_sub_f32 v182, v182, v243
v_sub_f32 v183, v183, v243
v_sub_f32 v226, v226, v243
v_cvt_i32_f32 v239, -v243
v_ldexp_f32 v230, v230, v239
v_lshlrev_b32 v243, 16, v144
v_and_b32 v238, s81, v144
v_ldexp_f32 v243, v243, v239
v_ldexp_f32 v238, v238, v239
pk 144,243,238
v_lshlrev_b32 v243, 16, v145
v_and_b32 v238, s81, v145
v_ldexp_f32 v243, v243, v239
v_ldexp_f32 v238, v238, v239
pk 145,243,238
v_lshlrev_b32 v243, 16, v146
v_and_b32 v238, s81, v146
v_ldexp_f32 v243, v243, v239
v_ldexp_f32 v238, v238, v239
pk 146,243,238
v_lshlrev_b32 v243, 16, v147
v_and_b32 v238, s81, v147
v_ldexp_f32 v243, v243, v239
v_ldexp_f32 v238, v238, v239
pk 147,243,238
v_accvgpr_read_b32 v243, a8
v_ldexp_f32 v243, v243, v239
v_accvgpr_write_b32 a8, v243
v_accvgpr_read_b32 v238, a9
v_ldexp_f32 v238, v238, v239
v_accvgpr_write_b32 a9, v238
v_accvgpr_read_b32 v243, a10
v_ldexp_f32 v243, v243, v239
v_accvgpr_write_b32 a10, v243
v_accvgpr_read_b32 v238, a11
v_ldexp_f32 v238, v238, v239
v_accvgpr_write_b32 a11, v238
v_accvgpr_read_b32 v243, a24
v_ldexp_f32 v243, v243, v239
v_accvgpr_write_b32 a24, v243
v_accvgpr_read_b32 v238, a25
v_ldexp_f32 v238, v238, v239
v_accvgpr_write_b32 a25, v238
v_accvgpr_read_b32 v243, a26
v_ldexp_f32 v243, v243, v239
v_accvgpr_write_b32 a26, v243
v_accvgpr_read_b32 v238, a27
v_ldexp_f32 v238, v238, v239
v_accvgpr_write_b32 a27, v238
v_accvgpr_read_b32 v243, a40
v_ldexp_f32 v243, v243, v239
v_accvgpr_write_b32 a40, v243
v_accvgpr_read_b32 v238, a41
v_ldexp_f32 v238, v238, v239
v_accvgpr_write_b32 a41, v238
v_accvgpr_read_b32 v243, a42
v_ldexp_f32 v243, v243, v239
v_accvgpr_write_b32 a42, v243
v_accvgpr_read_b32 v238, a43
v_ldexp_f32 v238, v238, v239
v_accvgpr_write_b32 a43, v238
v_accvgpr_read_b32 v243, a56
v_ldexp_f32 v243, v243, v239
v_accvgpr_write_b32 a56, v243
v_accvgpr_read_b32 v238, a57
v_ldexp_f32 v238, v238, v239
v_accvgpr_write_b32 a57, v238
v_accvgpr_read_b32 v243, a58
v_ldexp_f32 v243, v243, v239
v_accvgpr_write_b32 a58, v243
v_accvgpr_read_b32 v238, a59
v_ldexp_f32 v238, v238, v239
v_accvgpr_write_b32 a59, v238
v_accvgpr_read_b32 v243, a72
v_ldexp_f32 v243, v243, v239
v_accvgpr_write_b32 a72, v243
v_accvgpr_read_b32 v238, a73
v_ldexp_f32 v238, v238, v239
v_accvgpr_write_b32 a73, v238
v_accvgpr_read_b32 v243, a74
v_ldexp_f32 v243, v243, v239
v_accvgpr_write_b32 a74, v243
v_accvgpr_read_b32 v238, a75
v_ldexp_f32 v238, v238, v239
v_accvgpr_write_b32 a75, v238
v_accvgpr_read_b32 v243, a88
v_ldexp_f32 v243, v243, v239
v_accvgpr_write_b32 a88, v243
v_accvgpr_read_b32 v238, a89
v_ldexp_f32 v238, v238, v239
v_accvgpr_write_b32 a89, v238
v_accvgpr_read_b32 v243, a90
v_ldexp_f32 v243, v243, v239
v_accvgpr_write_b32 a90, v243
v_accvgpr_read_b32 v238, a91
v_ldexp_f32 v238, v238, v239
v_accvgpr_write_b32 a91, v238
v_accvgpr_read_b32 v243, a104
v_ldexp_f32 v243, v243, v239
v_accvgpr_write_b32 a104, v243
v_accvgpr_read_b32 v238, a105
v_ldexp_f32 v238, v238, v239
v_accvgpr_write_b32 a105, v238
v_accvgpr_read_b32 v243, a106
v_ldexp_f32 v243, v243, v239
v_accvgpr_write_b32 a106, v243
v_accvgpr_read_b32 v238, a107
v_ldexp_f32 v238, v238, v239
v_accvgpr_write_b32 a107, v238
v_accvgpr_read_b32 v243, a120
v_ldexp_f32 v243, v243, v239
v_accvgpr_write_b32 a120, v243
v_accvgpr_read_b32 v238, a121
v_ldexp_f32 v238, v238, v239
v_accvgpr_write_b32 a121, v238
v_accvgpr_read_b32 v243, a122
v_ldexp_f32 v243, v243, v239
v_accvgpr_write_b32 a122, v243
v_accvgpr_read_b32 v238, a123
v_ldexp_f32 v238, v238, v239
v_accvgpr_write_b32 a123, v238
v_accvgpr_read_b32 v243, a136
v_ldexp_f32 v243, v243, v239
v_accvgpr_write_b32 a136, v243
v_accvgpr_read_b32 v238, a137
v_ldexp_f32 v238, v238, v239
v_accvgpr_write_b32 a137, v238
v_accvgpr_read_b32 v243, a138
v_ldexp_f32 v243, v243, v239
v_accvgpr_write_b32 a138, v243
v_accvgpr_read_b32 v238, a139
v_ldexp_f32 v238, v238, v239
v_accvgpr_write_b32 a139, v238
v_accvgpr_read_b32 v243, a152
v_ldexp_f32 v243, v243, v239
v_accvgpr_write_b32 a152, v243
v_accvgpr_read_b32 v238, a153
v_ldexp_f32 v238, v238, v239
v_accvgpr_write_b32 a153, v238
v_accvgpr_read_b32 v243, a154
v_ldexp_f32 v243, v243, v239
v_accvgpr_write_b32 a154, v243
v_accvgpr_read_b32 v238, a155
v_ldexp_f32 v238, v238, v239
v_accvgpr_write_b32 a155, v238
v_accvgpr_read_b32 v243, a168
v_ldexp_f32 v243, v243, v239
v_accvgpr_write_b32 a168, v243
v_accvgpr_read_b32 v238, a169
v_ldexp_f32 v238, v238, v239
v_accvgpr_write_b32 a169, v238
v_accvgpr_read_b32 v243, a170
v_ldexp_f32 v243, v243, v239
v_accvgpr_write_b32 a170, v243
v_accvgpr_read_b32 v238, a171
v_ldexp_f32 v238, v238, v239
v_accvgpr_write_b32 a171, v238
v_accvgpr_read_b32 v243, a184
v_ldexp_f32 v243, v243, v239
v_accvgpr_write_b32 a184, v243
v_accvgpr_read_b32 v238, a185
v_ldexp_f32 v238, v238, v239
v_accvgpr_write_b32 a185, v238
v_accvgpr_read_b32 v243, a186
v_ldexp_f32 v243, v243, v239
v_accvgpr_write_b32 a186, v243
v_accvgpr_read_b32 v238, a187
v_ldexp_f32 v238, v238, v239
v_accvgpr_write_b32 a187, v238
v_accvgpr_read_b32 v243, a200
v_ldexp_f32 v243, v243, v239
v_accvgpr_write_b32 a200, v243
v_accvgpr_read_b32 v238, a201
v_ldexp_f32 v238, v238, v239
v_accvgpr_write_b32 a201, v238
v_accvgpr_read_b32 v243, a202
v_ldexp_f32 v243, v243, v239
v_accvgpr_write_b32 a202, v243
v_accvgpr_read_b32 v238, a203
v_ldexp_f32 v238, v238, v239
v_accvgpr_write_b32 a203, v238
v_accvgpr_read_b32 v243, a216
v_ldexp_f32 v243, v243, v239
v_accvgpr_write_b32 a216, v243
v_accvgpr_read_b32 v238, a217
v_ldexp_f32 v238, v238, v239
v_accvgpr_write_b32 a217, v238
v_accvgpr_read_b32 v243, a218
v_ldexp_f32 v243, v243, v239
v_accvgpr_write_b32 a218, v243
v_accvgpr_read_b32 v238, a219
v_ldexp_f32 v238, v238, v239
v_accvgpr_write_b32 a219, v238
v_accvgpr_read_b32 v243, a232
v_ldexp_f32 v243, v243, v239
v_accvgpr_write_b32 a232, v243
v_accvgpr_read_b32 v238, a233
v_ldexp_f32 v238, v238, v239
v_accvgpr_write_b32 a233, v238
v_accvgpr_read_b32 v243, a234
v_ldexp_f32 v243, v243, v239
v_accvgpr_write_b32 a234, v243
v_accvgpr_read_b32 v238, a235
v_ldexp_f32 v238, v238, v239
v_accvgpr_write_b32 a235, v238
v_accvgpr_read_b32 v243, a248
v_ldexp_f32 v243, v243, v239
v_accvgpr_write_b32 a248, v243
v_accvgpr_read_b32 v238, a249
v_ldexp_f32 v238, v238, v239
v_accvgpr_write_b32 a249, v238
v_accvgpr_read_b32 v243, a250
v_ldexp_f32 v243, v243, v239
v_accvgpr_write_b32 a250, v243
v_accvgpr_read_b32 v238, a251
v_ldexp_f32 v238, v238, v239
v_accvgpr_write_b32 a251, v238
v_max3_f32 v243, v184, v185, v186
v_max3_f32 v243, v243, v187, v188
v_max3_f32 v243, v243, v189, v190
v_max_f32 v243, v243, v191
v_mov_b32 v238, v243
s_nop 1
v_permlane32_swap_b32 v243, v238
s_nop 1
v_max_f32 v243, v243, v238
v_mov_b32 v238, v243
s_nop 1
v_permlane16_swap_b32 v243, v238
s_nop 1
v_max_f32 v243, v243, v238
v_ceil_f32 v243, v243
v_max_f32 v243, 0, v243
v_sub_f32 v184, v184, v243
v_sub_f32 v185, v185, v243
v_sub_f32 v186, v186, v243
v_sub_f32 v187, v187, v243
v_sub_f32 v188, v188, v243
v_sub_f32 v189, v189, v243
v_sub_f32 v190, v190, v243
v_sub_f32 v191, v191, v243
v_sub_f32 v227, v227, v243
v_cvt_i32_f32 v239, -v243
v_ldexp_f32 v231, v231, v239
v_lshlrev_b32 v243, 16, v152
v_and_b32 v238, s81, v152
v_ldexp_f32 v243, v243, v239
v_ldexp_f32 v238, v238, v239
pk 152,243,238
v_lshlrev_b32 v243, 16, v153
v_and_b32 v238, s81, v153
v_ldexp_f32 v243, v243, v239
v_ldexp_f32 v238, v238, v239
pk 153,243,238
v_lshlrev_b32 v243, 16, v154
v_and_b32 v238, s81, v154
v_ldexp_f32 v243, v243, v239
v_ldexp_f32 v238, v238, v239
pk 154,243,238
v_lshlrev_b32 v243, 16, v155
v_and_b32 v238, s81, v155
v_ldexp_f32 v243, v243, v239
v_ldexp_f32 v238, v238, v239
pk 155,243,238
v_accvgpr_read_b32 v243, a12
v_ldexp_f32 v243, v243, v239
v_accvgpr_write_b32 a12, v243
v_accvgpr_read_b32 v238, a13
v_ldexp_f32 v238, v238, v239
v_accvgpr_write_b32 a13, v238
v_accvgpr_read_b32 v243, a14
v_ldexp_f32 v243, v243, v239
v_accvgpr_write_b32 a14, v243
v_accvgpr_read_b32 v238, a15
v_ldexp_f32 v238, v238, v239
v_accvgpr_write_b32 a15, v238
v_accvgpr_read_b32 v243, a28
v_ldexp_f32 v243, v243, v239
v_accvgpr_write_b32 a28, v243
v_accvgpr_read_b32 v238, a29
v_ldexp_f32 v238, v238, v239
v_accvgpr_write_b32 a29, v238
v_accvgpr_read_b32 v243, a30
v_ldexp_f32 v243, v243, v239
v_accvgpr_write_b32 a30, v243
v_accvgpr_read_b32 v238, a31
v_ldexp_f32 v238, v238, v239
v_accvgpr_write_b32 a31, v238
v_accvgpr_read_b32 v243, a44
v_ldexp_f32 v243, v243, v239
v_accvgpr_write_b32 a44, v243
v_accvgpr_read_b32 v238, a45
v_ldexp_f32 v238, v238, v239
v_accvgpr_write_b32 a45, v238
v_accvgpr_read_b32 v243, a46
v_ldexp_f32 v243, v243, v239
v_accvgpr_write_b32 a46, v243
v_accvgpr_read_b32 v238, a47
v_ldexp_f32 v238, v238, v239
v_accvgpr_write_b32 a47, v238
v_accvgpr_read_b32 v243, a60
v_ldexp_f32 v243, v243, v239
v_accvgpr_write_b32 a60, v243
v_accvgpr_read_b32 v238, a61
v_ldexp_f32 v238, v238, v239
v_accvgpr_write_b32 a61, v238
v_accvgpr_read_b32 v243, a62
v_ldexp_f32 v243, v243, v239
v_accvgpr_write_b32 a62, v243
v_accvgpr_read_b32 v238, a63
v_ldexp_f32 v238, v238, v239
v_accvgpr_write_b32 a63, v238
v_accvgpr_read_b32 v243, a76
v_ldexp_f32 v243, v243, v239
v_accvgpr_write_b32 a76, v243
v_accvgpr_read_b32 v238, a77
v_ldexp_f32 v238, v238, v239
v_accvgpr_write_b32 a77, v238
v_accvgpr_read_b32 v243, a78
v_ldexp_f32 v243, v243, v239
v_accvgpr_write_b32 a78, v243
v_accvgpr_read_b32 v238, a79
v_ldexp_f32 v238, v238, v239
v_accvgpr_write_b32 a79, v238
v_accvgpr_read_b32 v243, a92
v_ldexp_f32 v243, v243, v239
v_accvgpr_write_b32 a92, v243
v_accvgpr_read_b32 v238, a93
v_ldexp_f32 v238, v238, v239
v_accvgpr_write_b32 a93, v238
v_accvgpr_read_b32 v243, a94
v_ldexp_f32 v243, v243, v239
v_accvgpr_write_b32 a94, v243
v_accvgpr_read_b32 v238, a95
v_ldexp_f32 v238, v238, v239
v_accvgpr_write_b32 a95, v238
v_accvgpr_read_b32 v243, a108
v_ldexp_f32 v243, v243, v239
v_accvgpr_write_b32 a108, v243
v_accvgpr_read_b32 v238, a109
v_ldexp_f32 v238, v238, v239
v_accvgpr_write_b32 a109, v238
v_accvgpr_read_b32 v243, a110
v_ldexp_f32 v243, v243, v239
v_accvgpr_write_b32 a110, v243
v_accvgpr_read_b32 v238, a111
v_ldexp_f32 v238, v238, v239
v_accvgpr_write_b32 a111, v238
v_accvgpr_read_b32 v243, a124
v_ldexp_f32 v243, v243, v239
v_accvgpr_write_b32 a124, v243
v_accvgpr_read_b32 v238, a125
v_ldexp_f32 v238, v238, v239
v_accvgpr_write_b32 a125, v238
v_accvgpr_read_b32 v243, a126
v_ldexp_f32 v243, v243, v239
v_accvgpr_write_b32 a126, v243
v_accvgpr_read_b32 v238, a127
v_ldexp_f32 v238, v238, v239
v_accvgpr_write_b32 a127, v238
v_accvgpr_read_b32 v243, a140
v_ldexp_f32 v243, v243, v239
v_accvgpr_write_b32 a140, v243
v_accvgpr_read_b32 v238, a141
v_ldexp_f32 v238, v238, v239
v_accvgpr_write_b32 a141, v238
v_accvgpr_read_b32 v243, a142
v_ldexp_f32 v243, v243, v239
v_accvgpr_write_b32 a142, v243
v_accvgpr_read_b32 v238, a143
v_ldexp_f32 v238, v238, v239
v_accvgpr_write_b32 a143, v238
v_accvgpr_read_b32 v243, a156
v_ldexp_f32 v243, v243, v239
v_accvgpr_write_b32 a156, v243
v_accvgpr_read_b32 v238, a157
v_ldexp_f32 v238, v238, v239
v_accvgpr_write_b32 a157, v238
v_accvgpr_read_b32 v243, a158
v_ldexp_f32 v243, v243, v239
v_accvgpr_write_b32 a158, v243
v_accvgpr_read_b32 v238, a159
v_ldexp_f32 v238, v238, v239
v_accvgpr_write_b32 a159, v238
v_accvgpr_read_b32 v243, a172
v_ldexp_f32 v243, v243, v239
v_accvgpr_write_b32 a172, v243
v_accvgpr_read_b32 v238, a173
v_ldexp_f32 v238, v238, v239
v_accvgpr_write_b32 a173, v238
v_accvgpr_read_b32 v243, a174
v_ldexp_f32 v243, v243, v239
v_accvgpr_write_b32 a174, v243
v_accvgpr_read_b32 v238, a175
v_ldexp_f32 v238, v238, v239
v_accvgpr_write_b32 a175, v238
v_accvgpr_read_b32 v243, a188
v_ldexp_f32 v243, v243, v239
v_accvgpr_write_b32 a188, v243
v_accvgpr_read_b32 v238, a189
v_ldexp_f32 v238, v238, v239
v_accvgpr_write_b32 a189, v238
v_accvgpr_read_b32 v243, a190
v_ldexp_f32 v243, v243, v239
v_accvgpr_write_b32 a190, v243
v_accvgpr_read_b32 v238, a191
v_ldexp_f32 v238, v238, v239
v_accvgpr_write_b32 a191, v238
v_accvgpr_read_b32 v243, a204
v_ldexp_f32 v243, v243, v239
v_accvgpr_write_b32 a204, v243
v_accvgpr_read_b32 v238, a205
v_ldexp_f32 v238, v238, v239
v_accvgpr_write_b32 a205, v238
v_accvgpr_read_b32 v243, a206
v_ldexp_f32 v243, v243, v239
v_accvgpr_write_b32 a206, v243
v_accvgpr_read_b32 v238, a207
v_ldexp_f32 v238, v238, v239
v_accvgpr_write_b32 a207, v238
v_accvgpr_read_b32 v243, a220
v_ldexp_f32 v243, v243, v239
v_accvgpr_write_b32 a220, v243
v_accvgpr_read_b32 v238, a221
v_ldexp_f32 v238, v238, v239
v_accvgpr_write_b32 a221, v238
v_accvgpr_read_b32 v243, a222
v_ldexp_f32 v243, v243, v239
v_accvgpr_write_b32 a222, v243
v_accvgpr_read_b32 v238, a223
v_ldexp_f32 v238, v238, v239
v_accvgpr_write_b32 a223, v238
v_accvgpr_read_b32 v243, a236
v_ldexp_f32 v243, v243, v239
v_accvgpr_write_b32 a236, v243
v_accvgpr_read_b32 v238, a237
v_ldexp_f32 v238, v238, v239
v_accvgpr_write_b32 a237, v238
v_accvgpr_read_b32 v243, a238
v_ldexp_f32 v243, v243, v239
v_accvgpr_write_b32 a238, v243
v_accvgpr_read_b32 v238, a239
v_ldexp_f32 v238, v238, v239
v_accvgpr_write_b32 a239, v238
v_accvgpr_read_b32 v243, a252
v_ldexp_f32 v243, v243, v239
v_accvgpr_write_b32 a252, v243
v_accvgpr_read_b32 v238, a253
v_ldexp_f32 v238, v238, v239
v_accvgpr_write_b32 a253, v238
v_accvgpr_read_b32 v243, a254
v_ldexp_f32 v243, v243, v239
v_accvgpr_write_b32 a254, v243
v_accvgpr_read_b32 v238, a255
v_ldexp_f32 v238, v238, v239
v_accvgpr_write_b32 a255, v238
s_mov_b64 vcc, 0
s_nop 0
s_cmp_eq_u32 s63, 1
s_cbranch_scc1 L_ret1w
s_cmp_eq_u32 s63, 3
s_cbranch_scc1 L_ret3w
s_cmp_eq_u32 s63, 13
s_cbranch_scc1 L_ret13w
s_cmp_eq_u32 s63, 15
s_cbranch_scc1 L_ret15w
s_cmp_eq_u32 s63, 29
s_cbranch_scc1 L_ret29w
s_branch L_ret31w
L_code_end:
s_endpgm
.section .rodata,"a"
.p2align 6
.amdhsa_kernel concat_heads__mha_block_cached__mha_block_cached__near_ridge_kernel
  .amdhsa_next_free_vgpr 512
  .amdhsa_next_free_sgpr 102
  .amdhsa_accum_offset 256
  .amdhsa_group_segment_fixed_size 0
  .amdhsa_kernarg_size 104
  .amdhsa_user_sgpr_count 2
  .amdhsa_user_sgpr_kernarg_segment_ptr 1
  .amdhsa_system_sgpr_workgroup_id_x 1
.end_amdhsa_kernel
```
